```python
import torch

def _softmax(x, axis=-1):
    return torch.softmax(x, dim=axis)

def _gelu(x):
    return torch.nn.functional.gelu(x, approximate='tanh')

def _silu(x):
    return torch.nn.functional.silu(x)

def _sigmoid(x):
    return torch.sigmoid(x)

def _layernorm(x, axis=-1, eps=1e-05):
    m = x.mean(dim=axis, keepdim=True)
    v = x.var(dim=axis, keepdim=True, unbiased=False)
    return (x - m) / torch.sqrt(v + eps)

def _scatter_add(tgt, idx, src, axis=0):
    return tgt.clone().index_add_(axis, idx, src)

def _segment_sum(src, seg, n):
    out = torch.zeros((n,) + src.shape[1:], dtype=src.dtype)
    return out.index_add_(0, seg, src)

def _pad(x, pw):
    flat = tuple((v for pair in reversed(pw) for v in pair))
    return torch.nn.functional.pad(x, flat)
kernel_name = 'adaLN_cond__memory_aug_recurrent_mem_tr__mixer_gmlp__prompt'

def setup_inputs():

    _w = lambda a: (lambda t: t.to(torch.bfloat16) if t.is_floating_point() else t)(torch.as_tensor(a))

    def _A_setup():
        B, S, Dm = (1, 2048, 512)
        H, Dh = (32, 128)
        M, seg = (8, 32)
        seg = min(seg, S)
        S = S // seg * seg
        return {'x': _w((lambda *s: torch.randn(*s, dtype=torch.bfloat16) * 0.05)(B, S, Dm)), 'mem0': _w((lambda *s: torch.randn(*s, dtype=torch.bfloat16) * 0.4)(B, M, Dm)), 'Wq': _w((lambda *s: torch.randn(*s, dtype=torch.bfloat16) * 3.2)(Dm, H, Dh) * Dm ** (-0.5)), 'Wk': _w((lambda *s: torch.randn(*s, dtype=torch.bfloat16) * 3.2)(Dm, H, Dh) * Dm ** (-0.5)), 'Wv': _w((lambda *s: torch.randn(*s, dtype=torch.bfloat16) * 0.4)(Dm, H, Dh) * Dm ** (-0.5)), 'Wo': _w((lambda *s: torch.randn(*s, dtype=torch.bfloat16) * 0.4)(H, Dh, Dm) * (H * Dh) ** (-0.5)), 'seg_len': seg}
    _A_in = _A_setup()

    def _B_setup():
        B, S, D, F = (1, 2048, 512, 1376)
        Fh = F // 2
        return {'x': _w((lambda *s: torch.randn(*s, dtype=torch.bfloat16) * 0.05)(B, S, D)), 'w_in': _w((lambda *s: torch.randn(*s, dtype=torch.bfloat16) * 0.8)(D, 2 * Fh)), 'w_sp': _w(0.01 * (lambda *s: torch.randn(*s, dtype=torch.bfloat16) * 0.8)(S, S)), 'b_sp': _w(1.0 + 0.01 * (lambda *s: torch.randn(*s, dtype=torch.bfloat16) * 0.05)(S)), 'w_out': _w((lambda *s: torch.randn(*s, dtype=torch.bfloat16) * 0.05)(Fh, D))}
    _B_in = _B_setup()
    return {'A_x': _A_in['x'], 'A_mem0': _A_in['mem0'], 'A_Wq': _A_in['Wq'], 'A_Wk': _A_in['Wk'], 'A_Wv': _A_in['Wv'], 'A_Wo': _A_in['Wo'], 'A_seg_len': _A_in['seg_len'], 'B_x': _B_in['x'], 'B_w_in': _B_in['w_in'], 'B_w_sp': _B_in['w_sp'], 'B_b_sp': _B_in['b_sp'], 'B_w_out': _B_in['w_out'], 'c': _w((lambda *s: torch.randn(*s, dtype=torch.bfloat16) * 0.1)(1, 512) * 8.0), 'w_mod': _w((lambda *s: torch.randn(*s, dtype=torch.bfloat16) * 0.1)(512, 6 * 512) * 512 ** (-0.5) * 8.0)}

def reference(A_x, A_mem0, A_Wq, A_Wk, A_Wv, A_Wo, A_seg_len, B_x, B_w_in, B_w_sp, B_b_sp, B_w_out, c, w_mod):

    def _A_ref(x, mem0, Wq, Wk, Wv, Wo, seg_len):
        B, S, Dm = x.shape
        H, Dh = (Wq.shape[1], Wq.shape[2])
        M = mem0.shape[1]
        scale = Dh ** (-0.5)
        n_seg = S // seg_len
        L = M + seg_len
        idx = torch.arange(L)
        mask = (idx[:, None] < M) | (idx[:, None] >= idx[None, :])
        mem = mem0
        outs = []
        for s in range(n_seg):
            xs = x[:, s * seg_len:(s + 1) * seg_len, :].clone()
            h = torch.concatenate([mem, xs], axis=1)
            q = torch.einsum('btd,dhe->bhte', h, Wq)
            k = torch.einsum('btd,dhe->bhte', h, Wk)
            v = torch.einsum('btd,dhe->bhte', h, Wv)
            scores = torch.einsum('bhqe,bhke->bhqk', q, k) * scale
            scores = torch.where(mask[None, None], scores, -1000000000.0)
            p = _softmax(scores, axis=-1)
            o = torch.einsum('bhqk,bhke->bhqe', p, v)
            o = torch.einsum('bhte,hed->btd', o, Wo)
            mem = o[:, :M, :].clone()
            outs.append(o[:, M:, :])
        return torch.concatenate(outs, axis=1)

    def _B_ref(x, w_in, w_sp, b_sp, w_out):
        B, S, D = x.shape
        F = w_in.shape[-1]
        Fh = F // 2
        z = _gelu(torch.einsum('bsd,df->bsf', x, w_in))
        z1 = z[..., :Fh].clone()
        z2 = _layernorm(z[..., Fh:], axis=-1)
        g = torch.einsum('ts,bsf->btf', w_sp, z2) + b_sp[None, :, None]
        return torch.einsum('bsf,fd->bsd', z1 * g, w_out)
    x = A_x
    mod = (_silu(c) @ w_mod).reshape(c.shape[0], 6, 1, -1)
    sa, ca, ga, sb, cb, gb = (mod[:, 0].clone(), mod[:, 1].clone(), mod[:, 2].clone(), mod[:, 3].clone(), mod[:, 4].clone(), mod[:, 5].clone())
    h = _layernorm(x, axis=-1) * (1 + ca) + sa
    x = x + ga * _A_ref(h, A_mem0, A_Wq, A_Wk, A_Wv, A_Wo, A_seg_len)
    h = _layernorm(x, axis=-1) * (1 + cb) + sb
    x = x + gb * _B_ref(h, B_w_in, B_w_sp, B_b_sp, B_w_out)
    return x
```

```asm
; @launch kernel=main_kernel grid=(256,1,1) block=(256,1,1) lds=163840
.amdgcn_target "amdgcn-amd-amdhsa--gfx950"
.text
.p2align 8
.globl main_kernel
.type main_kernel,@function
main_kernel:
    s_cmp_lt_u32 s2, 256
    s_cbranch_scc1 ch_go
    s_endpgm
ch_go:
    s_load_dwordx2 s[64:65], s[0:1], 8
    s_load_dwordx8 s[68:75], s[0:1], 16
    s_load_dwordx4 s[76:79], s[0:1], 120
    s_getreg_b32 s6, hwreg(HW_REG_XCC_ID, 0, 4)
    v_and_b32 v82, 63, v0
    v_lshrrev_b32 v83, 6, v0
    s_nop 0
    v_readfirstlane_b32 s3, v83
    s_waitcnt lgkmcnt(0)
    s_mov_b32 s36, s76
    s_mov_b32 s37, s77
    s_mov_b32 s38, 0x100
    s_mov_b32 s39, 0x20000
    v_mov_b32 v83, 0
    v_mov_b32 v86, 162816
    s_cmp_lg_u32 s3, 0
    s_cbranch_scc1 ch_rolewait
    s_mov_b64 exec, 1
    s_memrealtime s[8:9]
    s_waitcnt lgkmcnt(0)
    s_or_b32 s8, s8, 1
    v_mov_b32 v88, s8
    v_mov_b32 v89, 0
    buffer_atomic_cmpswap v[88:89], v83, s[36:39], 0 offen offset:8 sc0 sc1
    v_mov_b32 v84, 1
    s_sub_u32 s10, s6, 1
    s_mov_b32 s11, 7
    s_cmp_lg_u32 s6, 0
    s_cbranch_scc1 ch_hid
    buffer_atomic_add v84, v83, s[36:39], 0 offen sc0 sc1
    s_waitcnt vmcnt(0)
    v_readfirstlane_b32 s9, v84
    s_cmp_lt_u32 s9, 32
    s_cbranch_scc1 ch_full
ch_hid:
    s_cmp_ge_u32 s10, 7
    s_cselect_b32 s10, 0, s10
    s_mul_i32 s9, s10, 24
    v_mov_b32 v84, 1
    v_mov_b32 v85, s9
    buffer_atomic_add v84, v85, s[36:39], 0 offen offset:64 sc0 sc1
    s_waitcnt vmcnt(0)
    v_readfirstlane_b32 s9, v84
    s_cmp_lt_u32 s9, 32
    s_cbranch_scc1 ch_got
    s_add_u32 s10, s10, 1
    s_sub_u32 s11, s11, 1
    s_cmp_lg_u32 s11, 0
    s_cbranch_scc1 ch_hid
    v_mov_b32 v84, 1
    buffer_atomic_add v84, v83, s[36:39], 0 offen offset:12 sc0 sc1
    s_waitcnt vmcnt(0)
    v_readfirstlane_b32 s9, v84
    s_sub_u32 s9, 31, s9
    s_and_b32 s9, s9, 31
    s_or_b32 s9, s9, 0x10000
    s_branch ch_full
ch_got:
    s_lshl_b32 s10, s10, 5
    s_add_u32 s9, s9, s10
    s_add_u32 s9, s9, 0x100
ch_full:
    v_readfirstlane_b32 s10, v88
    s_cmp_eq_u32 s10, 0
    s_cselect_b32 s10, s8, s10
    s_mov_b64 exec, -1
    v_mov_b32 v84, s9
    v_mov_b32 v85, s10
    ds_write_b64 v86, v[84:85]
    s_waitcnt lgkmcnt(0)
ch_rolewait:
    s_barrier
    ds_read_b64 v[84:85], v86
    s_waitcnt lgkmcnt(0)
    v_readfirstlane_b32 s4, v84
    v_readfirstlane_b32 s101, v85
    s_and_b32 s7, s4, 0x10000
    s_add_u32 s7, s7, 1
    s_and_b32 s5, s4, 0x100
    s_and_b32 s4, s4, 0xff
    s_cmp_lg_u32 s5, 0
    s_cbranch_scc1 hp_entry
    s_and_b32 s4, s4, 31
    v_lshrrev_b32 v83, 4, v82
    v_and_b32 v84, 15, v82
    v_and_b32 v85, 1, v83
    v_xor_b32 v86, v84, v85
    v_lshlrev_b32 v85, 1, v85
    v_xor_b32 v87, v84, v85
    v_xor_b32 v88, 0, v86
    v_lshlrev_b32 v88, 4, v88
    v_lshl_add_u32 v20, v83, 13, v88
    v_xor_b32 v88, 0, v87
    v_lshlrev_b32 v88, 4, v88
    v_lshl_add_u32 v24, v83, 10, v88
    v_xor_b32 v88, 4, v86
    v_lshlrev_b32 v88, 4, v88
    v_lshl_add_u32 v21, v83, 13, v88
    v_xor_b32 v88, 0, v87
    v_lshlrev_b32 v88, 4, v88
    v_lshl_add_u32 v25, v83, 10, v88
    v_xor_b32 v88, 8, v86
    v_lshlrev_b32 v88, 4, v88
    v_lshl_add_u32 v22, v83, 13, v88
    v_xor_b32 v88, 4, v87
    v_lshlrev_b32 v88, 4, v88
    v_lshl_add_u32 v26, v83, 10, v88
    v_xor_b32 v88, 12, v86
    v_lshlrev_b32 v88, 4, v88
    v_lshl_add_u32 v23, v83, 13, v88
    v_xor_b32 v88, 4, v87
    v_lshlrev_b32 v88, 4, v88
    v_lshl_add_u32 v27, v83, 10, v88
    s_mov_b32 s80, s68
    s_mov_b32 s81, s69
    s_mov_b32 s82, 0x400000
    s_mov_b32 s83, 0x20000
    s_mov_b32 s84, s70
    s_mov_b32 s85, s71
    s_mov_b32 s86, 0x400000
    s_mov_b32 s87, 0x20000
    s_mov_b32 s88, s72
    s_mov_b32 s89, s73
    s_mov_b32 s90, 0x400000
    s_mov_b32 s91, 0x20000
    s_mov_b32 s8, s74
    s_mov_b32 s9, s75
    s_mov_b32 s10, 0x400000
    s_mov_b32 s11, 0x20000
    s_lshl_b32 s62, s4, 8
    s_lshl_b32 s63, s3, 17
    s_add_u32 s62, s62, s63
    s_lshl_b32 s63, s4, 17
    s_lshl_b32 s61, s3, 14
    s_add_u32 s63, s63, s61
    s_lshl_b32 s61, s3, 12
    s_add_u32 m0, s61, 0
    s_add_u32 s67, s62, 0
    buffer_load_dwordx4 v20, s[84:87], s67 offen lds
    s_add_u32 m0, s61, 1024
    s_add_u32 s67, s62, 32768
    buffer_load_dwordx4 v21, s[84:87], s67 offen lds
    s_add_u32 m0, s61, 2048
    s_add_u32 s67, s62, 65536
    buffer_load_dwordx4 v22, s[84:87], s67 offen lds
    s_add_u32 m0, s61, 3072
    s_add_u32 s67, s62, 98304
    buffer_load_dwordx4 v23, s[84:87], s67 offen lds
    s_add_u32 m0, s61, 16384
    s_add_u32 s67, s62, 524288
    buffer_load_dwordx4 v20, s[80:83], s67 offen lds
    s_add_u32 m0, s61, 17408
    s_add_u32 s67, s62, 557056
    buffer_load_dwordx4 v21, s[80:83], s67 offen lds
    s_add_u32 m0, s61, 18432
    s_add_u32 s67, s62, 589824
    buffer_load_dwordx4 v22, s[80:83], s67 offen lds
    s_add_u32 m0, s61, 19456
    s_add_u32 s67, s62, 622592
    buffer_load_dwordx4 v23, s[80:83], s67 offen lds
    s_add_u32 m0, s61, 32768
    s_add_u32 s67, s62, 1048576
    buffer_load_dwordx4 v20, s[80:83], s67 offen lds
    s_add_u32 m0, s61, 33792
    s_add_u32 s67, s62, 1081344
    buffer_load_dwordx4 v21, s[80:83], s67 offen lds
    s_add_u32 m0, s61, 34816
    s_add_u32 s67, s62, 1114112
    buffer_load_dwordx4 v22, s[80:83], s67 offen lds
    s_add_u32 m0, s61, 35840
    s_add_u32 s67, s62, 1146880
    buffer_load_dwordx4 v23, s[80:83], s67 offen lds
    s_add_u32 m0, s61, 49152
    s_add_u32 s67, s62, 1048576
    buffer_load_dwordx4 v20, s[84:87], s67 offen lds
    s_add_u32 m0, s61, 50176
    s_add_u32 s67, s62, 1081344
    buffer_load_dwordx4 v21, s[84:87], s67 offen lds
    s_add_u32 m0, s61, 51200
    s_add_u32 s67, s62, 1114112
    buffer_load_dwordx4 v22, s[84:87], s67 offen lds
    s_add_u32 m0, s61, 52224
    s_add_u32 s67, s62, 1146880
    buffer_load_dwordx4 v23, s[84:87], s67 offen lds
    s_add_u32 m0, s61, 65536
    s_add_u32 s67, s62, 1572864
    buffer_load_dwordx4 v20, s[84:87], s67 offen lds
    s_add_u32 m0, s61, 66560
    s_add_u32 s67, s62, 1605632
    buffer_load_dwordx4 v21, s[84:87], s67 offen lds
    s_add_u32 m0, s61, 67584
    s_add_u32 s67, s62, 1638400
    buffer_load_dwordx4 v22, s[84:87], s67 offen lds
    s_add_u32 m0, s61, 68608
    s_add_u32 s67, s62, 1671168
    buffer_load_dwordx4 v23, s[84:87], s67 offen lds
    s_add_u32 m0, s61, 81920
    s_add_u32 s67, s62, 2097152
    buffer_load_dwordx4 v20, s[80:83], s67 offen lds
    s_add_u32 m0, s61, 82944
    s_add_u32 s67, s62, 2129920
    buffer_load_dwordx4 v21, s[80:83], s67 offen lds
    s_add_u32 m0, s61, 83968
    s_add_u32 s67, s62, 2162688
    buffer_load_dwordx4 v22, s[80:83], s67 offen lds
    s_add_u32 m0, s61, 84992
    s_add_u32 s67, s62, 2195456
    buffer_load_dwordx4 v23, s[80:83], s67 offen lds
    s_add_u32 m0, s61, 98304
    s_add_u32 s67, s62, 2621440
    buffer_load_dwordx4 v20, s[80:83], s67 offen lds
    s_add_u32 m0, s61, 99328
    s_add_u32 s67, s62, 2654208
    buffer_load_dwordx4 v21, s[80:83], s67 offen lds
    s_add_u32 m0, s61, 100352
    s_add_u32 s67, s62, 2686976
    buffer_load_dwordx4 v22, s[80:83], s67 offen lds
    s_add_u32 m0, s61, 101376
    s_add_u32 s67, s62, 2719744
    buffer_load_dwordx4 v23, s[80:83], s67 offen lds
    s_add_u32 m0, s61, 114688
    s_add_u32 s67, s62, 2621440
    buffer_load_dwordx4 v20, s[84:87], s67 offen lds
    s_add_u32 m0, s61, 115712
    s_add_u32 s67, s62, 2654208
    buffer_load_dwordx4 v21, s[84:87], s67 offen lds
    s_add_u32 m0, s61, 116736
    s_add_u32 s67, s62, 2686976
    buffer_load_dwordx4 v22, s[84:87], s67 offen lds
    s_add_u32 m0, s61, 117760
    s_add_u32 s67, s62, 2719744
    buffer_load_dwordx4 v23, s[84:87], s67 offen lds
    s_add_u32 s12, s78, 0x7400000
    s_addc_u32 s13, s79, 0
    s_mov_b32 s14, 0x80000
    s_mov_b32 s15, 0x20000
    s_add_u32 s16, s78, 0x7500000
    s_addc_u32 s17, s79, 0
    s_mov_b32 s18, 0x2000
    s_mov_b32 s19, 0x20000
    s_add_u32 s20, s78, 0x2000000
    s_addc_u32 s21, s79, 0
    s_mov_b32 s22, 0x1000000
    s_mov_b32 s23, 0x20000
    s_add_u32 s24, s78, 0x3000000
    s_addc_u32 s25, s79, 0
    s_mov_b32 s26, 0x1000000
    s_mov_b32 s27, 0x20000
    s_add_u32 s28, s78, 0x4000000
    s_addc_u32 s29, s79, 0
    s_mov_b32 s30, 0x800000
    s_mov_b32 s31, 0x20000
    s_add_u32 s32, s78, 0x4800000
    s_addc_u32 s33, s79, 0
    s_mov_b32 s34, 0x400000
    s_mov_b32 s35, 0x20000
    s_mov_b32 s92, s64
    s_mov_b32 s93, s65
    s_mov_b32 s94, 0x2000
    s_mov_b32 s95, 0x20000
    v_lshlrev_b32 v1, 4, v82
    s_lshl_b32 s40, s3, 1
    s_lshr_b32 s41, s4, 4
    s_add_u32 s40, s40, s41
    s_and_b32 s50, s4, 15
    s_lshl_b32 s50, s50, 14
    s_lshl_b32 s41, s40, 11
    s_add_u32 s50, s50, s41
    s_lshl_b32 s43, s40, 10
    s_and_b32 s44, s4, 15
    s_lshl_b32 s44, s44, 6
    s_add_u32 s43, s43, s44
    v_and_b32 v85, 1, v82
    v_bfe_u32 v86, v82, 1, 2
    v_lshlrev_b32 v86, 1, v86
    v_and_b32 v88, 1, v83
    v_lshl_add_u32 v86, v88, 3, v86
    v_lshrrev_b32 v88, 1, v83
    v_lshl_add_u32 v87, v85, 4, v86
    v_lshl_add_u32 v87, v88, 5, v87
    v_add_u32 v3, s43, v87
    s_and_b32 s43, s4, 3
    s_lshl_b32 s43, s43, 11
    s_lshl_b32 s44, s40, 7
    s_add_u32 s43, s43, s44
    s_bfe_u32 s44, s4, 0x20002
    s_lshl_b32 s44, s44, 5
    s_add_u32 s43, s43, s44
    v_lshl_add_u32 v87, v85, 10, v86
    v_lshl_add_u32 v87, v88, 4, v87
    buffer_load_ushort v89, v87, s[92:95], s43 offen
    v_mov_b32 v28, -1
    v_mov_b32 v29, -1
    v_mov_b32 v30, -1
    v_mov_b32 v31, -1
    buffer_store_dwordx4 v[28:31], v1, s[12:15], s50 offen offset:0 sc1
    buffer_store_dwordx4 v[28:31], v1, s[12:15], s50 offen offset:1024 sc1
    v_cmp_eq_u32 vcc, 0, v86
    s_nop 1
    v_cndmask_b32 v19, 0, 1, vcc
    s_lshl_b32 s41, s4, 13
    s_lshl_b32 s42, s3, 11
    s_add_u32 s41, s41, s42
    s_add_u32 s96, s78, 0x7800000
    s_addc_u32 s97, s79, 0
    s_mov_b32 s98, 0x18000
    s_mov_b32 s99, 0x20000
    s_lshl_b32 s49, s4, 6
    s_add_u32 s49, s49, 16384
    s_sub_u32 s47, s101, 1
    s_lshl_b32 s42, s4, 12
    s_lshl_b32 s43, s3, 10
    s_add_u32 s42, s42, s43
    s_lshr_b32 s43, s42, 1
    s_sub_u32 s42, s42, 0x20000
    s_sub_u32 s43, s43, 0x10000
    v_mov_b32 v85, 0x4444
    v_mov_b32 v86, 0xeeee
    v_and_b32 v87, 2, v82
    v_cmp_eq_u32 vcc, 0, v87
    s_nop 1
    v_cndmask_b32 v0, v86, v85, vcc
    v_mov_b32 v87, 0x3f80
    v_mov_b32 v88, 0x3f800000
    v_mov_b32 v90, 0
    v_mov_b32 v7, 0
    v_lshlrev_b32 v85, 2, v83
    v_sub_u32 v86, v84, v85
    v_cmp_eq_u32 vcc, 0, v86
    s_nop 1
    v_cndmask_b32 v4, v90, v87, vcc
    v_cmp_eq_u32 vcc, 1, v86
    s_nop 1
    v_cndmask_b32 v4, v4, v88, vcc
    v_cmp_eq_u32 vcc, 2, v86
    s_nop 1
    v_cndmask_b32 v5, v90, v87, vcc
    v_cmp_eq_u32 vcc, 3, v86
    s_nop 1
    v_cndmask_b32 v5, v5, v88, vcc
    v_and_b32 v86, 7, v84
    v_cmp_eq_u32 vcc, 0, v86
    s_nop 1
    v_cndmask_b32 v8, v90, v87, vcc
    v_cmp_eq_u32 vcc, 1, v86
    s_nop 1
    v_cndmask_b32 v8, v8, v88, vcc
    v_cmp_eq_u32 vcc, 2, v86
    s_nop 1
    v_cndmask_b32 v9, v90, v87, vcc
    v_cmp_eq_u32 vcc, 3, v86
    s_nop 1
    v_cndmask_b32 v9, v9, v88, vcc
    v_cmp_eq_u32 vcc, 4, v86
    s_nop 1
    v_cndmask_b32 v10, v90, v87, vcc
    v_cmp_eq_u32 vcc, 5, v86
    s_nop 1
    v_cndmask_b32 v10, v10, v88, vcc
    v_cmp_eq_u32 vcc, 6, v86
    s_nop 1
    v_cndmask_b32 v11, v90, v87, vcc
    v_cmp_eq_u32 vcc, 7, v86
    s_nop 1
    v_cndmask_b32 v11, v11, v88, vcc
    v_lshrrev_b32 v86, 2, v84
    v_lshlrev_b32 v86, 1, v86
    v_and_b32 v90, 1, v84
    v_add_u32 v86, v86, v90
    v_bfe_u32 v90, v84, 1, 1
    v_lshlrev_b32 v85, 6, v83
    v_lshl_add_u32 v85, v86, 3, v85
    v_add_u32 v85, 159744, v85
    v_lshl_add_u32 v14, v90, 2, v85
    s_lshl_b32 s44, s3, 8
    v_add_u32 v85, s44, v85
    v_add_u32 v91, 162816, v1
    v_cmp_eq_u32 vcc, 0, v90
    s_nop 1
    v_cndmask_b32 v13, v91, v85, vcc
    v_add_u32 v16, 0x20000, v1
    v_add_u32 v17, 0x10000, v1
    v_lshlrev_b32 v85, 7, v83
    v_lshl_add_u32 v85, v86, 4, v85
    v_add_u32 v15, 160768, v85
    s_lshl_b32 s44, s3, 16
    s_lshl_b32 s45, s4, 6
    s_add_u32 s44, s44, s45
    v_lshlrev_b32 v85, 14, v83
    v_lshl_add_u32 v85, v84, 2, v85
    v_add_u32 v2, s44, v85
    v_and_b32 v86, 3, v84
    v_cmp_eq_u32 vcc, 0, v86
    s_nop 1
    v_cndmask_b32 v18, 0, 1, vcc
    v_lshlrev_b32 v85, 8, v83
    v_lshl_add_u32 v85, v86, 6, v85
    v_lshrrev_b32 v86, 2, v84
    v_lshl_add_u32 v12, v86, 4, v85
    v_bfe_u32 v85, v82, 2, 2
    v_and_b32 v86, 3, v82
    v_lshrrev_b32 v87, 1, v83
    v_lshlrev_b32 v87, 4, v87
    v_and_b32 v88, 1, v83
    v_lshl_add_u32 v87, v88, 2, v87
    v_and_b32 v88, 1, v85
    v_add_u32 v87, v87, v88
    v_lshrrev_b32 v88, 1, v85
    v_lshl_add_u32 v87, v88, 3, v87
    v_and_b32 v88, 1, v86
    v_lshlrev_b32 v88, 1, v88
    s_lshl_b32 s44, s3, 2
    v_add_u32 v88, s44, v88
    v_and_b32 v90, 13, v87
    v_xor_b32 v88, v88, v90
    v_lshlrev_b32 v87, 8, v87
    v_lshrrev_b32 v90, 1, v86
    v_lshl_add_u32 v87, v90, 3, v87
    v_lshl_add_u32 v92, v88, 4, v87
    v_xor_b32 v93, 16, v92
    v_lshlrev_b32 v87, 3, v83
    v_and_b32 v88, 1, v85
    v_add_u32 v87, v87, v88
    v_lshlrev_b32 v88, 1, v88
    v_and_b32 v90, 1, v83
    v_lshl_add_u32 v88, v90, 2, v88
    v_lshrrev_b32 v90, 1, v85
    v_lshlrev_b32 v90, 3, v90
    v_lshrrev_b32 v91, 1, v86
    v_add_u32 v90, v90, v91
    s_lshl_b32 s44, s3, 1
    v_add_u32 v90, s44, v90
    v_xor_b32 v88, v88, v90
    v_lshlrev_b32 v87, 8, v87
    v_and_b32 v90, 1, v86
    v_lshl_add_u32 v87, v90, 3, v87
    v_lshl_add_u32 v94, v88, 4, v87
    v_add_u32 v95, 8192, v94
    v_add_u32 v83, s61, v1
    v_add_u32 v84, 0x10000, v83
    v_add_u32 v85, 0x20000, v83
    s_mov_b32 s52, 0x0
    s_mov_b32 s53, 0x1000
    s_mov_b32 s54, 0x2000
    s_mov_b32 s55, 0x3000
    s_waitcnt vmcnt(31) lgkmcnt(0)
    s_barrier
    s_add_u32 m0, s61, 131072
    s_add_u32 s67, s62, 3145728
    buffer_load_dwordx4 v20, s[84:87], s67 offen lds
    s_add_u32 m0, s61, 132096
    s_add_u32 s67, s62, 3178496
    buffer_load_dwordx4 v21, s[84:87], s67 offen lds
    s_add_u32 m0, s61, 133120
    s_add_u32 s67, s62, 3211264
    buffer_load_dwordx4 v22, s[84:87], s67 offen lds
    s_add_u32 m0, s61, 134144
    s_add_u32 s67, s62, 3244032
    buffer_load_dwordx4 v23, s[84:87], s67 offen lds
    ds_read_b64_tr_b16 a[0:1], v92 offset:0
    ds_read_b64_tr_b16 a[2:3], v92 offset:512
    ds_read_b64_tr_b16 a[4:5], v92 offset:8192
    ds_read_b64_tr_b16 a[6:7], v92 offset:8704
    ds_read_b64_tr_b16 a[8:9], v93 offset:0
    ds_read_b64_tr_b16 a[10:11], v93 offset:512
    ds_read_b64_tr_b16 a[12:13], v93 offset:8192
    ds_read_b64_tr_b16 a[14:15], v93 offset:8704
    s_waitcnt vmcnt(31) lgkmcnt(0)
    s_barrier
    s_add_u32 m0, s61, 0
    s_add_u32 s67, s62, 3670016
    buffer_load_dwordx4 v20, s[80:83], s67 offen lds
    s_add_u32 m0, s61, 1024
    s_add_u32 s67, s62, 3702784
    buffer_load_dwordx4 v21, s[80:83], s67 offen lds
    s_add_u32 m0, s61, 2048
    s_add_u32 s67, s62, 3735552
    buffer_load_dwordx4 v22, s[80:83], s67 offen lds
    s_add_u32 m0, s61, 3072
    s_add_u32 s67, s62, 3768320
    buffer_load_dwordx4 v23, s[80:83], s67 offen lds
    ds_read_b64_tr_b16 a[16:17], v92 offset:16384
    ds_read_b64_tr_b16 a[18:19], v92 offset:16896
    ds_read_b64_tr_b16 a[20:21], v92 offset:24576
    ds_read_b64_tr_b16 a[22:23], v92 offset:25088
    ds_read_b64_tr_b16 a[24:25], v93 offset:16384
    ds_read_b64_tr_b16 a[26:27], v93 offset:16896
    ds_read_b64_tr_b16 a[28:29], v93 offset:24576
    ds_read_b64_tr_b16 a[30:31], v93 offset:25088
    s_waitcnt vmcnt(31) lgkmcnt(0)
    s_barrier
    s_add_u32 m0, s61, 16384
    s_add_u32 s67, s62, 0
    buffer_load_dwordx4 v20, s[88:91], s67 offen lds
    s_add_u32 m0, s61, 17408
    s_add_u32 s67, s62, 32768
    buffer_load_dwordx4 v21, s[88:91], s67 offen lds
    s_add_u32 m0, s61, 18432
    s_add_u32 s67, s62, 65536
    buffer_load_dwordx4 v22, s[88:91], s67 offen lds
    s_add_u32 m0, s61, 19456
    s_add_u32 s67, s62, 98304
    buffer_load_dwordx4 v23, s[88:91], s67 offen lds
    ds_read_b64_tr_b16 a[32:33], v92 offset:32768
    ds_read_b64_tr_b16 a[34:35], v92 offset:33280
    ds_read_b64_tr_b16 a[36:37], v92 offset:40960
    ds_read_b64_tr_b16 a[38:39], v92 offset:41472
    ds_read_b64_tr_b16 a[40:41], v93 offset:32768
    ds_read_b64_tr_b16 a[42:43], v93 offset:33280
    ds_read_b64_tr_b16 a[44:45], v93 offset:40960
    ds_read_b64_tr_b16 a[46:47], v93 offset:41472
    s_waitcnt vmcnt(31) lgkmcnt(0)
    s_barrier
    s_add_u32 m0, s61, 32768
    s_add_u32 s67, s62, 1048576
    buffer_load_dwordx4 v20, s[88:91], s67 offen lds
    s_add_u32 m0, s61, 33792
    s_add_u32 s67, s62, 1081344
    buffer_load_dwordx4 v21, s[88:91], s67 offen lds
    s_add_u32 m0, s61, 34816
    s_add_u32 s67, s62, 1114112
    buffer_load_dwordx4 v22, s[88:91], s67 offen lds
    s_add_u32 m0, s61, 35840
    s_add_u32 s67, s62, 1146880
    buffer_load_dwordx4 v23, s[88:91], s67 offen lds
    ds_read_b64_tr_b16 a[48:49], v92 offset:49152
    ds_read_b64_tr_b16 a[50:51], v92 offset:49664
    ds_read_b64_tr_b16 a[52:53], v92 offset:57344
    ds_read_b64_tr_b16 a[54:55], v92 offset:57856
    ds_read_b64_tr_b16 a[56:57], v93 offset:49152
    ds_read_b64_tr_b16 a[58:59], v93 offset:49664
    ds_read_b64_tr_b16 a[60:61], v93 offset:57344
    ds_read_b64_tr_b16 a[62:63], v93 offset:57856
    s_waitcnt vmcnt(31) lgkmcnt(0)
    s_barrier
    s_add_u32 m0, s61, 49152
    s_add_u32 s67, s62, 1572864
    buffer_load_dwordx4 v20, s[88:91], s67 offen lds
    s_add_u32 m0, s61, 50176
    s_add_u32 s67, s62, 1605632
    buffer_load_dwordx4 v21, s[88:91], s67 offen lds
    s_add_u32 m0, s61, 51200
    s_add_u32 s67, s62, 1638400
    buffer_load_dwordx4 v22, s[88:91], s67 offen lds
    s_add_u32 m0, s61, 52224
    s_add_u32 s67, s62, 1671168
    buffer_load_dwordx4 v23, s[88:91], s67 offen lds
    v_add_u32 v30, 0x10000, v92
    ds_read_b64_tr_b16 a[64:65], v30 offset:0
    ds_read_b64_tr_b16 a[66:67], v30 offset:512
    ds_read_b64_tr_b16 a[68:69], v30 offset:8192
    ds_read_b64_tr_b16 a[70:71], v30 offset:8704
    v_add_u32 v31, 0x10000, v93
    ds_read_b64_tr_b16 a[72:73], v31 offset:0
    ds_read_b64_tr_b16 a[74:75], v31 offset:512
    ds_read_b64_tr_b16 a[76:77], v31 offset:8192
    ds_read_b64_tr_b16 a[78:79], v31 offset:8704
    s_waitcnt vmcnt(31) lgkmcnt(0)
    s_barrier
    s_add_u32 m0, s61, 65536
    s_add_u32 s67, s62, 2621440
    buffer_load_dwordx4 v20, s[88:91], s67 offen lds
    s_add_u32 m0, s61, 66560
    s_add_u32 s67, s62, 2654208
    buffer_load_dwordx4 v21, s[88:91], s67 offen lds
    s_add_u32 m0, s61, 67584
    s_add_u32 s67, s62, 2686976
    buffer_load_dwordx4 v22, s[88:91], s67 offen lds
    s_add_u32 m0, s61, 68608
    s_add_u32 s67, s62, 2719744
    buffer_load_dwordx4 v23, s[88:91], s67 offen lds
    v_add_u32 v30, 0x14000, v92
    ds_read_b64_tr_b16 a[80:81], v30 offset:0
    ds_read_b64_tr_b16 a[82:83], v30 offset:512
    ds_read_b64_tr_b16 a[84:85], v30 offset:8192
    ds_read_b64_tr_b16 a[86:87], v30 offset:8704
    v_add_u32 v31, 0x14000, v93
    ds_read_b64_tr_b16 a[88:89], v31 offset:0
    ds_read_b64_tr_b16 a[90:91], v31 offset:512
    ds_read_b64_tr_b16 a[92:93], v31 offset:8192
    ds_read_b64_tr_b16 a[94:95], v31 offset:8704
    s_waitcnt vmcnt(31) lgkmcnt(0)
    s_barrier
    s_add_u32 m0, s61, 81920
    s_add_u32 s67, s62, 3145728
    buffer_load_dwordx4 v20, s[88:91], s67 offen lds
    s_add_u32 m0, s61, 82944
    s_add_u32 s67, s62, 3178496
    buffer_load_dwordx4 v21, s[88:91], s67 offen lds
    s_add_u32 m0, s61, 83968
    s_add_u32 s67, s62, 3211264
    buffer_load_dwordx4 v22, s[88:91], s67 offen lds
    s_add_u32 m0, s61, 84992
    s_add_u32 s67, s62, 3244032
    buffer_load_dwordx4 v23, s[88:91], s67 offen lds
    v_add_u32 v30, 0x18000, v92
    ds_read_b64_tr_b16 a[96:97], v30 offset:0
    ds_read_b64_tr_b16 a[98:99], v30 offset:512
    ds_read_b64_tr_b16 a[100:101], v30 offset:8192
    ds_read_b64_tr_b16 a[102:103], v30 offset:8704
    v_add_u32 v31, 0x18000, v93
    ds_read_b64_tr_b16 a[104:105], v31 offset:0
    ds_read_b64_tr_b16 a[106:107], v31 offset:512
    ds_read_b64_tr_b16 a[108:109], v31 offset:8192
    ds_read_b64_tr_b16 a[110:111], v31 offset:8704
    s_waitcnt vmcnt(31) lgkmcnt(0)
    s_barrier
    s_add_u32 m0, s61, 98304
    s_add_u32 s67, s63, 0
    buffer_load_dwordx4 v24, s[8:11], s67 offen lds
    s_add_u32 m0, s61, 99328
    s_add_u32 s67, s63, 4096
    buffer_load_dwordx4 v25, s[8:11], s67 offen lds
    s_add_u32 m0, s61, 100352
    s_add_u32 s67, s63, 8192
    buffer_load_dwordx4 v26, s[8:11], s67 offen lds
    s_add_u32 m0, s61, 101376
    s_add_u32 s67, s63, 12288
    buffer_load_dwordx4 v27, s[8:11], s67 offen lds
    v_add_u32 v30, 0x1c000, v92
    ds_read_b64_tr_b16 a[112:113], v30 offset:0
    ds_read_b64_tr_b16 a[114:115], v30 offset:512
    ds_read_b64_tr_b16 a[116:117], v30 offset:8192
    ds_read_b64_tr_b16 a[118:119], v30 offset:8704
    v_add_u32 v31, 0x1c000, v93
    ds_read_b64_tr_b16 a[120:121], v31 offset:0
    ds_read_b64_tr_b16 a[122:123], v31 offset:512
    ds_read_b64_tr_b16 a[124:125], v31 offset:8192
    ds_read_b64_tr_b16 a[126:127], v31 offset:8704
    s_waitcnt vmcnt(28) lgkmcnt(0)
    s_barrier
    v_bfi_b32 v89, v19, 0, v89
    buffer_store_short v89, v3, s[16:19], 0 offen sc1
    s_add_u32 m0, s61, 114688
    s_add_u32 s67, s63, 65536
    buffer_load_dwordx4 v24, s[8:11], s67 offen lds
    s_add_u32 m0, s61, 115712
    s_add_u32 s67, s63, 69632
    buffer_load_dwordx4 v25, s[8:11], s67 offen lds
    s_add_u32 m0, s61, 116736
    s_add_u32 s67, s63, 73728
    buffer_load_dwordx4 v26, s[8:11], s67 offen lds
    s_add_u32 m0, s61, 117760
    s_add_u32 s67, s63, 77824
    buffer_load_dwordx4 v27, s[8:11], s67 offen lds
    v_add_u32 v30, 0x20000, v92
    ds_read_b64_tr_b16 a[128:129], v30 offset:0
    ds_read_b64_tr_b16 a[130:131], v30 offset:512
    ds_read_b64_tr_b16 a[132:133], v30 offset:8192
    ds_read_b64_tr_b16 a[134:135], v30 offset:8704
    v_add_u32 v31, 0x20000, v93
    ds_read_b64_tr_b16 a[136:137], v31 offset:0
    ds_read_b64_tr_b16 a[138:139], v31 offset:512
    ds_read_b64_tr_b16 a[140:141], v31 offset:8192
    ds_read_b64_tr_b16 a[142:143], v31 offset:8704
    s_waitcnt vmcnt(29) lgkmcnt(0)
    s_barrier
    s_add_u32 m0, s61, 131072
    s_add_u32 s67, s63, 256
    buffer_load_dwordx4 v24, s[8:11], s67 offen lds
    s_add_u32 m0, s61, 132096
    s_add_u32 s67, s63, 4352
    buffer_load_dwordx4 v25, s[8:11], s67 offen lds
    s_add_u32 m0, s61, 133120
    s_add_u32 s67, s63, 8448
    buffer_load_dwordx4 v26, s[8:11], s67 offen lds
    s_add_u32 m0, s61, 134144
    s_add_u32 s67, s63, 12544
    buffer_load_dwordx4 v27, s[8:11], s67 offen lds
    ds_read_b64_tr_b16 a[144:145], v92 offset:0
    ds_read_b64_tr_b16 a[146:147], v92 offset:512
    ds_read_b64_tr_b16 a[148:149], v92 offset:8192
    ds_read_b64_tr_b16 a[150:151], v92 offset:8704
    ds_read_b64_tr_b16 a[152:153], v93 offset:0
    ds_read_b64_tr_b16 a[154:155], v93 offset:512
    ds_read_b64_tr_b16 a[156:157], v93 offset:8192
    ds_read_b64_tr_b16 a[158:159], v93 offset:8704
    s_waitcnt vmcnt(29) lgkmcnt(0)
    s_barrier
    s_add_u32 m0, s61, 0
    s_add_u32 s67, s63, 65792
    buffer_load_dwordx4 v24, s[8:11], s67 offen lds
    s_add_u32 m0, s61, 1024
    s_add_u32 s67, s63, 69888
    buffer_load_dwordx4 v25, s[8:11], s67 offen lds
    s_add_u32 m0, s61, 2048
    s_add_u32 s67, s63, 73984
    buffer_load_dwordx4 v26, s[8:11], s67 offen lds
    s_add_u32 m0, s61, 3072
    s_add_u32 s67, s63, 78080
    buffer_load_dwordx4 v27, s[8:11], s67 offen lds
    ds_read_b64_tr_b16 a[160:161], v92 offset:16384
    ds_read_b64_tr_b16 a[162:163], v92 offset:16896
    ds_read_b64_tr_b16 a[164:165], v92 offset:24576
    ds_read_b64_tr_b16 a[166:167], v92 offset:25088
    ds_read_b64_tr_b16 a[168:169], v93 offset:16384
    ds_read_b64_tr_b16 a[170:171], v93 offset:16896
    ds_read_b64_tr_b16 a[172:173], v93 offset:24576
    ds_read_b64_tr_b16 a[174:175], v93 offset:25088
    s_waitcnt vmcnt(29) lgkmcnt(0)
    s_barrier
    s_add_u32 m0, s61, 16384
    s_add_u32 s67, s63, 512
    buffer_load_dwordx4 v24, s[8:11], s67 offen lds
    s_add_u32 m0, s61, 17408
    s_add_u32 s67, s63, 4608
    buffer_load_dwordx4 v25, s[8:11], s67 offen lds
    s_add_u32 m0, s61, 18432
    s_add_u32 s67, s63, 8704
    buffer_load_dwordx4 v26, s[8:11], s67 offen lds
    s_add_u32 m0, s61, 19456
    s_add_u32 s67, s63, 12800
    buffer_load_dwordx4 v27, s[8:11], s67 offen lds
    ds_read_b64_tr_b16 a[176:177], v92 offset:32768
    ds_read_b64_tr_b16 a[178:179], v92 offset:33280
    ds_read_b64_tr_b16 a[180:181], v92 offset:40960
    ds_read_b64_tr_b16 a[182:183], v92 offset:41472
    ds_read_b64_tr_b16 a[184:185], v93 offset:32768
    ds_read_b64_tr_b16 a[186:187], v93 offset:33280
    ds_read_b64_tr_b16 a[188:189], v93 offset:40960
    ds_read_b64_tr_b16 a[190:191], v93 offset:41472
    s_waitcnt vmcnt(29) lgkmcnt(0)
    s_barrier
    s_add_u32 m0, s61, 32768
    s_add_u32 s67, s63, 66048
    buffer_load_dwordx4 v24, s[8:11], s67 offen lds
    s_add_u32 m0, s61, 33792
    s_add_u32 s67, s63, 70144
    buffer_load_dwordx4 v25, s[8:11], s67 offen lds
    s_add_u32 m0, s61, 34816
    s_add_u32 s67, s63, 74240
    buffer_load_dwordx4 v26, s[8:11], s67 offen lds
    s_add_u32 m0, s61, 35840
    s_add_u32 s67, s63, 78336
    buffer_load_dwordx4 v27, s[8:11], s67 offen lds
    ds_read_b64_tr_b16 a[192:193], v92 offset:49152
    ds_read_b64_tr_b16 a[194:195], v92 offset:49664
    ds_read_b64_tr_b16 a[196:197], v92 offset:57344
    ds_read_b64_tr_b16 a[198:199], v92 offset:57856
    ds_read_b64_tr_b16 a[200:201], v93 offset:49152
    ds_read_b64_tr_b16 a[202:203], v93 offset:49664
    ds_read_b64_tr_b16 a[204:205], v93 offset:57344
    ds_read_b64_tr_b16 a[206:207], v93 offset:57856
    s_waitcnt vmcnt(29) lgkmcnt(0)
    s_barrier
    s_add_u32 m0, s61, 49152
    s_add_u32 s67, s63, 768
    buffer_load_dwordx4 v24, s[8:11], s67 offen lds
    s_add_u32 m0, s61, 50176
    s_add_u32 s67, s63, 4864
    buffer_load_dwordx4 v25, s[8:11], s67 offen lds
    s_add_u32 m0, s61, 51200
    s_add_u32 s67, s63, 8960
    buffer_load_dwordx4 v26, s[8:11], s67 offen lds
    s_add_u32 m0, s61, 52224
    s_add_u32 s67, s63, 13056
    buffer_load_dwordx4 v27, s[8:11], s67 offen lds
    v_add_u32 v30, 0x10000, v92
    ds_read_b64_tr_b16 a[208:209], v30 offset:0
    ds_read_b64_tr_b16 a[210:211], v30 offset:512
    ds_read_b64_tr_b16 a[212:213], v30 offset:8192
    ds_read_b64_tr_b16 a[214:215], v30 offset:8704
    v_add_u32 v31, 0x10000, v93
    ds_read_b64_tr_b16 a[216:217], v31 offset:0
    ds_read_b64_tr_b16 a[218:219], v31 offset:512
    ds_read_b64_tr_b16 a[220:221], v31 offset:8192
    ds_read_b64_tr_b16 a[222:223], v31 offset:8704
    s_waitcnt vmcnt(29) lgkmcnt(0)
    s_barrier
    s_add_u32 m0, s61, 65536
    s_add_u32 s67, s63, 66304
    buffer_load_dwordx4 v24, s[8:11], s67 offen lds
    s_add_u32 m0, s61, 66560
    s_add_u32 s67, s63, 70400
    buffer_load_dwordx4 v25, s[8:11], s67 offen lds
    s_add_u32 m0, s61, 67584
    s_add_u32 s67, s63, 74496
    buffer_load_dwordx4 v26, s[8:11], s67 offen lds
    s_add_u32 m0, s61, 68608
    s_add_u32 s67, s63, 78592
    buffer_load_dwordx4 v27, s[8:11], s67 offen lds
    v_add_u32 v30, 0x14000, v92
    ds_read_b64_tr_b16 a[224:225], v30 offset:0
    ds_read_b64_tr_b16 a[226:227], v30 offset:512
    ds_read_b64_tr_b16 a[228:229], v30 offset:8192
    ds_read_b64_tr_b16 a[230:231], v30 offset:8704
    v_add_u32 v31, 0x14000, v93
    ds_read_b64_tr_b16 a[232:233], v31 offset:0
    ds_read_b64_tr_b16 a[234:235], v31 offset:512
    ds_read_b64_tr_b16 a[236:237], v31 offset:8192
    ds_read_b64_tr_b16 a[238:239], v31 offset:8704
    s_waitcnt vmcnt(29) lgkmcnt(0)
    s_barrier
    s_add_u32 m0, s61, 81920
    s_add_u32 s67, s62, 0
    buffer_load_dwordx4 v20, s[80:83], s67 offen lds
    s_add_u32 m0, s61, 82944
    s_add_u32 s67, s62, 32768
    buffer_load_dwordx4 v21, s[80:83], s67 offen lds
    s_add_u32 m0, s61, 83968
    s_add_u32 s67, s62, 65536
    buffer_load_dwordx4 v22, s[80:83], s67 offen lds
    s_add_u32 m0, s61, 84992
    s_add_u32 s67, s62, 98304
    buffer_load_dwordx4 v23, s[80:83], s67 offen lds
    v_add_u32 v30, 0x18000, v94
    ds_read_b64_tr_b16 a[240:241], v30 offset:0
    ds_read_b64_tr_b16 a[242:243], v30 offset:512
    ds_read_b64_tr_b16 a[244:245], v30 offset:1024
    ds_read_b64_tr_b16 a[246:247], v30 offset:1536
    v_add_u32 v31, 0x18000, v95
    ds_read_b64_tr_b16 a[248:249], v31 offset:0
    ds_read_b64_tr_b16 a[250:251], v31 offset:512
    ds_read_b64_tr_b16 a[252:253], v31 offset:1024
    ds_read_b64_tr_b16 a[254:255], v31 offset:1536
    s_waitcnt vmcnt(28) lgkmcnt(0)
    s_barrier
    s_add_u32 m0, s61, 98304
    s_add_u32 s67, s62, 524288
    buffer_load_dwordx4 v20, s[84:87], s67 offen lds
    s_add_u32 m0, s61, 99328
    s_add_u32 s67, s62, 557056
    buffer_load_dwordx4 v21, s[84:87], s67 offen lds
    s_add_u32 m0, s61, 100352
    s_add_u32 s67, s62, 589824
    buffer_load_dwordx4 v22, s[84:87], s67 offen lds
    s_add_u32 m0, s61, 101376
    s_add_u32 s67, s62, 622592
    buffer_load_dwordx4 v23, s[84:87], s67 offen lds
    v_add_u32 v30, 0x1c000, v94
    ds_read_b64_tr_b16 v[144:145], v30 offset:0
    ds_read_b64_tr_b16 v[146:147], v30 offset:512
    ds_read_b64_tr_b16 v[148:149], v30 offset:1024
    ds_read_b64_tr_b16 v[150:151], v30 offset:1536
    v_add_u32 v31, 0x1c000, v95
    ds_read_b64_tr_b16 v[152:153], v31 offset:0
    ds_read_b64_tr_b16 v[154:155], v31 offset:512
    ds_read_b64_tr_b16 v[156:157], v31 offset:1024
    ds_read_b64_tr_b16 v[158:159], v31 offset:1536
    s_waitcnt vmcnt(28) lgkmcnt(0)
    s_barrier
    s_add_u32 m0, s61, 114688
    s_add_u32 s67, s62, 1572864
    buffer_load_dwordx4 v20, s[80:83], s67 offen lds
    s_add_u32 m0, s61, 115712
    s_add_u32 s67, s62, 1605632
    buffer_load_dwordx4 v21, s[80:83], s67 offen lds
    s_add_u32 m0, s61, 116736
    s_add_u32 s67, s62, 1638400
    buffer_load_dwordx4 v22, s[80:83], s67 offen lds
    s_add_u32 m0, s61, 117760
    s_add_u32 s67, s62, 1671168
    buffer_load_dwordx4 v23, s[80:83], s67 offen lds
    v_add_u32 v30, 0x20000, v94
    ds_read_b64_tr_b16 v[160:161], v30 offset:0
    ds_read_b64_tr_b16 v[162:163], v30 offset:512
    ds_read_b64_tr_b16 v[164:165], v30 offset:1024
    ds_read_b64_tr_b16 v[166:167], v30 offset:1536
    v_add_u32 v31, 0x20000, v95
    ds_read_b64_tr_b16 v[168:169], v31 offset:0
    ds_read_b64_tr_b16 v[170:171], v31 offset:512
    ds_read_b64_tr_b16 v[172:173], v31 offset:1024
    ds_read_b64_tr_b16 v[174:175], v31 offset:1536
    s_waitcnt vmcnt(28) lgkmcnt(0)
    s_barrier
    s_add_u32 m0, s61, 131072
    s_add_u32 s67, s62, 2097152
    buffer_load_dwordx4 v20, s[84:87], s67 offen lds
    s_add_u32 m0, s61, 132096
    s_add_u32 s67, s62, 2129920
    buffer_load_dwordx4 v21, s[84:87], s67 offen lds
    s_add_u32 m0, s61, 133120
    s_add_u32 s67, s62, 2162688
    buffer_load_dwordx4 v22, s[84:87], s67 offen lds
    s_add_u32 m0, s61, 134144
    s_add_u32 s67, s62, 2195456
    buffer_load_dwordx4 v23, s[84:87], s67 offen lds
    ds_read_b64_tr_b16 v[176:177], v94 offset:0
    ds_read_b64_tr_b16 v[178:179], v94 offset:512
    ds_read_b64_tr_b16 v[180:181], v94 offset:1024
    ds_read_b64_tr_b16 v[182:183], v94 offset:1536
    ds_read_b64_tr_b16 v[184:185], v95 offset:0
    ds_read_b64_tr_b16 v[186:187], v95 offset:512
    ds_read_b64_tr_b16 v[188:189], v95 offset:1024
    ds_read_b64_tr_b16 v[190:191], v95 offset:1536
    s_cmp_lg_u32 s3, 0
    s_cbranch_scc1 ch_noarr
    v_mov_b32 v86, 4
    v_mov_b32 v87, s7
    s_mov_b64 exec, 1
    buffer_atomic_add v87, v86, s[36:39], 0 offen sc1
    s_mov_b64 exec, -1
ch_noarr:
    v_lshlrev_b32 v102, 21, v82
    buffer_load_dword v103, v102, s[20:23], 0 offen sc1
    buffer_load_dword v103, v102, s[24:27], 0 offen sc1
    buffer_load_dword v103, v102, s[28:31], 0 offen sc1
    buffer_load_dword v103, v102, s[32:35], 0 offen sc1
    v_lshrrev_b32 v91, 1, v1
    v_mov_b32 v96, -1
    v_mov_b32 v97, -1
    v_mov_b32 v98, -1
    v_mov_b32 v99, -1
    s_add_u32 s44, s42, 0x760000
    buffer_store_dwordx4 v[96:99], v1, s[28:31], s44 offen sc1
    s_add_u32 s44, s43, 0x3b0000
    buffer_store_dwordx2 v[96:97], v91, s[32:35], s44 offen sc1
    s_add_u32 s44, s42, 0x780000
    buffer_store_dwordx4 v[96:99], v1, s[28:31], s44 offen sc1
    s_add_u32 s44, s43, 0x3c0000
    buffer_store_dwordx2 v[96:97], v91, s[32:35], s44 offen sc1
    s_add_u32 s44, s42, 0x7a0000
    buffer_store_dwordx4 v[96:99], v1, s[28:31], s44 offen sc1
    s_add_u32 s44, s43, 0x3d0000
    buffer_store_dwordx2 v[96:97], v91, s[32:35], s44 offen sc1
    s_add_u32 s44, s42, 0x7c0000
    buffer_store_dwordx4 v[96:99], v1, s[28:31], s44 offen sc1
    s_add_u32 s44, s43, 0x3e0000
    buffer_store_dwordx2 v[96:97], v91, s[32:35], s44 offen sc1
    s_add_u32 s44, s42, 0x7e0000
    buffer_store_dwordx4 v[96:99], v1, s[28:31], s44 offen sc1
    s_add_u32 s44, s43, 0x3f0000
    buffer_store_dwordx2 v[96:97], v91, s[32:35], s44 offen sc1
    s_add_u32 s44, s42, 0x800000
    buffer_store_dwordx4 v[96:99], v1, s[28:31], s44 offen sc1
    s_add_u32 s44, s43, 0x400000
    buffer_store_dwordx2 v[96:97], v91, s[32:35], s44 offen sc1
    s_waitcnt vmcnt(44) lgkmcnt(0)
    s_barrier
    s_add_u32 m0, s61, 0
    s_add_u32 s67, s62, 3145728
    buffer_load_dwordx4 v20, s[80:83], s67 offen lds
    s_add_u32 m0, s61, 1024
    s_add_u32 s67, s62, 3178496
    buffer_load_dwordx4 v21, s[80:83], s67 offen lds
    s_add_u32 m0, s61, 2048
    s_add_u32 s67, s62, 3211264
    buffer_load_dwordx4 v22, s[80:83], s67 offen lds
    s_add_u32 m0, s61, 3072
    s_add_u32 s67, s62, 3244032
    buffer_load_dwordx4 v23, s[80:83], s67 offen lds
    ds_read_b64_tr_b16 v[192:193], v94 offset:16384
    ds_read_b64_tr_b16 v[194:195], v94 offset:16896
    ds_read_b64_tr_b16 v[196:197], v94 offset:17408
    ds_read_b64_tr_b16 v[198:199], v94 offset:17920
    ds_read_b64_tr_b16 v[200:201], v95 offset:16384
    ds_read_b64_tr_b16 v[202:203], v95 offset:16896
    ds_read_b64_tr_b16 v[204:205], v95 offset:17408
    ds_read_b64_tr_b16 v[206:207], v95 offset:17920
    s_waitcnt vmcnt(44) lgkmcnt(0)
    s_barrier
    s_add_u32 m0, s61, 16384
    s_add_u32 s67, s62, 3670016
    buffer_load_dwordx4 v20, s[84:87], s67 offen lds
    s_add_u32 m0, s61, 17408
    s_add_u32 s67, s62, 3702784
    buffer_load_dwordx4 v21, s[84:87], s67 offen lds
    s_add_u32 m0, s61, 18432
    s_add_u32 s67, s62, 3735552
    buffer_load_dwordx4 v22, s[84:87], s67 offen lds
    s_add_u32 m0, s61, 19456
    s_add_u32 s67, s62, 3768320
    buffer_load_dwordx4 v23, s[84:87], s67 offen lds
    ds_read_b64_tr_b16 v[208:209], v94 offset:32768
    ds_read_b64_tr_b16 v[210:211], v94 offset:33280
    ds_read_b64_tr_b16 v[212:213], v94 offset:33792
    ds_read_b64_tr_b16 v[214:215], v94 offset:34304
    ds_read_b64_tr_b16 v[216:217], v95 offset:32768
    ds_read_b64_tr_b16 v[218:219], v95 offset:33280
    ds_read_b64_tr_b16 v[220:221], v95 offset:33792
    ds_read_b64_tr_b16 v[222:223], v95 offset:34304
    s_waitcnt vmcnt(44) lgkmcnt(0)
    s_barrier
    s_add_u32 m0, s61, 32768
    s_add_u32 s67, s62, 524288
    buffer_load_dwordx4 v20, s[88:91], s67 offen lds
    s_add_u32 m0, s61, 33792
    s_add_u32 s67, s62, 557056
    buffer_load_dwordx4 v21, s[88:91], s67 offen lds
    s_add_u32 m0, s61, 34816
    s_add_u32 s67, s62, 589824
    buffer_load_dwordx4 v22, s[88:91], s67 offen lds
    s_add_u32 m0, s61, 35840
    s_add_u32 s67, s62, 622592
    buffer_load_dwordx4 v23, s[88:91], s67 offen lds
    ds_read_b64_tr_b16 v[224:225], v94 offset:49152
    ds_read_b64_tr_b16 v[226:227], v94 offset:49664
    ds_read_b64_tr_b16 v[228:229], v94 offset:50176
    ds_read_b64_tr_b16 v[230:231], v94 offset:50688
    ds_read_b64_tr_b16 v[232:233], v95 offset:49152
    ds_read_b64_tr_b16 v[234:235], v95 offset:49664
    ds_read_b64_tr_b16 v[236:237], v95 offset:50176
    ds_read_b64_tr_b16 v[238:239], v95 offset:50688
    s_waitcnt vmcnt(44) lgkmcnt(0)
    s_barrier
    s_add_u32 m0, s61, 49152
    s_add_u32 s67, s62, 2097152
    buffer_load_dwordx4 v20, s[88:91], s67 offen lds
    s_add_u32 m0, s61, 50176
    s_add_u32 s67, s62, 2129920
    buffer_load_dwordx4 v21, s[88:91], s67 offen lds
    s_add_u32 m0, s61, 51200
    s_add_u32 s67, s62, 2162688
    buffer_load_dwordx4 v22, s[88:91], s67 offen lds
    s_add_u32 m0, s61, 52224
    s_add_u32 s67, s62, 2195456
    buffer_load_dwordx4 v23, s[88:91], s67 offen lds
    v_add_u32 v30, 0x10000, v94
    ds_read_b64_tr_b16 v[240:241], v30 offset:0
    ds_read_b64_tr_b16 v[242:243], v30 offset:512
    ds_read_b64_tr_b16 v[244:245], v30 offset:1024
    ds_read_b64_tr_b16 v[246:247], v30 offset:1536
    v_add_u32 v31, 0x10000, v95
    ds_read_b64_tr_b16 v[248:249], v31 offset:0
    ds_read_b64_tr_b16 v[250:251], v31 offset:512
    ds_read_b64_tr_b16 v[252:253], v31 offset:1024
    ds_read_b64_tr_b16 v[254:255], v31 offset:1536
    s_waitcnt lgkmcnt(0)
    s_barrier
    s_add_u32 m0, s61, 65536
    s_add_u32 s67, s62, 3670016
    buffer_load_dwordx4 v20, s[88:91], s67 offen lds
    s_add_u32 m0, s61, 66560
    s_add_u32 s67, s62, 3702784
    buffer_load_dwordx4 v21, s[88:91], s67 offen lds
    s_add_u32 m0, s61, 67584
    s_add_u32 s67, s62, 3735552
    buffer_load_dwordx4 v22, s[88:91], s67 offen lds
    s_add_u32 m0, s61, 68608
    s_add_u32 s67, s62, 3768320
    buffer_load_dwordx4 v23, s[88:91], s67 offen lds
    s_waitcnt vmcnt(40)
    s_barrier
    v_add_u32 v30, 0x14000, v92
    ds_read_b64_tr_b16 v[96:97], v30 offset:0
    ds_read_b64_tr_b16 v[98:99], v30 offset:512
    ds_read_b64_tr_b16 v[100:101], v30 offset:8192
    ds_read_b64_tr_b16 v[102:103], v30 offset:8704
    v_add_u32 v31, 0x14000, v93
    ds_read_b64_tr_b16 v[104:105], v31 offset:0
    ds_read_b64_tr_b16 v[106:107], v31 offset:512
    ds_read_b64_tr_b16 v[108:109], v31 offset:8192
    ds_read_b64_tr_b16 v[110:111], v31 offset:8704
    s_waitcnt lgkmcnt(0)
    v_add_u32 v30, 0x18000, v92
    ds_read_b64_tr_b16 v[112:113], v30 offset:0
    ds_read_b64_tr_b16 v[114:115], v30 offset:512
    ds_read_b64_tr_b16 v[116:117], v30 offset:8192
    ds_read_b64_tr_b16 v[118:119], v30 offset:8704
    v_add_u32 v31, 0x18000, v93
    ds_read_b64_tr_b16 v[120:121], v31 offset:0
    ds_read_b64_tr_b16 v[122:123], v31 offset:512
    ds_read_b64_tr_b16 v[124:125], v31 offset:8192
    ds_read_b64_tr_b16 v[126:127], v31 offset:8704
    s_waitcnt lgkmcnt(0)
    v_add_u32 v30, 0x1c000, v92
    ds_read_b64_tr_b16 v[128:129], v30 offset:0
    ds_read_b64_tr_b16 v[130:131], v30 offset:512
    ds_read_b64_tr_b16 v[132:133], v30 offset:8192
    ds_read_b64_tr_b16 v[134:135], v30 offset:8704
    v_add_u32 v31, 0x1c000, v93
    ds_read_b64_tr_b16 v[136:137], v31 offset:0
    ds_read_b64_tr_b16 v[138:139], v31 offset:512
    ds_read_b64_tr_b16 v[140:141], v31 offset:8192
    ds_read_b64_tr_b16 v[142:143], v31 offset:8704
    s_waitcnt lgkmcnt(0)
    s_barrier
    ds_write_b128 v84, v[96:99] offset:16384
    ds_write_b128 v84, v[100:103] offset:17408
    ds_write_b128 v84, v[104:107] offset:18432
    ds_write_b128 v84, v[108:111] offset:19456
    ds_write_b128 v84, v[112:115] offset:32768
    ds_write_b128 v84, v[116:119] offset:33792
    ds_write_b128 v84, v[120:123] offset:34816
    ds_write_b128 v84, v[124:127] offset:35840
    ds_write_b128 v84, v[128:131] offset:49152
    ds_write_b128 v84, v[132:135] offset:50176
    ds_write_b128 v84, v[136:139] offset:51200
    ds_write_b128 v84, v[140:143] offset:52224
    s_waitcnt vmcnt(12)
    s_barrier
    v_add_u32 v30, 0x20000, v92
    ds_read_b64_tr_b16 v[96:97], v30 offset:0
    ds_read_b64_tr_b16 v[98:99], v30 offset:512
    ds_read_b64_tr_b16 v[100:101], v30 offset:8192
    ds_read_b64_tr_b16 v[102:103], v30 offset:8704
    v_add_u32 v31, 0x20000, v93
    ds_read_b64_tr_b16 v[104:105], v31 offset:0
    ds_read_b64_tr_b16 v[106:107], v31 offset:512
    ds_read_b64_tr_b16 v[108:109], v31 offset:8192
    ds_read_b64_tr_b16 v[110:111], v31 offset:8704
    s_waitcnt lgkmcnt(0)
    ds_read_b64_tr_b16 v[112:113], v92 offset:0
    ds_read_b64_tr_b16 v[114:115], v92 offset:512
    ds_read_b64_tr_b16 v[116:117], v92 offset:8192
    ds_read_b64_tr_b16 v[118:119], v92 offset:8704
    ds_read_b64_tr_b16 v[120:121], v93 offset:0
    ds_read_b64_tr_b16 v[122:123], v93 offset:512
    ds_read_b64_tr_b16 v[124:125], v93 offset:8192
    ds_read_b64_tr_b16 v[126:127], v93 offset:8704
    s_waitcnt lgkmcnt(0)
    ds_read_b64_tr_b16 v[128:129], v92 offset:16384
    ds_read_b64_tr_b16 v[130:131], v92 offset:16896
    ds_read_b64_tr_b16 v[132:133], v92 offset:24576
    ds_read_b64_tr_b16 v[134:135], v92 offset:25088
    ds_read_b64_tr_b16 v[136:137], v93 offset:16384
    ds_read_b64_tr_b16 v[138:139], v93 offset:16896
    ds_read_b64_tr_b16 v[140:141], v93 offset:24576
    ds_read_b64_tr_b16 v[142:143], v93 offset:25088
    s_waitcnt lgkmcnt(0)
    s_barrier
    ds_write_b128 v85, v[96:99] offset:0
    ds_write_b128 v85, v[100:103] offset:1024
    ds_write_b128 v85, v[104:107] offset:2048
    ds_write_b128 v85, v[108:111] offset:3072
    ds_write_b128 v83, v[112:115] offset:0
    ds_write_b128 v83, v[116:119] offset:1024
    ds_write_b128 v83, v[120:123] offset:2048
    ds_write_b128 v83, v[124:127] offset:3072
    ds_write_b128 v83, v[128:131] offset:16384
    ds_write_b128 v83, v[132:135] offset:17408
    ds_write_b128 v83, v[136:139] offset:18432
    ds_write_b128 v83, v[140:143] offset:19456
    s_waitcnt vmcnt(0)
    s_barrier
    ds_read_b64_tr_b16 v[96:97], v92 offset:32768
    ds_read_b64_tr_b16 v[98:99], v92 offset:33280
    ds_read_b64_tr_b16 v[100:101], v92 offset:40960
    ds_read_b64_tr_b16 v[102:103], v92 offset:41472
    ds_read_b64_tr_b16 v[104:105], v93 offset:32768
    ds_read_b64_tr_b16 v[106:107], v93 offset:33280
    ds_read_b64_tr_b16 v[108:109], v93 offset:40960
    ds_read_b64_tr_b16 v[110:111], v93 offset:41472
    s_waitcnt lgkmcnt(0)
    ds_read_b64_tr_b16 v[112:113], v92 offset:49152
    ds_read_b64_tr_b16 v[114:115], v92 offset:49664
    ds_read_b64_tr_b16 v[116:117], v92 offset:57344
    ds_read_b64_tr_b16 v[118:119], v92 offset:57856
    ds_read_b64_tr_b16 v[120:121], v93 offset:49152
    ds_read_b64_tr_b16 v[122:123], v93 offset:49664
    ds_read_b64_tr_b16 v[124:125], v93 offset:57344
    ds_read_b64_tr_b16 v[126:127], v93 offset:57856
    s_waitcnt lgkmcnt(0)
    v_add_u32 v30, 0x10000, v92
    ds_read_b64_tr_b16 v[128:129], v30 offset:0
    ds_read_b64_tr_b16 v[130:131], v30 offset:512
    ds_read_b64_tr_b16 v[132:133], v30 offset:8192
    ds_read_b64_tr_b16 v[134:135], v30 offset:8704
    v_add_u32 v31, 0x10000, v93
    ds_read_b64_tr_b16 v[136:137], v31 offset:0
    ds_read_b64_tr_b16 v[138:139], v31 offset:512
    ds_read_b64_tr_b16 v[140:141], v31 offset:8192
    ds_read_b64_tr_b16 v[142:143], v31 offset:8704
    s_waitcnt lgkmcnt(0)
    s_barrier
    ds_write_b128 v83, v[96:99] offset:32768
    ds_write_b128 v83, v[100:103] offset:33792
    ds_write_b128 v83, v[104:107] offset:34816
    ds_write_b128 v83, v[108:111] offset:35840
    ds_write_b128 v83, v[112:115] offset:49152
    ds_write_b128 v83, v[116:119] offset:50176
    ds_write_b128 v83, v[120:123] offset:51200
    ds_write_b128 v83, v[124:127] offset:52224
    ds_write_b128 v84, v[128:131] offset:0
    ds_write_b128 v84, v[132:135] offset:1024
    ds_write_b128 v84, v[136:139] offset:2048
    ds_write_b128 v84, v[140:143] offset:3072
    v_mov_b32 v86, 0
    s_mov_b32 s51, 0x100000
ch_tpoll:
    buffer_load_dword v88, v86, s[36:39], 0 offen offset:4 sc1
    s_waitcnt vmcnt(0)
    v_readfirstlane_b32 s44, v88
    s_sub_u32 s51, s51, 1
    s_cbranch_scc1 ch_end
    s_and_b32 s45, s44, 0xffff
    s_cmp_lt_u32 s45, 32
    s_cbranch_scc1 ch_tpoll
    s_lshr_b32 s5, s44, 16
    s_mov_b32 s56, 0
    s_mov_b32 s57, 0
    s_lshl_b32 s58, s4, 7
    s_mov_b32 s59, 0x40000
chp_kp:
    v_lshrrev_b32 v20, 2, v1
    v_and_b32 v20, 63, v20
    buffer_load_dword v21, v20, s[96:99], s58 offen sc1
    s_waitcnt vmcnt(0)
    v_subrev_u32 v21, s101, v21
    v_cmp_lt_u32 vcc, 16, v21
    s_nop 1
    v_cndmask_b32 v21, v21, 0, vcc
    s_nop 1
    v_min_u32_dpp v21, v21, v21 quad_perm:[1,0,3,2] row_mask:0xf bank_mask:0xf
    s_nop 1
    v_min_u32_dpp v21, v21, v21 quad_perm:[2,3,0,1] row_mask:0xf bank_mask:0xf
    s_nop 1
    v_min_u32_dpp v21, v21, v21 row_half_mirror row_mask:0xf bank_mask:0xf
    s_nop 1
    v_min_u32_dpp v21, v21, v21 row_mirror row_mask:0xf bank_mask:0xf
    s_nop 0
    v_readfirstlane_b32 s57, v21
    s_lshl_b32 s57, s57, 2
    s_sub_u32 s59, s59, 1
    s_cbranch_scc1 chp_kd
    s_cmp_ge_u32 s56, s57
    s_cbranch_scc1 chp_kp
chp_kd:
    buffer_load_dwordx4 v[48:51], v1, s[20:23], s41 offen offset:0 sc1
    buffer_load_dwordx4 v[52:55], v1, s[20:23], s41 offen offset:1024 sc1
    buffer_load_dwordx4 v[32:35], v1, s[24:27], s41 offen offset:0 sc1
    buffer_load_dwordx4 v[36:39], v1, s[24:27], s41 offen offset:1024 sc1
    s_add_u32 s41, s41, 0x40000
    s_mov_b32 s56, 1
    s_waitcnt vmcnt(0)
    s_mov_b32 s51, 0x40000
    s_mov_b32 s40, 63
    s_movk_i32 s45, 0x1000
    s_mov_b32 s48, 0
    s_mov_b32 s60, 0x3e0293ee
    s_waitcnt lgkmcnt(0)
    v_mov_b32 v56, 0
    v_mov_b32 v57, 0
    v_mov_b32 v58, 0
    v_mov_b32 v59, 0
    v_mov_b32 v60, 0
    v_mov_b32 v61, 0
    v_mov_b32 v62, 0
    v_mov_b32 v63, 0
    v_mov_b32 v64, 0
    v_mov_b32 v65, 0
    v_mov_b32 v66, 0
    v_mov_b32 v67, 0
    v_mov_b32 v68, 0
    v_mov_b32 v69, 0
    v_mov_b32 v70, 0
    v_mov_b32 v71, 0
    v_mov_b32 v72, 0
    v_mov_b32 v73, 0
    v_mov_b32 v74, 0
    v_mov_b32 v75, 0
    v_mov_b32 v76, 0
    v_mov_b32 v77, 0
    v_mov_b32 v78, 0
    v_mov_b32 v79, 0
    v_mov_b32 v40, v32
    v_mov_b32 v41, v33
    v_mov_b32 v42, v34
    v_mov_b32 v43, v35
    v_mov_b32 v44, v36
    v_mov_b32 v45, v37
    v_mov_b32 v46, v38
    v_mov_b32 v47, v39
    s_cmp_lg_u32 s5, 0
    s_cbranch_scc1 ch_slow
    s_cmp_eq_u32 s3, 0
    s_cbranch_scc1 ch_ent_0_0
    s_cmp_eq_u32 s3, 1
    s_cbranch_scc1 ch_ent_0_1
    s_cmp_eq_u32 s3, 2
    s_cbranch_scc1 ch_ent_0_2
    s_branch ch_ent_0_3
ch_slow:
    s_cmp_eq_u32 s3, 0
    s_cbranch_scc1 ch_ent_1_0
    s_cmp_eq_u32 s3, 1
    s_cbranch_scc1 ch_ent_1_1
    s_cmp_eq_u32 s3, 2
    s_cbranch_scc1 ch_ent_1_2
    s_branch ch_ent_1_3
    .p2align 6
ch_loop_0_0:
    v_lshrrev_b32 v30, 1, v1
    v_mov_b64 v[32:33], v[68:69]
    v_mov_b64 v[34:35], v[70:71]
    v_mov_b64 v[36:37], v[64:65]
    v_mov_b64 v[64:65], 0
    v_mov_b64 v[66:67], 0
    v_mov_b64 v[68:69], 0
    v_mov_b64 v[70:71], 0
    v_mov_b64 v[56:57], 0
    v_mov_b64 v[58:59], 0
    v_mov_b64 v[60:61], 0
    v_mov_b64 v[62:63], 0
    v_mov_b64 v[72:73], 0
    v_mov_b64 v[74:75], 0
    v_mov_b64 v[76:77], 0
    v_mov_b64 v[78:79], 0
    s_nop 13
    buffer_load_dwordx4 v[80:83], v1, s[16:19], 0 offen offset:0 sc1
    buffer_load_dwordx4 v[84:87], v1, s[16:19], 0 offen offset:1024 sc1
    s_nop 15
    s_nop 8
    buffer_load_dwordx4 v[20:23], v1, s[16:19], 0 offen offset:0 sc1
    buffer_load_dwordx4 v[24:27], v1, s[16:19], 0 offen offset:1024 sc1
    s_waitcnt lgkmcnt(0)
ch00_POLL:
    s_waitcnt vmcnt(2)
    v_bitop3_b32 v31, v80, v84, s48 bitop3:0x7e
    v_and_b32 v31, 1, v31
    v_cmp_ne_u32 vcc, 0, v31
    ds_write_b128 v16, v[80:83] offset:20480
    ds_write_b128 v16, v[84:87] offset:21504
    s_cbranch_vccz ch00_H0
    buffer_load_dwordx4 v[80:83], v1, s[16:19], 0 offen offset:0 sc1
    buffer_load_dwordx4 v[84:87], v1, s[16:19], 0 offen offset:1024 sc1
    s_waitcnt vmcnt(2)
    v_bitop3_b32 v31, v20, v24, s48 bitop3:0x7e
    v_and_b32 v31, 1, v31
    v_cmp_ne_u32 vcc, 0, v31
    ds_write_b128 v16, v[20:23] offset:20480
    ds_write_b128 v16, v[24:27] offset:21504
    s_cbranch_vccz ch00_HB
    buffer_load_dwordx4 v[20:23], v1, s[16:19], 0 offen offset:0 sc1
    buffer_load_dwordx4 v[24:27], v1, s[16:19], 0 offen offset:1024 sc1
    s_sub_u32 s51, s51, 1
    s_cbranch_scc0 ch00_POLL
    s_mov_b32 s51, 0
ch00_HB:
    v_mov_b64 v[80:81], v[20:21]
    v_mov_b64 v[82:83], v[22:23]
    v_mov_b64 v[84:85], v[24:25]
    v_mov_b64 v[86:87], v[26:27]
    s_nop 0
ch00_H0:
    v_smfmac_f32_16x16x64_bf16 v[56:59], v[80:83], v[112:119], v0
    ds_read_b128 v[112:115], v17 offset:49152
    v_smfmac_f32_16x16x64_bf16 v[60:63], v[80:83], v[120:127], v0
    ds_read_b128 v[116:119], v17 offset:50176
    v_smfmac_f32_16x16x64_bf16 v[56:59], v[84:87], a[16:23], v0
    ds_read_b128 v[120:123], v17 offset:51200
    v_smfmac_f32_16x16x64_bf16 v[60:63], v[84:87], a[24:31], v0
    ds_read_b128 v[124:127], v17 offset:52224
    s_waitcnt lgkmcnt(4)
    s_barrier
    ds_read_b128 v[88:91], v16 offset:22528
    ds_read_b128 v[92:95], v16 offset:23552
    ds_read_b128 v[96:99], v16 offset:24576
    ds_read_b128 v[100:103], v16 offset:25600
    ds_read_b128 v[104:107], v16 offset:26624
    ds_read_b128 v[108:111], v16 offset:27648
    v_mov_b32 v29, s47
    buffer_store_dword v29, v7, s[96:99], s49 offen sc1
    s_add_u32 s47, s47, 1
    s_cmp_lt_u32 s56, s57
    s_cbranch_scc0 ch00_KVW
ch00_KVOK:
    s_add_u32 s56, s56, 1
    v_smfmac_f32_16x16x64_bf16 v[64:67], v[80:83], a[0:7], v0
    v_smfmac_f32_16x16x64_bf16 v[68:71], v[80:83], a[8:15], v0
    v_smfmac_f32_16x16x64_bf16 v[64:67], v[84:87], v[128:135], v0
    ds_read_b128 v[128:131], v16 offset:0
    v_smfmac_f32_16x16x64_bf16 v[68:71], v[84:87], v[136:143], v0
    ds_read_b128 v[132:135], v16 offset:1024
    s_waitcnt lgkmcnt(7)
    v_smfmac_f32_16x16x64_bf16 v[56:59], v[88:91], a[32:39], v0
    ds_read_b128 v[136:139], v16 offset:2048
    v_smfmac_f32_16x16x64_bf16 v[60:63], v[88:91], a[40:47], v0
    ds_read_b128 v[140:143], v16 offset:3072
    buffer_store_dwordx4 v[32:35], v1, s[28:31], s42 offen sc1
    s_waitcnt lgkmcnt(8)
    v_smfmac_f32_16x16x64_bf16 v[56:59], v[92:95], v[112:119], v0
    ds_read_b128 v[112:115], v1 offset:0
    v_smfmac_f32_16x16x64_bf16 v[60:63], v[92:95], v[120:127], v0
    ds_read_b128 v[116:119], v1 offset:1024
    buffer_store_dwordx2 v[36:37], v30, s[32:35], s43 offen sc1
    s_add_u32 s42, s42, 0x20000
    s_add_u32 s43, s43, 0x10000
    v_smfmac_f32_16x16x64_bf16 v[64:67], v[88:91], a[48:55], v0
    ds_read_b128 v[120:123], v1 offset:2048
    v_smfmac_f32_16x16x64_bf16 v[68:71], v[88:91], a[56:63], v0
    ds_read_b128 v[124:127], v1 offset:3072
    s_waitcnt lgkmcnt(11)
    v_smfmac_f32_16x16x64_bf16 v[56:59], v[96:99], a[80:87], v0
    v_smfmac_f32_16x16x64_bf16 v[60:63], v[96:99], a[88:95], v0
    v_smfmac_f32_16x16x64_bf16 v[64:67], v[92:95], a[64:71], v0
    v_smfmac_f32_16x16x64_bf16 v[68:71], v[92:95], a[72:79], v0
    s_waitcnt lgkmcnt(10)
    v_smfmac_f32_16x16x64_bf16 v[56:59], v[100:103], a[96:103], v0
    v_smfmac_f32_16x16x64_bf16 v[60:63], v[100:103], a[104:111], v0
    s_waitcnt lgkmcnt(4)
    v_smfmac_f32_16x16x64_bf16 v[64:67], v[96:99], v[128:135], v0
    ds_read_b128 v[128:131], v1 offset:16384
    v_smfmac_f32_16x16x64_bf16 v[68:71], v[96:99], v[136:143], v0
    ds_read_b128 v[132:135], v1 offset:17408
    s_waitcnt lgkmcnt(2)
    v_smfmac_f32_16x16x64_bf16 v[56:59], v[104:107], v[112:119], v0
    ds_read_b128 v[136:139], v1 offset:18432
    v_smfmac_f32_16x16x64_bf16 v[60:63], v[104:107], v[120:127], v0
    ds_read_b128 v[140:143], v1 offset:19456
    v_smfmac_f32_16x16x64_bf16 v[64:67], v[100:103], a[112:119], v0
    ds_read_b128 v[112:115], v1 offset:32768
    v_smfmac_f32_16x16x64_bf16 v[68:71], v[100:103], a[120:127], v0
    ds_read_b128 v[116:119], v1 offset:33792
    v_smfmac_f32_16x16x64_bf16 v[56:59], v[108:111], a[144:151], v0
    ds_read_b128 v[120:123], v1 offset:34816
    v_smfmac_f32_16x16x64_bf16 v[60:63], v[108:111], a[152:159], v0
    ds_read_b128 v[124:127], v1 offset:35840
    v_smfmac_f32_16x16x64_bf16 v[64:67], v[104:107], a[128:135], v0
    v_smfmac_f32_16x16x64_bf16 v[68:71], v[104:107], a[136:143], v0
    s_waitcnt lgkmcnt(4)
    v_smfmac_f32_16x16x64_bf16 v[64:67], v[108:111], v[128:135], v0
    ds_read_b128 v[128:131], v1 offset:49152
    v_add_f32 v56, v56, v58
    v_smfmac_f32_16x16x64_bf16 v[68:71], v[108:111], v[136:143], v0
    ds_read_b128 v[132:135], v1 offset:50176
    v_add_f32 v57, v57, v59
ch00_QKOK:
    s_waitcnt vmcnt(3)
    v_add_f32 v60, v60, v62
    v_add_f32 v61, v61, v63
    v_cvt_pk_bf16_f32 v20, v56, v57
    v_cvt_pk_bf16_f32 v22, v60, v61
    v_add_f32 v64, v64, v66
    v_add_f32 v65, v65, v67
    v_cvt_pk_bf16_f32 v21, v64, v65
    v_add_f32 v68, v68, v70
    v_add_f32 v69, v69, v71
    v_mfma_f32_16x16x16_bf16 v[64:67], v[20:21], v[4:5], 0
    v_cvt_pk_bf16_f32 v23, v68, v69
    buffer_load_dwordx4 v[32:35], v1, s[24:27], s41 offen offset:0 sc1
    buffer_load_dwordx4 v[36:39], v1, s[24:27], s41 offen offset:1024 sc1
    v_mfma_f32_16x16x16_bf16 v[68:71], v[22:23], v[4:5], 0
    v_smfmac_f32_16x16x64_bf16 v[72:75], v[80:83], a[160:167], v0
    ds_read_b128 v[136:139], v1 offset:51200
    s_nop 0
    v_cvt_pk_bf16_f32 v56, v64, v65
    v_cvt_pk_bf16_f32 v57, v66, v67
    s_nop 0
    v_cvt_pk_bf16_f32 v58, v68, v69
    v_cvt_pk_bf16_f32 v59, v70, v71
    s_nop 1
    v_mfma_f32_16x16x32_bf16 v[68:71], v[56:59], v[56:59], 0
    v_mfma_f32_16x16x32_bf16 v[64:67], v[52:55], v[56:59], 0
    v_mfma_f32_16x16x32_bf16 v[60:63], v[48:51], v[56:59], 0
    buffer_load_dwordx4 v[48:51], v1, s[20:23], s41 offen offset:0 sc1
    buffer_load_dwordx4 v[52:55], v1, s[20:23], s41 offen offset:1024 sc1
    ds_write_b64 v13, v[70:71]
    v_smfmac_f32_16x16x64_bf16 v[76:79], v[80:83], a[168:175], v0
    ds_read_b128 v[140:143], v1 offset:52224
    s_mov_b32 vcc_lo, 0x33333333
    s_mov_b32 vcc_hi, 0x33333333
    s_nop 1
    v_cndmask_b32_dpp v60, v64, v60, vcc quad_perm:[0,1,0,1] row_mask:0xf bank_mask:0xf
    v_cndmask_b32_dpp v61, v65, v61, vcc quad_perm:[0,1,0,1] row_mask:0xf bank_mask:0xf
    v_cndmask_b32_dpp v62, v66, v62, vcc quad_perm:[0,1,0,1] row_mask:0xf bank_mask:0xf
    v_cndmask_b32_dpp v63, v67, v63, vcc quad_perm:[0,1,0,1] row_mask:0xf bank_mask:0xf
    ds_write_b128 v16, v[60:63] offset:16384
    s_waitcnt lgkmcnt(6)
    v_smfmac_f32_16x16x64_bf16 v[72:75], v[84:87], v[112:119], v0
    ds_read_b128 v[112:115], v17 offset:0
    v_smfmac_f32_16x16x64_bf16 v[76:79], v[84:87], v[120:127], v0
    ds_read_b128 v[116:119], v17 offset:1024
    v_smfmac_f32_16x16x64_bf16 v[72:75], v[88:91], a[176:183], v0
    ds_read_b128 v[120:123], v17 offset:2048
    v_smfmac_f32_16x16x64_bf16 v[76:79], v[88:91], a[184:191], v0
    ds_read_b128 v[124:127], v17 offset:3072
    v_smfmac_f32_16x16x64_bf16 v[72:75], v[92:95], a[192:199], v0
    v_smfmac_f32_16x16x64_bf16 v[76:79], v[92:95], a[200:207], v0
    s_waitcnt lgkmcnt(0)
    s_barrier
    ds_read_b128 v[20:23], v16 offset:17408
    ds_read_b128 v[24:27], v16 offset:18432
    ds_read_b128 v[64:67], v16 offset:19456
    ds_read2st64_b32 v[68:69], v14 offset0:0 offset1:1
    ds_read2st64_b32 v[70:71], v14 offset0:2 offset1:3
    v_smfmac_f32_16x16x64_bf16 v[72:75], v[96:99], v[128:135], v0
    v_smfmac_f32_16x16x64_bf16 v[76:79], v[96:99], v[136:143], v0
    v_smfmac_f32_16x16x64_bf16 v[72:75], v[100:103], a[208:215], v0
    v_smfmac_f32_16x16x64_bf16 v[76:79], v[100:103], a[216:223], v0
    s_waitcnt lgkmcnt(3)
    v_add_f32 v60, v60, v20
    v_add_f32 v61, v61, v21
    v_add_f32 v62, v62, v22
    v_add_f32 v63, v63, v23
    s_waitcnt lgkmcnt(2)
    v_pk_add_f32 v[24:25], v[24:25], v[64:65]
    v_pk_add_f32 v[26:27], v[26:27], v[66:67]
    s_waitcnt lgkmcnt(0)
    v_pk_add_f32 v[68:69], v[68:69], v[70:71]
    v_pk_add_f32 v[60:61], v[60:61], v[24:25]
    v_pk_add_f32 v[62:63], v[62:63], v[26:27]
    v_add_f32 v68, v68, v69
    v_max3_f32 v20, v60, v61, v62
    v_max3_f32 v20, v20, v63, v68
    v_smfmac_f32_16x16x64_bf16 v[72:75], v[104:107], a[224:231], v0
    s_nop 0
    v_max_f32_dpp v22, v20, v20 quad_perm:[2,3,0,1] row_mask:0xf bank_mask:0xf
    v_max_f32_dpp v23, v20, v20 quad_perm:[2,3,0,1] row_mask:0xf bank_mask:0xf
    v_smfmac_f32_16x16x64_bf16 v[76:79], v[104:107], a[232:239], v0
    s_nop 0
    v_permlane16_swap_b32 v22, v23
    v_max_f32 v20, v22, v23
    v_max_f32 v21, v22, v23
    v_smfmac_f32_16x16x64_bf16 v[72:75], v[108:111], v[112:119], v0
    s_nop 0
    v_permlane32_swap_b32 v20, v21
    v_max_f32 v20, v20, v21
    v_smfmac_f32_16x16x64_bf16 v[76:79], v[108:111], v[120:127], v0
    v_mul_f32 v20, s60, v20
    v_fma_f32 v60, v60, s60, -v20
    v_fma_f32 v61, v61, s60, -v20
    v_fma_f32 v62, v62, s60, -v20
    v_fma_f32 v63, v63, s60, -v20
    v_fma_f32 v68, v68, s60, -v20
    v_exp_f32 v60, v60
    v_exp_f32 v61, v61
    v_exp_f32 v62, v62
    v_exp_f32 v63, v63
    v_exp_f32 v68, v68
    v_cvt_pk_bf16_f32 v20, v60, v61
    v_cvt_pk_bf16_f32 v21, v62, v63
    v_pk_add_f32 v[28:29], v[60:61], v[62:63]
    v_mov_b32_dpp v24, v20 quad_perm:[0,1,0,1] row_mask:0xf bank_mask:0xf
    v_mov_b32_dpp v25, v21 quad_perm:[0,1,0,1] row_mask:0xf bank_mask:0xf
    v_mov_b32_dpp v26, v20 quad_perm:[2,3,2,3] row_mask:0xf bank_mask:0xf
    v_mov_b32_dpp v27, v21 quad_perm:[2,3,2,3] row_mask:0xf bank_mask:0xf
    v_pk_add_f32 v[72:73], v[72:73], v[74:75]
    v_pk_add_f32 v[76:77], v[76:77], v[78:79]
    v_mfma_f32_16x16x32_bf16 v[60:63], v[40:43], v[24:27], 0
    v_mov_b32_dpp v30, v68 quad_perm:[0,1,0,1] row_mask:0xf bank_mask:0xf
    v_mov_b32_dpp v31, v68 quad_perm:[2,3,2,3] row_mask:0xf bank_mask:0xf
    v_mfma_f32_16x16x32_bf16 v[20:23], v[44:47], v[24:27], 0
    v_add_f32 v28, v28, v29
    v_cvt_pk_bf16_f32 v6, v30, v31
    v_add_f32 v68, v68, v28
    v_cvt_pk_bf16_f32 v64, v72, v73
    v_cvt_pk_bf16_f32 v65, v76, v77
    v_add_f32_dpp v28, v68, v68 quad_perm:[2,3,0,1] row_mask:0xf bank_mask:0xf
    v_add_f32_dpp v29, v68, v68 quad_perm:[2,3,0,1] row_mask:0xf bank_mask:0xf
    v_mfma_f32_16x16x16_bf16 v[60:63], v[64:65], v[6:7], v[60:63]
    v_cvt_pk_bf16_f32 v66, v76, v77
    v_mov_b32 v67, 0
    v_permlane16_swap_b32 v28, v29
    v_add_f32 v68, v28, v29
    v_mfma_f32_16x16x16_bf16 v[20:23], v[66:67], v[6:7], v[20:23]
    v_add_f32 v69, v28, v29
    v_mov_b64 v[80:81], 0
    v_mov_b64 v[82:83], 0
    v_permlane32_swap_b32 v68, v69
    v_add_f32 v68, v68, v69
    v_rcp_f32 v68, v68
    v_mov_b64 v[84:85], 0
    v_pk_mul_f32 v[60:61], v[60:61], v[68:69] op_sel_hi:[1,0]
    v_pk_mul_f32 v[62:63], v[62:63], v[68:69] op_sel_hi:[1,0]
    v_pk_mul_f32 v[20:21], v[20:21], v[68:69] op_sel_hi:[1,0]
    v_pk_mul_f32 v[22:23], v[22:23], v[68:69] op_sel_hi:[1,0]
    v_cvt_pk_bf16_f32 v24, v60, v61
    v_cvt_pk_bf16_f32 v25, v62, v63
    v_cvt_pk_bf16_f32 v26, v20, v21
    v_cvt_pk_bf16_f32 v27, v22, v23
    ds_write_b128 v15, v[24:27] offset:0
    v_mov_b64 v[86:87], 0
    v_smfmac_f32_16x16x64_bf16 v[80:83], v[24:27], a[240:247], v0
    v_mov_b64 v[88:89], 0
    v_mov_b64 v[90:91], 0
    v_smfmac_f32_16x16x64_bf16 v[84:87], v[24:27], v[160:167], v0
    v_mov_b64 v[92:93], 0
    v_mov_b64 v[94:95], 0
    v_mov_b64 v[68:69], v[56:57]
    v_smfmac_f32_16x16x64_bf16 v[88:91], v[24:27], v[192:199], v0
    v_mov_b64 v[70:71], v[58:59]
    s_sub_u32 s40, s40, 1
    s_cbranch_scc1 ch_fin
    s_waitcnt lgkmcnt(0)
    s_barrier
    ds_read_b128 v[72:75], v15 offset:512
    ds_read_b128 v[76:79], v15 offset:1024
    ds_read_b128 v[60:63], v15 offset:1536
    v_smfmac_f32_16x16x64_bf16 v[92:95], v[24:27], v[224:231], v0
    s_add_u32 s41, s41, 0x40000
    s_waitcnt lgkmcnt(2)
    v_smfmac_f32_16x16x64_bf16 v[80:83], v[72:75], a[248:255], v0
    s_waitcnt lgkmcnt(1)
    v_smfmac_f32_16x16x64_bf16 v[80:83], v[76:79], v[144:151], v0
    s_waitcnt lgkmcnt(0)
    v_smfmac_f32_16x16x64_bf16 v[80:83], v[60:63], v[152:159], v0
    v_smfmac_f32_16x16x64_bf16 v[84:87], v[72:75], v[168:175], v0
    v_smfmac_f32_16x16x64_bf16 v[84:87], v[76:79], v[176:183], v0
    v_cvt_pk_bf16_f32 v80, v80, v81
    v_bfi_b32 v80, v18, s48, v80
    buffer_store_dword v80, v2, s[12:15], s52 offen offset:0
    v_smfmac_f32_16x16x64_bf16 v[84:87], v[60:63], v[184:191], v0
    v_cvt_pk_bf16_f32 v82, v82, v83
    v_bfi_b32 v82, v18, s48, v82
    buffer_store_dword v82, v2, s[12:15], s52 offen offset:2048
    v_smfmac_f32_16x16x64_bf16 v[88:91], v[72:75], v[200:207], v0
    v_smfmac_f32_16x16x64_bf16 v[88:91], v[76:79], v[208:215], v0
    v_cvt_pk_bf16_f32 v84, v84, v85
    v_bfi_b32 v84, v18, s48, v84
    buffer_store_dword v84, v2, s[12:15], s53 offen offset:0
    v_smfmac_f32_16x16x64_bf16 v[88:91], v[60:63], v[216:223], v0
    v_cvt_pk_bf16_f32 v86, v86, v87
    v_bfi_b32 v86, v18, s48, v86
    buffer_store_dword v86, v2, s[12:15], s53 offen offset:2048
    v_smfmac_f32_16x16x64_bf16 v[92:95], v[72:75], v[232:239], v0
    v_smfmac_f32_16x16x64_bf16 v[92:95], v[76:79], v[240:247], v0
    v_cvt_pk_bf16_f32 v88, v88, v89
    v_bfi_b32 v88, v18, s48, v88
    buffer_store_dword v88, v2, s[12:15], s54 offen offset:0
    v_smfmac_f32_16x16x64_bf16 v[92:95], v[60:63], v[248:255], v0
    v_cvt_pk_bf16_f32 v90, v90, v91
    v_bfi_b32 v90, v18, s48, v90
    buffer_store_dword v90, v2, s[12:15], s54 offen offset:2048
    s_nop 3
    v_cvt_pk_bf16_f32 v92, v92, v93
    v_bfi_b32 v92, v18, s48, v92
    buffer_store_dword v92, v2, s[12:15], s55 offen offset:0
    v_cvt_pk_bf16_f32 v94, v94, v95
    v_bfi_b32 v94, v18, s48, v94
    buffer_store_dword v94, v2, s[12:15], s55 offen offset:2048
    ds_read_b128 v[112:115], v17 offset:16384
    ds_read_b128 v[116:119], v17 offset:17408
    ds_read_b128 v[120:123], v17 offset:18432
    ds_read_b128 v[124:127], v17 offset:19456
    ds_read_b128 v[128:131], v17 offset:32768
    ds_read_b128 v[132:135], v17 offset:33792
    ds_read_b128 v[136:139], v17 offset:34816
    ds_read_b128 v[140:143], v17 offset:35840
    s_nop 15
    s_nop 0
    buffer_load_dwordx4 v[56:59], v12, s[12:15], s50 offen offset:0 sc1
    buffer_load_dwordx4 v[60:63], v12, s[12:15], s50 offen offset:1024 sc1
ch00_RC:
    s_waitcnt vmcnt(1)
    v_mfma_f32_16x16x32_bf16 v[28:31], v[56:59], v[8:11], 0
    s_waitcnt vmcnt(0)
    v_mfma_f32_16x16x32_bf16 v[28:31], v[60:63], v[8:11], v[28:31]
    v_bitop3_b32 v24, v56, v60, s48 bitop3:0x7e
    v_and_b32 v24, 1, v24
    v_cmp_ne_u32 vcc, 0, v24
    s_nop 3
    s_cbranch_vccz ch00_ROK
    buffer_load_dwordx4 v[56:59], v12, s[12:15], s50 offen offset:0 sc1
    buffer_load_dwordx4 v[60:63], v12, s[12:15], s50 offen offset:1024 sc1
    s_sub_u32 s51, s51, 1
    s_cbranch_scc0 ch00_RC
    s_mov_b32 s51, 0
    s_waitcnt vmcnt(0)
ch00_ROK:
    v_pk_add_f32 v[28:29], v[28:29], v[30:31]
    s_not_b32 s48, s48
    v_add_f32 v28, v28, v29
    v_cvt_pk_bf16_f32 v28, v28, v28
    v_bfi_b32 v28, v19, s48, v28
    buffer_store_short v28, v3, s[16:19], 0 offen
    v_mov_b64 v[40:41], v[32:33]
    v_mov_b64 v[42:43], v[34:35]
    v_mov_b64 v[44:45], v[36:37]
    v_mov_b64 v[46:47], v[38:39]
    s_branch ch_loop_0_0
ch_ent_0_0:
    ds_read_b128 v[112:115], v17 offset:16384
    ds_read_b128 v[116:119], v17 offset:17408
    ds_read_b128 v[120:123], v17 offset:18432
    ds_read_b128 v[124:127], v17 offset:19456
    ds_read_b128 v[128:131], v17 offset:32768
    ds_read_b128 v[132:135], v17 offset:33792
    ds_read_b128 v[136:139], v17 offset:34816
    ds_read_b128 v[140:143], v17 offset:35840
    s_branch ch_loop_0_0
ch00_KVW:
    s_cmp_ge_u32 s56, 64
    s_cbranch_scc1 ch00_KVOK
    s_mov_b32 s59, 0x40000
ch00_kp:
    v_lshrrev_b32 v20, 2, v1
    v_and_b32 v20, 63, v20
    buffer_load_dword v21, v20, s[96:99], s58 offen sc1
    s_waitcnt vmcnt(0)
    v_subrev_u32 v21, s101, v21
    v_cmp_lt_u32 vcc, 16, v21
    s_nop 1
    v_cndmask_b32 v21, v21, 0, vcc
    s_nop 1
    v_min_u32_dpp v21, v21, v21 quad_perm:[1,0,3,2] row_mask:0xf bank_mask:0xf
    s_nop 1
    v_min_u32_dpp v21, v21, v21 quad_perm:[2,3,0,1] row_mask:0xf bank_mask:0xf
    s_nop 1
    v_min_u32_dpp v21, v21, v21 row_half_mirror row_mask:0xf bank_mask:0xf
    s_nop 1
    v_min_u32_dpp v21, v21, v21 row_mirror row_mask:0xf bank_mask:0xf
    s_nop 0
    v_readfirstlane_b32 s57, v21
    s_lshl_b32 s57, s57, 2
    s_sub_u32 s59, s59, 1
    s_cbranch_scc1 ch00_kd
    s_cmp_ge_u32 s56, s57
    s_cbranch_scc1 ch00_kp
ch00_kd:
    s_branch ch00_KVOK
    .p2align 6
ch_loop_0_1:
    v_lshrrev_b32 v30, 1, v1
    v_mov_b64 v[32:33], v[68:69]
    v_mov_b64 v[34:35], v[70:71]
    v_mov_b64 v[36:37], v[64:65]
    v_mov_b64 v[64:65], 0
    v_mov_b64 v[66:67], 0
    v_mov_b64 v[68:69], 0
    v_mov_b64 v[70:71], 0
    v_mov_b64 v[56:57], 0
    v_mov_b64 v[58:59], 0
    v_mov_b64 v[60:61], 0
    v_mov_b64 v[62:63], 0
    v_mov_b64 v[72:73], 0
    v_mov_b64 v[74:75], 0
    v_mov_b64 v[76:77], 0
    v_mov_b64 v[78:79], 0
    s_nop 13
    buffer_load_dwordx4 v[88:91], v1, s[16:19], 0 offen offset:2048 sc1
    buffer_load_dwordx4 v[92:95], v1, s[16:19], 0 offen offset:3072 sc1
    s_nop 15
    s_nop 8
    buffer_load_dwordx4 v[20:23], v1, s[16:19], 0 offen offset:2048 sc1
    buffer_load_dwordx4 v[24:27], v1, s[16:19], 0 offen offset:3072 sc1
    s_waitcnt lgkmcnt(0)
ch01_POLL:
    s_waitcnt vmcnt(2)
    v_bitop3_b32 v31, v88, v92, s48 bitop3:0x7e
    v_and_b32 v31, 1, v31
    v_cmp_ne_u32 vcc, 0, v31
    ds_write_b128 v16, v[88:91] offset:22528
    ds_write_b128 v16, v[92:95] offset:23552
    s_cbranch_vccz ch01_H0
    buffer_load_dwordx4 v[88:91], v1, s[16:19], 0 offen offset:2048 sc1
    buffer_load_dwordx4 v[92:95], v1, s[16:19], 0 offen offset:3072 sc1
    s_waitcnt vmcnt(2)
    v_bitop3_b32 v31, v20, v24, s48 bitop3:0x7e
    v_and_b32 v31, 1, v31
    v_cmp_ne_u32 vcc, 0, v31
    ds_write_b128 v16, v[20:23] offset:22528
    ds_write_b128 v16, v[24:27] offset:23552
    s_cbranch_vccz ch01_HB
    buffer_load_dwordx4 v[20:23], v1, s[16:19], 0 offen offset:2048 sc1
    buffer_load_dwordx4 v[24:27], v1, s[16:19], 0 offen offset:3072 sc1
    s_sub_u32 s51, s51, 1
    s_cbranch_scc0 ch01_POLL
    s_mov_b32 s51, 0
ch01_HB:
    v_mov_b64 v[88:89], v[20:21]
    v_mov_b64 v[90:91], v[22:23]
    v_mov_b64 v[92:93], v[24:25]
    v_mov_b64 v[94:95], v[26:27]
    s_nop 0
ch01_H0:
    v_smfmac_f32_16x16x64_bf16 v[56:59], v[88:91], a[32:39], v0
    v_smfmac_f32_16x16x64_bf16 v[60:63], v[88:91], a[40:47], v0
    v_smfmac_f32_16x16x64_bf16 v[56:59], v[92:95], v[112:119], v0
    ds_read_b128 v[112:115], v17 offset:36864
    v_smfmac_f32_16x16x64_bf16 v[60:63], v[92:95], v[120:127], v0
    ds_read_b128 v[116:119], v17 offset:37888
    s_waitcnt lgkmcnt(2)
    s_barrier
    ds_read_b128 v[80:83], v16 offset:20480
    ds_read_b128 v[84:87], v16 offset:21504
    ds_read_b128 v[96:99], v16 offset:24576
    ds_read_b128 v[100:103], v16 offset:25600
    ds_read_b128 v[104:107], v16 offset:26624
    ds_read_b128 v[108:111], v16 offset:27648
    s_cmp_lt_u32 s56, s57
    s_cbranch_scc0 ch01_KVW
ch01_KVOK:
    s_add_u32 s56, s56, 1
    v_smfmac_f32_16x16x64_bf16 v[64:67], v[88:91], a[48:55], v0
    ds_read_b128 v[120:123], v17 offset:38912
    v_smfmac_f32_16x16x64_bf16 v[68:71], v[88:91], a[56:63], v0
    ds_read_b128 v[124:127], v17 offset:39936
    v_smfmac_f32_16x16x64_bf16 v[64:67], v[92:95], a[64:71], v0
    v_smfmac_f32_16x16x64_bf16 v[68:71], v[92:95], a[72:79], v0
    s_waitcnt lgkmcnt(7)
    v_smfmac_f32_16x16x64_bf16 v[56:59], v[80:83], v[128:135], v0
    ds_read_b128 v[128:131], v16 offset:4096
    v_smfmac_f32_16x16x64_bf16 v[60:63], v[80:83], v[136:143], v0
    ds_read_b128 v[132:135], v16 offset:5120
    s_waitcnt lgkmcnt(8)
    v_smfmac_f32_16x16x64_bf16 v[56:59], v[84:87], a[16:23], v0
    ds_read_b128 v[136:139], v16 offset:6144
    v_smfmac_f32_16x16x64_bf16 v[60:63], v[84:87], a[24:31], v0
    ds_read_b128 v[140:143], v16 offset:7168
    v_smfmac_f32_16x16x64_bf16 v[64:67], v[80:83], a[0:7], v0
    v_smfmac_f32_16x16x64_bf16 v[68:71], v[80:83], a[8:15], v0
    buffer_store_dwordx4 v[32:35], v1, s[28:31], s42 offen sc1
    s_waitcnt lgkmcnt(9)
    v_smfmac_f32_16x16x64_bf16 v[56:59], v[96:99], a[80:87], v0
    v_smfmac_f32_16x16x64_bf16 v[60:63], v[96:99], a[88:95], v0
    buffer_store_dwordx2 v[36:37], v30, s[32:35], s43 offen sc1
    s_add_u32 s42, s42, 0x20000
    s_add_u32 s43, s43, 0x10000
    s_waitcnt lgkmcnt(4)
    v_smfmac_f32_16x16x64_bf16 v[64:67], v[84:87], v[112:119], v0
    ds_read_b128 v[112:115], v1 offset:4096
    v_smfmac_f32_16x16x64_bf16 v[68:71], v[84:87], v[120:127], v0
    ds_read_b128 v[116:119], v1 offset:5120
    v_smfmac_f32_16x16x64_bf16 v[56:59], v[100:103], a[96:103], v0
    ds_read_b128 v[120:123], v1 offset:6144
    v_smfmac_f32_16x16x64_bf16 v[60:63], v[100:103], a[104:111], v0
    ds_read_b128 v[124:127], v1 offset:7168
    s_waitcnt lgkmcnt(4)
    v_smfmac_f32_16x16x64_bf16 v[64:67], v[96:99], v[128:135], v0
    ds_read_b128 v[128:131], v1 offset:20480
    v_smfmac_f32_16x16x64_bf16 v[68:71], v[96:99], v[136:143], v0
    ds_read_b128 v[132:135], v1 offset:21504
    s_waitcnt lgkmcnt(2)
    v_smfmac_f32_16x16x64_bf16 v[56:59], v[104:107], v[112:119], v0
    ds_read_b128 v[136:139], v1 offset:22528
    v_smfmac_f32_16x16x64_bf16 v[60:63], v[104:107], v[120:127], v0
    ds_read_b128 v[140:143], v1 offset:23552
    v_smfmac_f32_16x16x64_bf16 v[64:67], v[100:103], a[112:119], v0
    ds_read_b128 v[112:115], v1 offset:36864
    v_smfmac_f32_16x16x64_bf16 v[68:71], v[100:103], a[120:127], v0
    ds_read_b128 v[116:119], v1 offset:37888
    v_smfmac_f32_16x16x64_bf16 v[56:59], v[108:111], a[144:151], v0
    ds_read_b128 v[120:123], v1 offset:38912
    v_smfmac_f32_16x16x64_bf16 v[60:63], v[108:111], a[152:159], v0
    ds_read_b128 v[124:127], v1 offset:39936
    v_smfmac_f32_16x16x64_bf16 v[64:67], v[104:107], a[128:135], v0
    v_smfmac_f32_16x16x64_bf16 v[68:71], v[104:107], a[136:143], v0
    s_waitcnt lgkmcnt(4)
    v_smfmac_f32_16x16x64_bf16 v[64:67], v[108:111], v[128:135], v0
    ds_read_b128 v[128:131], v1 offset:53248
    v_add_f32 v56, v56, v58
    v_smfmac_f32_16x16x64_bf16 v[68:71], v[108:111], v[136:143], v0
    ds_read_b128 v[132:135], v1 offset:54272
    v_add_f32 v57, v57, v59
ch01_QKOK:
    s_waitcnt vmcnt(2)
    v_add_f32 v60, v60, v62
    v_add_f32 v61, v61, v63
    v_cvt_pk_bf16_f32 v20, v56, v57
    v_cvt_pk_bf16_f32 v22, v60, v61
    v_add_f32 v64, v64, v66
    v_add_f32 v65, v65, v67
    v_cvt_pk_bf16_f32 v21, v64, v65
    v_add_f32 v68, v68, v70
    v_add_f32 v69, v69, v71
    v_mfma_f32_16x16x16_bf16 v[64:67], v[20:21], v[4:5], 0
    v_cvt_pk_bf16_f32 v23, v68, v69
    buffer_load_dwordx4 v[32:35], v1, s[24:27], s41 offen offset:0 sc1
    buffer_load_dwordx4 v[36:39], v1, s[24:27], s41 offen offset:1024 sc1
    v_mfma_f32_16x16x16_bf16 v[68:71], v[22:23], v[4:5], 0
    v_smfmac_f32_16x16x64_bf16 v[72:75], v[80:83], a[160:167], v0
    ds_read_b128 v[136:139], v1 offset:55296
    s_nop 0
    v_cvt_pk_bf16_f32 v56, v64, v65
    v_cvt_pk_bf16_f32 v57, v66, v67
    s_nop 0
    v_cvt_pk_bf16_f32 v58, v68, v69
    v_cvt_pk_bf16_f32 v59, v70, v71
    s_nop 1
    v_mfma_f32_16x16x32_bf16 v[68:71], v[56:59], v[56:59], 0
    v_mfma_f32_16x16x32_bf16 v[64:67], v[52:55], v[56:59], 0
    v_mfma_f32_16x16x32_bf16 v[60:63], v[48:51], v[56:59], 0
    buffer_load_dwordx4 v[48:51], v1, s[20:23], s41 offen offset:0 sc1
    buffer_load_dwordx4 v[52:55], v1, s[20:23], s41 offen offset:1024 sc1
    ds_write_b64 v13, v[70:71]
    v_smfmac_f32_16x16x64_bf16 v[76:79], v[80:83], a[168:175], v0
    ds_read_b128 v[140:143], v1 offset:56320
    s_mov_b32 vcc_lo, 0x33333333
    s_mov_b32 vcc_hi, 0x33333333
    s_nop 1
    v_cndmask_b32_dpp v60, v64, v60, vcc quad_perm:[0,1,0,1] row_mask:0xf bank_mask:0xf
    v_cndmask_b32_dpp v61, v65, v61, vcc quad_perm:[0,1,0,1] row_mask:0xf bank_mask:0xf
    v_cndmask_b32_dpp v62, v66, v62, vcc quad_perm:[0,1,0,1] row_mask:0xf bank_mask:0xf
    v_cndmask_b32_dpp v63, v67, v63, vcc quad_perm:[0,1,0,1] row_mask:0xf bank_mask:0xf
    ds_write_b128 v16, v[60:63] offset:17408
    s_waitcnt lgkmcnt(6)
    v_smfmac_f32_16x16x64_bf16 v[72:75], v[84:87], v[112:119], v0
    ds_read_b128 v[112:115], v17 offset:4096
    v_smfmac_f32_16x16x64_bf16 v[76:79], v[84:87], v[120:127], v0
    ds_read_b128 v[116:119], v17 offset:5120
    v_smfmac_f32_16x16x64_bf16 v[72:75], v[88:91], a[176:183], v0
    ds_read_b128 v[120:123], v17 offset:6144
    v_smfmac_f32_16x16x64_bf16 v[76:79], v[88:91], a[184:191], v0
    ds_read_b128 v[124:127], v17 offset:7168
    v_smfmac_f32_16x16x64_bf16 v[72:75], v[92:95], a[192:199], v0
    v_smfmac_f32_16x16x64_bf16 v[76:79], v[92:95], a[200:207], v0
    s_waitcnt lgkmcnt(0)
    s_barrier
    ds_read_b128 v[20:23], v16 offset:16384
    ds_read_b128 v[24:27], v16 offset:18432
    ds_read_b128 v[64:67], v16 offset:19456
    ds_read2st64_b32 v[68:69], v14 offset0:0 offset1:1
    ds_read2st64_b32 v[70:71], v14 offset0:2 offset1:3
    v_smfmac_f32_16x16x64_bf16 v[72:75], v[96:99], v[128:135], v0
    v_smfmac_f32_16x16x64_bf16 v[76:79], v[96:99], v[136:143], v0
    v_smfmac_f32_16x16x64_bf16 v[72:75], v[100:103], a[208:215], v0
    v_smfmac_f32_16x16x64_bf16 v[76:79], v[100:103], a[216:223], v0
    s_waitcnt lgkmcnt(3)
    v_add_f32 v60, v60, v20
    v_add_f32 v61, v61, v21
    v_add_f32 v62, v62, v22
    v_add_f32 v63, v63, v23
    s_waitcnt lgkmcnt(2)
    v_pk_add_f32 v[24:25], v[24:25], v[64:65]
    v_pk_add_f32 v[26:27], v[26:27], v[66:67]
    s_waitcnt lgkmcnt(0)
    v_pk_add_f32 v[68:69], v[68:69], v[70:71]
    v_pk_add_f32 v[60:61], v[60:61], v[24:25]
    v_pk_add_f32 v[62:63], v[62:63], v[26:27]
    v_add_f32 v68, v68, v69
    v_max3_f32 v20, v60, v61, v62
    v_max3_f32 v20, v20, v63, v68
    v_smfmac_f32_16x16x64_bf16 v[72:75], v[104:107], a[224:231], v0
    s_nop 0
    v_max_f32_dpp v22, v20, v20 quad_perm:[2,3,0,1] row_mask:0xf bank_mask:0xf
    v_max_f32_dpp v23, v20, v20 quad_perm:[2,3,0,1] row_mask:0xf bank_mask:0xf
    v_smfmac_f32_16x16x64_bf16 v[76:79], v[104:107], a[232:239], v0
    s_nop 0
    v_permlane16_swap_b32 v22, v23
    v_max_f32 v20, v22, v23
    v_max_f32 v21, v22, v23
    v_smfmac_f32_16x16x64_bf16 v[72:75], v[108:111], v[112:119], v0
    s_nop 0
    v_permlane32_swap_b32 v20, v21
    v_max_f32 v20, v20, v21
    v_smfmac_f32_16x16x64_bf16 v[76:79], v[108:111], v[120:127], v0
    v_mul_f32 v20, s60, v20
    v_fma_f32 v60, v60, s60, -v20
    v_fma_f32 v61, v61, s60, -v20
    v_fma_f32 v62, v62, s60, -v20
    v_fma_f32 v63, v63, s60, -v20
    v_fma_f32 v68, v68, s60, -v20
    v_exp_f32 v60, v60
    v_exp_f32 v61, v61
    v_exp_f32 v62, v62
    v_exp_f32 v63, v63
    v_exp_f32 v68, v68
    v_cvt_pk_bf16_f32 v20, v60, v61
    v_cvt_pk_bf16_f32 v21, v62, v63
    v_pk_add_f32 v[28:29], v[60:61], v[62:63]
    v_mov_b32_dpp v24, v20 quad_perm:[0,1,0,1] row_mask:0xf bank_mask:0xf
    v_mov_b32_dpp v25, v21 quad_perm:[0,1,0,1] row_mask:0xf bank_mask:0xf
    v_mov_b32_dpp v26, v20 quad_perm:[2,3,2,3] row_mask:0xf bank_mask:0xf
    v_mov_b32_dpp v27, v21 quad_perm:[2,3,2,3] row_mask:0xf bank_mask:0xf
    v_pk_add_f32 v[72:73], v[72:73], v[74:75]
    v_pk_add_f32 v[76:77], v[76:77], v[78:79]
    v_mfma_f32_16x16x32_bf16 v[60:63], v[40:43], v[24:27], 0
    v_mov_b32_dpp v30, v68 quad_perm:[0,1,0,1] row_mask:0xf bank_mask:0xf
    v_mov_b32_dpp v31, v68 quad_perm:[2,3,2,3] row_mask:0xf bank_mask:0xf
    v_mfma_f32_16x16x32_bf16 v[20:23], v[44:47], v[24:27], 0
    v_add_f32 v28, v28, v29
    v_cvt_pk_bf16_f32 v6, v30, v31
    v_add_f32 v68, v68, v28
    v_cvt_pk_bf16_f32 v64, v72, v73
    v_cvt_pk_bf16_f32 v65, v76, v77
    v_add_f32_dpp v28, v68, v68 quad_perm:[2,3,0,1] row_mask:0xf bank_mask:0xf
    v_add_f32_dpp v29, v68, v68 quad_perm:[2,3,0,1] row_mask:0xf bank_mask:0xf
    v_mfma_f32_16x16x16_bf16 v[60:63], v[64:65], v[6:7], v[60:63]
    v_cvt_pk_bf16_f32 v66, v76, v77
    v_mov_b32 v67, 0
    v_permlane16_swap_b32 v28, v29
    v_add_f32 v68, v28, v29
    v_mfma_f32_16x16x16_bf16 v[20:23], v[66:67], v[6:7], v[20:23]
    v_add_f32 v69, v28, v29
    v_mov_b64 v[80:81], 0
    v_mov_b64 v[82:83], 0
    v_permlane32_swap_b32 v68, v69
    v_add_f32 v68, v68, v69
    v_rcp_f32 v68, v68
    v_mov_b64 v[84:85], 0
    v_pk_mul_f32 v[60:61], v[60:61], v[68:69] op_sel_hi:[1,0]
    v_pk_mul_f32 v[62:63], v[62:63], v[68:69] op_sel_hi:[1,0]
    v_pk_mul_f32 v[20:21], v[20:21], v[68:69] op_sel_hi:[1,0]
    v_pk_mul_f32 v[22:23], v[22:23], v[68:69] op_sel_hi:[1,0]
    v_cvt_pk_bf16_f32 v24, v60, v61
    v_cvt_pk_bf16_f32 v25, v62, v63
    v_cvt_pk_bf16_f32 v26, v20, v21
    v_cvt_pk_bf16_f32 v27, v22, v23
    ds_write_b128 v15, v[24:27] offset:512
    v_mov_b64 v[86:87], 0
    v_smfmac_f32_16x16x64_bf16 v[80:83], v[24:27], a[248:255], v0
    v_mov_b64 v[88:89], 0
    v_mov_b64 v[90:91], 0
    v_smfmac_f32_16x16x64_bf16 v[84:87], v[24:27], v[168:175], v0
    v_mov_b64 v[92:93], 0
    v_mov_b64 v[94:95], 0
    v_mov_b64 v[68:69], v[56:57]
    v_smfmac_f32_16x16x64_bf16 v[88:91], v[24:27], v[200:207], v0
    v_mov_b64 v[70:71], v[58:59]
    s_sub_u32 s40, s40, 1
    s_cbranch_scc1 ch_fin
    s_waitcnt lgkmcnt(0)
    s_barrier
    ds_read_b128 v[72:75], v15 offset:0
    ds_read_b128 v[76:79], v15 offset:1024
    ds_read_b128 v[60:63], v15 offset:1536
    v_smfmac_f32_16x16x64_bf16 v[92:95], v[24:27], v[232:239], v0
    s_add_u32 s41, s41, 0x40000
    s_waitcnt lgkmcnt(2)
    v_smfmac_f32_16x16x64_bf16 v[80:83], v[72:75], a[240:247], v0
    s_waitcnt lgkmcnt(1)
    v_smfmac_f32_16x16x64_bf16 v[80:83], v[76:79], v[144:151], v0
    s_waitcnt lgkmcnt(0)
    v_smfmac_f32_16x16x64_bf16 v[80:83], v[60:63], v[152:159], v0
    v_smfmac_f32_16x16x64_bf16 v[84:87], v[72:75], v[160:167], v0
    v_smfmac_f32_16x16x64_bf16 v[84:87], v[76:79], v[176:183], v0
    v_cvt_pk_bf16_f32 v80, v80, v81
    v_bfi_b32 v80, v18, s48, v80
    buffer_store_dword v80, v2, s[12:15], s52 offen offset:0
    v_smfmac_f32_16x16x64_bf16 v[84:87], v[60:63], v[184:191], v0
    v_cvt_pk_bf16_f32 v82, v82, v83
    v_bfi_b32 v82, v18, s48, v82
    buffer_store_dword v82, v2, s[12:15], s52 offen offset:2048
    v_smfmac_f32_16x16x64_bf16 v[88:91], v[72:75], v[192:199], v0
    v_smfmac_f32_16x16x64_bf16 v[88:91], v[76:79], v[208:215], v0
    v_cvt_pk_bf16_f32 v84, v84, v85
    v_bfi_b32 v84, v18, s48, v84
    buffer_store_dword v84, v2, s[12:15], s53 offen offset:0
    v_smfmac_f32_16x16x64_bf16 v[88:91], v[60:63], v[216:223], v0
    v_cvt_pk_bf16_f32 v86, v86, v87
    v_bfi_b32 v86, v18, s48, v86
    buffer_store_dword v86, v2, s[12:15], s53 offen offset:2048
    v_smfmac_f32_16x16x64_bf16 v[92:95], v[72:75], v[224:231], v0
    v_smfmac_f32_16x16x64_bf16 v[92:95], v[76:79], v[240:247], v0
    v_cvt_pk_bf16_f32 v88, v88, v89
    v_bfi_b32 v88, v18, s48, v88
    buffer_store_dword v88, v2, s[12:15], s54 offen offset:0
    v_smfmac_f32_16x16x64_bf16 v[92:95], v[60:63], v[248:255], v0
    v_cvt_pk_bf16_f32 v90, v90, v91
    v_bfi_b32 v90, v18, s48, v90
    buffer_store_dword v90, v2, s[12:15], s54 offen offset:2048
    s_nop 3
    v_cvt_pk_bf16_f32 v92, v92, v93
    v_bfi_b32 v92, v18, s48, v92
    buffer_store_dword v92, v2, s[12:15], s55 offen offset:0
    v_cvt_pk_bf16_f32 v94, v94, v95
    v_bfi_b32 v94, v18, s48, v94
    buffer_store_dword v94, v2, s[12:15], s55 offen offset:2048
    ds_read_b128 v[112:115], v17 offset:53248
    ds_read_b128 v[116:119], v17 offset:54272
    ds_read_b128 v[120:123], v17 offset:55296
    ds_read_b128 v[124:127], v17 offset:56320
    ds_read_b128 v[128:131], v17 offset:20480
    ds_read_b128 v[132:135], v17 offset:21504
    ds_read_b128 v[136:139], v17 offset:22528
    ds_read_b128 v[140:143], v17 offset:23552
    s_nop 15
    s_nop 15
    buffer_load_dwordx4 v[56:59], v12, s[12:15], s50 offen offset:0 sc1
    buffer_load_dwordx4 v[60:63], v12, s[12:15], s50 offen offset:1024 sc1
ch01_RC:
    s_waitcnt vmcnt(1)
    v_mfma_f32_16x16x32_bf16 v[28:31], v[56:59], v[8:11], 0
    s_waitcnt vmcnt(0)
    v_mfma_f32_16x16x32_bf16 v[28:31], v[60:63], v[8:11], v[28:31]
    v_bitop3_b32 v24, v56, v60, s48 bitop3:0x7e
    v_and_b32 v24, 1, v24
    v_cmp_ne_u32 vcc, 0, v24
    s_nop 3
    s_cbranch_vccz ch01_ROK
    buffer_load_dwordx4 v[56:59], v12, s[12:15], s50 offen offset:0 sc1
    buffer_load_dwordx4 v[60:63], v12, s[12:15], s50 offen offset:1024 sc1
    s_sub_u32 s51, s51, 1
    s_cbranch_scc0 ch01_RC
    s_mov_b32 s51, 0
    s_waitcnt vmcnt(0)
ch01_ROK:
    v_pk_add_f32 v[28:29], v[28:29], v[30:31]
    s_not_b32 s48, s48
    v_add_f32 v28, v28, v29
    v_cvt_pk_bf16_f32 v28, v28, v28
    v_bfi_b32 v28, v19, s48, v28
    buffer_store_short v28, v3, s[16:19], 0 offen
    v_mov_b64 v[40:41], v[32:33]
    v_mov_b64 v[42:43], v[34:35]
    v_mov_b64 v[44:45], v[36:37]
    v_mov_b64 v[46:47], v[38:39]
    s_branch ch_loop_0_1
ch_ent_0_1:
    ds_read_b128 v[112:115], v17 offset:53248
    ds_read_b128 v[116:119], v17 offset:54272
    ds_read_b128 v[120:123], v17 offset:55296
    ds_read_b128 v[124:127], v17 offset:56320
    ds_read_b128 v[128:131], v17 offset:20480
    ds_read_b128 v[132:135], v17 offset:21504
    ds_read_b128 v[136:139], v17 offset:22528
    ds_read_b128 v[140:143], v17 offset:23552
    s_branch ch_loop_0_1
ch01_KVW:
    s_cmp_ge_u32 s56, 64
    s_cbranch_scc1 ch01_KVOK
    s_mov_b32 s59, 0x40000
ch01_kp:
    v_lshrrev_b32 v20, 2, v1
    v_and_b32 v20, 63, v20
    buffer_load_dword v21, v20, s[96:99], s58 offen sc1
    s_waitcnt vmcnt(0)
    v_subrev_u32 v21, s101, v21
    v_cmp_lt_u32 vcc, 16, v21
    s_nop 1
    v_cndmask_b32 v21, v21, 0, vcc
    s_nop 1
    v_min_u32_dpp v21, v21, v21 quad_perm:[1,0,3,2] row_mask:0xf bank_mask:0xf
    s_nop 1
    v_min_u32_dpp v21, v21, v21 quad_perm:[2,3,0,1] row_mask:0xf bank_mask:0xf
    s_nop 1
    v_min_u32_dpp v21, v21, v21 row_half_mirror row_mask:0xf bank_mask:0xf
    s_nop 1
    v_min_u32_dpp v21, v21, v21 row_mirror row_mask:0xf bank_mask:0xf
    s_nop 0
    v_readfirstlane_b32 s57, v21
    s_lshl_b32 s57, s57, 2
    s_sub_u32 s59, s59, 1
    s_cbranch_scc1 ch01_kd
    s_cmp_ge_u32 s56, s57
    s_cbranch_scc1 ch01_kp
ch01_kd:
    s_branch ch01_KVOK
    .p2align 6
ch_loop_0_2:
    v_lshrrev_b32 v30, 1, v1
    v_mov_b64 v[32:33], v[68:69]
    v_mov_b64 v[34:35], v[70:71]
    v_mov_b64 v[36:37], v[64:65]
    v_mov_b64 v[64:65], 0
    v_mov_b64 v[66:67], 0
    v_mov_b64 v[68:69], 0
    v_mov_b64 v[70:71], 0
    v_mov_b64 v[56:57], 0
    v_mov_b64 v[58:59], 0
    v_mov_b64 v[60:61], 0
    v_mov_b64 v[62:63], 0
    v_mov_b64 v[72:73], 0
    v_mov_b64 v[74:75], 0
    v_mov_b64 v[76:77], 0
    v_mov_b64 v[78:79], 0
    s_nop 13
    buffer_load_dwordx4 v[96:99], v1, s[16:19], s45 offen offset:0 sc1
    buffer_load_dwordx4 v[100:103], v1, s[16:19], s45 offen offset:1024 sc1
    s_nop 15
    s_nop 8
    buffer_load_dwordx4 v[20:23], v1, s[16:19], s45 offen offset:0 sc1
    buffer_load_dwordx4 v[24:27], v1, s[16:19], s45 offen offset:1024 sc1
    s_waitcnt lgkmcnt(0)
ch02_POLL:
    s_waitcnt vmcnt(2)
    v_bitop3_b32 v31, v96, v100, s48 bitop3:0x7e
    v_and_b32 v31, 1, v31
    v_cmp_ne_u32 vcc, 0, v31
    ds_write_b128 v16, v[96:99] offset:24576
    ds_write_b128 v16, v[100:103] offset:25600
    s_cbranch_vccz ch02_H0
    buffer_load_dwordx4 v[96:99], v1, s[16:19], s45 offen offset:0 sc1
    buffer_load_dwordx4 v[100:103], v1, s[16:19], s45 offen offset:1024 sc1
    s_waitcnt vmcnt(2)
    v_bitop3_b32 v31, v20, v24, s48 bitop3:0x7e
    v_and_b32 v31, 1, v31
    v_cmp_ne_u32 vcc, 0, v31
    ds_write_b128 v16, v[20:23] offset:24576
    ds_write_b128 v16, v[24:27] offset:25600
    s_cbranch_vccz ch02_HB
    buffer_load_dwordx4 v[20:23], v1, s[16:19], s45 offen offset:0 sc1
    buffer_load_dwordx4 v[24:27], v1, s[16:19], s45 offen offset:1024 sc1
    s_sub_u32 s51, s51, 1
    s_cbranch_scc0 ch02_POLL
    s_mov_b32 s51, 0
ch02_HB:
    v_mov_b64 v[96:97], v[20:21]
    v_mov_b64 v[98:99], v[22:23]
    v_mov_b64 v[100:101], v[24:25]
    v_mov_b64 v[102:103], v[26:27]
    s_nop 0
ch02_H0:
    v_smfmac_f32_16x16x64_bf16 v[56:59], v[96:99], a[80:87], v0
    v_smfmac_f32_16x16x64_bf16 v[60:63], v[96:99], a[88:95], v0
    v_smfmac_f32_16x16x64_bf16 v[56:59], v[100:103], a[96:103], v0
    v_smfmac_f32_16x16x64_bf16 v[60:63], v[100:103], a[104:111], v0
    s_waitcnt lgkmcnt(0)
    s_barrier
    ds_read_b128 v[80:83], v16 offset:20480
    ds_read_b128 v[84:87], v16 offset:21504
    ds_read_b128 v[88:91], v16 offset:22528
    ds_read_b128 v[92:95], v16 offset:23552
    ds_read_b128 v[104:107], v16 offset:26624
    ds_read_b128 v[108:111], v16 offset:27648
    s_cmp_lt_u32 s56, s57
    s_cbranch_scc0 ch02_KVW
ch02_KVOK:
    s_add_u32 s56, s56, 1
    v_smfmac_f32_16x16x64_bf16 v[64:67], v[96:99], v[112:119], v0
    ds_read_b128 v[112:115], v17 offset:40960
    v_smfmac_f32_16x16x64_bf16 v[68:71], v[96:99], v[120:127], v0
    ds_read_b128 v[116:119], v17 offset:41984
    v_smfmac_f32_16x16x64_bf16 v[64:67], v[100:103], a[112:119], v0
    ds_read_b128 v[120:123], v17 offset:43008
    v_smfmac_f32_16x16x64_bf16 v[68:71], v[100:103], a[120:127], v0
    ds_read_b128 v[124:127], v17 offset:44032
    s_waitcnt lgkmcnt(9)
    v_smfmac_f32_16x16x64_bf16 v[56:59], v[80:83], v[128:135], v0
    ds_read_b128 v[128:131], v17 offset:57344
    v_smfmac_f32_16x16x64_bf16 v[60:63], v[80:83], v[136:143], v0
    ds_read_b128 v[132:135], v17 offset:58368
    s_waitcnt lgkmcnt(10)
    v_smfmac_f32_16x16x64_bf16 v[56:59], v[84:87], a[16:23], v0
    ds_read_b128 v[136:139], v17 offset:59392
    v_smfmac_f32_16x16x64_bf16 v[60:63], v[84:87], a[24:31], v0
    ds_read_b128 v[140:143], v17 offset:60416
    v_smfmac_f32_16x16x64_bf16 v[64:67], v[80:83], a[0:7], v0
    v_smfmac_f32_16x16x64_bf16 v[68:71], v[80:83], a[8:15], v0
    s_waitcnt lgkmcnt(11)
    v_smfmac_f32_16x16x64_bf16 v[56:59], v[88:91], a[32:39], v0
    v_smfmac_f32_16x16x64_bf16 v[60:63], v[88:91], a[40:47], v0
    s_waitcnt lgkmcnt(4)
    v_smfmac_f32_16x16x64_bf16 v[64:67], v[84:87], v[112:119], v0
    ds_read_b128 v[112:115], v1 offset:8192
    v_smfmac_f32_16x16x64_bf16 v[68:71], v[84:87], v[120:127], v0
    ds_read_b128 v[116:119], v1 offset:9216
    buffer_store_dwordx4 v[32:35], v1, s[28:31], s42 offen sc1
    s_waitcnt lgkmcnt(2)
    v_smfmac_f32_16x16x64_bf16 v[56:59], v[92:95], v[128:135], v0
    ds_read_b128 v[120:123], v1 offset:10240
    v_smfmac_f32_16x16x64_bf16 v[60:63], v[92:95], v[136:143], v0
    ds_read_b128 v[124:127], v1 offset:11264
    buffer_store_dwordx2 v[36:37], v30, s[32:35], s43 offen sc1
    s_add_u32 s42, s42, 0x20000
    s_add_u32 s43, s43, 0x10000
    v_smfmac_f32_16x16x64_bf16 v[64:67], v[88:91], a[48:55], v0
    ds_read_b128 v[128:131], v1 offset:24576
    v_smfmac_f32_16x16x64_bf16 v[68:71], v[88:91], a[56:63], v0
    ds_read_b128 v[132:135], v1 offset:25600
    s_waitcnt lgkmcnt(2)
    v_smfmac_f32_16x16x64_bf16 v[56:59], v[104:107], v[112:119], v0
    ds_read_b128 v[136:139], v1 offset:26624
    v_smfmac_f32_16x16x64_bf16 v[60:63], v[104:107], v[120:127], v0
    ds_read_b128 v[140:143], v1 offset:27648
    v_smfmac_f32_16x16x64_bf16 v[64:67], v[92:95], a[64:71], v0
    ds_read_b128 v[112:115], v1 offset:40960
    v_smfmac_f32_16x16x64_bf16 v[68:71], v[92:95], a[72:79], v0
    ds_read_b128 v[116:119], v1 offset:41984
    v_smfmac_f32_16x16x64_bf16 v[56:59], v[108:111], a[144:151], v0
    ds_read_b128 v[120:123], v1 offset:43008
    v_smfmac_f32_16x16x64_bf16 v[60:63], v[108:111], a[152:159], v0
    ds_read_b128 v[124:127], v1 offset:44032
    v_smfmac_f32_16x16x64_bf16 v[64:67], v[104:107], a[128:135], v0
    v_smfmac_f32_16x16x64_bf16 v[68:71], v[104:107], a[136:143], v0
    s_waitcnt lgkmcnt(4)
    v_smfmac_f32_16x16x64_bf16 v[64:67], v[108:111], v[128:135], v0
    ds_read_b128 v[128:131], v1 offset:57344
    v_add_f32 v56, v56, v58
    v_smfmac_f32_16x16x64_bf16 v[68:71], v[108:111], v[136:143], v0
    ds_read_b128 v[132:135], v1 offset:58368
    v_add_f32 v57, v57, v59
ch02_QKOK:
    s_waitcnt vmcnt(2)
    v_add_f32 v60, v60, v62
    v_add_f32 v61, v61, v63
    v_cvt_pk_bf16_f32 v20, v56, v57
    v_cvt_pk_bf16_f32 v22, v60, v61
    v_add_f32 v64, v64, v66
    v_add_f32 v65, v65, v67
    v_cvt_pk_bf16_f32 v21, v64, v65
    v_add_f32 v68, v68, v70
    v_add_f32 v69, v69, v71
    v_mfma_f32_16x16x16_bf16 v[64:67], v[20:21], v[4:5], 0
    v_cvt_pk_bf16_f32 v23, v68, v69
    buffer_load_dwordx4 v[32:35], v1, s[24:27], s41 offen offset:0 sc1
    buffer_load_dwordx4 v[36:39], v1, s[24:27], s41 offen offset:1024 sc1
    v_mfma_f32_16x16x16_bf16 v[68:71], v[22:23], v[4:5], 0
    v_smfmac_f32_16x16x64_bf16 v[72:75], v[80:83], a[160:167], v0
    ds_read_b128 v[136:139], v1 offset:59392
    s_nop 0
    v_cvt_pk_bf16_f32 v56, v64, v65
    v_cvt_pk_bf16_f32 v57, v66, v67
    s_nop 0
    v_cvt_pk_bf16_f32 v58, v68, v69
    v_cvt_pk_bf16_f32 v59, v70, v71
    s_nop 1
    v_mfma_f32_16x16x32_bf16 v[68:71], v[56:59], v[56:59], 0
    v_mfma_f32_16x16x32_bf16 v[64:67], v[52:55], v[56:59], 0
    v_mfma_f32_16x16x32_bf16 v[60:63], v[48:51], v[56:59], 0
    buffer_load_dwordx4 v[48:51], v1, s[20:23], s41 offen offset:0 sc1
    buffer_load_dwordx4 v[52:55], v1, s[20:23], s41 offen offset:1024 sc1
    ds_write_b64 v13, v[70:71]
    v_smfmac_f32_16x16x64_bf16 v[76:79], v[80:83], a[168:175], v0
    ds_read_b128 v[140:143], v1 offset:60416
    s_mov_b32 vcc_lo, 0x33333333
    s_mov_b32 vcc_hi, 0x33333333
    s_nop 1
    v_cndmask_b32_dpp v60, v64, v60, vcc quad_perm:[0,1,0,1] row_mask:0xf bank_mask:0xf
    v_cndmask_b32_dpp v61, v65, v61, vcc quad_perm:[0,1,0,1] row_mask:0xf bank_mask:0xf
    v_cndmask_b32_dpp v62, v66, v62, vcc quad_perm:[0,1,0,1] row_mask:0xf bank_mask:0xf
    v_cndmask_b32_dpp v63, v67, v63, vcc quad_perm:[0,1,0,1] row_mask:0xf bank_mask:0xf
    ds_write_b128 v16, v[60:63] offset:18432
    s_waitcnt lgkmcnt(6)
    v_smfmac_f32_16x16x64_bf16 v[72:75], v[84:87], v[112:119], v0
    ds_read_b128 v[112:115], v17 offset:8192
    v_smfmac_f32_16x16x64_bf16 v[76:79], v[84:87], v[120:127], v0
    ds_read_b128 v[116:119], v17 offset:9216
    v_smfmac_f32_16x16x64_bf16 v[72:75], v[88:91], a[176:183], v0
    ds_read_b128 v[120:123], v17 offset:10240
    v_smfmac_f32_16x16x64_bf16 v[76:79], v[88:91], a[184:191], v0
    ds_read_b128 v[124:127], v17 offset:11264
    v_smfmac_f32_16x16x64_bf16 v[72:75], v[92:95], a[192:199], v0
    v_smfmac_f32_16x16x64_bf16 v[76:79], v[92:95], a[200:207], v0
    s_waitcnt lgkmcnt(0)
    s_barrier
    ds_read_b128 v[20:23], v16 offset:16384
    ds_read_b128 v[24:27], v16 offset:17408
    ds_read_b128 v[64:67], v16 offset:19456
    ds_read2st64_b32 v[68:69], v14 offset0:0 offset1:1
    ds_read2st64_b32 v[70:71], v14 offset0:2 offset1:3
    v_smfmac_f32_16x16x64_bf16 v[72:75], v[96:99], v[128:135], v0
    v_smfmac_f32_16x16x64_bf16 v[76:79], v[96:99], v[136:143], v0
    v_smfmac_f32_16x16x64_bf16 v[72:75], v[100:103], a[208:215], v0
    v_smfmac_f32_16x16x64_bf16 v[76:79], v[100:103], a[216:223], v0
    s_waitcnt lgkmcnt(3)
    v_add_f32 v60, v60, v20
    v_add_f32 v61, v61, v21
    v_add_f32 v62, v62, v22
    v_add_f32 v63, v63, v23
    s_waitcnt lgkmcnt(2)
    v_pk_add_f32 v[24:25], v[24:25], v[64:65]
    v_pk_add_f32 v[26:27], v[26:27], v[66:67]
    s_waitcnt lgkmcnt(0)
    v_pk_add_f32 v[68:69], v[68:69], v[70:71]
    v_pk_add_f32 v[60:61], v[60:61], v[24:25]
    v_pk_add_f32 v[62:63], v[62:63], v[26:27]
    v_add_f32 v68, v68, v69
    v_max3_f32 v20, v60, v61, v62
    v_max3_f32 v20, v20, v63, v68
    v_smfmac_f32_16x16x64_bf16 v[72:75], v[104:107], a[224:231], v0
    s_nop 0
    v_max_f32_dpp v22, v20, v20 quad_perm:[2,3,0,1] row_mask:0xf bank_mask:0xf
    v_max_f32_dpp v23, v20, v20 quad_perm:[2,3,0,1] row_mask:0xf bank_mask:0xf
    v_smfmac_f32_16x16x64_bf16 v[76:79], v[104:107], a[232:239], v0
    s_nop 0
    v_permlane16_swap_b32 v22, v23
    v_max_f32 v20, v22, v23
    v_max_f32 v21, v22, v23
    v_smfmac_f32_16x16x64_bf16 v[72:75], v[108:111], v[112:119], v0
    s_nop 0
    v_permlane32_swap_b32 v20, v21
    v_max_f32 v20, v20, v21
    v_smfmac_f32_16x16x64_bf16 v[76:79], v[108:111], v[120:127], v0
    v_mul_f32 v20, s60, v20
    v_fma_f32 v60, v60, s60, -v20
    v_fma_f32 v61, v61, s60, -v20
    v_fma_f32 v62, v62, s60, -v20
    v_fma_f32 v63, v63, s60, -v20
    v_fma_f32 v68, v68, s60, -v20
    v_exp_f32 v60, v60
    v_exp_f32 v61, v61
    v_exp_f32 v62, v62
    v_exp_f32 v63, v63
    v_exp_f32 v68, v68
    v_cvt_pk_bf16_f32 v20, v60, v61
    v_cvt_pk_bf16_f32 v21, v62, v63
    v_pk_add_f32 v[28:29], v[60:61], v[62:63]
    v_mov_b32_dpp v24, v20 quad_perm:[0,1,0,1] row_mask:0xf bank_mask:0xf
    v_mov_b32_dpp v25, v21 quad_perm:[0,1,0,1] row_mask:0xf bank_mask:0xf
    v_mov_b32_dpp v26, v20 quad_perm:[2,3,2,3] row_mask:0xf bank_mask:0xf
    v_mov_b32_dpp v27, v21 quad_perm:[2,3,2,3] row_mask:0xf bank_mask:0xf
    v_pk_add_f32 v[72:73], v[72:73], v[74:75]
    v_pk_add_f32 v[76:77], v[76:77], v[78:79]
    v_mfma_f32_16x16x32_bf16 v[60:63], v[40:43], v[24:27], 0
    v_mov_b32_dpp v30, v68 quad_perm:[0,1,0,1] row_mask:0xf bank_mask:0xf
    v_mov_b32_dpp v31, v68 quad_perm:[2,3,2,3] row_mask:0xf bank_mask:0xf
    v_mfma_f32_16x16x32_bf16 v[20:23], v[44:47], v[24:27], 0
    v_add_f32 v28, v28, v29
    v_cvt_pk_bf16_f32 v6, v30, v31
    v_add_f32 v68, v68, v28
    v_cvt_pk_bf16_f32 v64, v72, v73
    v_cvt_pk_bf16_f32 v65, v76, v77
    v_add_f32_dpp v28, v68, v68 quad_perm:[2,3,0,1] row_mask:0xf bank_mask:0xf
    v_add_f32_dpp v29, v68, v68 quad_perm:[2,3,0,1] row_mask:0xf bank_mask:0xf
    v_mfma_f32_16x16x16_bf16 v[60:63], v[64:65], v[6:7], v[60:63]
    v_cvt_pk_bf16_f32 v66, v76, v77
    v_mov_b32 v67, 0
    v_permlane16_swap_b32 v28, v29
    v_add_f32 v68, v28, v29
    v_mfma_f32_16x16x16_bf16 v[20:23], v[66:67], v[6:7], v[20:23]
    v_add_f32 v69, v28, v29
    v_mov_b64 v[80:81], 0
    v_mov_b64 v[82:83], 0
    v_permlane32_swap_b32 v68, v69
    v_add_f32 v68, v68, v69
    v_rcp_f32 v68, v68
    v_mov_b64 v[84:85], 0
    v_pk_mul_f32 v[60:61], v[60:61], v[68:69] op_sel_hi:[1,0]
    v_pk_mul_f32 v[62:63], v[62:63], v[68:69] op_sel_hi:[1,0]
    v_pk_mul_f32 v[20:21], v[20:21], v[68:69] op_sel_hi:[1,0]
    v_pk_mul_f32 v[22:23], v[22:23], v[68:69] op_sel_hi:[1,0]
    v_cvt_pk_bf16_f32 v24, v60, v61
    v_cvt_pk_bf16_f32 v25, v62, v63
    v_cvt_pk_bf16_f32 v26, v20, v21
    v_cvt_pk_bf16_f32 v27, v22, v23
    ds_write_b128 v15, v[24:27] offset:1024
    v_mov_b64 v[86:87], 0
    v_smfmac_f32_16x16x64_bf16 v[80:83], v[24:27], v[144:151], v0
    v_mov_b64 v[88:89], 0
    v_mov_b64 v[90:91], 0
    v_smfmac_f32_16x16x64_bf16 v[84:87], v[24:27], v[176:183], v0
    v_mov_b64 v[92:93], 0
    v_mov_b64 v[94:95], 0
    v_mov_b64 v[68:69], v[56:57]
    v_smfmac_f32_16x16x64_bf16 v[88:91], v[24:27], v[208:215], v0
    v_mov_b64 v[70:71], v[58:59]
    s_sub_u32 s40, s40, 1
    s_cbranch_scc1 ch_fin
    s_waitcnt lgkmcnt(0)
    s_barrier
    ds_read_b128 v[72:75], v15 offset:0
    ds_read_b128 v[76:79], v15 offset:512
    ds_read_b128 v[60:63], v15 offset:1536
    v_smfmac_f32_16x16x64_bf16 v[92:95], v[24:27], v[240:247], v0
    s_add_u32 s41, s41, 0x40000
    s_waitcnt lgkmcnt(2)
    v_smfmac_f32_16x16x64_bf16 v[80:83], v[72:75], a[240:247], v0
    s_waitcnt lgkmcnt(1)
    v_smfmac_f32_16x16x64_bf16 v[80:83], v[76:79], a[248:255], v0
    s_waitcnt lgkmcnt(0)
    v_smfmac_f32_16x16x64_bf16 v[80:83], v[60:63], v[152:159], v0
    v_smfmac_f32_16x16x64_bf16 v[84:87], v[72:75], v[160:167], v0
    v_smfmac_f32_16x16x64_bf16 v[84:87], v[76:79], v[168:175], v0
    v_cvt_pk_bf16_f32 v80, v80, v81
    v_bfi_b32 v80, v18, s48, v80
    buffer_store_dword v80, v2, s[12:15], s52 offen offset:0
    v_smfmac_f32_16x16x64_bf16 v[84:87], v[60:63], v[184:191], v0
    v_cvt_pk_bf16_f32 v82, v82, v83
    v_bfi_b32 v82, v18, s48, v82
    buffer_store_dword v82, v2, s[12:15], s52 offen offset:2048
    v_smfmac_f32_16x16x64_bf16 v[88:91], v[72:75], v[192:199], v0
    v_smfmac_f32_16x16x64_bf16 v[88:91], v[76:79], v[200:207], v0
    v_cvt_pk_bf16_f32 v84, v84, v85
    v_bfi_b32 v84, v18, s48, v84
    buffer_store_dword v84, v2, s[12:15], s53 offen offset:0
    v_smfmac_f32_16x16x64_bf16 v[88:91], v[60:63], v[216:223], v0
    v_cvt_pk_bf16_f32 v86, v86, v87
    v_bfi_b32 v86, v18, s48, v86
    buffer_store_dword v86, v2, s[12:15], s53 offen offset:2048
    v_smfmac_f32_16x16x64_bf16 v[92:95], v[72:75], v[224:231], v0
    v_smfmac_f32_16x16x64_bf16 v[92:95], v[76:79], v[232:239], v0
    v_cvt_pk_bf16_f32 v88, v88, v89
    v_bfi_b32 v88, v18, s48, v88
    buffer_store_dword v88, v2, s[12:15], s54 offen offset:0
    v_smfmac_f32_16x16x64_bf16 v[92:95], v[60:63], v[248:255], v0
    v_cvt_pk_bf16_f32 v90, v90, v91
    v_bfi_b32 v90, v18, s48, v90
    buffer_store_dword v90, v2, s[12:15], s54 offen offset:2048
    s_nop 3
    v_cvt_pk_bf16_f32 v92, v92, v93
    v_bfi_b32 v92, v18, s48, v92
    buffer_store_dword v92, v2, s[12:15], s55 offen offset:0
    v_cvt_pk_bf16_f32 v94, v94, v95
    v_bfi_b32 v94, v18, s48, v94
    buffer_store_dword v94, v2, s[12:15], s55 offen offset:2048
    ds_read_b128 v[112:115], v16 offset:8192
    ds_read_b128 v[116:119], v16 offset:9216
    ds_read_b128 v[120:123], v16 offset:10240
    ds_read_b128 v[124:127], v16 offset:11264
    ds_read_b128 v[128:131], v17 offset:24576
    ds_read_b128 v[132:135], v17 offset:25600
    ds_read_b128 v[136:139], v17 offset:26624
    ds_read_b128 v[140:143], v17 offset:27648
    s_nop 15
    s_nop 15
    s_nop 14
    buffer_load_dwordx4 v[56:59], v12, s[12:15], s50 offen offset:0 sc1
    buffer_load_dwordx4 v[60:63], v12, s[12:15], s50 offen offset:1024 sc1
ch02_RC:
    s_waitcnt vmcnt(1)
    v_mfma_f32_16x16x32_bf16 v[28:31], v[56:59], v[8:11], 0
    s_waitcnt vmcnt(0)
    v_mfma_f32_16x16x32_bf16 v[28:31], v[60:63], v[8:11], v[28:31]
    v_bitop3_b32 v24, v56, v60, s48 bitop3:0x7e
    v_and_b32 v24, 1, v24
    v_cmp_ne_u32 vcc, 0, v24
    s_nop 3
    s_cbranch_vccz ch02_ROK
    buffer_load_dwordx4 v[56:59], v12, s[12:15], s50 offen offset:0 sc1
    buffer_load_dwordx4 v[60:63], v12, s[12:15], s50 offen offset:1024 sc1
    s_sub_u32 s51, s51, 1
    s_cbranch_scc0 ch02_RC
    s_mov_b32 s51, 0
    s_waitcnt vmcnt(0)
ch02_ROK:
    v_pk_add_f32 v[28:29], v[28:29], v[30:31]
    s_not_b32 s48, s48
    v_add_f32 v28, v28, v29
    v_cvt_pk_bf16_f32 v28, v28, v28
    v_bfi_b32 v28, v19, s48, v28
    buffer_store_short v28, v3, s[16:19], 0 offen
    v_mov_b64 v[40:41], v[32:33]
    v_mov_b64 v[42:43], v[34:35]
    v_mov_b64 v[44:45], v[36:37]
    v_mov_b64 v[46:47], v[38:39]
    s_branch ch_loop_0_2
ch_ent_0_2:
    ds_read_b128 v[112:115], v16 offset:8192
    ds_read_b128 v[116:119], v16 offset:9216
    ds_read_b128 v[120:123], v16 offset:10240
    ds_read_b128 v[124:127], v16 offset:11264
    ds_read_b128 v[128:131], v17 offset:24576
    ds_read_b128 v[132:135], v17 offset:25600
    ds_read_b128 v[136:139], v17 offset:26624
    ds_read_b128 v[140:143], v17 offset:27648
    s_branch ch_loop_0_2
ch02_KVW:
    s_cmp_ge_u32 s56, 64
    s_cbranch_scc1 ch02_KVOK
    s_mov_b32 s59, 0x40000
ch02_kp:
    v_lshrrev_b32 v20, 2, v1
    v_and_b32 v20, 63, v20
    buffer_load_dword v21, v20, s[96:99], s58 offen sc1
    s_waitcnt vmcnt(0)
    v_subrev_u32 v21, s101, v21
    v_cmp_lt_u32 vcc, 16, v21
    s_nop 1
    v_cndmask_b32 v21, v21, 0, vcc
    s_nop 1
    v_min_u32_dpp v21, v21, v21 quad_perm:[1,0,3,2] row_mask:0xf bank_mask:0xf
    s_nop 1
    v_min_u32_dpp v21, v21, v21 quad_perm:[2,3,0,1] row_mask:0xf bank_mask:0xf
    s_nop 1
    v_min_u32_dpp v21, v21, v21 row_half_mirror row_mask:0xf bank_mask:0xf
    s_nop 1
    v_min_u32_dpp v21, v21, v21 row_mirror row_mask:0xf bank_mask:0xf
    s_nop 0
    v_readfirstlane_b32 s57, v21
    s_lshl_b32 s57, s57, 2
    s_sub_u32 s59, s59, 1
    s_cbranch_scc1 ch02_kd
    s_cmp_ge_u32 s56, s57
    s_cbranch_scc1 ch02_kp
ch02_kd:
    s_branch ch02_KVOK
    .p2align 6
ch_loop_0_3:
    v_lshrrev_b32 v30, 1, v1
    v_mov_b64 v[32:33], v[68:69]
    v_mov_b64 v[34:35], v[70:71]
    v_mov_b64 v[36:37], v[64:65]
    v_mov_b64 v[64:65], 0
    v_mov_b64 v[66:67], 0
    v_mov_b64 v[68:69], 0
    v_mov_b64 v[70:71], 0
    v_mov_b64 v[56:57], 0
    v_mov_b64 v[58:59], 0
    v_mov_b64 v[60:61], 0
    v_mov_b64 v[62:63], 0
    v_mov_b64 v[72:73], 0
    v_mov_b64 v[74:75], 0
    v_mov_b64 v[76:77], 0
    v_mov_b64 v[78:79], 0
    s_nop 13
    buffer_load_dwordx4 v[104:107], v1, s[16:19], s45 offen offset:2048 sc1
    buffer_load_dwordx4 v[108:111], v1, s[16:19], s45 offen offset:3072 sc1
    s_nop 15
    s_nop 8
    buffer_load_dwordx4 v[20:23], v1, s[16:19], s45 offen offset:2048 sc1
    buffer_load_dwordx4 v[24:27], v1, s[16:19], s45 offen offset:3072 sc1
    s_waitcnt lgkmcnt(0)
ch03_POLL:
    s_waitcnt vmcnt(2)
    v_bitop3_b32 v31, v104, v108, s48 bitop3:0x7e
    v_and_b32 v31, 1, v31
    v_cmp_ne_u32 vcc, 0, v31
    ds_write_b128 v16, v[104:107] offset:26624
    ds_write_b128 v16, v[108:111] offset:27648
    s_cbranch_vccz ch03_H0
    buffer_load_dwordx4 v[104:107], v1, s[16:19], s45 offen offset:2048 sc1
    buffer_load_dwordx4 v[108:111], v1, s[16:19], s45 offen offset:3072 sc1
    s_waitcnt vmcnt(2)
    v_bitop3_b32 v31, v20, v24, s48 bitop3:0x7e
    v_and_b32 v31, 1, v31
    v_cmp_ne_u32 vcc, 0, v31
    ds_write_b128 v16, v[20:23] offset:26624
    ds_write_b128 v16, v[24:27] offset:27648
    s_cbranch_vccz ch03_HB
    buffer_load_dwordx4 v[20:23], v1, s[16:19], s45 offen offset:2048 sc1
    buffer_load_dwordx4 v[24:27], v1, s[16:19], s45 offen offset:3072 sc1
    s_sub_u32 s51, s51, 1
    s_cbranch_scc0 ch03_POLL
    s_mov_b32 s51, 0
ch03_HB:
    v_mov_b64 v[104:105], v[20:21]
    v_mov_b64 v[106:107], v[22:23]
    v_mov_b64 v[108:109], v[24:25]
    v_mov_b64 v[110:111], v[26:27]
    s_nop 0
ch03_H0:
    v_smfmac_f32_16x16x64_bf16 v[56:59], v[104:107], v[112:119], v0
    ds_read_b128 v[112:115], v17 offset:28672
    v_smfmac_f32_16x16x64_bf16 v[60:63], v[104:107], v[120:127], v0
    ds_read_b128 v[116:119], v17 offset:29696
    v_smfmac_f32_16x16x64_bf16 v[56:59], v[108:111], a[144:151], v0
    ds_read_b128 v[120:123], v17 offset:30720
    v_smfmac_f32_16x16x64_bf16 v[60:63], v[108:111], a[152:159], v0
    ds_read_b128 v[124:127], v17 offset:31744
    s_waitcnt lgkmcnt(4)
    s_barrier
    ds_read_b128 v[80:83], v16 offset:20480
    ds_read_b128 v[84:87], v16 offset:21504
    ds_read_b128 v[88:91], v16 offset:22528
    ds_read_b128 v[92:95], v16 offset:23552
    ds_read_b128 v[96:99], v16 offset:24576
    ds_read_b128 v[100:103], v16 offset:25600
    s_cmp_lt_u32 s56, s57
    s_cbranch_scc0 ch03_KVW
ch03_KVOK:
    s_add_u32 s56, s56, 1
    v_smfmac_f32_16x16x64_bf16 v[64:67], v[104:107], a[128:135], v0
    v_smfmac_f32_16x16x64_bf16 v[68:71], v[104:107], a[136:143], v0
    v_smfmac_f32_16x16x64_bf16 v[64:67], v[108:111], v[128:135], v0
    ds_read_b128 v[128:131], v17 offset:45056
    v_smfmac_f32_16x16x64_bf16 v[68:71], v[108:111], v[136:143], v0
    ds_read_b128 v[132:135], v17 offset:46080
    s_waitcnt lgkmcnt(7)
    v_smfmac_f32_16x16x64_bf16 v[56:59], v[80:83], v[112:119], v0
    ds_read_b128 v[136:139], v17 offset:47104
    v_smfmac_f32_16x16x64_bf16 v[60:63], v[80:83], v[120:127], v0
    ds_read_b128 v[140:143], v17 offset:48128
    s_waitcnt lgkmcnt(8)
    v_smfmac_f32_16x16x64_bf16 v[56:59], v[84:87], a[16:23], v0
    ds_read_b128 v[112:115], v17 offset:61440
    v_smfmac_f32_16x16x64_bf16 v[60:63], v[84:87], a[24:31], v0
    ds_read_b128 v[116:119], v17 offset:62464
    v_smfmac_f32_16x16x64_bf16 v[64:67], v[80:83], a[0:7], v0
    ds_read_b128 v[120:123], v17 offset:63488
    v_smfmac_f32_16x16x64_bf16 v[68:71], v[80:83], a[8:15], v0
    ds_read_b128 v[124:127], v17 offset:64512
    s_waitcnt lgkmcnt(11)
    v_smfmac_f32_16x16x64_bf16 v[56:59], v[88:91], a[32:39], v0
    v_smfmac_f32_16x16x64_bf16 v[60:63], v[88:91], a[40:47], v0
    s_waitcnt lgkmcnt(4)
    v_smfmac_f32_16x16x64_bf16 v[64:67], v[84:87], v[128:135], v0
    ds_read_b128 v[128:131], v16 offset:12288
    v_smfmac_f32_16x16x64_bf16 v[68:71], v[84:87], v[136:143], v0
    ds_read_b128 v[132:135], v16 offset:13312
    s_waitcnt lgkmcnt(2)
    v_smfmac_f32_16x16x64_bf16 v[56:59], v[92:95], v[112:119], v0
    ds_read_b128 v[136:139], v16 offset:14336
    v_smfmac_f32_16x16x64_bf16 v[60:63], v[92:95], v[120:127], v0
    ds_read_b128 v[140:143], v16 offset:15360
    v_smfmac_f32_16x16x64_bf16 v[64:67], v[88:91], a[48:55], v0
    ds_read_b128 v[112:115], v1 offset:45056
    v_smfmac_f32_16x16x64_bf16 v[68:71], v[88:91], a[56:63], v0
    ds_read_b128 v[116:119], v1 offset:46080
    buffer_store_dwordx4 v[32:35], v1, s[28:31], s42 offen sc1
    v_smfmac_f32_16x16x64_bf16 v[56:59], v[96:99], a[80:87], v0
    ds_read_b128 v[120:123], v1 offset:47104
    v_smfmac_f32_16x16x64_bf16 v[60:63], v[96:99], a[88:95], v0
    ds_read_b128 v[124:127], v1 offset:48128
    buffer_store_dwordx2 v[36:37], v30, s[32:35], s43 offen sc1
    s_add_u32 s42, s42, 0x20000
    s_add_u32 s43, s43, 0x10000
    v_smfmac_f32_16x16x64_bf16 v[64:67], v[92:95], a[64:71], v0
    v_smfmac_f32_16x16x64_bf16 v[68:71], v[92:95], a[72:79], v0
    v_smfmac_f32_16x16x64_bf16 v[56:59], v[100:103], a[96:103], v0
    v_smfmac_f32_16x16x64_bf16 v[60:63], v[100:103], a[104:111], v0
    s_waitcnt lgkmcnt(4)
    v_smfmac_f32_16x16x64_bf16 v[64:67], v[96:99], v[128:135], v0
    ds_read_b128 v[128:131], v1 offset:61440
    v_smfmac_f32_16x16x64_bf16 v[68:71], v[96:99], v[136:143], v0
    ds_read_b128 v[132:135], v1 offset:62464
    v_smfmac_f32_16x16x64_bf16 v[64:67], v[100:103], a[112:119], v0
    ds_read_b128 v[136:139], v1 offset:63488
    v_add_f32 v56, v56, v58
    v_smfmac_f32_16x16x64_bf16 v[68:71], v[100:103], a[120:127], v0
    ds_read_b128 v[140:143], v1 offset:64512
    v_add_f32 v57, v57, v59
ch03_QKOK:
    s_waitcnt vmcnt(2)
    v_add_f32 v60, v60, v62
    v_add_f32 v61, v61, v63
    v_cvt_pk_bf16_f32 v20, v56, v57
    v_cvt_pk_bf16_f32 v22, v60, v61
    v_add_f32 v64, v64, v66
    v_add_f32 v65, v65, v67
    v_cvt_pk_bf16_f32 v21, v64, v65
    v_add_f32 v68, v68, v70
    v_add_f32 v69, v69, v71
    v_mfma_f32_16x16x16_bf16 v[64:67], v[20:21], v[4:5], 0
    v_cvt_pk_bf16_f32 v23, v68, v69
    buffer_load_dwordx4 v[32:35], v1, s[24:27], s41 offen offset:0 sc1
    buffer_load_dwordx4 v[36:39], v1, s[24:27], s41 offen offset:1024 sc1
    v_mfma_f32_16x16x16_bf16 v[68:71], v[22:23], v[4:5], 0
    v_smfmac_f32_16x16x64_bf16 v[72:75], v[80:83], a[160:167], v0
    s_nop 0
    v_cvt_pk_bf16_f32 v56, v64, v65
    v_cvt_pk_bf16_f32 v57, v66, v67
    s_nop 0
    v_cvt_pk_bf16_f32 v58, v68, v69
    v_cvt_pk_bf16_f32 v59, v70, v71
    s_nop 1
    v_mfma_f32_16x16x32_bf16 v[68:71], v[56:59], v[56:59], 0
    v_mfma_f32_16x16x32_bf16 v[64:67], v[52:55], v[56:59], 0
    v_mfma_f32_16x16x32_bf16 v[60:63], v[48:51], v[56:59], 0
    buffer_load_dwordx4 v[48:51], v1, s[20:23], s41 offen offset:0 sc1
    buffer_load_dwordx4 v[52:55], v1, s[20:23], s41 offen offset:1024 sc1
    ds_write_b64 v13, v[70:71]
    v_smfmac_f32_16x16x64_bf16 v[76:79], v[80:83], a[168:175], v0
    s_mov_b32 vcc_lo, 0x33333333
    s_mov_b32 vcc_hi, 0x33333333
    s_nop 1
    v_cndmask_b32_dpp v60, v64, v60, vcc quad_perm:[0,1,0,1] row_mask:0xf bank_mask:0xf
    v_cndmask_b32_dpp v61, v65, v61, vcc quad_perm:[0,1,0,1] row_mask:0xf bank_mask:0xf
    v_cndmask_b32_dpp v62, v66, v62, vcc quad_perm:[0,1,0,1] row_mask:0xf bank_mask:0xf
    v_cndmask_b32_dpp v63, v67, v63, vcc quad_perm:[0,1,0,1] row_mask:0xf bank_mask:0xf
    ds_write_b128 v16, v[60:63] offset:19456
    s_waitcnt lgkmcnt(6)
    v_smfmac_f32_16x16x64_bf16 v[72:75], v[84:87], v[112:119], v0
    ds_read_b128 v[112:115], v17 offset:12288
    v_smfmac_f32_16x16x64_bf16 v[76:79], v[84:87], v[120:127], v0
    ds_read_b128 v[116:119], v17 offset:13312
    v_smfmac_f32_16x16x64_bf16 v[72:75], v[88:91], a[176:183], v0
    ds_read_b128 v[120:123], v17 offset:14336
    v_smfmac_f32_16x16x64_bf16 v[76:79], v[88:91], a[184:191], v0
    ds_read_b128 v[124:127], v17 offset:15360
    v_smfmac_f32_16x16x64_bf16 v[72:75], v[92:95], a[192:199], v0
    v_smfmac_f32_16x16x64_bf16 v[76:79], v[92:95], a[200:207], v0
    s_waitcnt lgkmcnt(0)
    s_barrier
    ds_read_b128 v[20:23], v16 offset:16384
    ds_read_b128 v[24:27], v16 offset:17408
    ds_read_b128 v[64:67], v16 offset:18432
    ds_read2st64_b32 v[68:69], v14 offset0:0 offset1:1
    ds_read2st64_b32 v[70:71], v14 offset0:2 offset1:3
    v_smfmac_f32_16x16x64_bf16 v[72:75], v[96:99], v[128:135], v0
    v_smfmac_f32_16x16x64_bf16 v[76:79], v[96:99], v[136:143], v0
    v_smfmac_f32_16x16x64_bf16 v[72:75], v[100:103], a[208:215], v0
    v_smfmac_f32_16x16x64_bf16 v[76:79], v[100:103], a[216:223], v0
    s_waitcnt lgkmcnt(3)
    v_add_f32 v60, v60, v20
    v_add_f32 v61, v61, v21
    v_add_f32 v62, v62, v22
    v_add_f32 v63, v63, v23
    s_waitcnt lgkmcnt(2)
    v_pk_add_f32 v[24:25], v[24:25], v[64:65]
    v_pk_add_f32 v[26:27], v[26:27], v[66:67]
    s_waitcnt lgkmcnt(0)
    v_pk_add_f32 v[68:69], v[68:69], v[70:71]
    v_pk_add_f32 v[60:61], v[60:61], v[24:25]
    v_pk_add_f32 v[62:63], v[62:63], v[26:27]
    v_add_f32 v68, v68, v69
    v_max3_f32 v20, v60, v61, v62
    v_max3_f32 v20, v20, v63, v68
    v_smfmac_f32_16x16x64_bf16 v[72:75], v[104:107], a[224:231], v0
    s_nop 0
    v_max_f32_dpp v22, v20, v20 quad_perm:[2,3,0,1] row_mask:0xf bank_mask:0xf
    v_max_f32_dpp v23, v20, v20 quad_perm:[2,3,0,1] row_mask:0xf bank_mask:0xf
    v_smfmac_f32_16x16x64_bf16 v[76:79], v[104:107], a[232:239], v0
    s_nop 0
    v_permlane16_swap_b32 v22, v23
    v_max_f32 v20, v22, v23
    v_max_f32 v21, v22, v23
    v_smfmac_f32_16x16x64_bf16 v[72:75], v[108:111], v[112:119], v0
    s_nop 0
    v_permlane32_swap_b32 v20, v21
    v_max_f32 v20, v20, v21
    v_smfmac_f32_16x16x64_bf16 v[76:79], v[108:111], v[120:127], v0
    v_mul_f32 v20, s60, v20
    v_fma_f32 v60, v60, s60, -v20
    v_fma_f32 v61, v61, s60, -v20
    v_fma_f32 v62, v62, s60, -v20
    v_fma_f32 v63, v63, s60, -v20
    v_fma_f32 v68, v68, s60, -v20
    v_exp_f32 v60, v60
    v_exp_f32 v61, v61
    v_exp_f32 v62, v62
    v_exp_f32 v63, v63
    v_exp_f32 v68, v68
    v_cvt_pk_bf16_f32 v20, v60, v61
    v_cvt_pk_bf16_f32 v21, v62, v63
    v_pk_add_f32 v[28:29], v[60:61], v[62:63]
    v_mov_b32_dpp v24, v20 quad_perm:[0,1,0,1] row_mask:0xf bank_mask:0xf
    v_mov_b32_dpp v25, v21 quad_perm:[0,1,0,1] row_mask:0xf bank_mask:0xf
    v_mov_b32_dpp v26, v20 quad_perm:[2,3,2,3] row_mask:0xf bank_mask:0xf
    v_mov_b32_dpp v27, v21 quad_perm:[2,3,2,3] row_mask:0xf bank_mask:0xf
    v_pk_add_f32 v[72:73], v[72:73], v[74:75]
    v_pk_add_f32 v[76:77], v[76:77], v[78:79]
    v_mfma_f32_16x16x32_bf16 v[60:63], v[40:43], v[24:27], 0
    v_mov_b32_dpp v30, v68 quad_perm:[0,1,0,1] row_mask:0xf bank_mask:0xf
    v_mov_b32_dpp v31, v68 quad_perm:[2,3,2,3] row_mask:0xf bank_mask:0xf
    v_mfma_f32_16x16x32_bf16 v[20:23], v[44:47], v[24:27], 0
    v_add_f32 v28, v28, v29
    v_cvt_pk_bf16_f32 v6, v30, v31
    v_add_f32 v68, v68, v28
    v_cvt_pk_bf16_f32 v64, v72, v73
    v_cvt_pk_bf16_f32 v65, v76, v77
    v_add_f32_dpp v28, v68, v68 quad_perm:[2,3,0,1] row_mask:0xf bank_mask:0xf
    v_add_f32_dpp v29, v68, v68 quad_perm:[2,3,0,1] row_mask:0xf bank_mask:0xf
    v_mfma_f32_16x16x16_bf16 v[60:63], v[64:65], v[6:7], v[60:63]
    v_cvt_pk_bf16_f32 v66, v76, v77
    v_mov_b32 v67, 0
    v_permlane16_swap_b32 v28, v29
    v_add_f32 v68, v28, v29
    v_mfma_f32_16x16x16_bf16 v[20:23], v[66:67], v[6:7], v[20:23]
    v_add_f32 v69, v28, v29
    v_mov_b64 v[80:81], 0
    v_mov_b64 v[82:83], 0
    v_permlane32_swap_b32 v68, v69
    v_add_f32 v68, v68, v69
    v_rcp_f32 v68, v68
    v_mov_b64 v[84:85], 0
    v_pk_mul_f32 v[60:61], v[60:61], v[68:69] op_sel_hi:[1,0]
    v_pk_mul_f32 v[62:63], v[62:63], v[68:69] op_sel_hi:[1,0]
    v_pk_mul_f32 v[20:21], v[20:21], v[68:69] op_sel_hi:[1,0]
    v_pk_mul_f32 v[22:23], v[22:23], v[68:69] op_sel_hi:[1,0]
    v_cvt_pk_bf16_f32 v24, v60, v61
    v_cvt_pk_bf16_f32 v25, v62, v63
    v_cvt_pk_bf16_f32 v26, v20, v21
    v_cvt_pk_bf16_f32 v27, v22, v23
    ds_write_b128 v15, v[24:27] offset:1536
    v_mov_b64 v[86:87], 0
    v_smfmac_f32_16x16x64_bf16 v[80:83], v[24:27], v[152:159], v0
    v_mov_b64 v[88:89], 0
    v_mov_b64 v[90:91], 0
    v_smfmac_f32_16x16x64_bf16 v[84:87], v[24:27], v[184:191], v0
    v_mov_b64 v[92:93], 0
    v_mov_b64 v[94:95], 0
    v_mov_b64 v[68:69], v[56:57]
    v_smfmac_f32_16x16x64_bf16 v[88:91], v[24:27], v[216:223], v0
    v_mov_b64 v[70:71], v[58:59]
    s_sub_u32 s40, s40, 1
    s_cbranch_scc1 ch_fin
    s_waitcnt lgkmcnt(0)
    s_barrier
    ds_read_b128 v[72:75], v15 offset:0
    ds_read_b128 v[76:79], v15 offset:512
    ds_read_b128 v[60:63], v15 offset:1024
    v_smfmac_f32_16x16x64_bf16 v[92:95], v[24:27], v[248:255], v0
    s_add_u32 s41, s41, 0x40000
    s_waitcnt lgkmcnt(2)
    v_smfmac_f32_16x16x64_bf16 v[80:83], v[72:75], a[240:247], v0
    s_waitcnt lgkmcnt(1)
    v_smfmac_f32_16x16x64_bf16 v[80:83], v[76:79], a[248:255], v0
    s_waitcnt lgkmcnt(0)
    v_smfmac_f32_16x16x64_bf16 v[80:83], v[60:63], v[144:151], v0
    v_smfmac_f32_16x16x64_bf16 v[84:87], v[72:75], v[160:167], v0
    v_smfmac_f32_16x16x64_bf16 v[84:87], v[76:79], v[168:175], v0
    v_cvt_pk_bf16_f32 v80, v80, v81
    v_bfi_b32 v80, v18, s48, v80
    buffer_store_dword v80, v2, s[12:15], s52 offen offset:0
    v_smfmac_f32_16x16x64_bf16 v[84:87], v[60:63], v[176:183], v0
    v_cvt_pk_bf16_f32 v82, v82, v83
    v_bfi_b32 v82, v18, s48, v82
    buffer_store_dword v82, v2, s[12:15], s52 offen offset:2048
    v_smfmac_f32_16x16x64_bf16 v[88:91], v[72:75], v[192:199], v0
    v_smfmac_f32_16x16x64_bf16 v[88:91], v[76:79], v[200:207], v0
    v_cvt_pk_bf16_f32 v84, v84, v85
    v_bfi_b32 v84, v18, s48, v84
    buffer_store_dword v84, v2, s[12:15], s53 offen offset:0
    v_smfmac_f32_16x16x64_bf16 v[88:91], v[60:63], v[208:215], v0
    v_cvt_pk_bf16_f32 v86, v86, v87
    v_bfi_b32 v86, v18, s48, v86
    buffer_store_dword v86, v2, s[12:15], s53 offen offset:2048
    v_smfmac_f32_16x16x64_bf16 v[92:95], v[72:75], v[224:231], v0
    v_smfmac_f32_16x16x64_bf16 v[92:95], v[76:79], v[232:239], v0
    v_cvt_pk_bf16_f32 v88, v88, v89
    v_bfi_b32 v88, v18, s48, v88
    buffer_store_dword v88, v2, s[12:15], s54 offen offset:0
    v_smfmac_f32_16x16x64_bf16 v[92:95], v[60:63], v[240:247], v0
    v_cvt_pk_bf16_f32 v90, v90, v91
    v_bfi_b32 v90, v18, s48, v90
    buffer_store_dword v90, v2, s[12:15], s54 offen offset:2048
    s_nop 3
    v_cvt_pk_bf16_f32 v92, v92, v93
    v_bfi_b32 v92, v18, s48, v92
    buffer_store_dword v92, v2, s[12:15], s55 offen offset:0
    v_cvt_pk_bf16_f32 v94, v94, v95
    v_bfi_b32 v94, v18, s48, v94
    buffer_store_dword v94, v2, s[12:15], s55 offen offset:2048
    ds_read_b128 v[112:115], v1 offset:12288
    ds_read_b128 v[116:119], v1 offset:13312
    ds_read_b128 v[120:123], v1 offset:14336
    ds_read_b128 v[124:127], v1 offset:15360
    ds_read_b128 v[128:131], v1 offset:28672
    ds_read_b128 v[132:135], v1 offset:29696
    ds_read_b128 v[136:139], v1 offset:30720
    ds_read_b128 v[140:143], v1 offset:31744
    s_nop 15
    s_nop 15
    s_nop 15
    s_nop 8
    buffer_load_dwordx4 v[56:59], v12, s[12:15], s50 offen offset:0 sc1
    buffer_load_dwordx4 v[60:63], v12, s[12:15], s50 offen offset:1024 sc1
ch03_RC:
    s_waitcnt vmcnt(1)
    v_mfma_f32_16x16x32_bf16 v[28:31], v[56:59], v[8:11], 0
    s_waitcnt vmcnt(0)
    v_mfma_f32_16x16x32_bf16 v[28:31], v[60:63], v[8:11], v[28:31]
    v_bitop3_b32 v24, v56, v60, s48 bitop3:0x7e
    v_and_b32 v24, 1, v24
    v_cmp_ne_u32 vcc, 0, v24
    s_nop 3
    s_cbranch_vccz ch03_ROK
    buffer_load_dwordx4 v[56:59], v12, s[12:15], s50 offen offset:0 sc1
    buffer_load_dwordx4 v[60:63], v12, s[12:15], s50 offen offset:1024 sc1
    s_sub_u32 s51, s51, 1
    s_cbranch_scc0 ch03_RC
    s_mov_b32 s51, 0
    s_waitcnt vmcnt(0)
ch03_ROK:
    v_pk_add_f32 v[28:29], v[28:29], v[30:31]
    s_not_b32 s48, s48
    v_add_f32 v28, v28, v29
    v_cvt_pk_bf16_f32 v28, v28, v28
    v_bfi_b32 v28, v19, s48, v28
    buffer_store_short v28, v3, s[16:19], 0 offen
    v_mov_b64 v[40:41], v[32:33]
    v_mov_b64 v[42:43], v[34:35]
    v_mov_b64 v[44:45], v[36:37]
    v_mov_b64 v[46:47], v[38:39]
    s_branch ch_loop_0_3
ch_ent_0_3:
    ds_read_b128 v[112:115], v1 offset:12288
    ds_read_b128 v[116:119], v1 offset:13312
    ds_read_b128 v[120:123], v1 offset:14336
    ds_read_b128 v[124:127], v1 offset:15360
    ds_read_b128 v[128:131], v1 offset:28672
    ds_read_b128 v[132:135], v1 offset:29696
    ds_read_b128 v[136:139], v1 offset:30720
    ds_read_b128 v[140:143], v1 offset:31744
    s_branch ch_loop_0_3
ch03_KVW:
    s_cmp_ge_u32 s56, 64
    s_cbranch_scc1 ch03_KVOK
    s_mov_b32 s59, 0x40000
ch03_kp:
    v_lshrrev_b32 v20, 2, v1
    v_and_b32 v20, 63, v20
    buffer_load_dword v21, v20, s[96:99], s58 offen sc1
    s_waitcnt vmcnt(0)
    v_subrev_u32 v21, s101, v21
    v_cmp_lt_u32 vcc, 16, v21
    s_nop 1
    v_cndmask_b32 v21, v21, 0, vcc
    s_nop 1
    v_min_u32_dpp v21, v21, v21 quad_perm:[1,0,3,2] row_mask:0xf bank_mask:0xf
    s_nop 1
    v_min_u32_dpp v21, v21, v21 quad_perm:[2,3,0,1] row_mask:0xf bank_mask:0xf
    s_nop 1
    v_min_u32_dpp v21, v21, v21 row_half_mirror row_mask:0xf bank_mask:0xf
    s_nop 1
    v_min_u32_dpp v21, v21, v21 row_mirror row_mask:0xf bank_mask:0xf
    s_nop 0
    v_readfirstlane_b32 s57, v21
    s_lshl_b32 s57, s57, 2
    s_sub_u32 s59, s59, 1
    s_cbranch_scc1 ch03_kd
    s_cmp_ge_u32 s56, s57
    s_cbranch_scc1 ch03_kp
ch03_kd:
    s_branch ch03_KVOK
ch_fin:
    v_lshrrev_b32 v30, 1, v1
    buffer_store_dwordx4 v[68:71], v1, s[28:31], s42 offen sc1
    buffer_store_dwordx2 v[64:65], v30, s[32:35], s43 offen sc1
    s_waitcnt vmcnt(0)
    s_barrier
    s_add_u32 s62, s101, 64
    v_mov_b32 v20, s62
    buffer_store_dword v20, v7, s[96:99], s49 offen sc1
ch_fin2:
    s_add_u32 s100, s4, 224
    s_branch xs_entry
ch_end:
    s_endpgm
hp_entry:
    s_mov_b32 s100, s4
    s_load_dwordx16 s[64:79], s[0:1], 0
    s_load_dwordx16 s[80:95], s[0:1], 64
    s_load_dwordx2 s[10:11], s[0:1], 128
    v_mbcnt_lo_u32_b32 v1, -1, 0
    v_mbcnt_hi_u32_b32 v1, -1, v1
    s_lshl_b32 s5, s3, 6
    v_add_u32 v0, s5, v1
    s_waitcnt lgkmcnt(0)
    s_add_u32 s40, s10, 0x7800000
    s_addc_u32 s41, s11, 0
    s_mov_b32 s42, 0x18000
    s_mov_b32 s43, 0x20000
    s_mov_b32 s12, s64
    s_mov_b32 s13, s65
    s_mov_b32 s14, 0x200000
    s_mov_b32 s15, 0x20000
    s_lshl_b32 s33, s100, 2
    s_add_u32 s33, s33, s3
    v_lshlrev_b32 v64, 4, v1
    s_lshl_b32 s34, s33, 10
    buffer_load_dwordx4 v[68:71], v64, s[12:15], s34 offen
    s_add_u32 s34, s34, 786432
    buffer_load_dwordx4 v[72:75], v64, s[12:15], s34 offen
    s_add_u32 s34, s34, 786432
    buffer_load_dwordx4 v[76:79], v64, s[12:15], s34 offen
    s_add_u32 s34, s34, 786432
    s_cmp_ge_u32 s100, 192
    s_cbranch_scc1 hp_nodma
    s_lshr_b32 s30, s100, 6
    s_and_b32 s31, s100, 63
    s_cmp_eq_u32 s30, 0
    s_cselect_b32 s12, s70, s72
    s_cselect_b32 s13, s71, s73
    s_cmp_eq_u32 s30, 2
    s_cselect_b32 s12, s68, s12
    s_cselect_b32 s13, s69, s13
    s_mov_b32 s14, 0x400000
    s_mov_b32 s15, 0x20000
    v_lshrrev_b32 v3, 3, v1
    v_and_b32 v4, 7, v1
    v_lshlrev_b32 v5, 1, v3
    v_and_b32 v5, 4, v5
    v_xor_b32 v4, v4, v5
    v_lshlrev_b32 v3, 13, v3
    v_lshl_add_u32 v3, v4, 4, v3
    s_lshl_b32 s44, s31, 7
    s_lshl_b32 s45, s3, 20
    s_add_u32 s44, s44, s45
    s_lshl_b32 s35, s3, 14
    v_mov_b32 v120, v3
    s_mov_b32 s53, s44
    s_mov_b32 s54, s35
    s_mov_b32 s56, s12
    s_mov_b32 s57, s13
    s_mov_b32 s58, s14
    s_mov_b32 s59, 0x20000
    s_add_u32 m0, s54, 0
    s_add_u32 s45, s53, 0
    buffer_load_dwordx4 v120, s[56:59], s45 offen lds
    s_add_u32 m0, s54, 1024
    s_add_u32 s45, s53, 65536
    buffer_load_dwordx4 v120, s[56:59], s45 offen lds
    s_add_u32 m0, s54, 2048
    s_add_u32 s45, s53, 131072
    buffer_load_dwordx4 v120, s[56:59], s45 offen lds
    s_add_u32 m0, s54, 3072
    s_add_u32 s45, s53, 196608
    buffer_load_dwordx4 v120, s[56:59], s45 offen lds
    s_add_u32 m0, s54, 4096
    s_add_u32 s45, s53, 262144
    buffer_load_dwordx4 v120, s[56:59], s45 offen lds
    s_add_u32 m0, s54, 5120
    s_add_u32 s45, s53, 327680
    buffer_load_dwordx4 v120, s[56:59], s45 offen lds
    s_add_u32 m0, s54, 6144
    s_add_u32 s45, s53, 393216
    buffer_load_dwordx4 v120, s[56:59], s45 offen lds
    s_add_u32 m0, s54, 7168
    s_add_u32 s45, s53, 458752
    buffer_load_dwordx4 v120, s[56:59], s45 offen lds
    s_add_u32 m0, s54, 8192
    s_add_u32 s45, s53, 524288
    buffer_load_dwordx4 v120, s[56:59], s45 offen lds
    s_add_u32 m0, s54, 9216
    s_add_u32 s45, s53, 589824
    buffer_load_dwordx4 v120, s[56:59], s45 offen lds
    s_add_u32 m0, s54, 10240
    s_add_u32 s45, s53, 655360
    buffer_load_dwordx4 v120, s[56:59], s45 offen lds
    s_add_u32 m0, s54, 11264
    s_add_u32 s45, s53, 720896
    buffer_load_dwordx4 v120, s[56:59], s45 offen lds
    s_add_u32 m0, s54, 12288
    s_add_u32 s45, s53, 786432
    buffer_load_dwordx4 v120, s[56:59], s45 offen lds
    s_add_u32 m0, s54, 13312
    s_add_u32 s45, s53, 851968
    buffer_load_dwordx4 v120, s[56:59], s45 offen lds
    s_add_u32 m0, s54, 14336
    s_add_u32 s45, s53, 917504
    buffer_load_dwordx4 v120, s[56:59], s45 offen lds
    s_add_u32 m0, s54, 15360
    s_add_u32 s45, s53, 983040
    buffer_load_dwordx4 v120, s[56:59], s45 offen lds
    s_branch hp_nomod
hp_nodma:
    s_mov_b32 s16, s88
    s_mov_b32 s17, s89
    s_mov_b32 s18, 0x400
    s_mov_b32 s19, 0x20000
    s_mov_b32 s20, s90
    s_mov_b32 s21, s91
    s_mov_b32 s22, 0x300000
    s_mov_b32 s23, 0x20000
    s_mov_b32 s24, s10
    s_mov_b32 s25, s11
    s_mov_b32 s26, 0x3000
    s_mov_b32 s27, 0x20000
    v_lshrrev_b32 v3, 2, v0
    v_and_b32 v4, 3, v0
    v_lshlrev_b32 v5, 4, v3
    buffer_load_dwordx4 v[8:11], v5, s[16:19], 0 offen
    s_mov_b32 s28, 49152
    v_mul_lo_u32 v6, v3, s28
    v_lshl_add_u32 v6, v4, 4, v6
    s_sub_u32 s30, s100, 192
    s_lshl_b32 s29, s30, 6
    v_mov_b32 v30, v6
    s_lshl_b32 s45, s30, 6
    s_add_u32 s48, s10, 0x10000
    s_addc_u32 s49, s11, 0
    s_mov_b32 s50, 0x2000
    s_mov_b32 s51, 0x20000
    s_add_u32 s44, s45, 0
    buffer_load_dwordx4 v[80:83], v30, s[20:23], s44 offen
    s_add_u32 s44, s45, 6144
    buffer_load_dwordx4 v[84:87], v30, s[20:23], s44 offen
    s_add_u32 s44, s45, 12288
    buffer_load_dwordx4 v[88:91], v30, s[20:23], s44 offen
    s_add_u32 s44, s45, 18432
    buffer_load_dwordx4 v[92:95], v30, s[20:23], s44 offen
    s_add_u32 s44, s45, 24576
    buffer_load_dwordx4 v[96:99], v30, s[20:23], s44 offen
    s_add_u32 s44, s45, 30720
    buffer_load_dwordx4 v[100:103], v30, s[20:23], s44 offen
    s_add_u32 s44, s45, 36864
    buffer_load_dwordx4 v[104:107], v30, s[20:23], s44 offen
    s_add_u32 s44, s45, 43008
    buffer_load_dwordx4 v[108:111], v30, s[20:23], s44 offen
    v_lshlrev_b32 v14, 5, v0
    v_and_b32 v3, 31, v0
    v_lshrrev_b32 v4, 5, v0
    v_lshlrev_b32 v15, 10, v4
    v_lshl_add_u32 v15, v3, 2, v15
    v_lshlrev_b32 v5, 2, v0
    v_lshlrev_b32 v6, 2, v3
    v_lshlrev_b32 v7, 3, v3
    s_waitcnt vmcnt(8)
    v_lshlrev_b32 v48, 16, v8
    v_and_b32 v49, 0xffff0000, v8
    v_lshlrev_b32 v50, 16, v9
    v_and_b32 v51, 0xffff0000, v9
    v_lshlrev_b32 v52, 16, v10
    v_and_b32 v53, 0xffff0000, v10
    v_lshlrev_b32 v54, 16, v11
    v_and_b32 v55, 0xffff0000, v11
    v_mul_f32 v56, 0xbfb8aa3b, v48
    v_mul_f32 v57, 0xbfb8aa3b, v49
    v_mul_f32 v58, 0xbfb8aa3b, v50
    v_mul_f32 v59, 0xbfb8aa3b, v51
    v_mul_f32 v60, 0xbfb8aa3b, v52
    v_mul_f32 v61, 0xbfb8aa3b, v53
    v_mul_f32 v62, 0xbfb8aa3b, v54
    v_mul_f32 v63, 0xbfb8aa3b, v55
    v_exp_f32 v56, v56
    v_exp_f32 v57, v57
    v_exp_f32 v58, v58
    v_exp_f32 v59, v59
    v_exp_f32 v60, v60
    v_exp_f32 v61, v61
    v_exp_f32 v62, v62
    v_exp_f32 v63, v63
    v_add_f32 v56, 1.0, v56
    v_add_f32 v57, 1.0, v57
    v_add_f32 v58, 1.0, v58
    v_add_f32 v59, 1.0, v59
    v_add_f32 v60, 1.0, v60
    v_add_f32 v61, 1.0, v61
    v_add_f32 v62, 1.0, v62
    v_add_f32 v63, 1.0, v63
    v_rcp_f32 v56, v56
    v_rcp_f32 v57, v57
    v_rcp_f32 v58, v58
    v_rcp_f32 v59, v59
    v_rcp_f32 v60, v60
    v_rcp_f32 v61, v61
    v_rcp_f32 v62, v62
    v_rcp_f32 v63, v63
    v_mul_f32 v48, v48, v56
    v_mul_f32 v49, v49, v57
    v_mul_f32 v50, v50, v58
    v_mul_f32 v51, v51, v59
    v_mul_f32 v52, v52, v60
    v_mul_f32 v53, v53, v61
    v_mul_f32 v54, v54, v62
    v_mul_f32 v55, v55, v63
    v_cvt_pk_bf16_f32 v12, v48, v49
    v_lshlrev_b32 v48, 16, v12
    v_and_b32 v49, 0xffff0000, v12
    v_cvt_pk_bf16_f32 v12, v50, v51
    v_lshlrev_b32 v50, 16, v12
    v_and_b32 v51, 0xffff0000, v12
    v_cvt_pk_bf16_f32 v12, v52, v53
    v_lshlrev_b32 v52, 16, v12
    v_and_b32 v53, 0xffff0000, v12
    v_cvt_pk_bf16_f32 v12, v54, v55
    v_lshlrev_b32 v54, 16, v12
    v_and_b32 v55, 0xffff0000, v12
    s_lshl_b32 s29, s30, 7
    s_lshl_b32 s28, s30, 8
    s_mov_b32 s31, 0
    s_waitcnt vmcnt(0)
hp_modl:
    v_lshlrev_b32 v12, 16, v80
    v_and_b32 v13, 0xffff0000, v80
    v_mul_f32 v56, v48, v12
    v_mul_f32 v57, v48, v13
    v_lshlrev_b32 v12, 16, v81
    v_and_b32 v13, 0xffff0000, v81
    v_mul_f32 v58, v48, v12
    v_mul_f32 v59, v48, v13
    v_lshlrev_b32 v12, 16, v82
    v_and_b32 v13, 0xffff0000, v82
    v_mul_f32 v60, v48, v12
    v_mul_f32 v61, v48, v13
    v_lshlrev_b32 v12, 16, v83
    v_and_b32 v13, 0xffff0000, v83
    v_mul_f32 v62, v48, v12
    v_mul_f32 v63, v48, v13
    v_lshlrev_b32 v12, 16, v84
    v_and_b32 v13, 0xffff0000, v84
    v_fmac_f32 v56, v49, v12
    v_fmac_f32 v57, v49, v13
    v_lshlrev_b32 v12, 16, v85
    v_and_b32 v13, 0xffff0000, v85
    v_fmac_f32 v58, v49, v12
    v_fmac_f32 v59, v49, v13
    v_lshlrev_b32 v12, 16, v86
    v_and_b32 v13, 0xffff0000, v86
    v_fmac_f32 v60, v49, v12
    v_fmac_f32 v61, v49, v13
    v_lshlrev_b32 v12, 16, v87
    v_and_b32 v13, 0xffff0000, v87
    v_fmac_f32 v62, v49, v12
    v_fmac_f32 v63, v49, v13
    v_lshlrev_b32 v12, 16, v88
    v_and_b32 v13, 0xffff0000, v88
    v_fmac_f32 v56, v50, v12
    v_fmac_f32 v57, v50, v13
    v_lshlrev_b32 v12, 16, v89
    v_and_b32 v13, 0xffff0000, v89
    v_fmac_f32 v58, v50, v12
    v_fmac_f32 v59, v50, v13
    v_lshlrev_b32 v12, 16, v90
    v_and_b32 v13, 0xffff0000, v90
    v_fmac_f32 v60, v50, v12
    v_fmac_f32 v61, v50, v13
    v_lshlrev_b32 v12, 16, v91
    v_and_b32 v13, 0xffff0000, v91
    v_fmac_f32 v62, v50, v12
    v_fmac_f32 v63, v50, v13
    v_lshlrev_b32 v12, 16, v92
    v_and_b32 v13, 0xffff0000, v92
    v_fmac_f32 v56, v51, v12
    v_fmac_f32 v57, v51, v13
    v_lshlrev_b32 v12, 16, v93
    v_and_b32 v13, 0xffff0000, v93
    v_fmac_f32 v58, v51, v12
    v_fmac_f32 v59, v51, v13
    v_lshlrev_b32 v12, 16, v94
    v_and_b32 v13, 0xffff0000, v94
    v_fmac_f32 v60, v51, v12
    v_fmac_f32 v61, v51, v13
    v_lshlrev_b32 v12, 16, v95
    v_and_b32 v13, 0xffff0000, v95
    v_fmac_f32 v62, v51, v12
    v_fmac_f32 v63, v51, v13
    v_lshlrev_b32 v12, 16, v96
    v_and_b32 v13, 0xffff0000, v96
    v_fmac_f32 v56, v52, v12
    v_fmac_f32 v57, v52, v13
    v_lshlrev_b32 v12, 16, v97
    v_and_b32 v13, 0xffff0000, v97
    v_fmac_f32 v58, v52, v12
    v_fmac_f32 v59, v52, v13
    v_lshlrev_b32 v12, 16, v98
    v_and_b32 v13, 0xffff0000, v98
    v_fmac_f32 v60, v52, v12
    v_fmac_f32 v61, v52, v13
    v_lshlrev_b32 v12, 16, v99
    v_and_b32 v13, 0xffff0000, v99
    v_fmac_f32 v62, v52, v12
    v_fmac_f32 v63, v52, v13
    v_lshlrev_b32 v12, 16, v100
    v_and_b32 v13, 0xffff0000, v100
    v_fmac_f32 v56, v53, v12
    v_fmac_f32 v57, v53, v13
    v_lshlrev_b32 v12, 16, v101
    v_and_b32 v13, 0xffff0000, v101
    v_fmac_f32 v58, v53, v12
    v_fmac_f32 v59, v53, v13
    v_lshlrev_b32 v12, 16, v102
    v_and_b32 v13, 0xffff0000, v102
    v_fmac_f32 v60, v53, v12
    v_fmac_f32 v61, v53, v13
    v_lshlrev_b32 v12, 16, v103
    v_and_b32 v13, 0xffff0000, v103
    v_fmac_f32 v62, v53, v12
    v_fmac_f32 v63, v53, v13
    v_lshlrev_b32 v12, 16, v104
    v_and_b32 v13, 0xffff0000, v104
    v_fmac_f32 v56, v54, v12
    v_fmac_f32 v57, v54, v13
    v_lshlrev_b32 v12, 16, v105
    v_and_b32 v13, 0xffff0000, v105
    v_fmac_f32 v58, v54, v12
    v_fmac_f32 v59, v54, v13
    v_lshlrev_b32 v12, 16, v106
    v_and_b32 v13, 0xffff0000, v106
    v_fmac_f32 v60, v54, v12
    v_fmac_f32 v61, v54, v13
    v_lshlrev_b32 v12, 16, v107
    v_and_b32 v13, 0xffff0000, v107
    v_fmac_f32 v62, v54, v12
    v_fmac_f32 v63, v54, v13
    v_lshlrev_b32 v12, 16, v108
    v_and_b32 v13, 0xffff0000, v108
    v_fmac_f32 v56, v55, v12
    v_fmac_f32 v57, v55, v13
    v_lshlrev_b32 v12, 16, v109
    v_and_b32 v13, 0xffff0000, v109
    v_fmac_f32 v58, v55, v12
    v_fmac_f32 v59, v55, v13
    v_lshlrev_b32 v12, 16, v110
    v_and_b32 v13, 0xffff0000, v110
    v_fmac_f32 v60, v55, v12
    v_fmac_f32 v61, v55, v13
    v_lshlrev_b32 v12, 16, v111
    v_and_b32 v13, 0xffff0000, v111
    v_fmac_f32 v62, v55, v12
    v_fmac_f32 v63, v55, v13
    ds_write_b128 v14, v[56:59]
    ds_write_b128 v14, v[60:63] offset:16
    s_waitcnt lgkmcnt(0)
    s_barrier
    ds_read_b32 v16, v15 offset:0
    ds_read_b32 v17, v15 offset:128
    ds_read_b32 v18, v15 offset:256
    ds_read_b32 v19, v15 offset:384
    ds_read_b32 v20, v15 offset:512
    ds_read_b32 v21, v15 offset:640
    ds_read_b32 v22, v15 offset:768
    ds_read_b32 v23, v15 offset:896
    s_waitcnt lgkmcnt(0)
    v_add_f32 v16, v16, v17
    v_add_f32 v16, v16, v18
    v_add_f32 v16, v16, v19
    v_add_f32 v16, v16, v20
    v_add_f32 v16, v16, v21
    v_add_f32 v16, v16, v22
    v_add_f32 v16, v16, v23
    ds_write_b32 v5, v16 offset:8192
    s_waitcnt lgkmcnt(0)
    s_barrier
    ds_read_b32 v16, v6 offset:8192
    ds_read_b32 v17, v6 offset:8320
    ds_read_b32 v18, v6 offset:8448
    ds_read_b32 v19, v6 offset:8576
    ds_read_b32 v20, v6 offset:8704
    ds_read_b32 v21, v6 offset:8832
    ds_read_b32 v22, v6 offset:8960
    ds_read_b32 v23, v6 offset:9088
    s_waitcnt lgkmcnt(0)
    v_add_f32 v16, v16, v17
    v_add_f32 v16, v16, v18
    v_add_f32 v16, v16, v19
    v_add_f32 v16, v16, v20
    v_add_f32 v16, v16, v21
    v_add_f32 v16, v16, v22
    v_add_f32 v16, v16, v23
    v_cvt_pk_bf16_f32 v16, v16, v16
    v_and_b32 v16, 0xffff0000, v16
    v_mov_b32 v17, s101
    s_cmp_lg_u32 s3, 0
    s_cbranch_scc1 hp_mods
    buffer_store_dwordx2 v[16:17], v7, s[48:51], s28 offen sc1
    buffer_store_dword v16, v6, s[24:27], s29 offen sc1
hp_mods:
    s_cmp_lg_u32 s31, 0
    s_cbranch_scc1 hp_modt
    s_add_u32 s44, s45, 2048
    buffer_load_dwordx4 v[112:115], v30, s[20:23], s44 offen
    s_add_u32 s44, s45, 8192
    buffer_load_dwordx4 v[116:119], v30, s[20:23], s44 offen
    s_add_u32 s44, s45, 14336
    buffer_load_dwordx4 v[120:123], v30, s[20:23], s44 offen
    s_add_u32 s44, s45, 20480
    buffer_load_dwordx4 v[124:127], v30, s[20:23], s44 offen
    s_add_u32 s44, s45, 26624
    buffer_load_dwordx4 v[128:131], v30, s[20:23], s44 offen
    s_add_u32 s44, s45, 32768
    buffer_load_dwordx4 v[132:135], v30, s[20:23], s44 offen
    s_add_u32 s44, s45, 38912
    buffer_load_dwordx4 v[136:139], v30, s[20:23], s44 offen
    s_add_u32 s44, s45, 45056
    buffer_load_dwordx4 v[140:143], v30, s[20:23], s44 offen
    s_add_u32 s44, s45, 4096
    buffer_load_dwordx4 v[144:147], v30, s[20:23], s44 offen
    s_add_u32 s44, s45, 10240
    buffer_load_dwordx4 v[148:151], v30, s[20:23], s44 offen
    s_add_u32 s44, s45, 16384
    buffer_load_dwordx4 v[152:155], v30, s[20:23], s44 offen
    s_add_u32 s44, s45, 22528
    buffer_load_dwordx4 v[156:159], v30, s[20:23], s44 offen
    s_add_u32 s44, s45, 28672
    buffer_load_dwordx4 v[160:163], v30, s[20:23], s44 offen
    s_add_u32 s44, s45, 34816
    buffer_load_dwordx4 v[164:167], v30, s[20:23], s44 offen
    s_add_u32 s44, s45, 40960
    buffer_load_dwordx4 v[168:171], v30, s[20:23], s44 offen
    s_add_u32 s44, s45, 47104
    buffer_load_dwordx4 v[172:175], v30, s[20:23], s44 offen
hp_modt:
    s_add_u32 s29, s29, 4096
    s_add_u32 s28, s28, 8192
    s_waitcnt vmcnt(0)
    v_mov_b64 v[80:81], v[112:113]
    v_mov_b64 v[82:83], v[114:115]
    v_mov_b64 v[84:85], v[116:117]
    v_mov_b64 v[86:87], v[118:119]
    v_mov_b64 v[88:89], v[120:121]
    v_mov_b64 v[90:91], v[122:123]
    v_mov_b64 v[92:93], v[124:125]
    v_mov_b64 v[94:95], v[126:127]
    v_mov_b64 v[96:97], v[128:129]
    v_mov_b64 v[98:99], v[130:131]
    v_mov_b64 v[100:101], v[132:133]
    v_mov_b64 v[102:103], v[134:135]
    v_mov_b64 v[104:105], v[136:137]
    v_mov_b64 v[106:107], v[138:139]
    v_mov_b64 v[108:109], v[140:141]
    v_mov_b64 v[110:111], v[142:143]
    v_mov_b64 v[112:113], v[144:145]
    v_mov_b64 v[114:115], v[146:147]
    v_mov_b64 v[116:117], v[148:149]
    v_mov_b64 v[118:119], v[150:151]
    v_mov_b64 v[120:121], v[152:153]
    v_mov_b64 v[122:123], v[154:155]
    v_mov_b64 v[124:125], v[156:157]
    v_mov_b64 v[126:127], v[158:159]
    v_mov_b64 v[128:129], v[160:161]
    v_mov_b64 v[130:131], v[162:163]
    v_mov_b64 v[132:133], v[164:165]
    v_mov_b64 v[134:135], v[166:167]
    v_mov_b64 v[136:137], v[168:169]
    v_mov_b64 v[138:139], v[170:171]
    v_mov_b64 v[140:141], v[172:173]
    v_mov_b64 v[142:143], v[174:175]
    s_add_u32 s31, s31, 1
    s_cmp_lt_u32 s31, 3
    s_cbranch_scc1 hp_modl
    s_branch hp_pool6
hp_nomod:
    s_add_u32 s16, s10, 0x10000
    s_addc_u32 s17, s11, 0
    s_mov_b32 s18, 0x2000
    s_mov_b32 s19, 0x20000
    s_add_u32 s20, s10, 0x100000
    s_addc_u32 s21, s11, 0
    s_mov_b32 s22, 0x200000
    s_mov_b32 s23, 0x20000
    v_lshlrev_b32 v3, 6, v1
    s_movk_i32 s35, 0x1000
    v_lshrrev_b32 v33, 1, v1
    v_lshlrev_b32 v32, 10, v33
    v_and_b32 v33, 1, v1
    v_lshl_add_u32 v32, v33, 9, v32
    s_mov_b32 s98, 0x20000
hp_mp:
    buffer_load_dwordx4 v[80:83], v3, s[16:19], 0 offen offset:0 sc1
    buffer_load_dwordx4 v[84:87], v3, s[16:19], 0 offen offset:16 sc1
    buffer_load_dwordx4 v[88:91], v3, s[16:19], 0 offen offset:32 sc1
    buffer_load_dwordx4 v[92:95], v3, s[16:19], 0 offen offset:48 sc1
    buffer_load_dwordx4 v[96:99], v3, s[16:19], s35 offen offset:0 sc1
    buffer_load_dwordx4 v[100:103], v3, s[16:19], s35 offen offset:16 sc1
    buffer_load_dwordx4 v[104:107], v3, s[16:19], s35 offen offset:32 sc1
    buffer_load_dwordx4 v[108:111], v3, s[16:19], s35 offen offset:48 sc1
    v_mov_b32 v4, 0
    s_waitcnt vmcnt(0)
    v_bitop3_b32 v5, v81, v83, s101 bitop3:0x7e
    v_or_b32 v4, v4, v5
    v_bitop3_b32 v5, v85, v87, s101 bitop3:0x7e
    v_or_b32 v4, v4, v5
    v_bitop3_b32 v5, v89, v91, s101 bitop3:0x7e
    v_or_b32 v4, v4, v5
    v_bitop3_b32 v5, v93, v95, s101 bitop3:0x7e
    v_or_b32 v4, v4, v5
    v_bitop3_b32 v5, v97, v99, s101 bitop3:0x7e
    v_or_b32 v4, v4, v5
    v_bitop3_b32 v5, v101, v103, s101 bitop3:0x7e
    v_or_b32 v4, v4, v5
    v_bitop3_b32 v5, v105, v107, s101 bitop3:0x7e
    v_or_b32 v4, v4, v5
    v_bitop3_b32 v5, v109, v111, s101 bitop3:0x7e
    v_or_b32 v4, v4, v5
    v_cmp_ne_u32 vcc, 0, v4
    s_cbranch_vccz hp_md
    s_sleep 2
    s_sub_u32 s98, s98, 1
    s_cbranch_scc0 hp_mp
hp_md:
    v_mov_b32 v24, v80
    v_mov_b32 v25, v82
    v_mov_b32 v26, v84
    v_mov_b32 v27, v86
    v_mov_b32 v28, v88
    v_mov_b32 v29, v90
    v_mov_b32 v30, v92
    v_mov_b32 v31, v94
    v_add_f32 v16, 1.0, v96
    v_add_f32 v17, 1.0, v98
    v_add_f32 v18, 1.0, v100
    v_add_f32 v19, 1.0, v102
    v_add_f32 v20, 1.0, v104
    v_add_f32 v21, 1.0, v106
    v_add_f32 v22, 1.0, v108
    v_add_f32 v23, 1.0, v110
    v_cvt_pk_bf16_f32 v33, v16, v17
    v_lshlrev_b32 v16, 16, v33
    v_and_b32 v17, 0xffff0000, v33
    v_cvt_pk_bf16_f32 v33, v18, v19
    v_lshlrev_b32 v18, 16, v33
    v_and_b32 v19, 0xffff0000, v33
    v_cvt_pk_bf16_f32 v33, v20, v21
    v_lshlrev_b32 v20, 16, v33
    v_and_b32 v21, 0xffff0000, v33
    v_cvt_pk_bf16_f32 v33, v22, v23
    v_lshlrev_b32 v22, 16, v33
    v_and_b32 v23, 0xffff0000, v33
    s_lshr_b32 s34, s33, 5
    s_lshl_b32 s34, s34, 15
    s_and_b32 s35, s33, 31
    s_lshl_b32 s35, s35, 4
    s_add_u32 s34, s34, s35
    s_lshl_b32 s35, s33, 2
    s_add_u32 s35, s35, 20480
    s_mov_b32 s28, 1
    v_mov_b32 v64, 0
hp_lnl:
    v_lshlrev_b32 v8, 16, v68
    v_and_b32 v9, 0xffff0000, v68
    v_lshlrev_b32 v10, 16, v69
    v_and_b32 v11, 0xffff0000, v69
    v_lshlrev_b32 v12, 16, v70
    v_and_b32 v13, 0xffff0000, v70
    v_lshlrev_b32 v14, 16, v71
    v_and_b32 v15, 0xffff0000, v71
    v_add_f32 v36, v8, v9
    v_add_f32 v36, v36, v10
    v_add_f32 v36, v36, v11
    v_add_f32 v36, v36, v12
    v_add_f32 v36, v36, v13
    v_add_f32 v36, v36, v14
    v_add_f32 v36, v36, v15
    s_nop 1
    v_add_f32_dpp v36, v36, v36 quad_perm:[1,0,3,2] row_mask:0xf bank_mask:0xf
    s_nop 1
    v_add_f32_dpp v36, v36, v36 quad_perm:[2,3,0,1] row_mask:0xf bank_mask:0xf
    s_nop 1
    v_add_f32_dpp v36, v36, v36 row_half_mirror row_mask:0xf bank_mask:0xf
    s_nop 1
    v_add_f32_dpp v36, v36, v36 row_mirror row_mask:0xf bank_mask:0xf
    v_mov_b32 v37, v36
    s_nop 1
    v_permlane16_swap_b32 v36, v37
    s_nop 0
    v_add_f32 v36, v36, v37
    v_mov_b32 v37, v36
    s_nop 1
    v_permlane32_swap_b32 v36, v37
    s_nop 0
    v_add_f32 v36, v36, v37
    v_mul_f32 v38, 0x3b000000, v36
    v_sub_f32 v39, v8, v38
    v_sub_f32 v40, v9, v38
    v_sub_f32 v41, v10, v38
    v_sub_f32 v42, v11, v38
    v_sub_f32 v43, v12, v38
    v_sub_f32 v44, v13, v38
    v_sub_f32 v45, v14, v38
    v_sub_f32 v46, v15, v38
    v_mul_f32 v36, v39, v39
    v_fmac_f32 v36, v40, v40
    v_fmac_f32 v36, v41, v41
    v_fmac_f32 v36, v42, v42
    v_fmac_f32 v36, v43, v43
    v_fmac_f32 v36, v44, v44
    v_fmac_f32 v36, v45, v45
    v_fmac_f32 v36, v46, v46
    s_nop 1
    v_add_f32_dpp v36, v36, v36 quad_perm:[1,0,3,2] row_mask:0xf bank_mask:0xf
    s_nop 1
    v_add_f32_dpp v36, v36, v36 quad_perm:[2,3,0,1] row_mask:0xf bank_mask:0xf
    s_nop 1
    v_add_f32_dpp v36, v36, v36 row_half_mirror row_mask:0xf bank_mask:0xf
    s_nop 1
    v_add_f32_dpp v36, v36, v36 row_mirror row_mask:0xf bank_mask:0xf
    v_mov_b32 v37, v36
    s_nop 1
    v_permlane16_swap_b32 v36, v37
    s_nop 0
    v_add_f32 v36, v36, v37
    v_mov_b32 v37, v36
    s_nop 1
    v_permlane32_swap_b32 v36, v37
    s_nop 0
    v_add_f32 v36, v36, v37
    v_mul_f32 v36, 0x3b000000, v36
    v_cvt_pk_bf16_f32 v37, v38, v36
    v_lshlrev_b32 v38, 16, v37
    v_and_b32 v36, 0xffff0000, v37
    v_add_f32 v36, 0x3727c5ac, v36
    v_cvt_pk_bf16_f32 v36, v36, v36
    v_and_b32 v36, 0xffff0000, v36
    v_sqrt_f32 v36, v36
    s_nop 0
    v_cvt_pk_bf16_f32 v36, v36, v36
    v_and_b32 v36, 0xffff0000, v36
    v_rcp_f32 v36, v36
    v_sub_f32 v8, v8, v38
    v_sub_f32 v9, v9, v38
    v_sub_f32 v10, v10, v38
    v_sub_f32 v11, v11, v38
    v_sub_f32 v12, v12, v38
    v_sub_f32 v13, v13, v38
    v_sub_f32 v14, v14, v38
    v_sub_f32 v15, v15, v38
    v_cvt_pk_bf16_f32 v37, v8, v9
    v_lshlrev_b32 v8, 16, v37
    v_and_b32 v9, 0xffff0000, v37
    v_cvt_pk_bf16_f32 v37, v10, v11
    v_lshlrev_b32 v10, 16, v37
    v_and_b32 v11, 0xffff0000, v37
    v_cvt_pk_bf16_f32 v37, v12, v13
    v_lshlrev_b32 v12, 16, v37
    v_and_b32 v13, 0xffff0000, v37
    v_cvt_pk_bf16_f32 v37, v14, v15
    v_lshlrev_b32 v14, 16, v37
    v_and_b32 v15, 0xffff0000, v37
    v_mul_f32 v8, v8, v36
    v_mul_f32 v9, v9, v36
    v_mul_f32 v10, v10, v36
    v_mul_f32 v11, v11, v36
    v_mul_f32 v12, v12, v36
    v_mul_f32 v13, v13, v36
    v_mul_f32 v14, v14, v36
    v_mul_f32 v15, v15, v36
    v_cvt_pk_bf16_f32 v37, v8, v9
    v_lshlrev_b32 v8, 16, v37
    v_and_b32 v9, 0xffff0000, v37
    v_cvt_pk_bf16_f32 v37, v10, v11
    v_lshlrev_b32 v10, 16, v37
    v_and_b32 v11, 0xffff0000, v37
    v_cvt_pk_bf16_f32 v37, v12, v13
    v_lshlrev_b32 v12, 16, v37
    v_and_b32 v13, 0xffff0000, v37
    v_cvt_pk_bf16_f32 v37, v14, v15
    v_lshlrev_b32 v14, 16, v37
    v_and_b32 v15, 0xffff0000, v37
    v_mul_f32 v8, v8, v16
    v_mul_f32 v9, v9, v17
    v_mul_f32 v10, v10, v18
    v_mul_f32 v11, v11, v19
    v_mul_f32 v12, v12, v20
    v_mul_f32 v13, v13, v21
    v_mul_f32 v14, v14, v22
    v_mul_f32 v15, v15, v23
    v_cvt_pk_bf16_f32 v37, v8, v9
    v_lshlrev_b32 v8, 16, v37
    v_and_b32 v9, 0xffff0000, v37
    v_cvt_pk_bf16_f32 v37, v10, v11
    v_lshlrev_b32 v10, 16, v37
    v_and_b32 v11, 0xffff0000, v37
    v_cvt_pk_bf16_f32 v37, v12, v13
    v_lshlrev_b32 v12, 16, v37
    v_and_b32 v13, 0xffff0000, v37
    v_cvt_pk_bf16_f32 v37, v14, v15
    v_lshlrev_b32 v14, 16, v37
    v_and_b32 v15, 0xffff0000, v37
    v_add_f32 v8, v8, v24
    v_add_f32 v9, v9, v25
    v_add_f32 v10, v10, v26
    v_add_f32 v11, v11, v27
    v_add_f32 v12, v12, v28
    v_add_f32 v13, v13, v29
    v_add_f32 v14, v14, v30
    v_add_f32 v15, v15, v31
    v_cvt_pk_bf16_f32 v4, v8, v9
    v_cvt_pk_bf16_f32 v5, v10, v11
    v_cvt_pk_bf16_f32 v6, v12, v13
    v_cvt_pk_bf16_f32 v7, v14, v15
    buffer_store_dwordx4 v[4:7], v32, s[20:23], s34 offen sc1
    s_add_u32 s34, s34, 786432
    v_mov_b64 v[68:69], v[72:73]
    v_mov_b64 v[70:71], v[74:75]
    v_mov_b64 v[72:73], v[76:77]
    v_mov_b64 v[74:75], v[78:79]
    s_cmp_eq_u32 s28, 2
    s_cbranch_scc1 hp_lnn
    s_waitcnt vmcnt(0)
    s_add_u32 s97, s101, s28
    v_mov_b32 v65, s97
    buffer_store_dword v65, v64, s[40:43], s35 offen sc1
hp_lnn:
    s_add_u32 s28, s28, 1
    s_cmp_lt_u32 s28, 4
    s_cbranch_scc1 hp_lnl
    s_waitcnt vmcnt(0)
    s_barrier
    s_add_u32 s16, s10, 0x100000
    s_addc_u32 s17, s11, 0
    s_mov_b32 s18, 0x200000
    s_mov_b32 s19, 0x20000
    s_add_u32 s32, s30, 2
    s_cmp_eq_u32 s30, 2
    s_cselect_b32 s32, 1, s32
    s_lshl_b32 s32, s32, 24
    s_add_u32 s20, s10, s32
    s_addc_u32 s21, s11, 0
    s_mov_b32 s22, 0x1000000
    s_mov_b32 s23, 0x20000
    v_lshrrev_b32 v3, 5, v1
    v_lshlrev_b32 v3, 3, v3
    v_bfe_u32 v4, v1, 2, 2
    v_add_u32 v3, v3, v4
    v_bfe_u32 v4, v1, 4, 1
    v_lshlrev_b32 v4, 1, v4
    v_bfe_u32 v5, v1, 1, 1
    v_add_u32 v4, v4, v5
    v_lshlrev_b32 v5, 1, v3
    v_and_b32 v5, 4, v5
    v_xor_b32 v7, v4, v5
    v_xor_b32 v8, 4, v7
    v_lshlrev_b32 v3, 7, v3
    v_and_b32 v4, 1, v1
    v_lshl_add_u32 v3, v4, 3, v3
    v_lshl_add_u32 v7, v7, 4, v3
    v_lshl_add_u32 v8, v8, 4, v3
    ds_read_b64_tr_b16 a[0:1], v7 offset:0
    ds_read_b64_tr_b16 a[2:3], v7 offset:512
    ds_read_b64_tr_b16 a[4:5], v8 offset:0
    ds_read_b64_tr_b16 a[6:7], v8 offset:512
    ds_read_b64_tr_b16 a[8:9], v7 offset:2048
    ds_read_b64_tr_b16 a[10:11], v7 offset:2560
    ds_read_b64_tr_b16 a[12:13], v8 offset:2048
    ds_read_b64_tr_b16 a[14:15], v8 offset:2560
    s_waitcnt lgkmcnt(4)
    ds_read_b64_tr_b16 a[16:17], v7 offset:4096
    ds_read_b64_tr_b16 a[18:19], v7 offset:4608
    ds_read_b64_tr_b16 a[20:21], v8 offset:4096
    ds_read_b64_tr_b16 a[22:23], v8 offset:4608
    ds_read_b64_tr_b16 a[24:25], v7 offset:6144
    ds_read_b64_tr_b16 a[26:27], v7 offset:6656
    ds_read_b64_tr_b16 a[28:29], v8 offset:6144
    ds_read_b64_tr_b16 a[30:31], v8 offset:6656
    s_waitcnt lgkmcnt(4)
    ds_read_b64_tr_b16 a[32:33], v7 offset:8192
    ds_read_b64_tr_b16 a[34:35], v7 offset:8704
    ds_read_b64_tr_b16 a[36:37], v8 offset:8192
    ds_read_b64_tr_b16 a[38:39], v8 offset:8704
    ds_read_b64_tr_b16 a[40:41], v7 offset:10240
    ds_read_b64_tr_b16 a[42:43], v7 offset:10752
    ds_read_b64_tr_b16 a[44:45], v8 offset:10240
    ds_read_b64_tr_b16 a[46:47], v8 offset:10752
    s_waitcnt lgkmcnt(4)
    ds_read_b64_tr_b16 a[48:49], v7 offset:12288
    ds_read_b64_tr_b16 a[50:51], v7 offset:12800
    ds_read_b64_tr_b16 a[52:53], v8 offset:12288
    ds_read_b64_tr_b16 a[54:55], v8 offset:12800
    ds_read_b64_tr_b16 a[56:57], v7 offset:14336
    ds_read_b64_tr_b16 a[58:59], v7 offset:14848
    ds_read_b64_tr_b16 a[60:61], v8 offset:14336
    ds_read_b64_tr_b16 a[62:63], v8 offset:14848
    s_waitcnt lgkmcnt(4)
    ds_read_b64_tr_b16 a[64:65], v7 offset:16384
    ds_read_b64_tr_b16 a[66:67], v7 offset:16896
    ds_read_b64_tr_b16 a[68:69], v8 offset:16384
    ds_read_b64_tr_b16 a[70:71], v8 offset:16896
    ds_read_b64_tr_b16 a[72:73], v7 offset:18432
    ds_read_b64_tr_b16 a[74:75], v7 offset:18944
    ds_read_b64_tr_b16 a[76:77], v8 offset:18432
    ds_read_b64_tr_b16 a[78:79], v8 offset:18944
    s_waitcnt lgkmcnt(4)
    ds_read_b64_tr_b16 a[80:81], v7 offset:20480
    ds_read_b64_tr_b16 a[82:83], v7 offset:20992
    ds_read_b64_tr_b16 a[84:85], v8 offset:20480
    ds_read_b64_tr_b16 a[86:87], v8 offset:20992
    ds_read_b64_tr_b16 a[88:89], v7 offset:22528
    ds_read_b64_tr_b16 a[90:91], v7 offset:23040
    ds_read_b64_tr_b16 a[92:93], v8 offset:22528
    ds_read_b64_tr_b16 a[94:95], v8 offset:23040
    s_waitcnt lgkmcnt(4)
    ds_read_b64_tr_b16 a[96:97], v7 offset:24576
    ds_read_b64_tr_b16 a[98:99], v7 offset:25088
    ds_read_b64_tr_b16 a[100:101], v8 offset:24576
    ds_read_b64_tr_b16 a[102:103], v8 offset:25088
    ds_read_b64_tr_b16 a[104:105], v7 offset:26624
    ds_read_b64_tr_b16 a[106:107], v7 offset:27136
    ds_read_b64_tr_b16 a[108:109], v8 offset:26624
    ds_read_b64_tr_b16 a[110:111], v8 offset:27136
    s_waitcnt lgkmcnt(4)
    ds_read_b64_tr_b16 a[112:113], v7 offset:28672
    ds_read_b64_tr_b16 a[114:115], v7 offset:29184
    ds_read_b64_tr_b16 a[116:117], v8 offset:28672
    ds_read_b64_tr_b16 a[118:119], v8 offset:29184
    ds_read_b64_tr_b16 a[120:121], v7 offset:30720
    ds_read_b64_tr_b16 a[122:123], v7 offset:31232
    ds_read_b64_tr_b16 a[124:125], v8 offset:30720
    ds_read_b64_tr_b16 a[126:127], v8 offset:31232
    s_waitcnt lgkmcnt(4)
    ds_read_b64_tr_b16 a[128:129], v7 offset:32768
    ds_read_b64_tr_b16 a[130:131], v7 offset:33280
    ds_read_b64_tr_b16 a[132:133], v8 offset:32768
    ds_read_b64_tr_b16 a[134:135], v8 offset:33280
    ds_read_b64_tr_b16 a[136:137], v7 offset:34816
    ds_read_b64_tr_b16 a[138:139], v7 offset:35328
    ds_read_b64_tr_b16 a[140:141], v8 offset:34816
    ds_read_b64_tr_b16 a[142:143], v8 offset:35328
    s_waitcnt lgkmcnt(4)
    ds_read_b64_tr_b16 a[144:145], v7 offset:36864
    ds_read_b64_tr_b16 a[146:147], v7 offset:37376
    ds_read_b64_tr_b16 a[148:149], v8 offset:36864
    ds_read_b64_tr_b16 a[150:151], v8 offset:37376
    ds_read_b64_tr_b16 a[152:153], v7 offset:38912
    ds_read_b64_tr_b16 a[154:155], v7 offset:39424
    ds_read_b64_tr_b16 a[156:157], v8 offset:38912
    ds_read_b64_tr_b16 a[158:159], v8 offset:39424
    s_waitcnt lgkmcnt(4)
    ds_read_b64_tr_b16 a[160:161], v7 offset:40960
    ds_read_b64_tr_b16 a[162:163], v7 offset:41472
    ds_read_b64_tr_b16 a[164:165], v8 offset:40960
    ds_read_b64_tr_b16 a[166:167], v8 offset:41472
    ds_read_b64_tr_b16 a[168:169], v7 offset:43008
    ds_read_b64_tr_b16 a[170:171], v7 offset:43520
    ds_read_b64_tr_b16 a[172:173], v8 offset:43008
    ds_read_b64_tr_b16 a[174:175], v8 offset:43520
    s_waitcnt lgkmcnt(4)
    ds_read_b64_tr_b16 a[176:177], v7 offset:45056
    ds_read_b64_tr_b16 a[178:179], v7 offset:45568
    ds_read_b64_tr_b16 a[180:181], v8 offset:45056
    ds_read_b64_tr_b16 a[182:183], v8 offset:45568
    ds_read_b64_tr_b16 a[184:185], v7 offset:47104
    ds_read_b64_tr_b16 a[186:187], v7 offset:47616
    ds_read_b64_tr_b16 a[188:189], v8 offset:47104
    ds_read_b64_tr_b16 a[190:191], v8 offset:47616
    s_waitcnt lgkmcnt(4)
    ds_read_b64_tr_b16 a[192:193], v7 offset:49152
    ds_read_b64_tr_b16 a[194:195], v7 offset:49664
    ds_read_b64_tr_b16 a[196:197], v8 offset:49152
    ds_read_b64_tr_b16 a[198:199], v8 offset:49664
    ds_read_b64_tr_b16 a[200:201], v7 offset:51200
    ds_read_b64_tr_b16 a[202:203], v7 offset:51712
    ds_read_b64_tr_b16 a[204:205], v8 offset:51200
    ds_read_b64_tr_b16 a[206:207], v8 offset:51712
    s_waitcnt lgkmcnt(4)
    ds_read_b64_tr_b16 a[208:209], v7 offset:53248
    ds_read_b64_tr_b16 a[210:211], v7 offset:53760
    ds_read_b64_tr_b16 a[212:213], v8 offset:53248
    ds_read_b64_tr_b16 a[214:215], v8 offset:53760
    ds_read_b64_tr_b16 a[216:217], v7 offset:55296
    ds_read_b64_tr_b16 a[218:219], v7 offset:55808
    ds_read_b64_tr_b16 a[220:221], v8 offset:55296
    ds_read_b64_tr_b16 a[222:223], v8 offset:55808
    s_waitcnt lgkmcnt(4)
    ds_read_b64_tr_b16 a[224:225], v7 offset:57344
    ds_read_b64_tr_b16 a[226:227], v7 offset:57856
    ds_read_b64_tr_b16 a[228:229], v8 offset:57344
    ds_read_b64_tr_b16 a[230:231], v8 offset:57856
    ds_read_b64_tr_b16 a[232:233], v7 offset:59392
    ds_read_b64_tr_b16 a[234:235], v7 offset:59904
    ds_read_b64_tr_b16 a[236:237], v8 offset:59392
    ds_read_b64_tr_b16 a[238:239], v8 offset:59904
    s_waitcnt lgkmcnt(4)
    ds_read_b64_tr_b16 a[240:241], v7 offset:61440
    ds_read_b64_tr_b16 a[242:243], v7 offset:61952
    ds_read_b64_tr_b16 a[244:245], v8 offset:61440
    ds_read_b64_tr_b16 a[246:247], v8 offset:61952
    ds_read_b64_tr_b16 a[248:249], v7 offset:63488
    ds_read_b64_tr_b16 a[250:251], v7 offset:64000
    ds_read_b64_tr_b16 a[252:253], v8 offset:63488
    ds_read_b64_tr_b16 a[254:255], v8 offset:64000
    s_waitcnt lgkmcnt(4)
    v_lshrrev_b32 v4, 5, v1
    v_lshlrev_b32 v4, 9, v4
    v_and_b32 v3, 15, v1
    v_bfe_u32 v5, v1, 4, 1
    v_lshl_add_u32 v9, v3, 4, v4
    v_lshl_add_u32 v9, v5, 10, v9
    v_bfe_u32 v3, v1, 3, 1
    v_lshl_add_u32 v10, v3, 10, v4
    v_bfe_u32 v3, v1, 2, 1
    v_lshl_add_u32 v10, v3, 7, v10
    v_bfe_u32 v3, v1, 4, 1
    v_lshl_add_u32 v10, v3, 6, v10
    v_and_b32 v3, 3, v1
    v_lshl_add_u32 v10, v3, 4, v10
    s_cmp_lg_u32 s30, 2
    s_cselect_b64 s[44:45], -1, 0
    v_cndmask_b32 v9, v9, v10, s[44:45]
    s_lshl_b32 s47, s3, 18
    s_lshl_b32 s34, s31, 12
    s_add_u32 s47, s47, s34
    s_lshr_b32 s48, s31, 1
    s_lshl_b32 s48, s48, 7
    s_lshl_b32 s34, s30, 5
    s_add_u32 s48, s48, s34
    s_and_b32 s34, s31, 1
    s_lshl_b32 s34, s34, 4
    s_add_u32 s48, s48, s34
    s_lshl_b32 s34, s3, 2
    s_add_u32 s48, s48, s34
    v_mov_b32 v11, s101
    v_mov_b32 v12, 0
    v_lshlrev_b32 v6, 4, v1
    s_lshl_b32 s49, s3, 15
    v_lshlrev_b32 v13, 2, v1
    s_mul_i32 s52, s3, 768
    s_add_u32 s52, s52, 20480
    s_add_u32 s97, s101, 1
    s_mov_b32 s98, 0x40000
hpq_pp:
    buffer_load_dword v16, v13, s[40:43], s52 offen offset:0 sc1
    buffer_load_dword v17, v13, s[40:43], s52 offen offset:256 sc1
    buffer_load_dword v18, v13, s[40:43], s52 offen offset:512 sc1
    s_waitcnt vmcnt(0)
    v_subrev_u32 v16, s97, v16
    v_subrev_u32 v17, s97, v17
    v_subrev_u32 v18, s97, v18
    v_max_u32 v16, v16, v17
    v_max_u32 v16, v16, v18
    v_cmp_lt_u32 vcc, 2, v16
    s_cbranch_vccz hpq_pd
    s_sleep 2
    s_sub_u32 s98, s98, 1
    s_cbranch_scc0 hpq_pp
hpq_pd:
    s_barrier
    s_add_u32 s46, s49, 0
    buffer_load_dwordx4 v[64:67], v6, s[16:19], s46 offen offset:0
    buffer_load_dwordx4 v[68:71], v6, s[16:19], s46 offen offset:1024
    buffer_load_dwordx4 v[72:75], v6, s[16:19], s46 offen offset:2048
    buffer_load_dwordx4 v[76:79], v6, s[16:19], s46 offen offset:3072
    s_add_u32 s46, s49, 4096
    buffer_load_dwordx4 v[80:83], v6, s[16:19], s46 offen offset:0
    buffer_load_dwordx4 v[84:87], v6, s[16:19], s46 offen offset:1024
    buffer_load_dwordx4 v[88:91], v6, s[16:19], s46 offen offset:2048
    buffer_load_dwordx4 v[92:95], v6, s[16:19], s46 offen offset:3072
    s_add_u32 s46, s49, 8192
    buffer_load_dwordx4 v[96:99], v6, s[16:19], s46 offen offset:0
    buffer_load_dwordx4 v[100:103], v6, s[16:19], s46 offen offset:1024
    buffer_load_dwordx4 v[104:107], v6, s[16:19], s46 offen offset:2048
    buffer_load_dwordx4 v[108:111], v6, s[16:19], s46 offen offset:3072
    s_add_u32 s46, s49, 12288
    buffer_load_dwordx4 v[112:115], v6, s[16:19], s46 offen offset:0
    buffer_load_dwordx4 v[116:119], v6, s[16:19], s46 offen offset:1024
    buffer_load_dwordx4 v[120:123], v6, s[16:19], s46 offen offset:2048
    buffer_load_dwordx4 v[124:127], v6, s[16:19], s46 offen offset:3072
    s_mov_b32 s50, 16
    s_cmp_eq_u32 s30, 1
    s_cbranch_scc1 qkv_loopV
qkv_loopKQ:
    s_add_u32 s51, s49, 0x20000
    s_cmp_eq_u32 s50, 11
    s_cbranch_scc0 qkv_nlKQ
    s_add_u32 s97, s101, 3
    s_mov_b32 s98, 0x40000
hprKQ_pp:
    buffer_load_dword v48, v13, s[40:43], s52 offen offset:0 sc1
    buffer_load_dword v49, v13, s[40:43], s52 offen offset:256 sc1
    buffer_load_dword v50, v13, s[40:43], s52 offen offset:512 sc1
    s_waitcnt vmcnt(0)
    v_subrev_u32 v48, s97, v48
    v_subrev_u32 v49, s97, v49
    v_subrev_u32 v50, s97, v50
    v_max_u32 v48, v48, v49
    v_max_u32 v48, v48, v50
    v_cmp_lt_u32 vcc, 0, v48
    s_cbranch_vccz hprKQ_pd
    s_sleep 2
    s_sub_u32 s98, s98, 1
    s_cbranch_scc0 hprKQ_pp
hprKQ_pd:
    s_barrier
qkv_nlKQ:
    s_waitcnt vmcnt(15)
    v_mfma_f32_32x32x16_bf16 v[16:31], a[0:3], v[64:67], 0
    v_mfma_f32_32x32x16_bf16 v[32:47], a[4:7], v[64:67], 0
    s_add_u32 s46, s49, 16384
    buffer_load_dwordx4 v[64:67], v6, s[16:19], s46 offen offset:0
    s_waitcnt vmcnt(15)
    v_mfma_f32_32x32x16_bf16 v[16:31], a[8:11], v[68:71], v[16:31]
    v_mfma_f32_32x32x16_bf16 v[32:47], a[12:15], v[68:71], v[32:47]
    buffer_load_dwordx4 v[68:71], v6, s[16:19], s46 offen offset:1024
    s_waitcnt vmcnt(15)
    v_mfma_f32_32x32x16_bf16 v[16:31], a[16:19], v[72:75], v[16:31]
    v_mfma_f32_32x32x16_bf16 v[32:47], a[20:23], v[72:75], v[32:47]
    buffer_load_dwordx4 v[72:75], v6, s[16:19], s46 offen offset:2048
    s_waitcnt vmcnt(15)
    v_mfma_f32_32x32x16_bf16 v[16:31], a[24:27], v[76:79], v[16:31]
    v_mfma_f32_32x32x16_bf16 v[32:47], a[28:31], v[76:79], v[32:47]
    buffer_load_dwordx4 v[76:79], v6, s[16:19], s46 offen offset:3072
    s_waitcnt vmcnt(15)
    v_mfma_f32_32x32x16_bf16 v[16:31], a[32:35], v[80:83], v[16:31]
    v_mfma_f32_32x32x16_bf16 v[32:47], a[36:39], v[80:83], v[32:47]
    s_add_u32 s46, s49, 20480
    buffer_load_dwordx4 v[80:83], v6, s[16:19], s46 offen offset:0
    s_waitcnt vmcnt(15)
    v_mfma_f32_32x32x16_bf16 v[16:31], a[40:43], v[84:87], v[16:31]
    v_mfma_f32_32x32x16_bf16 v[32:47], a[44:47], v[84:87], v[32:47]
    buffer_load_dwordx4 v[84:87], v6, s[16:19], s46 offen offset:1024
    s_waitcnt vmcnt(15)
    v_mfma_f32_32x32x16_bf16 v[16:31], a[48:51], v[88:91], v[16:31]
    v_mfma_f32_32x32x16_bf16 v[32:47], a[52:55], v[88:91], v[32:47]
    buffer_load_dwordx4 v[88:91], v6, s[16:19], s46 offen offset:2048
    s_waitcnt vmcnt(15)
    v_mfma_f32_32x32x16_bf16 v[16:31], a[56:59], v[92:95], v[16:31]
    v_mfma_f32_32x32x16_bf16 v[32:47], a[60:63], v[92:95], v[32:47]
    buffer_load_dwordx4 v[92:95], v6, s[16:19], s46 offen offset:3072
    s_waitcnt vmcnt(15)
    v_mfma_f32_32x32x16_bf16 v[16:31], a[64:67], v[96:99], v[16:31]
    v_mfma_f32_32x32x16_bf16 v[32:47], a[68:71], v[96:99], v[32:47]
    s_add_u32 s46, s49, 24576
    buffer_load_dwordx4 v[96:99], v6, s[16:19], s46 offen offset:0
    s_waitcnt vmcnt(15)
    v_mfma_f32_32x32x16_bf16 v[16:31], a[72:75], v[100:103], v[16:31]
    v_mfma_f32_32x32x16_bf16 v[32:47], a[76:79], v[100:103], v[32:47]
    buffer_load_dwordx4 v[100:103], v6, s[16:19], s46 offen offset:1024
    s_waitcnt vmcnt(15)
    v_mfma_f32_32x32x16_bf16 v[16:31], a[80:83], v[104:107], v[16:31]
    v_mfma_f32_32x32x16_bf16 v[32:47], a[84:87], v[104:107], v[32:47]
    buffer_load_dwordx4 v[104:107], v6, s[16:19], s46 offen offset:2048
    s_waitcnt vmcnt(15)
    v_mfma_f32_32x32x16_bf16 v[16:31], a[88:91], v[108:111], v[16:31]
    v_mfma_f32_32x32x16_bf16 v[32:47], a[92:95], v[108:111], v[32:47]
    buffer_load_dwordx4 v[108:111], v6, s[16:19], s46 offen offset:3072
    s_waitcnt vmcnt(15)
    v_mfma_f32_32x32x16_bf16 v[16:31], a[96:99], v[112:115], v[16:31]
    v_mfma_f32_32x32x16_bf16 v[32:47], a[100:103], v[112:115], v[32:47]
    s_add_u32 s46, s49, 28672
    buffer_load_dwordx4 v[112:115], v6, s[16:19], s46 offen offset:0
    s_waitcnt vmcnt(15)
    v_mfma_f32_32x32x16_bf16 v[16:31], a[104:107], v[116:119], v[16:31]
    v_mfma_f32_32x32x16_bf16 v[32:47], a[108:111], v[116:119], v[32:47]
    buffer_load_dwordx4 v[116:119], v6, s[16:19], s46 offen offset:1024
    s_waitcnt vmcnt(15)
    v_mfma_f32_32x32x16_bf16 v[16:31], a[112:115], v[120:123], v[16:31]
    v_mfma_f32_32x32x16_bf16 v[32:47], a[116:119], v[120:123], v[32:47]
    buffer_load_dwordx4 v[120:123], v6, s[16:19], s46 offen offset:2048
    s_waitcnt vmcnt(15)
    v_mfma_f32_32x32x16_bf16 v[16:31], a[120:123], v[124:127], v[16:31]
    v_mfma_f32_32x32x16_bf16 v[32:47], a[124:127], v[124:127], v[32:47]
    buffer_load_dwordx4 v[124:127], v6, s[16:19], s46 offen offset:3072
    s_waitcnt vmcnt(15)
    v_mfma_f32_32x32x16_bf16 v[16:31], a[128:131], v[64:67], v[16:31]
    v_mfma_f32_32x32x16_bf16 v[32:47], a[132:135], v[64:67], v[32:47]
    s_add_u32 s46, s51, 0
    buffer_load_dwordx4 v[64:67], v6, s[16:19], s46 offen offset:0
    s_waitcnt vmcnt(15)
    v_mfma_f32_32x32x16_bf16 v[16:31], a[136:139], v[68:71], v[16:31]
    v_mfma_f32_32x32x16_bf16 v[32:47], a[140:143], v[68:71], v[32:47]
    buffer_load_dwordx4 v[68:71], v6, s[16:19], s46 offen offset:1024
    buffer_store_dword v11, v12, s[40:43], s48 offen sc1
    s_waitcnt vmcnt(15)
    v_mfma_f32_32x32x16_bf16 v[16:31], a[144:147], v[72:75], v[16:31]
    v_mfma_f32_32x32x16_bf16 v[32:47], a[148:151], v[72:75], v[32:47]
    buffer_load_dwordx4 v[72:75], v6, s[16:19], s46 offen offset:2048
    s_waitcnt vmcnt(15)
    v_mfma_f32_32x32x16_bf16 v[16:31], a[152:155], v[76:79], v[16:31]
    v_mfma_f32_32x32x16_bf16 v[32:47], a[156:159], v[76:79], v[32:47]
    buffer_load_dwordx4 v[76:79], v6, s[16:19], s46 offen offset:3072
    s_waitcnt vmcnt(15)
    v_mfma_f32_32x32x16_bf16 v[16:31], a[160:163], v[80:83], v[16:31]
    v_mfma_f32_32x32x16_bf16 v[32:47], a[164:167], v[80:83], v[32:47]
    s_add_u32 s46, s51, 4096
    buffer_load_dwordx4 v[80:83], v6, s[16:19], s46 offen offset:0
    s_waitcnt vmcnt(15)
    v_mfma_f32_32x32x16_bf16 v[16:31], a[168:171], v[84:87], v[16:31]
    v_mfma_f32_32x32x16_bf16 v[32:47], a[172:175], v[84:87], v[32:47]
    buffer_load_dwordx4 v[84:87], v6, s[16:19], s46 offen offset:1024
    s_waitcnt vmcnt(15)
    v_mfma_f32_32x32x16_bf16 v[16:31], a[176:179], v[88:91], v[16:31]
    v_mfma_f32_32x32x16_bf16 v[32:47], a[180:183], v[88:91], v[32:47]
    buffer_load_dwordx4 v[88:91], v6, s[16:19], s46 offen offset:2048
    s_waitcnt vmcnt(15)
    v_mfma_f32_32x32x16_bf16 v[16:31], a[184:187], v[92:95], v[16:31]
    v_mfma_f32_32x32x16_bf16 v[32:47], a[188:191], v[92:95], v[32:47]
    buffer_load_dwordx4 v[92:95], v6, s[16:19], s46 offen offset:3072
    s_waitcnt vmcnt(15)
    v_mfma_f32_32x32x16_bf16 v[16:31], a[192:195], v[96:99], v[16:31]
    v_mfma_f32_32x32x16_bf16 v[32:47], a[196:199], v[96:99], v[32:47]
    s_add_u32 s46, s51, 8192
    buffer_load_dwordx4 v[96:99], v6, s[16:19], s46 offen offset:0
    s_waitcnt vmcnt(15)
    v_mfma_f32_32x32x16_bf16 v[16:31], a[200:203], v[100:103], v[16:31]
    v_mfma_f32_32x32x16_bf16 v[32:47], a[204:207], v[100:103], v[32:47]
    buffer_load_dwordx4 v[100:103], v6, s[16:19], s46 offen offset:1024
    s_waitcnt vmcnt(15)
    v_mfma_f32_32x32x16_bf16 v[16:31], a[208:211], v[104:107], v[16:31]
    v_mfma_f32_32x32x16_bf16 v[32:47], a[212:215], v[104:107], v[32:47]
    buffer_load_dwordx4 v[104:107], v6, s[16:19], s46 offen offset:2048
    s_waitcnt vmcnt(15)
    v_mfma_f32_32x32x16_bf16 v[16:31], a[216:219], v[108:111], v[16:31]
    v_mfma_f32_32x32x16_bf16 v[32:47], a[220:223], v[108:111], v[32:47]
    buffer_load_dwordx4 v[108:111], v6, s[16:19], s46 offen offset:3072
    s_waitcnt vmcnt(15)
    v_mfma_f32_32x32x16_bf16 v[16:31], a[224:227], v[112:115], v[16:31]
    v_mfma_f32_32x32x16_bf16 v[32:47], a[228:231], v[112:115], v[32:47]
    s_add_u32 s46, s51, 12288
    buffer_load_dwordx4 v[112:115], v6, s[16:19], s46 offen offset:0
    s_waitcnt vmcnt(15)
    v_mfma_f32_32x32x16_bf16 v[16:31], a[232:235], v[116:119], v[16:31]
    v_mfma_f32_32x32x16_bf16 v[32:47], a[236:239], v[116:119], v[32:47]
    buffer_load_dwordx4 v[116:119], v6, s[16:19], s46 offen offset:1024
    s_waitcnt vmcnt(15)
    v_mfma_f32_32x32x16_bf16 v[16:31], a[240:243], v[120:123], v[16:31]
    v_mfma_f32_32x32x16_bf16 v[32:47], a[244:247], v[120:123], v[32:47]
    buffer_load_dwordx4 v[120:123], v6, s[16:19], s46 offen offset:2048
    s_waitcnt vmcnt(15)
    v_mfma_f32_32x32x16_bf16 v[16:31], a[248:251], v[124:127], v[16:31]
    v_mfma_f32_32x32x16_bf16 v[32:47], a[252:255], v[124:127], v[32:47]
    buffer_load_dwordx4 v[124:127], v6, s[16:19], s46 offen offset:3072
    s_mov_b32 s49, s51
    v_add_u32 v11, 1, v11
    s_nop 10
    v_cvt_pk_bf16_f32 v48, v16, v17
    v_cvt_pk_bf16_f32 v49, v18, v19
    v_cvt_pk_bf16_f32 v50, v20, v21
    v_cvt_pk_bf16_f32 v51, v22, v23
    v_cvt_pk_bf16_f32 v52, v24, v25
    v_cvt_pk_bf16_f32 v53, v26, v27
    v_cvt_pk_bf16_f32 v54, v28, v29
    v_cvt_pk_bf16_f32 v55, v30, v31
    v_cvt_pk_bf16_f32 v56, v32, v33
    v_cvt_pk_bf16_f32 v57, v34, v35
    v_cvt_pk_bf16_f32 v58, v36, v37
    v_cvt_pk_bf16_f32 v59, v38, v39
    v_cvt_pk_bf16_f32 v60, v40, v41
    v_cvt_pk_bf16_f32 v61, v42, v43
    v_cvt_pk_bf16_f32 v62, v44, v45
    v_cvt_pk_bf16_f32 v63, v46, v47
    buffer_store_dwordx4 v[48:51], v9, s[20:23], s47 offen offset:0 sc1
    buffer_store_dwordx4 v[52:55], v9, s[20:23], s47 offen offset:256 sc1
    buffer_store_dwordx4 v[56:59], v9, s[20:23], s47 offen offset:2048 sc1
    buffer_store_dwordx4 v[60:63], v9, s[20:23], s47 offen offset:2304 sc1
    s_add_u32 s47, s47, 0x100000
    s_cmp_eq_u32 s50, 16
    s_cbranch_scc0 qkv_nfKQ
    s_waitcnt vmcnt(0)
    buffer_store_dword v11, v12, s[40:43], s48 offen sc1
qkv_nfKQ:
    s_sub_u32 s50, s50, 1
    s_cmp_lg_u32 s50, 0
    s_cbranch_scc1 qkv_loopKQ
    s_branch qkv_done
qkv_loopV:
    s_add_u32 s51, s49, 0x20000
    s_cmp_eq_u32 s50, 11
    s_cbranch_scc0 qkv_nlV
    s_add_u32 s97, s101, 3
    s_mov_b32 s98, 0x40000
hprV_pp:
    buffer_load_dword v48, v13, s[40:43], s52 offen offset:0 sc1
    buffer_load_dword v49, v13, s[40:43], s52 offen offset:256 sc1
    buffer_load_dword v50, v13, s[40:43], s52 offen offset:512 sc1
    s_waitcnt vmcnt(0)
    v_subrev_u32 v48, s97, v48
    v_subrev_u32 v49, s97, v49
    v_subrev_u32 v50, s97, v50
    v_max_u32 v48, v48, v49
    v_max_u32 v48, v48, v50
    v_cmp_lt_u32 vcc, 0, v48
    s_cbranch_vccz hprV_pd
    s_sleep 2
    s_sub_u32 s98, s98, 1
    s_cbranch_scc0 hprV_pp
hprV_pd:
    s_barrier
qkv_nlV:
    s_waitcnt vmcnt(15)
    v_mfma_f32_32x32x16_bf16 v[16:31], v[64:67], a[0:3], 0
    v_mfma_f32_32x32x16_bf16 v[32:47], v[64:67], a[4:7], 0
    s_add_u32 s46, s49, 16384
    buffer_load_dwordx4 v[64:67], v6, s[16:19], s46 offen offset:0
    s_waitcnt vmcnt(15)
    v_mfma_f32_32x32x16_bf16 v[16:31], v[68:71], a[8:11], v[16:31]
    v_mfma_f32_32x32x16_bf16 v[32:47], v[68:71], a[12:15], v[32:47]
    buffer_load_dwordx4 v[68:71], v6, s[16:19], s46 offen offset:1024
    s_waitcnt vmcnt(15)
    v_mfma_f32_32x32x16_bf16 v[16:31], v[72:75], a[16:19], v[16:31]
    v_mfma_f32_32x32x16_bf16 v[32:47], v[72:75], a[20:23], v[32:47]
    buffer_load_dwordx4 v[72:75], v6, s[16:19], s46 offen offset:2048
    s_waitcnt vmcnt(15)
    v_mfma_f32_32x32x16_bf16 v[16:31], v[76:79], a[24:27], v[16:31]
    v_mfma_f32_32x32x16_bf16 v[32:47], v[76:79], a[28:31], v[32:47]
    buffer_load_dwordx4 v[76:79], v6, s[16:19], s46 offen offset:3072
    s_waitcnt vmcnt(15)
    v_mfma_f32_32x32x16_bf16 v[16:31], v[80:83], a[32:35], v[16:31]
    v_mfma_f32_32x32x16_bf16 v[32:47], v[80:83], a[36:39], v[32:47]
    s_add_u32 s46, s49, 20480
    buffer_load_dwordx4 v[80:83], v6, s[16:19], s46 offen offset:0
    s_waitcnt vmcnt(15)
    v_mfma_f32_32x32x16_bf16 v[16:31], v[84:87], a[40:43], v[16:31]
    v_mfma_f32_32x32x16_bf16 v[32:47], v[84:87], a[44:47], v[32:47]
    buffer_load_dwordx4 v[84:87], v6, s[16:19], s46 offen offset:1024
    s_waitcnt vmcnt(15)
    v_mfma_f32_32x32x16_bf16 v[16:31], v[88:91], a[48:51], v[16:31]
    v_mfma_f32_32x32x16_bf16 v[32:47], v[88:91], a[52:55], v[32:47]
    buffer_load_dwordx4 v[88:91], v6, s[16:19], s46 offen offset:2048
    s_waitcnt vmcnt(15)
    v_mfma_f32_32x32x16_bf16 v[16:31], v[92:95], a[56:59], v[16:31]
    v_mfma_f32_32x32x16_bf16 v[32:47], v[92:95], a[60:63], v[32:47]
    buffer_load_dwordx4 v[92:95], v6, s[16:19], s46 offen offset:3072
    s_waitcnt vmcnt(15)
    v_mfma_f32_32x32x16_bf16 v[16:31], v[96:99], a[64:67], v[16:31]
    v_mfma_f32_32x32x16_bf16 v[32:47], v[96:99], a[68:71], v[32:47]
    s_add_u32 s46, s49, 24576
    buffer_load_dwordx4 v[96:99], v6, s[16:19], s46 offen offset:0
    s_waitcnt vmcnt(15)
    v_mfma_f32_32x32x16_bf16 v[16:31], v[100:103], a[72:75], v[16:31]
    v_mfma_f32_32x32x16_bf16 v[32:47], v[100:103], a[76:79], v[32:47]
    buffer_load_dwordx4 v[100:103], v6, s[16:19], s46 offen offset:1024
    s_waitcnt vmcnt(15)
    v_mfma_f32_32x32x16_bf16 v[16:31], v[104:107], a[80:83], v[16:31]
    v_mfma_f32_32x32x16_bf16 v[32:47], v[104:107], a[84:87], v[32:47]
    buffer_load_dwordx4 v[104:107], v6, s[16:19], s46 offen offset:2048
    s_waitcnt vmcnt(15)
    v_mfma_f32_32x32x16_bf16 v[16:31], v[108:111], a[88:91], v[16:31]
    v_mfma_f32_32x32x16_bf16 v[32:47], v[108:111], a[92:95], v[32:47]
    buffer_load_dwordx4 v[108:111], v6, s[16:19], s46 offen offset:3072
    s_waitcnt vmcnt(15)
    v_mfma_f32_32x32x16_bf16 v[16:31], v[112:115], a[96:99], v[16:31]
    v_mfma_f32_32x32x16_bf16 v[32:47], v[112:115], a[100:103], v[32:47]
    s_add_u32 s46, s49, 28672
    buffer_load_dwordx4 v[112:115], v6, s[16:19], s46 offen offset:0
    s_waitcnt vmcnt(15)
    v_mfma_f32_32x32x16_bf16 v[16:31], v[116:119], a[104:107], v[16:31]
    v_mfma_f32_32x32x16_bf16 v[32:47], v[116:119], a[108:111], v[32:47]
    buffer_load_dwordx4 v[116:119], v6, s[16:19], s46 offen offset:1024
    s_waitcnt vmcnt(15)
    v_mfma_f32_32x32x16_bf16 v[16:31], v[120:123], a[112:115], v[16:31]
    v_mfma_f32_32x32x16_bf16 v[32:47], v[120:123], a[116:119], v[32:47]
    buffer_load_dwordx4 v[120:123], v6, s[16:19], s46 offen offset:2048
    s_waitcnt vmcnt(15)
    v_mfma_f32_32x32x16_bf16 v[16:31], v[124:127], a[120:123], v[16:31]
    v_mfma_f32_32x32x16_bf16 v[32:47], v[124:127], a[124:127], v[32:47]
    buffer_load_dwordx4 v[124:127], v6, s[16:19], s46 offen offset:3072
    s_waitcnt vmcnt(15)
    v_mfma_f32_32x32x16_bf16 v[16:31], v[64:67], a[128:131], v[16:31]
    v_mfma_f32_32x32x16_bf16 v[32:47], v[64:67], a[132:135], v[32:47]
    s_add_u32 s46, s51, 0
    buffer_load_dwordx4 v[64:67], v6, s[16:19], s46 offen offset:0
    s_waitcnt vmcnt(15)
    v_mfma_f32_32x32x16_bf16 v[16:31], v[68:71], a[136:139], v[16:31]
    v_mfma_f32_32x32x16_bf16 v[32:47], v[68:71], a[140:143], v[32:47]
    buffer_load_dwordx4 v[68:71], v6, s[16:19], s46 offen offset:1024
    buffer_store_dword v11, v12, s[40:43], s48 offen sc1
    s_waitcnt vmcnt(15)
    v_mfma_f32_32x32x16_bf16 v[16:31], v[72:75], a[144:147], v[16:31]
    v_mfma_f32_32x32x16_bf16 v[32:47], v[72:75], a[148:151], v[32:47]
    buffer_load_dwordx4 v[72:75], v6, s[16:19], s46 offen offset:2048
    s_waitcnt vmcnt(15)
    v_mfma_f32_32x32x16_bf16 v[16:31], v[76:79], a[152:155], v[16:31]
    v_mfma_f32_32x32x16_bf16 v[32:47], v[76:79], a[156:159], v[32:47]
    buffer_load_dwordx4 v[76:79], v6, s[16:19], s46 offen offset:3072
    s_waitcnt vmcnt(15)
    v_mfma_f32_32x32x16_bf16 v[16:31], v[80:83], a[160:163], v[16:31]
    v_mfma_f32_32x32x16_bf16 v[32:47], v[80:83], a[164:167], v[32:47]
    s_add_u32 s46, s51, 4096
    buffer_load_dwordx4 v[80:83], v6, s[16:19], s46 offen offset:0
    s_waitcnt vmcnt(15)
    v_mfma_f32_32x32x16_bf16 v[16:31], v[84:87], a[168:171], v[16:31]
    v_mfma_f32_32x32x16_bf16 v[32:47], v[84:87], a[172:175], v[32:47]
    buffer_load_dwordx4 v[84:87], v6, s[16:19], s46 offen offset:1024
    s_waitcnt vmcnt(15)
    v_mfma_f32_32x32x16_bf16 v[16:31], v[88:91], a[176:179], v[16:31]
    v_mfma_f32_32x32x16_bf16 v[32:47], v[88:91], a[180:183], v[32:47]
    buffer_load_dwordx4 v[88:91], v6, s[16:19], s46 offen offset:2048
    s_waitcnt vmcnt(15)
    v_mfma_f32_32x32x16_bf16 v[16:31], v[92:95], a[184:187], v[16:31]
    v_mfma_f32_32x32x16_bf16 v[32:47], v[92:95], a[188:191], v[32:47]
    buffer_load_dwordx4 v[92:95], v6, s[16:19], s46 offen offset:3072
    s_waitcnt vmcnt(15)
    v_mfma_f32_32x32x16_bf16 v[16:31], v[96:99], a[192:195], v[16:31]
    v_mfma_f32_32x32x16_bf16 v[32:47], v[96:99], a[196:199], v[32:47]
    s_add_u32 s46, s51, 8192
    buffer_load_dwordx4 v[96:99], v6, s[16:19], s46 offen offset:0
    s_waitcnt vmcnt(15)
    v_mfma_f32_32x32x16_bf16 v[16:31], v[100:103], a[200:203], v[16:31]
    v_mfma_f32_32x32x16_bf16 v[32:47], v[100:103], a[204:207], v[32:47]
    buffer_load_dwordx4 v[100:103], v6, s[16:19], s46 offen offset:1024
    s_waitcnt vmcnt(15)
    v_mfma_f32_32x32x16_bf16 v[16:31], v[104:107], a[208:211], v[16:31]
    v_mfma_f32_32x32x16_bf16 v[32:47], v[104:107], a[212:215], v[32:47]
    buffer_load_dwordx4 v[104:107], v6, s[16:19], s46 offen offset:2048
    s_waitcnt vmcnt(15)
    v_mfma_f32_32x32x16_bf16 v[16:31], v[108:111], a[216:219], v[16:31]
    v_mfma_f32_32x32x16_bf16 v[32:47], v[108:111], a[220:223], v[32:47]
    buffer_load_dwordx4 v[108:111], v6, s[16:19], s46 offen offset:3072
    s_waitcnt vmcnt(15)
    v_mfma_f32_32x32x16_bf16 v[16:31], v[112:115], a[224:227], v[16:31]
    v_mfma_f32_32x32x16_bf16 v[32:47], v[112:115], a[228:231], v[32:47]
    s_add_u32 s46, s51, 12288
    buffer_load_dwordx4 v[112:115], v6, s[16:19], s46 offen offset:0
    s_waitcnt vmcnt(15)
    v_mfma_f32_32x32x16_bf16 v[16:31], v[116:119], a[232:235], v[16:31]
    v_mfma_f32_32x32x16_bf16 v[32:47], v[116:119], a[236:239], v[32:47]
    buffer_load_dwordx4 v[116:119], v6, s[16:19], s46 offen offset:1024
    s_waitcnt vmcnt(15)
    v_mfma_f32_32x32x16_bf16 v[16:31], v[120:123], a[240:243], v[16:31]
    v_mfma_f32_32x32x16_bf16 v[32:47], v[120:123], a[244:247], v[32:47]
    buffer_load_dwordx4 v[120:123], v6, s[16:19], s46 offen offset:2048
    s_waitcnt vmcnt(15)
    v_mfma_f32_32x32x16_bf16 v[16:31], v[124:127], a[248:251], v[16:31]
    v_mfma_f32_32x32x16_bf16 v[32:47], v[124:127], a[252:255], v[32:47]
    buffer_load_dwordx4 v[124:127], v6, s[16:19], s46 offen offset:3072
    s_mov_b32 s49, s51
    v_add_u32 v11, 1, v11
    s_nop 10
    v_cvt_pk_bf16_f32 v48, v16, v17
    v_cvt_pk_bf16_f32 v49, v18, v19
    v_cvt_pk_bf16_f32 v50, v20, v21
    v_cvt_pk_bf16_f32 v51, v22, v23
    v_cvt_pk_bf16_f32 v52, v24, v25
    v_cvt_pk_bf16_f32 v53, v26, v27
    v_cvt_pk_bf16_f32 v54, v28, v29
    v_cvt_pk_bf16_f32 v55, v30, v31
    v_cvt_pk_bf16_f32 v56, v32, v33
    v_cvt_pk_bf16_f32 v57, v34, v35
    v_cvt_pk_bf16_f32 v58, v36, v37
    v_cvt_pk_bf16_f32 v59, v38, v39
    v_cvt_pk_bf16_f32 v60, v40, v41
    v_cvt_pk_bf16_f32 v61, v42, v43
    v_cvt_pk_bf16_f32 v62, v44, v45
    v_cvt_pk_bf16_f32 v63, v46, v47
    buffer_store_dwordx4 v[48:51], v9, s[20:23], s47 offen offset:0 sc1
    buffer_store_dwordx4 v[52:55], v9, s[20:23], s47 offen offset:256 sc1
    buffer_store_dwordx4 v[56:59], v9, s[20:23], s47 offen offset:2048 sc1
    buffer_store_dwordx4 v[60:63], v9, s[20:23], s47 offen offset:2304 sc1
    s_add_u32 s47, s47, 0x100000
    s_cmp_eq_u32 s50, 16
    s_cbranch_scc0 qkv_nfV
    s_waitcnt vmcnt(0)
    buffer_store_dword v11, v12, s[40:43], s48 offen sc1
qkv_nfV:
    s_sub_u32 s50, s50, 1
    s_cmp_lg_u32 s50, 0
    s_cbranch_scc1 qkv_loopV
qkv_done:
    s_waitcnt vmcnt(0)
    buffer_store_dword v11, v12, s[40:43], s48 offen sc1
    s_sub_u32 s4, s100, 128
    s_cmp_ge_u32 s100, 160
    s_cbranch_scc1 hp_ogroup
    s_cmp_ge_u32 s100, 128
    s_cbranch_scc1 hp_wgroup
    s_cmp_lt_u32 s100, 32
    s_cbranch_scc1 hp_agroup
    s_cmp_lt_u32 s100, 120
    s_cbranch_scc1 hp_ggroup
    s_mov_b32 s16, s86
    s_mov_b32 s17, s87
    s_mov_b32 s18, 0xac000
    s_mov_b32 s19, 0x20000
    s_add_u32 s20, s10, 0x6600000
    s_addc_u32 s21, s11, 0
    s_mov_b32 s22, 0xac000
    s_mov_b32 s23, 0x20000
    v_and_b32 v3, 31, v1
    v_lshrrev_b32 v4, 5, v1
    s_sub_u32 s5, s100, 120
hp_woutl:
    s_lshl_b32 s32, s5, 14
    s_lshl_b32 s33, s3, 8
    s_add_u32 s33, s33, s32
    v_lshlrev_b32 v6, 12, v4
    v_lshl_add_u32 v6, v3, 1, v6
    v_add_u32 v6, s33, v6
    s_lshl_b32 s33, s3, 12
    s_add_u32 s33, s33, s32
    v_lshlrev_b32 v7, 4, v1
    v_add_u32 v7, s33, v7
    s_mov_b32 s24, 0
    buffer_load_ushort v16, v6, s[16:19], s24 offen
    s_mov_b32 s25, 1024
    buffer_load_ushort v17, v6, s[16:19], s25 offen
    s_mov_b32 s26, 2048
    buffer_load_ushort v18, v6, s[16:19], s26 offen
    s_mov_b32 s27, 3072
    buffer_load_ushort v19, v6, s[16:19], s27 offen
    s_mov_b32 s28, 8192
    buffer_load_ushort v20, v6, s[16:19], s28 offen
    s_mov_b32 s29, 9216
    buffer_load_ushort v21, v6, s[16:19], s29 offen
    s_mov_b32 s30, 10240
    buffer_load_ushort v22, v6, s[16:19], s30 offen
    s_mov_b32 s31, 11264
    buffer_load_ushort v23, v6, s[16:19], s31 offen
    s_mov_b32 s24, 64
    buffer_load_ushort v24, v6, s[16:19], s24 offen
    s_mov_b32 s25, 1088
    buffer_load_ushort v25, v6, s[16:19], s25 offen
    s_mov_b32 s26, 2112
    buffer_load_ushort v26, v6, s[16:19], s26 offen
    s_mov_b32 s27, 3136
    buffer_load_ushort v27, v6, s[16:19], s27 offen
    s_mov_b32 s28, 8256
    buffer_load_ushort v28, v6, s[16:19], s28 offen
    s_mov_b32 s29, 9280
    buffer_load_ushort v29, v6, s[16:19], s29 offen
    s_mov_b32 s30, 10304
    buffer_load_ushort v30, v6, s[16:19], s30 offen
    s_mov_b32 s31, 11328
    buffer_load_ushort v31, v6, s[16:19], s31 offen
    s_mov_b32 s24, 128
    buffer_load_ushort v32, v6, s[16:19], s24 offen
    s_mov_b32 s25, 1152
    buffer_load_ushort v33, v6, s[16:19], s25 offen
    s_mov_b32 s26, 2176
    buffer_load_ushort v34, v6, s[16:19], s26 offen
    s_mov_b32 s27, 3200
    buffer_load_ushort v35, v6, s[16:19], s27 offen
    s_mov_b32 s28, 8320
    buffer_load_ushort v36, v6, s[16:19], s28 offen
    s_mov_b32 s29, 9344
    buffer_load_ushort v37, v6, s[16:19], s29 offen
    s_mov_b32 s30, 10368
    buffer_load_ushort v38, v6, s[16:19], s30 offen
    s_mov_b32 s31, 11392
    buffer_load_ushort v39, v6, s[16:19], s31 offen
    s_mov_b32 s24, 192
    buffer_load_ushort v40, v6, s[16:19], s24 offen
    s_mov_b32 s25, 1216
    buffer_load_ushort v41, v6, s[16:19], s25 offen
    s_mov_b32 s26, 2240
    buffer_load_ushort v42, v6, s[16:19], s26 offen
    s_mov_b32 s27, 3264
    buffer_load_ushort v43, v6, s[16:19], s27 offen
    s_mov_b32 s28, 8384
    buffer_load_ushort v44, v6, s[16:19], s28 offen
    s_mov_b32 s29, 9408
    buffer_load_ushort v45, v6, s[16:19], s29 offen
    s_mov_b32 s30, 10432
    buffer_load_ushort v46, v6, s[16:19], s30 offen
    s_mov_b32 s31, 11456
    buffer_load_ushort v47, v6, s[16:19], s31 offen
    s_waitcnt vmcnt(24)
    v_lshl_or_b32 v48, v17, 16, v16
    v_lshl_or_b32 v49, v19, 16, v18
    v_lshl_or_b32 v50, v21, 16, v20
    v_lshl_or_b32 v51, v23, 16, v22
    buffer_store_dwordx4 v[48:51], v7, s[20:23], 0 offen offset:0 sc1
    s_waitcnt vmcnt(17)
    v_lshl_or_b32 v52, v25, 16, v24
    v_lshl_or_b32 v53, v27, 16, v26
    v_lshl_or_b32 v54, v29, 16, v28
    v_lshl_or_b32 v55, v31, 16, v30
    buffer_store_dwordx4 v[52:55], v7, s[20:23], 0 offen offset:1024 sc1
    s_waitcnt vmcnt(10)
    v_lshl_or_b32 v56, v33, 16, v32
    v_lshl_or_b32 v57, v35, 16, v34
    v_lshl_or_b32 v58, v37, 16, v36
    v_lshl_or_b32 v59, v39, 16, v38
    buffer_store_dwordx4 v[56:59], v7, s[20:23], 0 offen offset:2048 sc1
    s_waitcnt vmcnt(3)
    v_lshl_or_b32 v60, v41, 16, v40
    v_lshl_or_b32 v61, v43, 16, v42
    v_lshl_or_b32 v62, v45, 16, v44
    v_lshl_or_b32 v63, v47, 16, v46
    buffer_store_dwordx4 v[60:63], v7, s[20:23], 0 offen offset:3072 sc1
    s_add_u32 s5, s5, 8
    s_cmp_lt_u32 s5, 43
    s_cbranch_scc1 hp_woutl
    s_waitcnt vmcnt(0)
    s_barrier
    s_sub_u32 s5, s100, 120
    s_lshl_b32 s5, s5, 2
    s_add_u32 s5, s5, 24832
    v_mov_b32 v8, 0
    s_add_u32 s97, s101, 0
    v_mov_b32 v9, s97
    buffer_store_dword v9, v8, s[40:43], s5 offen sc1
xs_entry:
    s_mov_b32 s96, 1
xs_entry2:
    s_load_dwordx2 s[8:9], s[0:1], 112
    s_load_dwordx2 s[10:11], s[0:1], 128
    v_mbcnt_lo_u32_b32 v1, -1, 0
    v_mbcnt_hi_u32_b32 v1, -1, v1
    v_lshlrev_b32 v3, 4, v1
    s_lshr_b32 s32, s100, 3
    s_and_b32 s33, s100, 7
    s_lshl_b32 s44, s32, 1
    s_lshr_b32 s45, s3, 1
    s_add_u32 s44, s44, s45
    s_lshl_b32 s44, s44, 15
    s_lshl_b32 s46, s33, 1
    s_and_b32 s45, s3, 1
    s_add_u32 s46, s46, s45
    s_lshl_b32 s45, s46, 6
    s_add_u32 s44, s44, s45
    s_lshl_b32 s46, s46, 7
    s_add_u32 s46, s46, 10240
    v_and_b32 v7, 31, v1
    v_lshlrev_b32 v7, 10, v7
    v_lshrrev_b32 v8, 5, v1
    v_lshl_add_u32 v7, v8, 3, v7
    v_lshlrev_b32 v8, 4, v8
    s_mul_i32 s36, s3, 11264
    v_add_u32 v6, 45056, v3
    s_lshl_b32 s4, s3, 12
    v_add_u32 v4, s4, v3
    s_lshl_b32 s4, s3, 14
    v_add_u32 v5, s4, v3
    s_lshl_b32 s37, s32, 6
    s_add_u32 s37, s37, 29696
    s_waitcnt lgkmcnt(0)
    s_add_u32 s40, s10, 0x7800000
    s_addc_u32 s41, s11, 0
    s_mov_b32 s42, 0x18000
    s_mov_b32 s43, 0x20000
    s_add_u32 s16, s10, 0x7000000
    s_addc_u32 s17, s11, 0
    s_mov_b32 s18, 0x0
    s_mov_b32 s19, 0x20000
    s_add_u32 s20, s10, 0x700000
    s_addc_u32 s21, s11, 0
    s_mov_b32 s22, 0x0
    s_mov_b32 s23, 0x20000
    s_mov_b32 s24, s8
    s_mov_b32 s25, s9
    s_mov_b32 s26, 0x0
    s_mov_b32 s27, 0x20000
    s_cmp_eq_u32 s96, 3
    s_cbranch_scc1 xs_real
    s_add_u32 s12, s10, 0x6600000
    s_addc_u32 s13, s11, 0
    s_mov_b32 s14, 0xac000
    s_mov_b32 s15, 0x20000
    s_mov_b32 s28, s10
    s_mov_b32 s29, s11
    s_mov_b32 s30, 0x3000
    s_mov_b32 s31, 0x20000
    v_and_b32 v9, 31, v1
    v_lshlrev_b32 v9, 2, v9
    s_movk_i32 s35, 24576
    s_add_u32 s97, s101, 1
    s_mov_b32 s98, 0x40000
xsm_pp:
    buffer_load_dword v2, v9, s[40:43], s35 offen offset:0 sc1
    s_waitcnt vmcnt(0)
    v_subrev_u32 v2, s97, v2
    v_cmp_lt_u32 vcc, 1, v2
    s_cbranch_vccz xsm_pd
    s_sleep 8
    s_sub_u32 s98, s98, 1
    s_cbranch_scc0 xsm_pp
xsm_pd:
    v_and_b32 v9, 7, v1
    v_lshlrev_b32 v9, 2, v9
    s_movk_i32 s35, 24832
    s_add_u32 s97, s101, 0
    s_mov_b32 s98, 0x40000
xsw_pp:
    buffer_load_dword v2, v9, s[40:43], s35 offen offset:0 sc1
    s_waitcnt vmcnt(0)
    v_subrev_u32 v2, s97, v2
    v_cmp_lt_u32 vcc, 0, v2
    s_cbranch_vccz xsw_pd
    s_sleep 8
    s_sub_u32 s98, s98, 1
    s_cbranch_scc0 xsw_pp
xsw_pd:
    s_mul_i32 s34, s3, 180224
    s_lshl_b32 s35, s33, 11
    s_add_u32 s34, s34, s35
    buffer_load_dwordx4 a[0:3], v3, s[12:15], s34 offen offset:0
    buffer_load_dwordx4 a[4:7], v3, s[12:15], s34 offen offset:1024
    s_add_u32 s34, s34, 16384
    buffer_load_dwordx4 a[8:11], v3, s[12:15], s34 offen offset:0
    buffer_load_dwordx4 a[12:15], v3, s[12:15], s34 offen offset:1024
    s_add_u32 s34, s34, 16384
    buffer_load_dwordx4 a[16:19], v3, s[12:15], s34 offen offset:0
    buffer_load_dwordx4 a[20:23], v3, s[12:15], s34 offen offset:1024
    s_add_u32 s34, s34, 16384
    buffer_load_dwordx4 a[24:27], v3, s[12:15], s34 offen offset:0
    buffer_load_dwordx4 a[28:31], v3, s[12:15], s34 offen offset:1024
    s_add_u32 s34, s34, 16384
    buffer_load_dwordx4 a[32:35], v3, s[12:15], s34 offen offset:0
    buffer_load_dwordx4 a[36:39], v3, s[12:15], s34 offen offset:1024
    s_add_u32 s34, s34, 16384
    buffer_load_dwordx4 a[40:43], v3, s[12:15], s34 offen offset:0
    buffer_load_dwordx4 a[44:47], v3, s[12:15], s34 offen offset:1024
    s_add_u32 s34, s34, 16384
    buffer_load_dwordx4 a[48:51], v3, s[12:15], s34 offen offset:0
    buffer_load_dwordx4 a[52:55], v3, s[12:15], s34 offen offset:1024
    s_add_u32 s34, s34, 16384
    buffer_load_dwordx4 a[56:59], v3, s[12:15], s34 offen offset:0
    buffer_load_dwordx4 a[60:63], v3, s[12:15], s34 offen offset:1024
    s_add_u32 s34, s34, 16384
    buffer_load_dwordx4 a[64:67], v3, s[12:15], s34 offen offset:0
    buffer_load_dwordx4 a[68:71], v3, s[12:15], s34 offen offset:1024
    s_add_u32 s34, s34, 16384
    buffer_load_dwordx4 a[72:75], v3, s[12:15], s34 offen offset:0
    buffer_load_dwordx4 a[76:79], v3, s[12:15], s34 offen offset:1024
    s_add_u32 s34, s34, 16384
    buffer_load_dwordx4 a[80:83], v3, s[12:15], s34 offen offset:0
    buffer_load_dwordx4 a[84:87], v3, s[12:15], s34 offen offset:1024
    s_add_u32 s34, s34, 16384
    buffer_load_dwordx4 v[200:203], v8, s[28:31], s46 offen offset:0
    buffer_load_dwordx4 v[204:207], v8, s[28:31], s46 offen offset:32
    buffer_load_dwordx4 v[208:211], v8, s[28:31], s46 offen offset:64
    buffer_load_dwordx4 v[212:215], v8, s[28:31], s46 offen offset:96
    s_mov_b32 s35, 0
    s_barrier
    s_branch xsu_pd
xs_real:
    s_mov_b32 s96, 0
    s_mov_b32 s18, 2883584
    s_mov_b32 s22, 0x200000
    s_mov_b32 s26, 0x200000
    s_mul_i32 s35, s32, 90112
    s_add_u32 s35, s35, s36
    v_min_u32 v9, 10, v1
    v_lshlrev_b32 v9, 2, v9
    s_barrier
    s_add_u32 s97, s101, 0
    s_mov_b32 s98, 0x40000
    buffer_load_dword v12, v9, s[40:43], s37 offen sc1
    s_waitcnt vmcnt(0)
    v_subrev_u32 v12, s97, v12
    v_cmp_lt_u32 vcc, 0, v12
    s_cbranch_vccz xsu_pd
    buffer_load_dword v12, v9, s[40:43], s37 offen sc1
    s_sleep 6
    s_sleep 6
    buffer_load_dword v13, v9, s[40:43], s37 offen sc1
xsu_pp:
    s_waitcnt vmcnt(1)
    v_subrev_u32 v12, s97, v12
    v_cmp_lt_u32 vcc, 0, v12
    s_cbranch_vccz xsu_pd
    buffer_load_dword v12, v9, s[40:43], s37 offen sc1
    s_waitcnt vmcnt(1)
    v_subrev_u32 v13, s97, v13
    v_cmp_lt_u32 vcc, 0, v13
    s_cbranch_vccz xsu_pd
    buffer_load_dword v13, v9, s[40:43], s37 offen sc1
    s_sub_u32 s98, s98, 1
    s_cbranch_scc0 xsu_pp
xsu_pd:
    buffer_load_dwordx4 v[80:83], v3, s[16:19], s35 offen
    buffer_load_dwordx4 v[84:87], v6, s[16:19], s35 offen
    s_add_u32 s35, s35, 1024
    buffer_load_dwordx4 v[88:91], v3, s[16:19], s35 offen
    buffer_load_dwordx4 v[92:95], v6, s[16:19], s35 offen
    s_add_u32 s35, s35, 1024
    buffer_load_dwordx4 v[96:99], v3, s[16:19], s35 offen
    buffer_load_dwordx4 v[100:103], v6, s[16:19], s35 offen
    s_add_u32 s35, s35, 1024
    buffer_load_dwordx4 v[104:107], v3, s[16:19], s35 offen
    buffer_load_dwordx4 v[108:111], v6, s[16:19], s35 offen
    s_add_u32 s35, s35, 1024
    buffer_load_dwordx4 v[112:115], v3, s[16:19], s35 offen
    buffer_load_dwordx4 v[116:119], v6, s[16:19], s35 offen
    s_add_u32 s35, s35, 1024
    buffer_load_dwordx4 v[120:123], v3, s[16:19], s35 offen
    buffer_load_dwordx4 v[124:127], v6, s[16:19], s35 offen
    s_add_u32 s35, s35, 1024
    buffer_load_dwordx4 v[128:131], v3, s[16:19], s35 offen
    buffer_load_dwordx4 v[132:135], v6, s[16:19], s35 offen
    s_add_u32 s35, s35, 1024
    buffer_load_dwordx4 v[136:139], v3, s[16:19], s35 offen
    buffer_load_dwordx4 v[140:143], v6, s[16:19], s35 offen
    s_add_u32 s35, s35, 1024
    buffer_load_dwordx4 v[144:147], v3, s[16:19], s35 offen
    buffer_load_dwordx4 v[148:151], v6, s[16:19], s35 offen
    s_add_u32 s35, s35, 1024
    buffer_load_dwordx4 v[152:155], v3, s[16:19], s35 offen
    buffer_load_dwordx4 v[156:159], v6, s[16:19], s35 offen
    s_add_u32 s35, s35, 1024
    s_cmp_eq_u32 s3, 3
    s_cbranch_scc1 xs_nl
    buffer_load_dwordx4 v[160:163], v3, s[16:19], s35 offen
    buffer_load_dwordx4 v[164:167], v6, s[16:19], s35 offen
    s_add_u32 s35, s35, 1024
    s_branch xs_l2
xs_nl:
    v_mov_b64 v[160:161], 0
    v_mov_b64 v[162:163], 0
    v_mov_b64 v[164:165], 0
    v_mov_b64 v[166:167], 0
    buffer_load_dword v10, v3, s[16:19], s35 offen
    buffer_load_dword v10, v3, s[16:19], s35 offen
xs_l2:
    buffer_load_dwordx2 v[216:217], v7, s[20:23], s44 offen offset:0 sc1
    buffer_load_dwordx2 v[218:219], v7, s[20:23], s44 offen offset:16 sc1
    buffer_load_dwordx2 v[220:221], v7, s[20:23], s44 offen offset:32 sc1
    buffer_load_dwordx2 v[222:223], v7, s[20:23], s44 offen offset:48 sc1
    s_waitcnt vmcnt(24)
    v_mfma_f32_32x32x16_bf16 v[16:31], a[0:3], v[80:83], 0
    v_mfma_f32_32x32x16_bf16 v[32:47], a[4:7], v[80:83], 0
    v_mfma_f32_32x32x16_bf16 v[48:63], a[0:3], v[84:87], 0
    v_mfma_f32_32x32x16_bf16 v[64:79], a[4:7], v[84:87], 0
    s_waitcnt vmcnt(22)
    v_mfma_f32_32x32x16_bf16 v[16:31], a[8:11], v[88:91], v[16:31]
    v_mfma_f32_32x32x16_bf16 v[32:47], a[12:15], v[88:91], v[32:47]
    v_mfma_f32_32x32x16_bf16 v[48:63], a[8:11], v[92:95], v[48:63]
    v_mfma_f32_32x32x16_bf16 v[64:79], a[12:15], v[92:95], v[64:79]
    s_waitcnt vmcnt(20)
    v_mfma_f32_32x32x16_bf16 v[16:31], a[16:19], v[96:99], v[16:31]
    v_mfma_f32_32x32x16_bf16 v[32:47], a[20:23], v[96:99], v[32:47]
    v_mfma_f32_32x32x16_bf16 v[48:63], a[16:19], v[100:103], v[48:63]
    v_mfma_f32_32x32x16_bf16 v[64:79], a[20:23], v[100:103], v[64:79]
    s_waitcnt vmcnt(18)
    v_mfma_f32_32x32x16_bf16 v[16:31], a[24:27], v[104:107], v[16:31]
    v_mfma_f32_32x32x16_bf16 v[32:47], a[28:31], v[104:107], v[32:47]
    v_mfma_f32_32x32x16_bf16 v[48:63], a[24:27], v[108:111], v[48:63]
    v_mfma_f32_32x32x16_bf16 v[64:79], a[28:31], v[108:111], v[64:79]
    s_waitcnt vmcnt(16)
    v_mfma_f32_32x32x16_bf16 v[16:31], a[32:35], v[112:115], v[16:31]
    v_mfma_f32_32x32x16_bf16 v[32:47], a[36:39], v[112:115], v[32:47]
    v_mfma_f32_32x32x16_bf16 v[48:63], a[32:35], v[116:119], v[48:63]
    v_mfma_f32_32x32x16_bf16 v[64:79], a[36:39], v[116:119], v[64:79]
    s_waitcnt vmcnt(14)
    v_mfma_f32_32x32x16_bf16 v[16:31], a[40:43], v[120:123], v[16:31]
    v_mfma_f32_32x32x16_bf16 v[32:47], a[44:47], v[120:123], v[32:47]
    v_mfma_f32_32x32x16_bf16 v[48:63], a[40:43], v[124:127], v[48:63]
    v_mfma_f32_32x32x16_bf16 v[64:79], a[44:47], v[124:127], v[64:79]
    s_waitcnt vmcnt(12)
    v_mfma_f32_32x32x16_bf16 v[16:31], a[48:51], v[128:131], v[16:31]
    v_mfma_f32_32x32x16_bf16 v[32:47], a[52:55], v[128:131], v[32:47]
    v_mfma_f32_32x32x16_bf16 v[48:63], a[48:51], v[132:135], v[48:63]
    v_mfma_f32_32x32x16_bf16 v[64:79], a[52:55], v[132:135], v[64:79]
    s_waitcnt vmcnt(10)
    v_mfma_f32_32x32x16_bf16 v[16:31], a[56:59], v[136:139], v[16:31]
    v_mfma_f32_32x32x16_bf16 v[32:47], a[60:63], v[136:139], v[32:47]
    v_mfma_f32_32x32x16_bf16 v[48:63], a[56:59], v[140:143], v[48:63]
    v_mfma_f32_32x32x16_bf16 v[64:79], a[60:63], v[140:143], v[64:79]
    s_waitcnt vmcnt(8)
    v_mfma_f32_32x32x16_bf16 v[16:31], a[64:67], v[144:147], v[16:31]
    v_mfma_f32_32x32x16_bf16 v[32:47], a[68:71], v[144:147], v[32:47]
    v_mfma_f32_32x32x16_bf16 v[48:63], a[64:67], v[148:151], v[48:63]
    v_mfma_f32_32x32x16_bf16 v[64:79], a[68:71], v[148:151], v[64:79]
    s_waitcnt vmcnt(6)
    v_mfma_f32_32x32x16_bf16 v[16:31], a[72:75], v[152:155], v[16:31]
    v_mfma_f32_32x32x16_bf16 v[32:47], a[76:79], v[152:155], v[32:47]
    v_mfma_f32_32x32x16_bf16 v[48:63], a[72:75], v[156:159], v[48:63]
    v_mfma_f32_32x32x16_bf16 v[64:79], a[76:79], v[156:159], v[64:79]
    s_waitcnt vmcnt(4)
    v_mfma_f32_32x32x16_bf16 v[16:31], a[80:83], v[160:163], v[16:31]
    v_mfma_f32_32x32x16_bf16 v[32:47], a[84:87], v[160:163], v[32:47]
    v_mfma_f32_32x32x16_bf16 v[48:63], a[80:83], v[164:167], v[48:63]
    v_mfma_f32_32x32x16_bf16 v[64:79], a[84:87], v[164:167], v[64:79]
    s_nop 11
    ds_write_b128 v4, v[16:19] offset:0
    ds_write_b128 v4, v[20:23] offset:1024
    ds_write_b128 v4, v[24:27] offset:2048
    ds_write_b128 v4, v[28:31] offset:3072
    ds_write_b128 v4, v[32:35] offset:16384
    ds_write_b128 v4, v[36:39] offset:17408
    ds_write_b128 v4, v[40:43] offset:18432
    ds_write_b128 v4, v[44:47] offset:19456
    ds_write_b128 v4, v[48:51] offset:32768
    ds_write_b128 v4, v[52:55] offset:33792
    ds_write_b128 v4, v[56:59] offset:34816
    ds_write_b128 v4, v[60:63] offset:35840
    ds_write_b128 v4, v[64:67] offset:49152
    ds_write_b128 v4, v[68:71] offset:50176
    ds_write_b128 v4, v[72:75] offset:51200
    ds_write_b128 v4, v[76:79] offset:52224
    s_waitcnt lgkmcnt(0)
    s_barrier
    ds_read_b128 v[16:19], v5 offset:0
    ds_read_b128 v[20:23], v5 offset:1024
    ds_read_b128 v[24:27], v5 offset:2048
    ds_read_b128 v[28:31], v5 offset:3072
    ds_read_b128 v[32:35], v5 offset:4096
    ds_read_b128 v[36:39], v5 offset:5120
    ds_read_b128 v[40:43], v5 offset:6144
    ds_read_b128 v[44:47], v5 offset:7168
    ds_read_b128 v[48:51], v5 offset:8192
    ds_read_b128 v[52:55], v5 offset:9216
    ds_read_b128 v[56:59], v5 offset:10240
    ds_read_b128 v[60:63], v5 offset:11264
    ds_read_b128 v[64:67], v5 offset:12288
    ds_read_b128 v[68:71], v5 offset:13312
    ds_read_b128 v[72:75], v5 offset:14336
    ds_read_b128 v[76:79], v5 offset:15360
    s_waitcnt lgkmcnt(0)
    v_pk_add_f32 v[16:17], v[16:17], v[32:33]
    v_pk_add_f32 v[48:49], v[48:49], v[64:65]
    v_pk_add_f32 v[18:19], v[18:19], v[34:35]
    v_pk_add_f32 v[50:51], v[50:51], v[66:67]
    v_pk_add_f32 v[20:21], v[20:21], v[36:37]
    v_pk_add_f32 v[52:53], v[52:53], v[68:69]
    v_pk_add_f32 v[22:23], v[22:23], v[38:39]
    v_pk_add_f32 v[54:55], v[54:55], v[70:71]
    v_pk_add_f32 v[24:25], v[24:25], v[40:41]
    v_pk_add_f32 v[56:57], v[56:57], v[72:73]
    v_pk_add_f32 v[26:27], v[26:27], v[42:43]
    v_pk_add_f32 v[58:59], v[58:59], v[74:75]
    v_pk_add_f32 v[28:29], v[28:29], v[44:45]
    v_pk_add_f32 v[60:61], v[60:61], v[76:77]
    v_pk_add_f32 v[30:31], v[30:31], v[46:47]
    v_pk_add_f32 v[62:63], v[62:63], v[78:79]
    v_pk_add_f32 v[16:17], v[16:17], v[48:49]
    v_pk_add_f32 v[18:19], v[18:19], v[50:51]
    v_pk_add_f32 v[20:21], v[20:21], v[52:53]
    v_pk_add_f32 v[22:23], v[22:23], v[54:55]
    v_pk_add_f32 v[24:25], v[24:25], v[56:57]
    v_pk_add_f32 v[26:27], v[26:27], v[58:59]
    v_pk_add_f32 v[28:29], v[28:29], v[60:61]
    v_pk_add_f32 v[30:31], v[30:31], v[62:63]
    s_waitcnt vmcnt(0)
    v_cvt_pk_bf16_f32 v9, v16, v17
    v_lshlrev_b32 v16, 16, v9
    v_and_b32 v17, 0xffff0000, v9
    v_cvt_pk_bf16_f32 v9, v18, v19
    v_lshlrev_b32 v18, 16, v9
    v_and_b32 v19, 0xffff0000, v9
    v_cvt_pk_bf16_f32 v9, v20, v21
    v_lshlrev_b32 v20, 16, v9
    v_and_b32 v21, 0xffff0000, v9
    v_cvt_pk_bf16_f32 v9, v22, v23
    v_lshlrev_b32 v22, 16, v9
    v_and_b32 v23, 0xffff0000, v9
    v_cvt_pk_bf16_f32 v9, v24, v25
    v_lshlrev_b32 v24, 16, v9
    v_and_b32 v25, 0xffff0000, v9
    v_cvt_pk_bf16_f32 v9, v26, v27
    v_lshlrev_b32 v26, 16, v9
    v_and_b32 v27, 0xffff0000, v9
    v_cvt_pk_bf16_f32 v9, v28, v29
    v_lshlrev_b32 v28, 16, v9
    v_and_b32 v29, 0xffff0000, v9
    v_cvt_pk_bf16_f32 v9, v30, v31
    v_lshlrev_b32 v30, 16, v9
    v_and_b32 v31, 0xffff0000, v9
    v_mul_f32 v16, v16, v200
    v_mul_f32 v17, v17, v201
    v_mul_f32 v18, v18, v202
    v_mul_f32 v19, v19, v203
    v_mul_f32 v20, v20, v204
    v_mul_f32 v21, v21, v205
    v_mul_f32 v22, v22, v206
    v_mul_f32 v23, v23, v207
    v_mul_f32 v24, v24, v208
    v_mul_f32 v25, v25, v209
    v_mul_f32 v26, v26, v210
    v_mul_f32 v27, v27, v211
    v_mul_f32 v28, v28, v212
    v_mul_f32 v29, v29, v213
    v_mul_f32 v30, v30, v214
    v_mul_f32 v31, v31, v215
    v_cvt_pk_bf16_f32 v9, v16, v17
    v_lshlrev_b32 v16, 16, v9
    v_and_b32 v17, 0xffff0000, v9
    v_lshlrev_b32 v10, 16, v216
    v_and_b32 v11, 0xffff0000, v216
    v_add_f32 v16, v16, v10
    v_add_f32 v17, v17, v11
    v_cvt_pk_bf16_f32 v216, v16, v17
    v_cvt_pk_bf16_f32 v9, v18, v19
    v_lshlrev_b32 v18, 16, v9
    v_and_b32 v19, 0xffff0000, v9
    v_lshlrev_b32 v10, 16, v217
    v_and_b32 v11, 0xffff0000, v217
    v_add_f32 v18, v18, v10
    v_add_f32 v19, v19, v11
    v_cvt_pk_bf16_f32 v217, v18, v19
    buffer_store_dwordx2 v[216:217], v7, s[24:27], s44 offen offset:0
    v_cvt_pk_bf16_f32 v9, v20, v21
    v_lshlrev_b32 v20, 16, v9
    v_and_b32 v21, 0xffff0000, v9
    v_lshlrev_b32 v10, 16, v218
    v_and_b32 v11, 0xffff0000, v218
    v_add_f32 v20, v20, v10
    v_add_f32 v21, v21, v11
    v_cvt_pk_bf16_f32 v218, v20, v21
    v_cvt_pk_bf16_f32 v9, v22, v23
    v_lshlrev_b32 v22, 16, v9
    v_and_b32 v23, 0xffff0000, v9
    v_lshlrev_b32 v10, 16, v219
    v_and_b32 v11, 0xffff0000, v219
    v_add_f32 v22, v22, v10
    v_add_f32 v23, v23, v11
    v_cvt_pk_bf16_f32 v219, v22, v23
    buffer_store_dwordx2 v[218:219], v7, s[24:27], s44 offen offset:16
    v_cvt_pk_bf16_f32 v9, v24, v25
    v_lshlrev_b32 v24, 16, v9
    v_and_b32 v25, 0xffff0000, v9
    v_lshlrev_b32 v10, 16, v220
    v_and_b32 v11, 0xffff0000, v220
    v_add_f32 v24, v24, v10
    v_add_f32 v25, v25, v11
    v_cvt_pk_bf16_f32 v220, v24, v25
    v_cvt_pk_bf16_f32 v9, v26, v27
    v_lshlrev_b32 v26, 16, v9
    v_and_b32 v27, 0xffff0000, v9
    v_lshlrev_b32 v10, 16, v221
    v_and_b32 v11, 0xffff0000, v221
    v_add_f32 v26, v26, v10
    v_add_f32 v27, v27, v11
    v_cvt_pk_bf16_f32 v221, v26, v27
    buffer_store_dwordx2 v[220:221], v7, s[24:27], s44 offen offset:32
    v_cvt_pk_bf16_f32 v9, v28, v29
    v_lshlrev_b32 v28, 16, v9
    v_and_b32 v29, 0xffff0000, v9
    v_lshlrev_b32 v10, 16, v222
    v_and_b32 v11, 0xffff0000, v222
    v_add_f32 v28, v28, v10
    v_add_f32 v29, v29, v11
    v_cvt_pk_bf16_f32 v222, v28, v29
    v_cvt_pk_bf16_f32 v9, v30, v31
    v_lshlrev_b32 v30, 16, v9
    v_and_b32 v31, 0xffff0000, v9
    v_lshlrev_b32 v10, 16, v223
    v_and_b32 v11, 0xffff0000, v223
    v_add_f32 v30, v30, v10
    v_add_f32 v31, v31, v11
    v_cvt_pk_bf16_f32 v223, v30, v31
    buffer_store_dwordx2 v[222:223], v7, s[24:27], s44 offen offset:48
    s_cmp_eq_u32 s96, 2
    s_cbranch_scc1 gs_entry2
    s_cmp_eq_u32 s96, 1
    s_cbranch_scc1 xs_real
    s_endpgm
hp_agroup:
    s_add_u32 s12, s10, 0x1000000
    s_addc_u32 s13, s11, 0
    s_mov_b32 s14, 0x3000000
    s_mov_b32 s15, 0x20000
    s_add_u32 s16, s10, 0x4000000
    s_addc_u32 s17, s11, 0
    s_mov_b32 s18, 0x800000
    s_mov_b32 s19, 0x20000
    s_add_u32 s20, s10, 0x4800000
    s_addc_u32 s21, s11, 0
    s_mov_b32 s22, 0x400000
    s_mov_b32 s23, 0x20000
    s_add_u32 s24, s10, 0x5000000
    s_addc_u32 s25, s11, 0
    s_mov_b32 s26, 0x1000000
    s_mov_b32 s27, 0x20000
    v_lshlrev_b32 v3, 4, v1
    v_lshlrev_b32 v4, 3, v1
    s_lshl_b32 s4, s100, 2
    s_add_u32 s4, s4, s3
    s_and_b32 s96, s4, 31
    v_lshrrev_b32 v5, 4, v1
    v_and_b32 v6, 15, v1
    v_and_b32 v7, 1, v5
    v_lshlrev_b32 v7, 4, v7
    v_lshrrev_b32 v8, 1, v5
    v_lshl_add_u32 v7, v8, 2, v7
    v_sub_u32 v7, v6, v7
    v_lshlrev_b32 v9, 10, v8
    v_and_b32 v8, 1, v5
    v_lshl_add_u32 v9, v8, 9, v9
    v_lshl_add_u32 v9, v6, 4, v9
    v_cmp_le_u32 s[62:63], 2, v5
    v_cmp_le_i32 s[28:29], 0, v7
    v_cmp_le_i32 s[30:31], 1, v7
    v_cmp_le_i32 s[32:33], 2, v7
    v_cmp_le_i32 s[34:35], 3, v7
    v_cmp_le_i32 s[44:45], 8, v7
    v_cmp_le_i32 s[46:47], 9, v7
    v_cmp_le_i32 s[48:49], 10, v7
    v_cmp_le_i32 s[50:51], 11, v7
    v_cmp_le_i32 s[52:53], -16, v7
    v_cmp_le_i32 s[54:55], -15, v7
    v_cmp_le_i32 s[56:57], -14, v7
    v_cmp_le_i32 s[58:59], -13, v7
    v_cmp_le_i32 s[64:65], -8, v7
    v_cmp_le_i32 s[66:67], -7, v7
    v_cmp_le_i32 s[68:69], -6, v7
    v_cmp_le_i32 s[70:71], -5, v7
    v_mov_b32 v10, 0xce6e6b28
    s_mov_b32 s60, 0x3db504f3
    s_mov_b32 s61, 0x3fb8aa3b
    v_min_u32 v14, 23, v1
    v_lshlrev_b32 v14, 2, v14
    s_lshl_b32 s72, s96, 7
    s_add_u32 s97, s101, 16
    s_mov_b32 s98, 0x40000
atq_pp:
    buffer_load_dword v2, v14, s[40:43], s72 offen offset:0 sc1
    s_waitcnt vmcnt(0)
    v_subrev_u32 v2, s97, v2
    v_cmp_lt_u32 vcc, 0, v2
    s_cbranch_vccz atq_pd
    s_sleep 8
    s_sub_u32 s98, s98, 1
    s_cbranch_scc0 atq_pp
atq_pd:
    v_mov_b32 v14, 0
    s_lshl_b32 s72, s96, 6
    s_add_u32 s72, s72, 16384
    v_mov_b32 v15, 0
    v_mov_b32 v16, s101
at_loop:
    s_lshl_b32 s5, s4, 13
    s_lshl_b32 s6, s4, 12
    s_lshl_b32 s7, s4, 11
    buffer_load_dwordx4 v[32:35], v3, s[12:15], s5 offen offset:0 sc1
    buffer_load_dwordx4 v[36:39], v3, s[12:15], s5 offen offset:1024 sc1
    buffer_load_dwordx4 v[40:43], v3, s[12:15], s5 offen offset:2048 sc1
    buffer_load_dwordx4 v[44:47], v3, s[12:15], s5 offen offset:3072 sc1
    s_add_u32 s9, s5, 0x1000
    buffer_load_dwordx4 v[48:51], v3, s[12:15], s9 offen offset:0 sc1
    buffer_load_dwordx4 v[52:55], v3, s[12:15], s9 offen offset:1024 sc1
    buffer_load_dwordx4 v[56:59], v3, s[12:15], s9 offen offset:2048 sc1
    buffer_load_dwordx4 v[60:63], v3, s[12:15], s9 offen offset:3072 sc1
    s_add_u32 s8, s5, 0x1000000
    buffer_load_dwordx4 v[64:67], v3, s[12:15], s8 offen offset:0 sc1
    buffer_load_dwordx4 v[68:71], v3, s[12:15], s8 offen offset:1024 sc1
    buffer_load_dwordx4 v[72:75], v3, s[12:15], s8 offen offset:2048 sc1
    buffer_load_dwordx4 v[76:79], v3, s[12:15], s8 offen offset:3072 sc1
    s_add_u32 s9, s8, 0x1000
    buffer_load_dwordx4 v[80:83], v3, s[12:15], s9 offen offset:0 sc1
    buffer_load_dwordx4 v[84:87], v3, s[12:15], s9 offen offset:1024 sc1
    buffer_load_dwordx4 v[88:91], v3, s[12:15], s9 offen offset:2048 sc1
    buffer_load_dwordx4 v[92:95], v3, s[12:15], s9 offen offset:3072 sc1
    s_add_u32 s8, s5, 0x2000000
    buffer_load_dwordx4 v[96:99], v3, s[12:15], s8 offen offset:0 sc1
    buffer_load_dwordx4 v[100:103], v3, s[12:15], s8 offen offset:1024 sc1
    buffer_load_dwordx4 v[104:107], v3, s[12:15], s8 offen offset:2048 sc1
    buffer_load_dwordx4 v[108:111], v3, s[12:15], s8 offen offset:3072 sc1
    s_add_u32 s9, s8, 0x1000
    buffer_load_dwordx4 v[112:115], v3, s[12:15], s9 offen offset:0 sc1
    buffer_load_dwordx4 v[116:119], v3, s[12:15], s9 offen offset:1024 sc1
    buffer_load_dwordx4 v[120:123], v3, s[12:15], s9 offen offset:2048 sc1
    buffer_load_dwordx4 v[124:127], v3, s[12:15], s9 offen offset:3072 sc1
    s_cmp_ge_u32 s4, 1856
    s_cbranch_scc1 at_dir
    s_lshr_b32 s73, s4, 5
    s_add_u32 s73, s73, 1
    s_add_u32 s97, s101, s73
    s_mov_b32 s98, 0x40000
    buffer_load_dword v18, v14, s[40:43], s72 offen sc1
    s_waitcnt vmcnt(0)
    v_subrev_u32 v18, s97, v18
    v_cmp_lt_u32 vcc, 64, v18
    s_cbranch_vccz atc_pd
    buffer_load_dword v18, v14, s[40:43], s72 offen sc1
    s_sleep 6
    s_sleep 6
    buffer_load_dword v19, v14, s[40:43], s72 offen sc1
atc_pp:
    s_waitcnt vmcnt(1)
    v_subrev_u32 v18, s97, v18
    v_cmp_lt_u32 vcc, 64, v18
    s_cbranch_vccz atc_pd
    buffer_load_dword v18, v14, s[40:43], s72 offen sc1
    s_waitcnt vmcnt(1)
    v_subrev_u32 v19, s97, v19
    v_cmp_lt_u32 vcc, 64, v19
    s_cbranch_vccz atc_pd
    buffer_load_dword v19, v14, s[40:43], s72 offen sc1
    s_sub_u32 s98, s98, 1
    s_cbranch_scc0 atc_pp
atc_pd:
    buffer_load_dwordx4 v[128:131], v3, s[16:19], s6 offen offset:0 sc1
    buffer_load_dwordx4 v[132:135], v3, s[16:19], s6 offen offset:1024 sc1
    buffer_load_dwordx4 v[136:139], v3, s[16:19], s6 offen offset:2048 sc1
    buffer_load_dwordx4 v[140:143], v3, s[16:19], s6 offen offset:3072 sc1
    buffer_load_dwordx2 v[144:145], v4, s[20:23], s7 offen offset:0 sc1
    buffer_load_dwordx2 v[146:147], v4, s[20:23], s7 offen offset:512 sc1
    buffer_load_dwordx2 v[148:149], v4, s[20:23], s7 offen offset:1024 sc1
    buffer_load_dwordx2 v[150:151], v4, s[20:23], s7 offen offset:1536 sc1
    s_branch at_go
at_dir:
    s_mov_b32 s98, 0x40000
at_dp:
    buffer_load_dwordx4 v[128:131], v3, s[16:19], s6 offen offset:0 sc1
    buffer_load_dwordx4 v[132:135], v3, s[16:19], s6 offen offset:1024 sc1
    buffer_load_dwordx4 v[136:139], v3, s[16:19], s6 offen offset:2048 sc1
    buffer_load_dwordx4 v[140:143], v3, s[16:19], s6 offen offset:3072 sc1
    buffer_load_dwordx2 v[144:145], v4, s[20:23], s7 offen offset:0 sc1
    buffer_load_dwordx2 v[146:147], v4, s[20:23], s7 offen offset:512 sc1
    buffer_load_dwordx2 v[148:149], v4, s[20:23], s7 offen offset:1024 sc1
    buffer_load_dwordx2 v[150:151], v4, s[20:23], s7 offen offset:1536 sc1
    s_waitcnt vmcnt(0)
    v_max3_u32 v18, v128, v129, v130
    v_max3_u32 v18, v18, v131, v132
    v_max3_u32 v18, v18, v133, v134
    v_max3_u32 v18, v18, v135, v136
    v_max3_u32 v18, v18, v137, v138
    v_max3_u32 v18, v18, v139, v140
    v_max3_u32 v18, v18, v141, v142
    v_max3_u32 v18, v18, v143, v144
    v_max3_u32 v18, v18, v145, v146
    v_max3_u32 v18, v18, v147, v148
    v_max3_u32 v18, v18, v149, v150
    v_max_u32 v18, v18, v151
    v_cmp_eq_u32 vcc, -1, v18
    s_cbranch_vccz at_dd
    s_sleep 2
    s_sub_u32 s98, s98, 1
    s_cbranch_scc0 at_dp
at_dd:
at_go:
    v_mfma_f32_16x16x32_bf16 v[152:155], v[64:67], v[32:35], 0
    v_mfma_f32_16x16x32_bf16 v[156:159], v[68:71], v[32:35], 0
    v_mfma_f32_16x16x32_bf16 v[160:163], v[64:67], v[36:39], 0
    v_mfma_f32_16x16x32_bf16 v[164:167], v[68:71], v[36:39], 0
    v_mfma_f32_16x16x32_bf16 v[152:155], v[72:75], v[40:43], v[152:155]
    v_mfma_f32_16x16x32_bf16 v[156:159], v[76:79], v[40:43], v[156:159]
    v_mfma_f32_16x16x32_bf16 v[160:163], v[72:75], v[44:47], v[160:163]
    v_mfma_f32_16x16x32_bf16 v[164:167], v[76:79], v[44:47], v[164:167]
    v_mfma_f32_16x16x32_bf16 v[152:155], v[80:83], v[48:51], v[152:155]
    v_mfma_f32_16x16x32_bf16 v[156:159], v[84:87], v[48:51], v[156:159]
    v_mfma_f32_16x16x32_bf16 v[160:163], v[80:83], v[52:55], v[160:163]
    v_mfma_f32_16x16x32_bf16 v[164:167], v[84:87], v[52:55], v[164:167]
    v_mfma_f32_16x16x32_bf16 v[152:155], v[88:91], v[56:59], v[152:155]
    v_mfma_f32_16x16x32_bf16 v[156:159], v[92:95], v[56:59], v[156:159]
    v_mfma_f32_16x16x32_bf16 v[160:163], v[88:91], v[60:63], v[160:163]
    v_mfma_f32_16x16x32_bf16 v[164:167], v[92:95], v[60:63], v[164:167]
    s_waitcnt vmcnt(7)
    v_mfma_f32_16x16x32_bf16 v[168:171], v[128:131], v[32:35], 0
    v_mfma_f32_16x16x32_bf16 v[172:175], v[128:131], v[36:39], 0
    s_waitcnt vmcnt(6)
    v_mfma_f32_16x16x32_bf16 v[168:171], v[132:135], v[40:43], v[168:171]
    v_mfma_f32_16x16x32_bf16 v[172:175], v[132:135], v[44:47], v[172:175]
    s_waitcnt vmcnt(5)
    v_mfma_f32_16x16x32_bf16 v[168:171], v[136:139], v[48:51], v[168:171]
    v_mfma_f32_16x16x32_bf16 v[172:175], v[136:139], v[52:55], v[172:175]
    s_waitcnt vmcnt(4)
    v_mfma_f32_16x16x32_bf16 v[168:171], v[140:143], v[56:59], v[168:171]
    v_mfma_f32_16x16x32_bf16 v[172:175], v[140:143], v[60:63], v[172:175]
    s_nop 7
    v_cvt_pk_bf16_f32 v11, v152, v153
    v_lshlrev_b32 v152, 16, v11
    v_and_b32 v153, 0xffff0000, v11
    v_cvt_pk_bf16_f32 v11, v154, v155
    v_lshlrev_b32 v154, 16, v11
    v_and_b32 v155, 0xffff0000, v11
    v_cvt_pk_bf16_f32 v11, v156, v157
    v_lshlrev_b32 v156, 16, v11
    v_and_b32 v157, 0xffff0000, v11
    v_cvt_pk_bf16_f32 v11, v158, v159
    v_lshlrev_b32 v158, 16, v11
    v_and_b32 v159, 0xffff0000, v11
    v_cvt_pk_bf16_f32 v11, v170, v171
    v_lshlrev_b32 v170, 16, v11
    v_and_b32 v171, 0xffff0000, v11
    v_mul_f32 v152, s60, v152
    v_mul_f32 v153, s60, v153
    v_mul_f32 v154, s60, v154
    v_mul_f32 v155, s60, v155
    v_mul_f32 v156, s60, v156
    v_mul_f32 v157, s60, v157
    v_mul_f32 v158, s60, v158
    v_mul_f32 v159, s60, v159
    v_mul_f32 v170, s60, v170
    v_mul_f32 v171, s60, v171
    v_cvt_pk_bf16_f32 v11, v152, v153
    v_lshlrev_b32 v152, 16, v11
    v_and_b32 v153, 0xffff0000, v11
    v_cvt_pk_bf16_f32 v11, v154, v155
    v_lshlrev_b32 v154, 16, v11
    v_and_b32 v155, 0xffff0000, v11
    v_cvt_pk_bf16_f32 v11, v156, v157
    v_lshlrev_b32 v156, 16, v11
    v_and_b32 v157, 0xffff0000, v11
    v_cvt_pk_bf16_f32 v11, v158, v159
    v_lshlrev_b32 v158, 16, v11
    v_and_b32 v159, 0xffff0000, v11
    v_cvt_pk_bf16_f32 v11, v170, v171
    v_lshlrev_b32 v170, 16, v11
    v_and_b32 v171, 0xffff0000, v11
    v_cndmask_b32 v152, v10, v152, s[28:29]
    v_cndmask_b32 v153, v10, v153, s[30:31]
    v_cndmask_b32 v154, v10, v154, s[32:33]
    v_cndmask_b32 v155, v10, v155, s[34:35]
    v_cndmask_b32 v156, v10, v156, s[44:45]
    v_cndmask_b32 v157, v10, v157, s[46:47]
    v_cndmask_b32 v158, v10, v158, s[48:49]
    v_cndmask_b32 v159, v10, v159, s[50:51]
    v_max3_f32 v12, v152, v153, v154
    v_max3_f32 v12, v12, v155, v156
    v_max3_f32 v12, v12, v157, v158
    v_max3_f32 v12, v12, v159, v170
    v_max_f32 v12, v12, v171
    v_mov_b32 v13, v12
    s_nop 1
    v_permlane16_swap_b32 v12, v13
    s_nop 0
    v_max_f32 v12, v12, v13
    v_mov_b32 v13, v12
    s_nop 1
    v_permlane32_swap_b32 v12, v13
    s_nop 0
    v_max_f32 v12, v12, v13
    v_sub_f32 v152, v152, v12
    v_sub_f32 v153, v153, v12
    v_sub_f32 v154, v154, v12
    v_sub_f32 v155, v155, v12
    v_sub_f32 v156, v156, v12
    v_sub_f32 v157, v157, v12
    v_sub_f32 v158, v158, v12
    v_sub_f32 v159, v159, v12
    v_sub_f32 v170, v170, v12
    v_sub_f32 v171, v171, v12
    v_mul_f32 v152, s61, v152
    v_mul_f32 v153, s61, v153
    v_mul_f32 v154, s61, v154
    v_mul_f32 v155, s61, v155
    v_mul_f32 v156, s61, v156
    v_mul_f32 v157, s61, v157
    v_mul_f32 v158, s61, v158
    v_mul_f32 v159, s61, v159
    v_mul_f32 v170, s61, v170
    v_mul_f32 v171, s61, v171
    v_exp_f32 v152, v152
    v_exp_f32 v153, v153
    v_exp_f32 v154, v154
    v_exp_f32 v155, v155
    v_exp_f32 v156, v156
    v_exp_f32 v157, v157
    v_exp_f32 v158, v158
    v_exp_f32 v159, v159
    v_exp_f32 v170, v170
    v_exp_f32 v171, v171
    s_nop 0
    v_add_f32 v12, v152, v153
    v_add_f32 v12, v12, v154
    v_add_f32 v12, v12, v155
    v_add_f32 v12, v12, v156
    v_add_f32 v12, v12, v157
    v_add_f32 v12, v12, v158
    v_add_f32 v12, v12, v159
    v_add_f32 v12, v12, v170
    v_add_f32 v12, v12, v171
    v_mov_b32 v13, v12
    s_nop 1
    v_permlane16_swap_b32 v12, v13
    s_nop 0
    v_add_f32 v12, v12, v13
    v_mov_b32 v13, v12
    s_nop 1
    v_permlane32_swap_b32 v12, v13
    s_nop 0
    v_add_f32 v12, v12, v13
    v_rcp_f32 v12, v12
    s_nop 0
    v_mul_f32 v152, v152, v12
    v_mul_f32 v153, v153, v12
    v_mul_f32 v154, v154, v12
    v_mul_f32 v155, v155, v12
    v_mul_f32 v156, v156, v12
    v_mul_f32 v157, v157, v12
    v_mul_f32 v158, v158, v12
    v_mul_f32 v159, v159, v12
    v_mul_f32 v170, v170, v12
    v_mul_f32 v171, v171, v12
    v_cvt_pk_bf16_f32 v176, v152, v153
    v_cvt_pk_bf16_f32 v177, v154, v155
    v_cvt_pk_bf16_f32 v178, v156, v157
    v_cvt_pk_bf16_f32 v179, v158, v159
    v_cvt_pk_bf16_f32 v184, v170, v171
    v_cvt_pk_bf16_f32 v187, v170, v171
    v_mov_b32 v185, 0
    v_mov_b32 v186, 0
    v_cvt_pk_bf16_f32 v11, v160, v161
    v_lshlrev_b32 v160, 16, v11
    v_and_b32 v161, 0xffff0000, v11
    v_cvt_pk_bf16_f32 v11, v162, v163
    v_lshlrev_b32 v162, 16, v11
    v_and_b32 v163, 0xffff0000, v11
    v_cvt_pk_bf16_f32 v11, v164, v165
    v_lshlrev_b32 v164, 16, v11
    v_and_b32 v165, 0xffff0000, v11
    v_cvt_pk_bf16_f32 v11, v166, v167
    v_lshlrev_b32 v166, 16, v11
    v_and_b32 v167, 0xffff0000, v11
    v_cvt_pk_bf16_f32 v11, v174, v175
    v_lshlrev_b32 v174, 16, v11
    v_and_b32 v175, 0xffff0000, v11
    v_mul_f32 v160, s60, v160
    v_mul_f32 v161, s60, v161
    v_mul_f32 v162, s60, v162
    v_mul_f32 v163, s60, v163
    v_mul_f32 v164, s60, v164
    v_mul_f32 v165, s60, v165
    v_mul_f32 v166, s60, v166
    v_mul_f32 v167, s60, v167
    v_mul_f32 v174, s60, v174
    v_mul_f32 v175, s60, v175
    v_cvt_pk_bf16_f32 v11, v160, v161
    v_lshlrev_b32 v160, 16, v11
    v_and_b32 v161, 0xffff0000, v11
    v_cvt_pk_bf16_f32 v11, v162, v163
    v_lshlrev_b32 v162, 16, v11
    v_and_b32 v163, 0xffff0000, v11
    v_cvt_pk_bf16_f32 v11, v164, v165
    v_lshlrev_b32 v164, 16, v11
    v_and_b32 v165, 0xffff0000, v11
    v_cvt_pk_bf16_f32 v11, v166, v167
    v_lshlrev_b32 v166, 16, v11
    v_and_b32 v167, 0xffff0000, v11
    v_cvt_pk_bf16_f32 v11, v174, v175
    v_lshlrev_b32 v174, 16, v11
    v_and_b32 v175, 0xffff0000, v11
    v_cndmask_b32 v160, v10, v160, s[52:53]
    v_cndmask_b32 v161, v10, v161, s[54:55]
    v_cndmask_b32 v162, v10, v162, s[56:57]
    v_cndmask_b32 v163, v10, v163, s[58:59]
    v_cndmask_b32 v164, v10, v164, s[64:65]
    v_cndmask_b32 v165, v10, v165, s[66:67]
    v_cndmask_b32 v166, v10, v166, s[68:69]
    v_cndmask_b32 v167, v10, v167, s[70:71]
    v_max3_f32 v12, v160, v161, v162
    v_max3_f32 v12, v12, v163, v164
    v_max3_f32 v12, v12, v165, v166
    v_max3_f32 v12, v12, v167, v174
    v_max_f32 v12, v12, v175
    v_mov_b32 v13, v12
    s_nop 1
    v_permlane16_swap_b32 v12, v13
    s_nop 0
    v_max_f32 v12, v12, v13
    v_mov_b32 v13, v12
    s_nop 1
    v_permlane32_swap_b32 v12, v13
    s_nop 0
    v_max_f32 v12, v12, v13
    v_sub_f32 v160, v160, v12
    v_sub_f32 v161, v161, v12
    v_sub_f32 v162, v162, v12
    v_sub_f32 v163, v163, v12
    v_sub_f32 v164, v164, v12
    v_sub_f32 v165, v165, v12
    v_sub_f32 v166, v166, v12
    v_sub_f32 v167, v167, v12
    v_sub_f32 v174, v174, v12
    v_sub_f32 v175, v175, v12
    v_mul_f32 v160, s61, v160
    v_mul_f32 v161, s61, v161
    v_mul_f32 v162, s61, v162
    v_mul_f32 v163, s61, v163
    v_mul_f32 v164, s61, v164
    v_mul_f32 v165, s61, v165
    v_mul_f32 v166, s61, v166
    v_mul_f32 v167, s61, v167
    v_mul_f32 v174, s61, v174
    v_mul_f32 v175, s61, v175
    v_exp_f32 v160, v160
    v_exp_f32 v161, v161
    v_exp_f32 v162, v162
    v_exp_f32 v163, v163
    v_exp_f32 v164, v164
    v_exp_f32 v165, v165
    v_exp_f32 v166, v166
    v_exp_f32 v167, v167
    v_exp_f32 v174, v174
    v_exp_f32 v175, v175
    s_nop 0
    v_add_f32 v12, v160, v161
    v_add_f32 v12, v12, v162
    v_add_f32 v12, v12, v163
    v_add_f32 v12, v12, v164
    v_add_f32 v12, v12, v165
    v_add_f32 v12, v12, v166
    v_add_f32 v12, v12, v167
    v_add_f32 v12, v12, v174
    v_add_f32 v12, v12, v175
    v_mov_b32 v13, v12
    s_nop 1
    v_permlane16_swap_b32 v12, v13
    s_nop 0
    v_add_f32 v12, v12, v13
    v_mov_b32 v13, v12
    s_nop 1
    v_permlane32_swap_b32 v12, v13
    s_nop 0
    v_add_f32 v12, v12, v13
    v_rcp_f32 v12, v12
    s_nop 0
    v_mul_f32 v160, v160, v12
    v_mul_f32 v161, v161, v12
    v_mul_f32 v162, v162, v12
    v_mul_f32 v163, v163, v12
    v_mul_f32 v164, v164, v12
    v_mul_f32 v165, v165, v12
    v_mul_f32 v166, v166, v12
    v_mul_f32 v167, v167, v12
    v_mul_f32 v174, v174, v12
    v_mul_f32 v175, v175, v12
    v_cvt_pk_bf16_f32 v180, v160, v161
    v_cvt_pk_bf16_f32 v181, v162, v163
    v_cvt_pk_bf16_f32 v182, v164, v165
    v_cvt_pk_bf16_f32 v183, v166, v167
    v_cvt_pk_bf16_f32 v188, v174, v175
    v_cvt_pk_bf16_f32 v191, v174, v175
    v_mov_b32 v189, 0
    v_mov_b32 v190, 0
    s_waitcnt vmcnt(0)
    v_mfma_f32_16x16x32_bf16 v[32:35], v[96:99], v[176:179], 0
    v_mfma_f32_16x16x32_bf16 v[40:43], v[100:103], v[176:179], 0
    v_mfma_f32_16x16x32_bf16 v[48:51], v[104:107], v[176:179], 0
    v_mfma_f32_16x16x32_bf16 v[56:59], v[108:111], v[176:179], 0
    v_mfma_f32_16x16x32_bf16 v[64:67], v[112:115], v[176:179], 0
    v_mfma_f32_16x16x32_bf16 v[72:75], v[116:119], v[176:179], 0
    v_mfma_f32_16x16x32_bf16 v[80:83], v[120:123], v[176:179], 0
    v_mfma_f32_16x16x32_bf16 v[88:91], v[124:127], v[176:179], 0
    v_mfma_f32_16x16x16_bf16 v[32:35], v[144:145], v[184:185], v[32:35]
    v_mfma_f32_16x16x16_bf16 v[40:43], v[144:145], v[186:187], v[40:43]
    v_mfma_f32_16x16x16_bf16 v[48:51], v[146:147], v[184:185], v[48:51]
    v_mfma_f32_16x16x16_bf16 v[56:59], v[146:147], v[186:187], v[56:59]
    v_mfma_f32_16x16x16_bf16 v[64:67], v[148:149], v[184:185], v[64:67]
    v_mfma_f32_16x16x16_bf16 v[72:75], v[148:149], v[186:187], v[72:75]
    v_mfma_f32_16x16x16_bf16 v[80:83], v[150:151], v[184:185], v[80:83]
    v_mfma_f32_16x16x16_bf16 v[88:91], v[150:151], v[186:187], v[88:91]
    v_mfma_f32_16x16x32_bf16 v[36:39], v[96:99], v[180:183], 0
    v_mfma_f32_16x16x32_bf16 v[44:47], v[100:103], v[180:183], 0
    v_mfma_f32_16x16x32_bf16 v[52:55], v[104:107], v[180:183], 0
    v_mfma_f32_16x16x32_bf16 v[60:63], v[108:111], v[180:183], 0
    v_mfma_f32_16x16x32_bf16 v[68:71], v[112:115], v[180:183], 0
    v_mfma_f32_16x16x32_bf16 v[76:79], v[116:119], v[180:183], 0
    v_mfma_f32_16x16x32_bf16 v[84:87], v[120:123], v[180:183], 0
    v_mfma_f32_16x16x32_bf16 v[92:95], v[124:127], v[180:183], 0
    v_mfma_f32_16x16x16_bf16 v[36:39], v[144:145], v[188:189], v[36:39]
    v_mfma_f32_16x16x16_bf16 v[44:47], v[144:145], v[190:191], v[44:47]
    v_mfma_f32_16x16x16_bf16 v[52:55], v[146:147], v[188:189], v[52:55]
    v_mfma_f32_16x16x16_bf16 v[60:63], v[146:147], v[190:191], v[60:63]
    v_mfma_f32_16x16x16_bf16 v[68:71], v[148:149], v[188:189], v[68:71]
    v_mfma_f32_16x16x16_bf16 v[76:79], v[148:149], v[190:191], v[76:79]
    v_mfma_f32_16x16x16_bf16 v[84:87], v[150:151], v[188:189], v[84:87]
    v_mfma_f32_16x16x16_bf16 v[92:95], v[150:151], v[190:191], v[92:95]
    s_nop 7
    v_cvt_pk_bf16_f32 v192, v32, v33
    v_cvt_pk_bf16_f32 v193, v34, v35
    v_cvt_pk_bf16_f32 v194, v40, v41
    v_cvt_pk_bf16_f32 v195, v42, v43
    buffer_store_dwordx4 v[192:195], v9, s[24:27], s5 offen offset:0 sc1
    v_cvt_pk_bf16_f32 v196, v48, v49
    v_cvt_pk_bf16_f32 v197, v50, v51
    v_cvt_pk_bf16_f32 v198, v56, v57
    v_cvt_pk_bf16_f32 v199, v58, v59
    buffer_store_dwordx4 v[196:199], v9, s[24:27], s5 offen offset:2048 sc1
    v_cvt_pk_bf16_f32 v200, v64, v65
    v_cvt_pk_bf16_f32 v201, v66, v67
    v_cvt_pk_bf16_f32 v202, v72, v73
    v_cvt_pk_bf16_f32 v203, v74, v75
    s_add_u32 s9, s5, 0x1000
    buffer_store_dwordx4 v[200:203], v9, s[24:27], s9 offen offset:0 sc1
    v_cvt_pk_bf16_f32 v204, v80, v81
    v_cvt_pk_bf16_f32 v205, v82, v83
    v_cvt_pk_bf16_f32 v206, v88, v89
    v_cvt_pk_bf16_f32 v207, v90, v91
    buffer_store_dwordx4 v[204:207], v9, s[24:27], s9 offen offset:2048 sc1
    v_cvt_pk_bf16_f32 v208, v36, v37
    v_cvt_pk_bf16_f32 v209, v38, v39
    v_cvt_pk_bf16_f32 v210, v44, v45
    v_cvt_pk_bf16_f32 v211, v46, v47
    buffer_store_dwordx4 v[208:211], v9, s[24:27], s5 offen offset:256 sc1
    v_cvt_pk_bf16_f32 v212, v52, v53
    v_cvt_pk_bf16_f32 v213, v54, v55
    v_cvt_pk_bf16_f32 v214, v60, v61
    v_cvt_pk_bf16_f32 v215, v62, v63
    buffer_store_dwordx4 v[212:215], v9, s[24:27], s5 offen offset:2304 sc1
    v_cvt_pk_bf16_f32 v216, v68, v69
    v_cvt_pk_bf16_f32 v217, v70, v71
    v_cvt_pk_bf16_f32 v218, v76, v77
    v_cvt_pk_bf16_f32 v219, v78, v79
    s_add_u32 s9, s5, 0x1000
    buffer_store_dwordx4 v[216:219], v9, s[24:27], s9 offen offset:256 sc1
    v_cvt_pk_bf16_f32 v220, v84, v85
    v_cvt_pk_bf16_f32 v221, v86, v87
    v_cvt_pk_bf16_f32 v222, v92, v93
    v_cvt_pk_bf16_f32 v223, v94, v95
    buffer_store_dwordx4 v[220:223], v9, s[24:27], s9 offen offset:2304 sc1
    s_lshl_b32 s8, s4, 2
    s_add_u32 s8, s8, 4096
    s_waitcnt vmcnt(0)
    buffer_store_dword v16, v15, s[40:43], s8 offen sc1
    s_add_u32 s4, s4, 128
    s_cmp_lt_u32 s4, 2048
    s_cbranch_scc1 at_loop
    s_branch xs_entry
hp_ggroup:
    s_mov_b32 s96, 2
    s_branch xs_entry2
gs_entry2:
    s_sub_u32 s4, s100, 32
    s_and_b32 s5, s4, 7
    s_lshr_b32 s6, s4, 3
    s_add_u32 s12, s10, 0x6c00000
    s_addc_u32 s13, s11, 0
    s_mov_b32 s14, 0x2c0000
    s_mov_b32 s15, 0x20000
    s_mov_b32 s16, s82
    s_mov_b32 s17, s83
    s_mov_b32 s18, 0x800000
    s_mov_b32 s19, 0x20000
    s_add_u32 s20, s10, 0x6800000
    s_addc_u32 s21, s11, 0
    s_mov_b32 s22, 0x2c0000
    s_mov_b32 s23, 0x20000
    s_add_u32 s24, s10, 0x7000000
    s_addc_u32 s25, s11, 0
    s_mov_b32 s26, 0x2c0000
    s_mov_b32 s27, 0x20000
    s_mov_b32 s28, s84
    s_mov_b32 s29, s85
    s_mov_b32 s30, 0x1000
    s_mov_b32 s31, 0x20000
    v_lshlrev_b32 v3, 4, v1
    v_lshlrev_b32 v4, 2, v1
    v_and_b32 v6, 31, v1
    v_lshlrev_b32 v9, 1, v6
    v_lshlrev_b32 v6, 12, v6
    v_lshrrev_b32 v7, 5, v1
    v_lshl_add_u32 v6, v7, 4, v6
    v_add_u32 v7, 0x20000, v6
    s_lshl_b32 s32, s5, 2
    s_add_u32 s32, s32, s3
    s_lshl_b32 s33, s32, 18
    s_lshl_b32 s34, s6, 11
    s_lshl_b32 s44, s32, 7
    buffer_load_ushort v12, v9, s[28:31], s44 offen
    buffer_load_ushort v13, v9, s[28:31], s44 offen offset:64
    buffer_load_dwordx4 v[80:83], v6, s[16:19], s33 offen offset:0
    buffer_load_dwordx4 v[84:87], v7, s[16:19], s33 offen offset:0
    buffer_load_dwordx4 v[88:91], v6, s[16:19], s33 offen offset:32
    buffer_load_dwordx4 v[92:95], v7, s[16:19], s33 offen offset:32
    buffer_load_dwordx4 v[96:99], v6, s[16:19], s33 offen offset:64
    buffer_load_dwordx4 v[100:103], v7, s[16:19], s33 offen offset:64
    buffer_load_dwordx4 v[104:107], v6, s[16:19], s33 offen offset:96
    buffer_load_dwordx4 v[108:111], v7, s[16:19], s33 offen offset:96
    buffer_load_dwordx4 v[112:115], v6, s[16:19], s33 offen offset:128
    buffer_load_dwordx4 v[116:119], v7, s[16:19], s33 offen offset:128
    buffer_load_dwordx4 v[120:123], v6, s[16:19], s33 offen offset:160
    buffer_load_dwordx4 v[124:127], v7, s[16:19], s33 offen offset:160
    buffer_load_dwordx4 v[128:131], v6, s[16:19], s33 offen offset:192
    buffer_load_dwordx4 v[132:135], v7, s[16:19], s33 offen offset:192
    buffer_load_dwordx4 v[136:139], v6, s[16:19], s33 offen offset:224
    buffer_load_dwordx4 v[140:143], v7, s[16:19], s33 offen offset:224
    s_mov_b32 s26, 0
    s_mov_b32 s44, 0
    s_mov_b32 s35, 0
    s_branch gs_epi
gs_start:
    s_mov_b32 s96, 0
    s_mov_b32 s26, 2883584
    v_mov_b64 v[16:17], 0
    v_mov_b64 v[18:19], 0
    v_mov_b64 v[20:21], 0
    v_mov_b64 v[22:23], 0
    v_mov_b64 v[24:25], 0
    v_mov_b64 v[26:27], 0
    v_mov_b64 v[28:29], 0
    v_mov_b64 v[30:31], 0
    v_mov_b64 v[32:33], 0
    v_mov_b64 v[34:35], 0
    v_mov_b64 v[36:37], 0
    v_mov_b64 v[38:39], 0
    v_mov_b64 v[40:41], 0
    v_mov_b64 v[42:43], 0
    v_mov_b64 v[44:45], 0
    v_mov_b64 v[46:47], 0
    v_mov_b64 v[48:49], 0
    v_mov_b64 v[50:51], 0
    v_mov_b64 v[52:53], 0
    v_mov_b64 v[54:55], 0
    v_mov_b64 v[56:57], 0
    v_mov_b64 v[58:59], 0
    v_mov_b64 v[60:61], 0
    v_mov_b64 v[62:63], 0
    v_mov_b64 v[64:65], 0
    v_mov_b64 v[66:67], 0
    v_mov_b64 v[68:69], 0
    v_mov_b64 v[70:71], 0
    v_mov_b64 v[72:73], 0
    v_mov_b64 v[74:75], 0
    v_mov_b64 v[76:77], 0
    v_mov_b64 v[78:79], 0
    s_mov_b32 s45, 0
    s_mov_b32 s46, 0
    s_movk_i32 s47, 28672
gs_loop:
    s_add_u32 s45, s45, 2
    s_cmp_le_u32 s45, s46
    s_cbranch_scc1 gs_ok0
    s_mov_b32 s98, 0x40000
gs_p0:
    buffer_load_dword v160, v4, s[40:43], s47 offen offset:0 sc1
    buffer_load_dword v161, v4, s[40:43], s47 offen offset:256 sc1
    buffer_load_dword v162, v4, s[40:43], s47 offen offset:512 sc1
    buffer_load_dword v163, v4, s[40:43], s47 offen offset:768 sc1
    s_waitcnt vmcnt(0)
    v_cmp_eq_u32 s[48:49], s101, v160
    v_cmp_eq_u32 s[50:51], s101, v162
    v_cmp_eq_u32 s[52:53], s101, v161
    v_cmp_eq_u32 s[54:55], s101, v163
    s_nop 0
    s_and_b64 s[48:49], s[48:49], s[50:51]
    s_and_b64 s[52:53], s[52:53], s[54:55]
    s_ff0_i32_b64 s46, s[48:49]
    s_ff0_i32_b64 s50, s[52:53]
    s_cmp_eq_i32 s50, -1
    s_cselect_b32 s50, 64, s50
    s_add_u32 s50, s50, 64
    s_cmp_eq_i32 s46, -1
    s_cselect_b32 s46, s50, s46
    s_cmp_le_u32 s45, s46
    s_cbranch_scc1 gs_ok0
    s_sleep 4
    s_sub_u32 s98, s98, 1
    s_cbranch_scc0 gs_p0
gs_ok0:
    s_add_u32 s35, s34, 22528
    buffer_load_dwordx4 v[144:147], v3, s[12:15], s34 offen offset:0
    buffer_load_dwordx4 v[148:151], v3, s[12:15], s34 offen offset:1024
    buffer_load_dwordx4 v[152:155], v3, s[12:15], s35 offen offset:0
    buffer_load_dwordx4 v[156:159], v3, s[12:15], s35 offen offset:1024
    s_add_u32 s34, s34, 45056
    s_waitcnt vmcnt(0)
    v_mfma_f32_32x32x16_bf16 v[16:31], v[144:147], v[80:83], v[16:31]
    v_mfma_f32_32x32x16_bf16 v[48:63], v[144:147], v[84:87], v[48:63]
    v_mfma_f32_32x32x16_bf16 v[32:47], v[148:151], v[80:83], v[32:47]
    v_mfma_f32_32x32x16_bf16 v[64:79], v[148:151], v[84:87], v[64:79]
    v_mfma_f32_32x32x16_bf16 v[16:31], v[152:155], v[88:91], v[16:31]
    v_mfma_f32_32x32x16_bf16 v[48:63], v[152:155], v[92:95], v[48:63]
    v_mfma_f32_32x32x16_bf16 v[32:47], v[156:159], v[88:91], v[32:47]
    v_mfma_f32_32x32x16_bf16 v[64:79], v[156:159], v[92:95], v[64:79]
    buffer_load_dwordx4 v[80:83], v6, s[16:19], s33 offen offset:256
    buffer_load_dwordx4 v[84:87], v7, s[16:19], s33 offen offset:256
    buffer_load_dwordx4 v[88:91], v6, s[16:19], s33 offen offset:288
    buffer_load_dwordx4 v[92:95], v7, s[16:19], s33 offen offset:288
    s_add_u32 s45, s45, 2
    s_cmp_le_u32 s45, s46
    s_cbranch_scc1 gs_ok1
    s_mov_b32 s98, 0x40000
gs_p1:
    buffer_load_dword v160, v4, s[40:43], s47 offen offset:0 sc1
    buffer_load_dword v161, v4, s[40:43], s47 offen offset:256 sc1
    buffer_load_dword v162, v4, s[40:43], s47 offen offset:512 sc1
    buffer_load_dword v163, v4, s[40:43], s47 offen offset:768 sc1
    s_waitcnt vmcnt(0)
    v_cmp_eq_u32 s[48:49], s101, v160
    v_cmp_eq_u32 s[50:51], s101, v162
    v_cmp_eq_u32 s[52:53], s101, v161
    v_cmp_eq_u32 s[54:55], s101, v163
    s_nop 0
    s_and_b64 s[48:49], s[48:49], s[50:51]
    s_and_b64 s[52:53], s[52:53], s[54:55]
    s_ff0_i32_b64 s46, s[48:49]
    s_ff0_i32_b64 s50, s[52:53]
    s_cmp_eq_i32 s50, -1
    s_cselect_b32 s50, 64, s50
    s_add_u32 s50, s50, 64
    s_cmp_eq_i32 s46, -1
    s_cselect_b32 s46, s50, s46
    s_cmp_le_u32 s45, s46
    s_cbranch_scc1 gs_ok1
    s_sleep 4
    s_sub_u32 s98, s98, 1
    s_cbranch_scc0 gs_p1
gs_ok1:
    s_add_u32 s35, s34, 22528
    buffer_load_dwordx4 v[144:147], v3, s[12:15], s34 offen offset:0
    buffer_load_dwordx4 v[148:151], v3, s[12:15], s34 offen offset:1024
    buffer_load_dwordx4 v[152:155], v3, s[12:15], s35 offen offset:0
    buffer_load_dwordx4 v[156:159], v3, s[12:15], s35 offen offset:1024
    s_add_u32 s34, s34, 45056
    s_waitcnt vmcnt(0)
    v_mfma_f32_32x32x16_bf16 v[16:31], v[144:147], v[96:99], v[16:31]
    v_mfma_f32_32x32x16_bf16 v[48:63], v[144:147], v[100:103], v[48:63]
    v_mfma_f32_32x32x16_bf16 v[32:47], v[148:151], v[96:99], v[32:47]
    v_mfma_f32_32x32x16_bf16 v[64:79], v[148:151], v[100:103], v[64:79]
    v_mfma_f32_32x32x16_bf16 v[16:31], v[152:155], v[104:107], v[16:31]
    v_mfma_f32_32x32x16_bf16 v[48:63], v[152:155], v[108:111], v[48:63]
    v_mfma_f32_32x32x16_bf16 v[32:47], v[156:159], v[104:107], v[32:47]
    v_mfma_f32_32x32x16_bf16 v[64:79], v[156:159], v[108:111], v[64:79]
    buffer_load_dwordx4 v[96:99], v6, s[16:19], s33 offen offset:320
    buffer_load_dwordx4 v[100:103], v7, s[16:19], s33 offen offset:320
    buffer_load_dwordx4 v[104:107], v6, s[16:19], s33 offen offset:352
    buffer_load_dwordx4 v[108:111], v7, s[16:19], s33 offen offset:352
    s_add_u32 s45, s45, 2
    s_cmp_le_u32 s45, s46
    s_cbranch_scc1 gs_ok2
    s_mov_b32 s98, 0x40000
gs_p2:
    buffer_load_dword v160, v4, s[40:43], s47 offen offset:0 sc1
    buffer_load_dword v161, v4, s[40:43], s47 offen offset:256 sc1
    buffer_load_dword v162, v4, s[40:43], s47 offen offset:512 sc1
    buffer_load_dword v163, v4, s[40:43], s47 offen offset:768 sc1
    s_waitcnt vmcnt(0)
    v_cmp_eq_u32 s[48:49], s101, v160
    v_cmp_eq_u32 s[50:51], s101, v162
    v_cmp_eq_u32 s[52:53], s101, v161
    v_cmp_eq_u32 s[54:55], s101, v163
    s_nop 0
    s_and_b64 s[48:49], s[48:49], s[50:51]
    s_and_b64 s[52:53], s[52:53], s[54:55]
    s_ff0_i32_b64 s46, s[48:49]
    s_ff0_i32_b64 s50, s[52:53]
    s_cmp_eq_i32 s50, -1
    s_cselect_b32 s50, 64, s50
    s_add_u32 s50, s50, 64
    s_cmp_eq_i32 s46, -1
    s_cselect_b32 s46, s50, s46
    s_cmp_le_u32 s45, s46
    s_cbranch_scc1 gs_ok2
    s_sleep 4
    s_sub_u32 s98, s98, 1
    s_cbranch_scc0 gs_p2
gs_ok2:
    s_add_u32 s35, s34, 22528
    buffer_load_dwordx4 v[144:147], v3, s[12:15], s34 offen offset:0
    buffer_load_dwordx4 v[148:151], v3, s[12:15], s34 offen offset:1024
    buffer_load_dwordx4 v[152:155], v3, s[12:15], s35 offen offset:0
    buffer_load_dwordx4 v[156:159], v3, s[12:15], s35 offen offset:1024
    s_add_u32 s34, s34, 45056
    s_waitcnt vmcnt(0)
    v_mfma_f32_32x32x16_bf16 v[16:31], v[144:147], v[112:115], v[16:31]
    v_mfma_f32_32x32x16_bf16 v[48:63], v[144:147], v[116:119], v[48:63]
    v_mfma_f32_32x32x16_bf16 v[32:47], v[148:151], v[112:115], v[32:47]
    v_mfma_f32_32x32x16_bf16 v[64:79], v[148:151], v[116:119], v[64:79]
    v_mfma_f32_32x32x16_bf16 v[16:31], v[152:155], v[120:123], v[16:31]
    v_mfma_f32_32x32x16_bf16 v[48:63], v[152:155], v[124:127], v[48:63]
    v_mfma_f32_32x32x16_bf16 v[32:47], v[156:159], v[120:123], v[32:47]
    v_mfma_f32_32x32x16_bf16 v[64:79], v[156:159], v[124:127], v[64:79]
    buffer_load_dwordx4 v[112:115], v6, s[16:19], s33 offen offset:384
    buffer_load_dwordx4 v[116:119], v7, s[16:19], s33 offen offset:384
    buffer_load_dwordx4 v[120:123], v6, s[16:19], s33 offen offset:416
    buffer_load_dwordx4 v[124:127], v7, s[16:19], s33 offen offset:416
    s_add_u32 s45, s45, 2
    s_cmp_eq_u32 s45, 128
    s_cbranch_scc1 gs_last
    s_cmp_le_u32 s45, s46
    s_cbranch_scc1 gs_ok3
    s_mov_b32 s98, 0x40000
gs_p3:
    buffer_load_dword v160, v4, s[40:43], s47 offen offset:0 sc1
    buffer_load_dword v161, v4, s[40:43], s47 offen offset:256 sc1
    buffer_load_dword v162, v4, s[40:43], s47 offen offset:512 sc1
    buffer_load_dword v163, v4, s[40:43], s47 offen offset:768 sc1
    s_waitcnt vmcnt(0)
    v_cmp_eq_u32 s[48:49], s101, v160
    v_cmp_eq_u32 s[50:51], s101, v162
    v_cmp_eq_u32 s[52:53], s101, v161
    v_cmp_eq_u32 s[54:55], s101, v163
    s_nop 0
    s_and_b64 s[48:49], s[48:49], s[50:51]
    s_and_b64 s[52:53], s[52:53], s[54:55]
    s_ff0_i32_b64 s46, s[48:49]
    s_ff0_i32_b64 s50, s[52:53]
    s_cmp_eq_i32 s50, -1
    s_cselect_b32 s50, 64, s50
    s_add_u32 s50, s50, 64
    s_cmp_eq_i32 s46, -1
    s_cselect_b32 s46, s50, s46
    s_cmp_le_u32 s45, s46
    s_cbranch_scc1 gs_ok3
    s_sleep 4
    s_sub_u32 s98, s98, 1
    s_cbranch_scc0 gs_p3
gs_ok3:
    s_add_u32 s35, s34, 22528
    buffer_load_dwordx4 v[144:147], v3, s[12:15], s34 offen offset:0
    buffer_load_dwordx4 v[148:151], v3, s[12:15], s34 offen offset:1024
    buffer_load_dwordx4 v[152:155], v3, s[12:15], s35 offen offset:0
    buffer_load_dwordx4 v[156:159], v3, s[12:15], s35 offen offset:1024
    s_add_u32 s34, s34, 45056
    s_waitcnt vmcnt(0)
gs_go:
    v_mfma_f32_32x32x16_bf16 v[16:31], v[144:147], v[128:131], v[16:31]
    v_mfma_f32_32x32x16_bf16 v[48:63], v[144:147], v[132:135], v[48:63]
    v_mfma_f32_32x32x16_bf16 v[32:47], v[148:151], v[128:131], v[32:47]
    v_mfma_f32_32x32x16_bf16 v[64:79], v[148:151], v[132:135], v[64:79]
    v_mfma_f32_32x32x16_bf16 v[16:31], v[152:155], v[136:139], v[16:31]
    v_mfma_f32_32x32x16_bf16 v[48:63], v[152:155], v[140:143], v[48:63]
    v_mfma_f32_32x32x16_bf16 v[32:47], v[156:159], v[136:139], v[32:47]
    v_mfma_f32_32x32x16_bf16 v[64:79], v[156:159], v[140:143], v[64:79]
    buffer_load_dwordx4 v[128:131], v6, s[16:19], s33 offen offset:448
    buffer_load_dwordx4 v[132:135], v7, s[16:19], s33 offen offset:448
    buffer_load_dwordx4 v[136:139], v6, s[16:19], s33 offen offset:480
    buffer_load_dwordx4 v[140:143], v7, s[16:19], s33 offen offset:480
    s_add_u32 s33, s33, 256
    s_cmp_lt_u32 s45, 128
    s_cbranch_scc1 gs_loop
    v_lshlrev_b32 v12, 16, v12
    v_lshlrev_b32 v13, 16, v13
    s_nop 7
gs_epi:
    v_cvt_pk_bf16_f32 v9, v16, v17
    v_lshlrev_b32 v16, 16, v9
    v_and_b32 v17, 0xffff0000, v9
    v_add_f32 v16, v16, v12
    v_add_f32 v17, v17, v12
    v_cvt_pk_bf16_f32 v9, v16, v17
    v_lshlrev_b32 v16, 16, v9
    v_and_b32 v17, 0xffff0000, v9
    v_lshlrev_b32 v10, 16, v168
    v_and_b32 v11, 0xffff0000, v168
    v_mul_f32 v16, v16, v10
    v_mul_f32 v17, v17, v11
    v_cvt_pk_bf16_f32 v168, v16, v17
    v_cvt_pk_bf16_f32 v9, v18, v19
    v_lshlrev_b32 v18, 16, v9
    v_and_b32 v19, 0xffff0000, v9
    v_add_f32 v18, v18, v12
    v_add_f32 v19, v19, v12
    v_cvt_pk_bf16_f32 v9, v18, v19
    v_lshlrev_b32 v18, 16, v9
    v_and_b32 v19, 0xffff0000, v9
    v_lshlrev_b32 v10, 16, v169
    v_and_b32 v11, 0xffff0000, v169
    v_mul_f32 v18, v18, v10
    v_mul_f32 v19, v19, v11
    v_cvt_pk_bf16_f32 v169, v18, v19
    v_cvt_pk_bf16_f32 v9, v20, v21
    v_lshlrev_b32 v20, 16, v9
    v_and_b32 v21, 0xffff0000, v9
    v_add_f32 v20, v20, v12
    v_add_f32 v21, v21, v12
    v_cvt_pk_bf16_f32 v9, v20, v21
    v_lshlrev_b32 v20, 16, v9
    v_and_b32 v21, 0xffff0000, v9
    v_lshlrev_b32 v10, 16, v170
    v_and_b32 v11, 0xffff0000, v170
    v_mul_f32 v20, v20, v10
    v_mul_f32 v21, v21, v11
    v_cvt_pk_bf16_f32 v170, v20, v21
    v_cvt_pk_bf16_f32 v9, v22, v23
    v_lshlrev_b32 v22, 16, v9
    v_and_b32 v23, 0xffff0000, v9
    v_add_f32 v22, v22, v12
    v_add_f32 v23, v23, v12
    v_cvt_pk_bf16_f32 v9, v22, v23
    v_lshlrev_b32 v22, 16, v9
    v_and_b32 v23, 0xffff0000, v9
    v_lshlrev_b32 v10, 16, v171
    v_and_b32 v11, 0xffff0000, v171
    v_mul_f32 v22, v22, v10
    v_mul_f32 v23, v23, v11
    v_cvt_pk_bf16_f32 v171, v22, v23
    buffer_store_dwordx4 v[168:171], v3, s[24:27], s44 offen offset:0 sc1
    v_cvt_pk_bf16_f32 v9, v24, v25
    v_lshlrev_b32 v24, 16, v9
    v_and_b32 v25, 0xffff0000, v9
    v_add_f32 v24, v24, v12
    v_add_f32 v25, v25, v12
    v_cvt_pk_bf16_f32 v9, v24, v25
    v_lshlrev_b32 v24, 16, v9
    v_and_b32 v25, 0xffff0000, v9
    v_lshlrev_b32 v10, 16, v172
    v_and_b32 v11, 0xffff0000, v172
    v_mul_f32 v24, v24, v10
    v_mul_f32 v25, v25, v11
    v_cvt_pk_bf16_f32 v172, v24, v25
    v_cvt_pk_bf16_f32 v9, v26, v27
    v_lshlrev_b32 v26, 16, v9
    v_and_b32 v27, 0xffff0000, v9
    v_add_f32 v26, v26, v12
    v_add_f32 v27, v27, v12
    v_cvt_pk_bf16_f32 v9, v26, v27
    v_lshlrev_b32 v26, 16, v9
    v_and_b32 v27, 0xffff0000, v9
    v_lshlrev_b32 v10, 16, v173
    v_and_b32 v11, 0xffff0000, v173
    v_mul_f32 v26, v26, v10
    v_mul_f32 v27, v27, v11
    v_cvt_pk_bf16_f32 v173, v26, v27
    v_cvt_pk_bf16_f32 v9, v28, v29
    v_lshlrev_b32 v28, 16, v9
    v_and_b32 v29, 0xffff0000, v9
    v_add_f32 v28, v28, v12
    v_add_f32 v29, v29, v12
    v_cvt_pk_bf16_f32 v9, v28, v29
    v_lshlrev_b32 v28, 16, v9
    v_and_b32 v29, 0xffff0000, v9
    v_lshlrev_b32 v10, 16, v174
    v_and_b32 v11, 0xffff0000, v174
    v_mul_f32 v28, v28, v10
    v_mul_f32 v29, v29, v11
    v_cvt_pk_bf16_f32 v174, v28, v29
    v_cvt_pk_bf16_f32 v9, v30, v31
    v_lshlrev_b32 v30, 16, v9
    v_and_b32 v31, 0xffff0000, v9
    v_add_f32 v30, v30, v12
    v_add_f32 v31, v31, v12
    v_cvt_pk_bf16_f32 v9, v30, v31
    v_lshlrev_b32 v30, 16, v9
    v_and_b32 v31, 0xffff0000, v9
    v_lshlrev_b32 v10, 16, v175
    v_and_b32 v11, 0xffff0000, v175
    v_mul_f32 v30, v30, v10
    v_mul_f32 v31, v31, v11
    v_cvt_pk_bf16_f32 v175, v30, v31
    buffer_store_dwordx4 v[172:175], v3, s[24:27], s44 offen offset:1024 sc1
    v_cvt_pk_bf16_f32 v9, v32, v33
    v_lshlrev_b32 v32, 16, v9
    v_and_b32 v33, 0xffff0000, v9
    v_add_f32 v32, v32, v12
    v_add_f32 v33, v33, v12
    v_cvt_pk_bf16_f32 v9, v32, v33
    v_lshlrev_b32 v32, 16, v9
    v_and_b32 v33, 0xffff0000, v9
    v_lshlrev_b32 v10, 16, v176
    v_and_b32 v11, 0xffff0000, v176
    v_mul_f32 v32, v32, v10
    v_mul_f32 v33, v33, v11
    v_cvt_pk_bf16_f32 v176, v32, v33
    v_cvt_pk_bf16_f32 v9, v34, v35
    v_lshlrev_b32 v34, 16, v9
    v_and_b32 v35, 0xffff0000, v9
    v_add_f32 v34, v34, v12
    v_add_f32 v35, v35, v12
    v_cvt_pk_bf16_f32 v9, v34, v35
    v_lshlrev_b32 v34, 16, v9
    v_and_b32 v35, 0xffff0000, v9
    v_lshlrev_b32 v10, 16, v177
    v_and_b32 v11, 0xffff0000, v177
    v_mul_f32 v34, v34, v10
    v_mul_f32 v35, v35, v11
    v_cvt_pk_bf16_f32 v177, v34, v35
    v_cvt_pk_bf16_f32 v9, v36, v37
    v_lshlrev_b32 v36, 16, v9
    v_and_b32 v37, 0xffff0000, v9
    v_add_f32 v36, v36, v12
    v_add_f32 v37, v37, v12
    v_cvt_pk_bf16_f32 v9, v36, v37
    v_lshlrev_b32 v36, 16, v9
    v_and_b32 v37, 0xffff0000, v9
    v_lshlrev_b32 v10, 16, v178
    v_and_b32 v11, 0xffff0000, v178
    v_mul_f32 v36, v36, v10
    v_mul_f32 v37, v37, v11
    v_cvt_pk_bf16_f32 v178, v36, v37
    v_cvt_pk_bf16_f32 v9, v38, v39
    v_lshlrev_b32 v38, 16, v9
    v_and_b32 v39, 0xffff0000, v9
    v_add_f32 v38, v38, v12
    v_add_f32 v39, v39, v12
    v_cvt_pk_bf16_f32 v9, v38, v39
    v_lshlrev_b32 v38, 16, v9
    v_and_b32 v39, 0xffff0000, v9
    v_lshlrev_b32 v10, 16, v179
    v_and_b32 v11, 0xffff0000, v179
    v_mul_f32 v38, v38, v10
    v_mul_f32 v39, v39, v11
    v_cvt_pk_bf16_f32 v179, v38, v39
    buffer_store_dwordx4 v[176:179], v3, s[24:27], s44 offen offset:2048 sc1
    v_cvt_pk_bf16_f32 v9, v40, v41
    v_lshlrev_b32 v40, 16, v9
    v_and_b32 v41, 0xffff0000, v9
    v_add_f32 v40, v40, v12
    v_add_f32 v41, v41, v12
    v_cvt_pk_bf16_f32 v9, v40, v41
    v_lshlrev_b32 v40, 16, v9
    v_and_b32 v41, 0xffff0000, v9
    v_lshlrev_b32 v10, 16, v180
    v_and_b32 v11, 0xffff0000, v180
    v_mul_f32 v40, v40, v10
    v_mul_f32 v41, v41, v11
    v_cvt_pk_bf16_f32 v180, v40, v41
    v_cvt_pk_bf16_f32 v9, v42, v43
    v_lshlrev_b32 v42, 16, v9
    v_and_b32 v43, 0xffff0000, v9
    v_add_f32 v42, v42, v12
    v_add_f32 v43, v43, v12
    v_cvt_pk_bf16_f32 v9, v42, v43
    v_lshlrev_b32 v42, 16, v9
    v_and_b32 v43, 0xffff0000, v9
    v_lshlrev_b32 v10, 16, v181
    v_and_b32 v11, 0xffff0000, v181
    v_mul_f32 v42, v42, v10
    v_mul_f32 v43, v43, v11
    v_cvt_pk_bf16_f32 v181, v42, v43
    v_cvt_pk_bf16_f32 v9, v44, v45
    v_lshlrev_b32 v44, 16, v9
    v_and_b32 v45, 0xffff0000, v9
    v_add_f32 v44, v44, v12
    v_add_f32 v45, v45, v12
    v_cvt_pk_bf16_f32 v9, v44, v45
    v_lshlrev_b32 v44, 16, v9
    v_and_b32 v45, 0xffff0000, v9
    v_lshlrev_b32 v10, 16, v182
    v_and_b32 v11, 0xffff0000, v182
    v_mul_f32 v44, v44, v10
    v_mul_f32 v45, v45, v11
    v_cvt_pk_bf16_f32 v182, v44, v45
    v_cvt_pk_bf16_f32 v9, v46, v47
    v_lshlrev_b32 v46, 16, v9
    v_and_b32 v47, 0xffff0000, v9
    v_add_f32 v46, v46, v12
    v_add_f32 v47, v47, v12
    v_cvt_pk_bf16_f32 v9, v46, v47
    v_lshlrev_b32 v46, 16, v9
    v_and_b32 v47, 0xffff0000, v9
    v_lshlrev_b32 v10, 16, v183
    v_and_b32 v11, 0xffff0000, v183
    v_mul_f32 v46, v46, v10
    v_mul_f32 v47, v47, v11
    v_cvt_pk_bf16_f32 v183, v46, v47
    buffer_store_dwordx4 v[180:183], v3, s[24:27], s44 offen offset:3072 sc1
    v_cvt_pk_bf16_f32 v9, v48, v49
    v_lshlrev_b32 v48, 16, v9
    v_and_b32 v49, 0xffff0000, v9
    v_add_f32 v48, v48, v13
    v_add_f32 v49, v49, v13
    v_cvt_pk_bf16_f32 v9, v48, v49
    v_lshlrev_b32 v48, 16, v9
    v_and_b32 v49, 0xffff0000, v9
    v_lshlrev_b32 v10, 16, v184
    v_and_b32 v11, 0xffff0000, v184
    v_mul_f32 v48, v48, v10
    v_mul_f32 v49, v49, v11
    v_cvt_pk_bf16_f32 v184, v48, v49
    v_cvt_pk_bf16_f32 v9, v50, v51
    v_lshlrev_b32 v50, 16, v9
    v_and_b32 v51, 0xffff0000, v9
    v_add_f32 v50, v50, v13
    v_add_f32 v51, v51, v13
    v_cvt_pk_bf16_f32 v9, v50, v51
    v_lshlrev_b32 v50, 16, v9
    v_and_b32 v51, 0xffff0000, v9
    v_lshlrev_b32 v10, 16, v185
    v_and_b32 v11, 0xffff0000, v185
    v_mul_f32 v50, v50, v10
    v_mul_f32 v51, v51, v11
    v_cvt_pk_bf16_f32 v185, v50, v51
    v_cvt_pk_bf16_f32 v9, v52, v53
    v_lshlrev_b32 v52, 16, v9
    v_and_b32 v53, 0xffff0000, v9
    v_add_f32 v52, v52, v13
    v_add_f32 v53, v53, v13
    v_cvt_pk_bf16_f32 v9, v52, v53
    v_lshlrev_b32 v52, 16, v9
    v_and_b32 v53, 0xffff0000, v9
    v_lshlrev_b32 v10, 16, v186
    v_and_b32 v11, 0xffff0000, v186
    v_mul_f32 v52, v52, v10
    v_mul_f32 v53, v53, v11
    v_cvt_pk_bf16_f32 v186, v52, v53
    v_cvt_pk_bf16_f32 v9, v54, v55
    v_lshlrev_b32 v54, 16, v9
    v_and_b32 v55, 0xffff0000, v9
    v_add_f32 v54, v54, v13
    v_add_f32 v55, v55, v13
    v_cvt_pk_bf16_f32 v9, v54, v55
    v_lshlrev_b32 v54, 16, v9
    v_and_b32 v55, 0xffff0000, v9
    v_lshlrev_b32 v10, 16, v187
    v_and_b32 v11, 0xffff0000, v187
    v_mul_f32 v54, v54, v10
    v_mul_f32 v55, v55, v11
    v_cvt_pk_bf16_f32 v187, v54, v55
    buffer_store_dwordx4 v[184:187], v3, s[24:27], s35 offen offset:0 sc1
    v_cvt_pk_bf16_f32 v9, v56, v57
    v_lshlrev_b32 v56, 16, v9
    v_and_b32 v57, 0xffff0000, v9
    v_add_f32 v56, v56, v13
    v_add_f32 v57, v57, v13
    v_cvt_pk_bf16_f32 v9, v56, v57
    v_lshlrev_b32 v56, 16, v9
    v_and_b32 v57, 0xffff0000, v9
    v_lshlrev_b32 v10, 16, v188
    v_and_b32 v11, 0xffff0000, v188
    v_mul_f32 v56, v56, v10
    v_mul_f32 v57, v57, v11
    v_cvt_pk_bf16_f32 v188, v56, v57
    v_cvt_pk_bf16_f32 v9, v58, v59
    v_lshlrev_b32 v58, 16, v9
    v_and_b32 v59, 0xffff0000, v9
    v_add_f32 v58, v58, v13
    v_add_f32 v59, v59, v13
    v_cvt_pk_bf16_f32 v9, v58, v59
    v_lshlrev_b32 v58, 16, v9
    v_and_b32 v59, 0xffff0000, v9
    v_lshlrev_b32 v10, 16, v189
    v_and_b32 v11, 0xffff0000, v189
    v_mul_f32 v58, v58, v10
    v_mul_f32 v59, v59, v11
    v_cvt_pk_bf16_f32 v189, v58, v59
    v_cvt_pk_bf16_f32 v9, v60, v61
    v_lshlrev_b32 v60, 16, v9
    v_and_b32 v61, 0xffff0000, v9
    v_add_f32 v60, v60, v13
    v_add_f32 v61, v61, v13
    v_cvt_pk_bf16_f32 v9, v60, v61
    v_lshlrev_b32 v60, 16, v9
    v_and_b32 v61, 0xffff0000, v9
    v_lshlrev_b32 v10, 16, v190
    v_and_b32 v11, 0xffff0000, v190
    v_mul_f32 v60, v60, v10
    v_mul_f32 v61, v61, v11
    v_cvt_pk_bf16_f32 v190, v60, v61
    v_cvt_pk_bf16_f32 v9, v62, v63
    v_lshlrev_b32 v62, 16, v9
    v_and_b32 v63, 0xffff0000, v9
    v_add_f32 v62, v62, v13
    v_add_f32 v63, v63, v13
    v_cvt_pk_bf16_f32 v9, v62, v63
    v_lshlrev_b32 v62, 16, v9
    v_and_b32 v63, 0xffff0000, v9
    v_lshlrev_b32 v10, 16, v191
    v_and_b32 v11, 0xffff0000, v191
    v_mul_f32 v62, v62, v10
    v_mul_f32 v63, v63, v11
    v_cvt_pk_bf16_f32 v191, v62, v63
    buffer_store_dwordx4 v[188:191], v3, s[24:27], s35 offen offset:1024 sc1
    v_cvt_pk_bf16_f32 v9, v64, v65
    v_lshlrev_b32 v64, 16, v9
    v_and_b32 v65, 0xffff0000, v9
    v_add_f32 v64, v64, v13
    v_add_f32 v65, v65, v13
    v_cvt_pk_bf16_f32 v9, v64, v65
    v_lshlrev_b32 v64, 16, v9
    v_and_b32 v65, 0xffff0000, v9
    v_lshlrev_b32 v10, 16, v192
    v_and_b32 v11, 0xffff0000, v192
    v_mul_f32 v64, v64, v10
    v_mul_f32 v65, v65, v11
    v_cvt_pk_bf16_f32 v192, v64, v65
    v_cvt_pk_bf16_f32 v9, v66, v67
    v_lshlrev_b32 v66, 16, v9
    v_and_b32 v67, 0xffff0000, v9
    v_add_f32 v66, v66, v13
    v_add_f32 v67, v67, v13
    v_cvt_pk_bf16_f32 v9, v66, v67
    v_lshlrev_b32 v66, 16, v9
    v_and_b32 v67, 0xffff0000, v9
    v_lshlrev_b32 v10, 16, v193
    v_and_b32 v11, 0xffff0000, v193
    v_mul_f32 v66, v66, v10
    v_mul_f32 v67, v67, v11
    v_cvt_pk_bf16_f32 v193, v66, v67
    v_cvt_pk_bf16_f32 v9, v68, v69
    v_lshlrev_b32 v68, 16, v9
    v_and_b32 v69, 0xffff0000, v9
    v_add_f32 v68, v68, v13
    v_add_f32 v69, v69, v13
    v_cvt_pk_bf16_f32 v9, v68, v69
    v_lshlrev_b32 v68, 16, v9
    v_and_b32 v69, 0xffff0000, v9
    v_lshlrev_b32 v10, 16, v194
    v_and_b32 v11, 0xffff0000, v194
    v_mul_f32 v68, v68, v10
    v_mul_f32 v69, v69, v11
    v_cvt_pk_bf16_f32 v194, v68, v69
    v_cvt_pk_bf16_f32 v9, v70, v71
    v_lshlrev_b32 v70, 16, v9
    v_and_b32 v71, 0xffff0000, v9
    v_add_f32 v70, v70, v13
    v_add_f32 v71, v71, v13
    v_cvt_pk_bf16_f32 v9, v70, v71
    v_lshlrev_b32 v70, 16, v9
    v_and_b32 v71, 0xffff0000, v9
    v_lshlrev_b32 v10, 16, v195
    v_and_b32 v11, 0xffff0000, v195
    v_mul_f32 v70, v70, v10
    v_mul_f32 v71, v71, v11
    v_cvt_pk_bf16_f32 v195, v70, v71
    buffer_store_dwordx4 v[192:195], v3, s[24:27], s35 offen offset:2048 sc1
    v_cvt_pk_bf16_f32 v9, v72, v73
    v_lshlrev_b32 v72, 16, v9
    v_and_b32 v73, 0xffff0000, v9
    v_add_f32 v72, v72, v13
    v_add_f32 v73, v73, v13
    v_cvt_pk_bf16_f32 v9, v72, v73
    v_lshlrev_b32 v72, 16, v9
    v_and_b32 v73, 0xffff0000, v9
    v_lshlrev_b32 v10, 16, v196
    v_and_b32 v11, 0xffff0000, v196
    v_mul_f32 v72, v72, v10
    v_mul_f32 v73, v73, v11
    v_cvt_pk_bf16_f32 v196, v72, v73
    v_cvt_pk_bf16_f32 v9, v74, v75
    v_lshlrev_b32 v74, 16, v9
    v_and_b32 v75, 0xffff0000, v9
    v_add_f32 v74, v74, v13
    v_add_f32 v75, v75, v13
    v_cvt_pk_bf16_f32 v9, v74, v75
    v_lshlrev_b32 v74, 16, v9
    v_and_b32 v75, 0xffff0000, v9
    v_lshlrev_b32 v10, 16, v197
    v_and_b32 v11, 0xffff0000, v197
    v_mul_f32 v74, v74, v10
    v_mul_f32 v75, v75, v11
    v_cvt_pk_bf16_f32 v197, v74, v75
    v_cvt_pk_bf16_f32 v9, v76, v77
    v_lshlrev_b32 v76, 16, v9
    v_and_b32 v77, 0xffff0000, v9
    v_add_f32 v76, v76, v13
    v_add_f32 v77, v77, v13
    v_cvt_pk_bf16_f32 v9, v76, v77
    v_lshlrev_b32 v76, 16, v9
    v_and_b32 v77, 0xffff0000, v9
    v_lshlrev_b32 v10, 16, v198
    v_and_b32 v11, 0xffff0000, v198
    v_mul_f32 v76, v76, v10
    v_mul_f32 v77, v77, v11
    v_cvt_pk_bf16_f32 v198, v76, v77
    v_cvt_pk_bf16_f32 v9, v78, v79
    v_lshlrev_b32 v78, 16, v9
    v_and_b32 v79, 0xffff0000, v9
    v_add_f32 v78, v78, v13
    v_add_f32 v79, v79, v13
    v_cvt_pk_bf16_f32 v9, v78, v79
    v_lshlrev_b32 v78, 16, v9
    v_and_b32 v79, 0xffff0000, v9
    v_lshlrev_b32 v10, 16, v199
    v_and_b32 v11, 0xffff0000, v199
    v_mul_f32 v78, v78, v10
    v_mul_f32 v79, v79, v11
    v_cvt_pk_bf16_f32 v199, v78, v79
    buffer_store_dwordx4 v[196:199], v3, s[24:27], s35 offen offset:3072 sc1
    s_cmp_lg_u32 s96, 0
    s_cbranch_scc1 gs_start
    s_lshl_b32 s44, s32, 6
    s_lshl_b32 s45, s6, 2
    s_add_u32 s44, s44, s45
    s_add_u32 s44, s44, 29696
    v_mov_b32 v8, 0
    s_waitcnt vmcnt(0)
    s_add_u32 s97, s101, 0
    v_mov_b32 v9, s97
    buffer_store_dword v9, v8, s[40:43], s44 offen sc1
    s_mov_b32 s96, 3
    s_branch xs_entry2
gs_last:
    s_add_u32 s50, s34, 22528
    s_mul_i32 s44, s32, 90112
    s_lshl_b32 s35, s6, 12
    s_add_u32 s44, s44, s35
    s_add_u32 s35, s44, 45056
    s_mov_b32 s98, 0x40000
gs_lp1:
    buffer_load_dwordx4 v[168:171], v3, s[20:23], s44 offen offset:0 sc1
    buffer_load_dwordx4 v[172:175], v3, s[20:23], s44 offen offset:1024 sc1
    buffer_load_dwordx4 v[176:179], v3, s[20:23], s44 offen offset:2048 sc1
    buffer_load_dwordx4 v[180:183], v3, s[20:23], s44 offen offset:3072 sc1
    buffer_load_dwordx4 v[184:187], v3, s[20:23], s35 offen offset:0 sc1
    buffer_load_dwordx4 v[188:191], v3, s[20:23], s35 offen offset:1024 sc1
    buffer_load_dwordx4 v[192:195], v3, s[20:23], s35 offen offset:2048 sc1
    buffer_load_dwordx4 v[196:199], v3, s[20:23], s35 offen offset:3072 sc1
gs_lp:
    buffer_load_dwordx4 v[144:147], v3, s[12:15], s34 offen offset:0 sc1
    buffer_load_dwordx4 v[148:151], v3, s[12:15], s34 offen offset:1024 sc1
    buffer_load_dwordx4 v[152:155], v3, s[12:15], s50 offen offset:0 sc1
    buffer_load_dwordx4 v[156:159], v3, s[12:15], s50 offen offset:1024 sc1
    s_waitcnt vmcnt(4)
    v_max3_u32 v161, v168, v169, v170
    v_max3_u32 v161, v161, v171, v172
    v_max3_u32 v161, v161, v173, v174
    v_max3_u32 v161, v161, v175, v176
    v_max3_u32 v161, v161, v177, v178
    v_max3_u32 v161, v161, v179, v180
    v_max3_u32 v161, v161, v181, v182
    v_max3_u32 v161, v161, v183, v184
    v_max3_u32 v161, v161, v185, v186
    v_max3_u32 v161, v161, v187, v188
    v_max3_u32 v161, v161, v189, v190
    v_max3_u32 v161, v161, v191, v192
    v_max3_u32 v161, v161, v193, v194
    v_max3_u32 v161, v161, v195, v196
    v_max3_u32 v161, v161, v197, v198
    v_max_u32 v161, v161, v199
    s_waitcnt vmcnt(0)
    v_max3_u32 v160, v144, v145, v146
    v_max3_u32 v160, v160, v147, v148
    v_max3_u32 v160, v160, v149, v150
    v_max3_u32 v160, v160, v151, v152
    v_max3_u32 v160, v160, v153, v154
    v_max3_u32 v160, v160, v155, v156
    v_max3_u32 v160, v160, v157, v158
    v_max_u32 v160, v160, v159
    s_sub_u32 s98, s98, 1
    s_cbranch_scc1 gs_ld
    v_cmp_eq_u32 vcc, -1, v161
    s_cbranch_vccnz gs_lp1
    v_cmp_eq_u32 vcc, -1, v160
    s_cbranch_vccz gs_ld
    s_branch gs_lp
gs_ld:
    s_branch gs_go
hp_wgroup:
    s_sub_u32 s4, s100, 128
    s_lshr_b32 s32, s4, 1
    s_and_b32 s33, s4, 1
    v_lshlrev_b32 v3, 4, v1
    s_add_u32 s12, s10, 0x700000
    s_addc_u32 s13, s11, 0
    s_mov_b32 s14, 0x200000
    s_mov_b32 s15, 0x20000
    s_mov_b32 s16, s10
    s_mov_b32 s17, s11
    s_mov_b32 s18, 0x3000
    s_mov_b32 s19, 0x20000
    s_add_u32 s20, s10, 0x6400000
    s_addc_u32 s21, s11, 0
    s_mov_b32 s22, 0x158000
    s_mov_b32 s23, 0x20000
    s_mov_b32 s4, 0x6c00000
    s_cmp_eq_u32 s33, 0
    s_cselect_b32 s4, 0x6800000, s4
    s_add_u32 s24, s10, s4
    s_addc_u32 s25, s11, 0
    s_mov_b32 s26, 2883584
    s_mov_b32 s27, 0x20000
    v_and_b32 v9, 31, v1
    v_lshlrev_b32 v9, 2, v9
    s_movk_i32 s35, 24576
    s_add_u32 s97, s101, 2
    s_mov_b32 s98, 0x40000
wiw_pp:
    buffer_load_dword v2, v9, s[40:43], s35 offen offset:0 sc1
    s_waitcnt vmcnt(0)
    v_subrev_u32 v2, s97, v2
    v_cmp_lt_u32 vcc, 0, v2
    s_cbranch_vccz wiw_pd
    s_sleep 8
    s_sub_u32 s98, s98, 1
    s_cbranch_scc0 wiw_pp
wiw_pd:
    s_mul_i32 s37, s33, 704512
    s_lshl_b32 s46, s3, 14
    s_add_u32 s47, s37, s46
    s_mov_b32 s48, 0xc0135761
    s_mov_b32 s49, 0xbdd2d3e8
    v_and_b32 v6, 15, v1
    v_lshrrev_b32 v7, 4, v1
    s_add_u32 s46, s47, 0
    buffer_load_dwordx4 a[0:3], v3, s[20:23], s46 offen offset:0
    buffer_load_dwordx4 a[4:7], v3, s[20:23], s46 offen offset:1024
    buffer_load_dwordx4 a[8:11], v3, s[20:23], s46 offen offset:2048
    buffer_load_dwordx4 a[12:15], v3, s[20:23], s46 offen offset:3072
    s_add_u32 s46, s47, 4096
    buffer_load_dwordx4 a[16:19], v3, s[20:23], s46 offen offset:0
    buffer_load_dwordx4 a[20:23], v3, s[20:23], s46 offen offset:1024
    buffer_load_dwordx4 a[24:27], v3, s[20:23], s46 offen offset:2048
    buffer_load_dwordx4 a[28:31], v3, s[20:23], s46 offen offset:3072
    s_add_u32 s46, s47, 8192
    buffer_load_dwordx4 a[32:35], v3, s[20:23], s46 offen offset:0
    buffer_load_dwordx4 a[36:39], v3, s[20:23], s46 offen offset:1024
    buffer_load_dwordx4 a[40:43], v3, s[20:23], s46 offen offset:2048
    buffer_load_dwordx4 a[44:47], v3, s[20:23], s46 offen offset:3072
    s_add_u32 s46, s47, 12288
    buffer_load_dwordx4 a[48:51], v3, s[20:23], s46 offen offset:0
    buffer_load_dwordx4 a[52:55], v3, s[20:23], s46 offen offset:1024
    buffer_load_dwordx4 a[56:59], v3, s[20:23], s46 offen offset:2048
    buffer_load_dwordx4 a[60:63], v3, s[20:23], s46 offen offset:3072
    s_add_u32 s46, s47, 65536
    buffer_load_dwordx4 a[64:67], v3, s[20:23], s46 offen offset:0
    buffer_load_dwordx4 a[68:71], v3, s[20:23], s46 offen offset:1024
    buffer_load_dwordx4 a[72:75], v3, s[20:23], s46 offen offset:2048
    buffer_load_dwordx4 a[76:79], v3, s[20:23], s46 offen offset:3072
    s_add_u32 s46, s47, 69632
    buffer_load_dwordx4 a[80:83], v3, s[20:23], s46 offen offset:0
    buffer_load_dwordx4 a[84:87], v3, s[20:23], s46 offen offset:1024
    buffer_load_dwordx4 a[88:91], v3, s[20:23], s46 offen offset:2048
    buffer_load_dwordx4 a[92:95], v3, s[20:23], s46 offen offset:3072
    s_add_u32 s46, s47, 73728
    buffer_load_dwordx4 a[96:99], v3, s[20:23], s46 offen offset:0
    buffer_load_dwordx4 a[100:103], v3, s[20:23], s46 offen offset:1024
    buffer_load_dwordx4 a[104:107], v3, s[20:23], s46 offen offset:2048
    buffer_load_dwordx4 a[108:111], v3, s[20:23], s46 offen offset:3072
    s_add_u32 s46, s47, 77824
    buffer_load_dwordx4 a[112:115], v3, s[20:23], s46 offen offset:0
    buffer_load_dwordx4 a[116:119], v3, s[20:23], s46 offen offset:1024
    buffer_load_dwordx4 a[120:123], v3, s[20:23], s46 offen offset:2048
    buffer_load_dwordx4 a[124:127], v3, s[20:23], s46 offen offset:3072
    s_waitcnt vmcnt(16)
    s_add_u32 s46, s47, 131072
    buffer_load_dwordx4 a[128:131], v3, s[20:23], s46 offen offset:0
    buffer_load_dwordx4 a[132:135], v3, s[20:23], s46 offen offset:1024
    buffer_load_dwordx4 a[136:139], v3, s[20:23], s46 offen offset:2048
    buffer_load_dwordx4 a[140:143], v3, s[20:23], s46 offen offset:3072
    s_add_u32 s46, s47, 135168
    buffer_load_dwordx4 a[144:147], v3, s[20:23], s46 offen offset:0
    buffer_load_dwordx4 a[148:151], v3, s[20:23], s46 offen offset:1024
    buffer_load_dwordx4 a[152:155], v3, s[20:23], s46 offen offset:2048
    buffer_load_dwordx4 a[156:159], v3, s[20:23], s46 offen offset:3072
    s_add_u32 s46, s47, 139264
    buffer_load_dwordx4 a[160:163], v3, s[20:23], s46 offen offset:0
    buffer_load_dwordx4 a[164:167], v3, s[20:23], s46 offen offset:1024
    buffer_load_dwordx4 a[168:171], v3, s[20:23], s46 offen offset:2048
    buffer_load_dwordx4 a[172:175], v3, s[20:23], s46 offen offset:3072
    s_add_u32 s46, s47, 143360
    buffer_load_dwordx4 a[176:179], v3, s[20:23], s46 offen offset:0
    buffer_load_dwordx4 a[180:183], v3, s[20:23], s46 offen offset:1024
    buffer_load_dwordx4 a[184:187], v3, s[20:23], s46 offen offset:2048
    buffer_load_dwordx4 a[188:191], v3, s[20:23], s46 offen offset:3072
    s_add_u32 s46, s47, 196608
    buffer_load_dwordx4 a[192:195], v3, s[20:23], s46 offen offset:0
    buffer_load_dwordx4 a[196:199], v3, s[20:23], s46 offen offset:1024
    buffer_load_dwordx4 a[200:203], v3, s[20:23], s46 offen offset:2048
    buffer_load_dwordx4 a[204:207], v3, s[20:23], s46 offen offset:3072
    s_add_u32 s46, s47, 200704
    buffer_load_dwordx4 a[208:211], v3, s[20:23], s46 offen offset:0
    buffer_load_dwordx4 a[212:215], v3, s[20:23], s46 offen offset:1024
    buffer_load_dwordx4 a[216:219], v3, s[20:23], s46 offen offset:2048
    buffer_load_dwordx4 a[220:223], v3, s[20:23], s46 offen offset:3072
    s_add_u32 s46, s47, 204800
    buffer_load_dwordx4 a[224:227], v3, s[20:23], s46 offen offset:0
    buffer_load_dwordx4 a[228:231], v3, s[20:23], s46 offen offset:1024
    buffer_load_dwordx4 a[232:235], v3, s[20:23], s46 offen offset:2048
    buffer_load_dwordx4 a[236:239], v3, s[20:23], s46 offen offset:3072
    s_add_u32 s46, s47, 208896
    buffer_load_dwordx4 a[240:243], v3, s[20:23], s46 offen offset:0
    buffer_load_dwordx4 a[244:247], v3, s[20:23], s46 offen offset:1024
    buffer_load_dwordx4 a[248:251], v3, s[20:23], s46 offen offset:2048
    buffer_load_dwordx4 a[252:255], v3, s[20:23], s46 offen offset:3072
    s_waitcnt vmcnt(16)
    s_mul_i32 s44, s3, 34816
    s_add_u32 s44, s44, 20480
    s_mov_b32 s50, s44
    s_add_u32 m0, s44, 0
    s_add_u32 s46, s47, 262144
    buffer_load_dwordx4 v3, s[20:23], s46 offen lds
    s_add_u32 m0, s44, 1024
    s_add_u32 s46, s47, 263168
    buffer_load_dwordx4 v3, s[20:23], s46 offen lds
    s_add_u32 m0, s44, 2048
    s_add_u32 s46, s47, 264192
    buffer_load_dwordx4 v3, s[20:23], s46 offen lds
    s_add_u32 m0, s44, 3072
    s_add_u32 s46, s47, 265216
    buffer_load_dwordx4 v3, s[20:23], s46 offen lds
    s_add_u32 m0, s44, 4096
    s_add_u32 s46, s47, 266240
    buffer_load_dwordx4 v3, s[20:23], s46 offen lds
    s_add_u32 m0, s44, 5120
    s_add_u32 s46, s47, 267264
    buffer_load_dwordx4 v3, s[20:23], s46 offen lds
    s_add_u32 m0, s44, 6144
    s_add_u32 s46, s47, 268288
    buffer_load_dwordx4 v3, s[20:23], s46 offen lds
    s_add_u32 m0, s44, 7168
    s_add_u32 s46, s47, 269312
    buffer_load_dwordx4 v3, s[20:23], s46 offen lds
    s_add_u32 m0, s44, 8192
    s_add_u32 s46, s47, 270336
    buffer_load_dwordx4 v3, s[20:23], s46 offen lds
    s_add_u32 m0, s44, 9216
    s_add_u32 s46, s47, 271360
    buffer_load_dwordx4 v3, s[20:23], s46 offen lds
    s_add_u32 m0, s44, 10240
    s_add_u32 s46, s47, 272384
    buffer_load_dwordx4 v3, s[20:23], s46 offen lds
    s_add_u32 m0, s44, 11264
    s_add_u32 s46, s47, 273408
    buffer_load_dwordx4 v3, s[20:23], s46 offen lds
    s_add_u32 m0, s44, 12288
    s_add_u32 s46, s47, 274432
    buffer_load_dwordx4 v3, s[20:23], s46 offen lds
    s_add_u32 m0, s44, 13312
    s_add_u32 s46, s47, 275456
    buffer_load_dwordx4 v3, s[20:23], s46 offen lds
    s_add_u32 m0, s44, 14336
    s_add_u32 s46, s47, 276480
    buffer_load_dwordx4 v3, s[20:23], s46 offen lds
    s_add_u32 m0, s44, 15360
    s_add_u32 s46, s47, 277504
    buffer_load_dwordx4 v3, s[20:23], s46 offen lds
    s_add_u32 m0, s44, 16384
    s_add_u32 s46, s47, 327680
    buffer_load_dwordx4 v3, s[20:23], s46 offen lds
    s_add_u32 m0, s44, 17408
    s_add_u32 s46, s47, 328704
    buffer_load_dwordx4 v3, s[20:23], s46 offen lds
    s_add_u32 m0, s44, 18432
    s_add_u32 s46, s47, 329728
    buffer_load_dwordx4 v3, s[20:23], s46 offen lds
    s_add_u32 m0, s44, 19456
    s_add_u32 s46, s47, 330752
    buffer_load_dwordx4 v3, s[20:23], s46 offen lds
    s_add_u32 m0, s44, 20480
    s_add_u32 s46, s47, 331776
    buffer_load_dwordx4 v3, s[20:23], s46 offen lds
    s_add_u32 m0, s44, 21504
    s_add_u32 s46, s47, 332800
    buffer_load_dwordx4 v3, s[20:23], s46 offen lds
    s_add_u32 m0, s44, 22528
    s_add_u32 s46, s47, 333824
    buffer_load_dwordx4 v3, s[20:23], s46 offen lds
    s_add_u32 m0, s44, 23552
    s_add_u32 s46, s47, 334848
    buffer_load_dwordx4 v3, s[20:23], s46 offen lds
    s_add_u32 m0, s44, 24576
    s_add_u32 s46, s47, 335872
    buffer_load_dwordx4 v3, s[20:23], s46 offen lds
    s_add_u32 m0, s44, 25600
    s_add_u32 s46, s47, 336896
    buffer_load_dwordx4 v3, s[20:23], s46 offen lds
    s_add_u32 m0, s44, 26624
    s_add_u32 s46, s47, 337920
    buffer_load_dwordx4 v3, s[20:23], s46 offen lds
    s_add_u32 m0, s44, 27648
    s_add_u32 s46, s47, 338944
    buffer_load_dwordx4 v3, s[20:23], s46 offen lds
    s_add_u32 m0, s44, 28672
    s_add_u32 s46, s47, 339968
    buffer_load_dwordx4 v3, s[20:23], s46 offen lds
    s_add_u32 m0, s44, 29696
    s_add_u32 s46, s47, 340992
    buffer_load_dwordx4 v3, s[20:23], s46 offen lds
    s_add_u32 m0, s44, 30720
    s_add_u32 s46, s47, 342016
    buffer_load_dwordx4 v3, s[20:23], s46 offen lds
    s_add_u32 m0, s44, 31744
    s_add_u32 s46, s47, 343040
    buffer_load_dwordx4 v3, s[20:23], s46 offen lds
    s_add_u32 m0, s44, 32768
    s_add_u32 s46, s47, 393216
    buffer_load_dwordx4 v3, s[20:23], s46 offen lds
    s_add_u32 m0, s44, 33792
    s_add_u32 s46, s47, 394240
    buffer_load_dwordx4 v3, s[20:23], s46 offen lds
    s_cmp_lt_u32 s32, 14
    s_cbranch_scc1 wi_npo
    v_mov_b32 v8, -1
    v_mov_b32 v9, -1
    s_cmp_eq_u32 s33, 1
    s_cbranch_scc1 wi_po2
    s_and_b32 s45, s32, 1
    s_lshl_b32 s45, s45, 8
    s_add_u32 s44, s45, 2838528
    s_lshl_b32 s45, s3, 10
    s_add_u32 s44, s44, s45
    v_and_b32 v10, 1, v7
    v_lshlrev_b32 v10, 9, v10
    v_lshl_add_u32 v10, v6, 4, v10
    v_lshrrev_b32 v11, 1, v7
    v_lshl_add_u32 v10, v11, 3, v10
    buffer_store_dwordx2 v[8:9], v10, s[24:27], s44 offen sc1
    s_add_u32 s44, s44, 4096
    buffer_store_dwordx2 v[8:9], v10, s[24:27], s44 offen sc1
    s_add_u32 s44, s44, 4096
    buffer_store_dwordx2 v[8:9], v10, s[24:27], s44 offen sc1
    s_add_u32 s44, s44, 4096
    buffer_store_dwordx2 v[8:9], v10, s[24:27], s44 offen sc1
    s_add_u32 s44, s44, 4096
    buffer_store_dwordx2 v[8:9], v10, s[24:27], s44 offen sc1
    s_add_u32 s44, s44, 4096
    buffer_store_dwordx2 v[8:9], v10, s[24:27], s44 offen sc1
    s_add_u32 s44, s44, 4096
    buffer_store_dwordx2 v[8:9], v10, s[24:27], s44 offen sc1
    s_add_u32 s44, s44, 4096
    buffer_store_dwordx2 v[8:9], v10, s[24:27], s44 offen sc1
    s_add_u32 s44, s44, 4096
    buffer_store_dwordx2 v[8:9], v10, s[24:27], s44 offen sc1
    s_add_u32 s44, s44, 4096
    buffer_store_dwordx2 v[8:9], v10, s[24:27], s44 offen sc1
    s_add_u32 s44, s44, 4096
    buffer_store_dwordx2 v[8:9], v10, s[24:27], s44 offen sc1
    s_add_u32 s44, s44, 4096
    s_branch wi_npo
wi_po2:
    s_add_u32 s44, s32, 112
    s_mul_i32 s44, s44, 22528
    s_lshr_b32 s45, s3, 1
    s_lshl_b32 s45, s45, 10
    s_add_u32 s44, s44, s45
    s_and_b32 s45, s3, 1
    s_lshl_b32 s45, s45, 8
    s_add_u32 s44, s44, s45
    v_lshrrev_b32 v10, 1, v7
    v_lshlrev_b32 v10, 9, v10
    v_lshl_add_u32 v10, v6, 4, v10
    v_and_b32 v11, 1, v7
    v_lshl_add_u32 v10, v11, 3, v10
    buffer_store_dwordx2 v[8:9], v10, s[24:27], s44 offen sc1
    s_add_u32 s44, s44, 2048
    buffer_store_dwordx2 v[8:9], v10, s[24:27], s44 offen sc1
    s_add_u32 s44, s44, 2048
    buffer_store_dwordx2 v[8:9], v10, s[24:27], s44 offen sc1
    s_add_u32 s44, s44, 2048
    buffer_store_dwordx2 v[8:9], v10, s[24:27], s44 offen sc1
    s_add_u32 s44, s44, 2048
    buffer_store_dwordx2 v[8:9], v10, s[24:27], s44 offen sc1
    s_add_u32 s44, s44, 2048
    buffer_store_dwordx2 v[8:9], v10, s[24:27], s44 offen sc1
    s_add_u32 s44, s44, 2048
    buffer_store_dwordx2 v[8:9], v10, s[24:27], s44 offen sc1
    s_add_u32 s44, s44, 2048
    buffer_store_dwordx2 v[8:9], v10, s[24:27], s44 offen sc1
    s_add_u32 s44, s44, 2048
    buffer_store_dwordx2 v[8:9], v10, s[24:27], s44 offen sc1
    s_add_u32 s44, s44, 2048
    buffer_store_dwordx2 v[8:9], v10, s[24:27], s44 offen sc1
    s_add_u32 s44, s44, 2048
    buffer_store_dwordx2 v[8:9], v10, s[24:27], s44 offen sc1
    s_add_u32 s44, s44, 2048
wi_npo:
wi_loop:
    s_waitcnt vmcnt(16)
    s_add_u32 s46, s47, 393216
    buffer_load_dwordx4 v[144:147], v3, s[20:23], s46 offen offset:2048
    buffer_load_dwordx4 v[148:151], v3, s[20:23], s46 offen offset:3072
    s_add_u32 s46, s47, 397312
    buffer_load_dwordx4 v[152:155], v3, s[20:23], s46 offen offset:0
    buffer_load_dwordx4 v[156:159], v3, s[20:23], s46 offen offset:1024
    buffer_load_dwordx4 v[160:163], v3, s[20:23], s46 offen offset:2048
    buffer_load_dwordx4 v[164:167], v3, s[20:23], s46 offen offset:3072
    s_add_u32 s46, s47, 401408
    buffer_load_dwordx4 v[168:171], v3, s[20:23], s46 offen offset:0
    buffer_load_dwordx4 v[172:175], v3, s[20:23], s46 offen offset:1024
    buffer_load_dwordx4 v[176:179], v3, s[20:23], s46 offen offset:2048
    buffer_load_dwordx4 v[180:183], v3, s[20:23], s46 offen offset:3072
    s_add_u32 s46, s47, 405504
    buffer_load_dwordx4 v[184:187], v3, s[20:23], s46 offen offset:0
    buffer_load_dwordx4 v[188:191], v3, s[20:23], s46 offen offset:1024
    buffer_load_dwordx4 v[192:195], v3, s[20:23], s46 offen offset:2048
    buffer_load_dwordx4 v[196:199], v3, s[20:23], s46 offen offset:3072
    s_add_u32 s46, s47, 458752
    buffer_load_dwordx4 v[200:203], v3, s[20:23], s46 offen offset:0
    buffer_load_dwordx4 v[204:207], v3, s[20:23], s46 offen offset:1024
    buffer_load_dwordx4 v[208:211], v3, s[20:23], s46 offen offset:2048
    buffer_load_dwordx4 v[212:215], v3, s[20:23], s46 offen offset:3072
    s_add_u32 s46, s47, 462848
    buffer_load_dwordx4 v[216:219], v3, s[20:23], s46 offen offset:0
    buffer_load_dwordx4 v[220:223], v3, s[20:23], s46 offen offset:1024
    buffer_load_dwordx4 v[224:227], v3, s[20:23], s46 offen offset:2048
    buffer_load_dwordx4 v[228:231], v3, s[20:23], s46 offen offset:3072
    s_add_u32 s46, s47, 466944
    buffer_load_dwordx4 v[232:235], v3, s[20:23], s46 offen offset:0
    buffer_load_dwordx4 v[236:239], v3, s[20:23], s46 offen offset:1024
    buffer_load_dwordx4 v[240:243], v3, s[20:23], s46 offen offset:2048
    buffer_load_dwordx4 v[244:247], v3, s[20:23], s46 offen offset:3072
    s_add_u32 s46, s47, 471040
    buffer_load_dwordx4 v[248:251], v3, s[20:23], s46 offen offset:0
    buffer_load_dwordx4 v[252:255], v3, s[20:23], s46 offen offset:1024
    v_lshlrev_b32 v4, 5, v1
    s_movk_i32 s35, 0x1800
    s_movk_i32 s36, 0x2000
    buffer_load_dwordx4 v[24:27], v4, s[16:19], s35 offen
    buffer_load_dwordx4 v[28:31], v4, s[16:19], s35 offen offset:16
    buffer_load_dwordx4 v[16:19], v4, s[16:19], s36 offen
    buffer_load_dwordx4 v[20:23], v4, s[16:19], s36 offen offset:16
    v_lshlrev_b32 v4, 2, v6
    s_lshr_b32 s34, s32, 1
    s_lshl_b32 s34, s34, 6
    s_add_u32 s34, s34, 12288
    s_lshl_b32 s36, s32, 14
    s_lshl_b32 s35, s3, 12
    s_add_u32 s36, s36, s35
    s_cmp_ge_u32 s32, 116
    s_cbranch_scc1 wi_dir
    s_add_u32 s97, s101, 0
    s_mov_b32 s98, 0x40000
    buffer_load_dword v58, v4, s[40:43], s34 offen sc1
    s_waitcnt vmcnt(0)
    v_subrev_u32 v58, s97, v58
    v_cmp_lt_u32 vcc, 0, v58
    s_cbranch_vccz wip_pd
    buffer_load_dword v58, v4, s[40:43], s34 offen sc1
    s_sleep 6
    s_sleep 6
    buffer_load_dword v59, v4, s[40:43], s34 offen sc1
wip_pp:
    s_waitcnt vmcnt(1)
    v_subrev_u32 v58, s97, v58
    v_cmp_lt_u32 vcc, 0, v58
    s_cbranch_vccz wip_pd
    buffer_load_dword v58, v4, s[40:43], s34 offen sc1
    s_waitcnt vmcnt(1)
    v_subrev_u32 v59, s97, v59
    v_cmp_lt_u32 vcc, 0, v59
    s_cbranch_vccz wip_pd
    buffer_load_dword v59, v4, s[40:43], s34 offen sc1
    s_sub_u32 s98, s98, 1
    s_cbranch_scc0 wip_pp
wip_pd:
    buffer_load_dwordx4 v[64:67], v3, s[12:15], s36 offen offset:0 sc1
    buffer_load_dwordx4 v[68:71], v3, s[12:15], s36 offen offset:1024 sc1
    buffer_load_dwordx4 v[72:75], v3, s[12:15], s36 offen offset:2048 sc1
    buffer_load_dwordx4 v[76:79], v3, s[12:15], s36 offen offset:3072 sc1
    s_branch wi_go
wi_dir:
    s_mov_b32 s98, 0x40000
wi_dp:
    buffer_load_dwordx4 v[64:67], v3, s[12:15], s36 offen offset:0 sc1
    buffer_load_dwordx4 v[68:71], v3, s[12:15], s36 offen offset:1024 sc1
    buffer_load_dwordx4 v[72:75], v3, s[12:15], s36 offen offset:2048 sc1
    buffer_load_dwordx4 v[76:79], v3, s[12:15], s36 offen offset:3072 sc1
    s_waitcnt vmcnt(0)
    v_max3_u32 v58, v64, v65, v66
    v_max3_u32 v58, v58, v67, v68
    v_max3_u32 v58, v58, v69, v70
    v_max3_u32 v58, v58, v71, v72
    v_max3_u32 v58, v58, v73, v74
    v_max3_u32 v58, v58, v75, v76
    v_max3_u32 v58, v58, v77, v78
    v_max_u32 v58, v58, v79
    v_cmp_eq_u32 vcc, -1, v58
    s_cbranch_vccz wi_go
    s_sleep 2
    s_sub_u32 s98, s98, 1
    s_cbranch_scc0 wi_dp
wi_go:
    v_add_f32 v16, 1.0, v16
    v_add_f32 v17, 1.0, v17
    v_add_f32 v18, 1.0, v18
    v_add_f32 v19, 1.0, v19
    v_add_f32 v20, 1.0, v20
    v_add_f32 v21, 1.0, v21
    v_add_f32 v22, 1.0, v22
    v_add_f32 v23, 1.0, v23
    v_cvt_pk_bf16_f32 v33, v16, v17
    v_lshlrev_b32 v16, 16, v33
    v_and_b32 v17, 0xffff0000, v33
    v_cvt_pk_bf16_f32 v33, v18, v19
    v_lshlrev_b32 v18, 16, v33
    v_and_b32 v19, 0xffff0000, v33
    v_cvt_pk_bf16_f32 v33, v20, v21
    v_lshlrev_b32 v20, 16, v33
    v_and_b32 v21, 0xffff0000, v33
    v_cvt_pk_bf16_f32 v33, v22, v23
    v_lshlrev_b32 v22, 16, v33
    v_and_b32 v23, 0xffff0000, v33
    s_mul_i32 s35, s3, 4160
    v_add_u32 v5, s35, v3
    s_waitcnt vmcnt(3)
    v_lshlrev_b32 v8, 16, v64
    v_and_b32 v9, 0xffff0000, v64
    v_lshlrev_b32 v10, 16, v65
    v_and_b32 v11, 0xffff0000, v65
    v_lshlrev_b32 v12, 16, v66
    v_and_b32 v13, 0xffff0000, v66
    v_lshlrev_b32 v14, 16, v67
    v_and_b32 v15, 0xffff0000, v67
    v_add_f32 v36, v8, v9
    v_add_f32 v36, v36, v10
    v_add_f32 v36, v36, v11
    v_add_f32 v36, v36, v12
    v_add_f32 v36, v36, v13
    v_add_f32 v36, v36, v14
    v_add_f32 v36, v36, v15
    s_nop 1
    v_add_f32_dpp v36, v36, v36 quad_perm:[1,0,3,2] row_mask:0xf bank_mask:0xf
    s_nop 1
    v_add_f32_dpp v36, v36, v36 quad_perm:[2,3,0,1] row_mask:0xf bank_mask:0xf
    s_nop 1
    v_add_f32_dpp v36, v36, v36 row_half_mirror row_mask:0xf bank_mask:0xf
    s_nop 1
    v_add_f32_dpp v36, v36, v36 row_mirror row_mask:0xf bank_mask:0xf
    v_mov_b32 v37, v36
    s_nop 1
    v_permlane16_swap_b32 v36, v37
    s_nop 0
    v_add_f32 v36, v36, v37
    v_mov_b32 v37, v36
    s_nop 1
    v_permlane32_swap_b32 v36, v37
    s_nop 0
    v_add_f32 v36, v36, v37
    v_mul_f32 v38, 0x3b000000, v36
    v_sub_f32 v39, v8, v38
    v_sub_f32 v40, v9, v38
    v_sub_f32 v41, v10, v38
    v_sub_f32 v42, v11, v38
    v_sub_f32 v43, v12, v38
    v_sub_f32 v44, v13, v38
    v_sub_f32 v45, v14, v38
    v_sub_f32 v46, v15, v38
    v_mul_f32 v36, v39, v39
    v_fmac_f32 v36, v40, v40
    v_fmac_f32 v36, v41, v41
    v_fmac_f32 v36, v42, v42
    v_fmac_f32 v36, v43, v43
    v_fmac_f32 v36, v44, v44
    v_fmac_f32 v36, v45, v45
    v_fmac_f32 v36, v46, v46
    s_nop 1
    v_add_f32_dpp v36, v36, v36 quad_perm:[1,0,3,2] row_mask:0xf bank_mask:0xf
    s_nop 1
    v_add_f32_dpp v36, v36, v36 quad_perm:[2,3,0,1] row_mask:0xf bank_mask:0xf
    s_nop 1
    v_add_f32_dpp v36, v36, v36 row_half_mirror row_mask:0xf bank_mask:0xf
    s_nop 1
    v_add_f32_dpp v36, v36, v36 row_mirror row_mask:0xf bank_mask:0xf
    v_mov_b32 v37, v36
    s_nop 1
    v_permlane16_swap_b32 v36, v37
    s_nop 0
    v_add_f32 v36, v36, v37
    v_mov_b32 v37, v36
    s_nop 1
    v_permlane32_swap_b32 v36, v37
    s_nop 0
    v_add_f32 v36, v36, v37
    v_mul_f32 v36, 0x3b000000, v36
    v_cvt_pk_bf16_f32 v37, v38, v36
    v_lshlrev_b32 v38, 16, v37
    v_and_b32 v36, 0xffff0000, v37
    v_add_f32 v36, 0x3727c5ac, v36
    v_cvt_pk_bf16_f32 v36, v36, v36
    v_and_b32 v36, 0xffff0000, v36
    v_sqrt_f32 v36, v36
    s_nop 0
    v_cvt_pk_bf16_f32 v36, v36, v36
    v_and_b32 v36, 0xffff0000, v36
    v_rcp_f32 v36, v36
    v_sub_f32 v8, v8, v38
    v_sub_f32 v9, v9, v38
    v_sub_f32 v10, v10, v38
    v_sub_f32 v11, v11, v38
    v_sub_f32 v12, v12, v38
    v_sub_f32 v13, v13, v38
    v_sub_f32 v14, v14, v38
    v_sub_f32 v15, v15, v38
    v_cvt_pk_bf16_f32 v37, v8, v9
    v_lshlrev_b32 v8, 16, v37
    v_and_b32 v9, 0xffff0000, v37
    v_cvt_pk_bf16_f32 v37, v10, v11
    v_lshlrev_b32 v10, 16, v37
    v_and_b32 v11, 0xffff0000, v37
    v_cvt_pk_bf16_f32 v37, v12, v13
    v_lshlrev_b32 v12, 16, v37
    v_and_b32 v13, 0xffff0000, v37
    v_cvt_pk_bf16_f32 v37, v14, v15
    v_lshlrev_b32 v14, 16, v37
    v_and_b32 v15, 0xffff0000, v37
    v_mul_f32 v8, v8, v36
    v_mul_f32 v9, v9, v36
    v_mul_f32 v10, v10, v36
    v_mul_f32 v11, v11, v36
    v_mul_f32 v12, v12, v36
    v_mul_f32 v13, v13, v36
    v_mul_f32 v14, v14, v36
    v_mul_f32 v15, v15, v36
    v_cvt_pk_bf16_f32 v37, v8, v9
    v_lshlrev_b32 v8, 16, v37
    v_and_b32 v9, 0xffff0000, v37
    v_cvt_pk_bf16_f32 v37, v10, v11
    v_lshlrev_b32 v10, 16, v37
    v_and_b32 v11, 0xffff0000, v37
    v_cvt_pk_bf16_f32 v37, v12, v13
    v_lshlrev_b32 v12, 16, v37
    v_and_b32 v13, 0xffff0000, v37
    v_cvt_pk_bf16_f32 v37, v14, v15
    v_lshlrev_b32 v14, 16, v37
    v_and_b32 v15, 0xffff0000, v37
    v_mul_f32 v8, v8, v16
    v_mul_f32 v9, v9, v17
    v_mul_f32 v10, v10, v18
    v_mul_f32 v11, v11, v19
    v_mul_f32 v12, v12, v20
    v_mul_f32 v13, v13, v21
    v_mul_f32 v14, v14, v22
    v_mul_f32 v15, v15, v23
    v_cvt_pk_bf16_f32 v37, v8, v9
    v_lshlrev_b32 v8, 16, v37
    v_and_b32 v9, 0xffff0000, v37
    v_cvt_pk_bf16_f32 v37, v10, v11
    v_lshlrev_b32 v10, 16, v37
    v_and_b32 v11, 0xffff0000, v37
    v_cvt_pk_bf16_f32 v37, v12, v13
    v_lshlrev_b32 v12, 16, v37
    v_and_b32 v13, 0xffff0000, v37
    v_cvt_pk_bf16_f32 v37, v14, v15
    v_lshlrev_b32 v14, 16, v37
    v_and_b32 v15, 0xffff0000, v37
    v_add_f32 v8, v8, v24
    v_add_f32 v9, v9, v25
    v_add_f32 v10, v10, v26
    v_add_f32 v11, v11, v27
    v_add_f32 v12, v12, v28
    v_add_f32 v13, v13, v29
    v_add_f32 v14, v14, v30
    v_add_f32 v15, v15, v31
    v_cvt_pk_bf16_f32 v48, v8, v9
    v_cvt_pk_bf16_f32 v49, v10, v11
    v_cvt_pk_bf16_f32 v50, v12, v13
    v_cvt_pk_bf16_f32 v51, v14, v15
    ds_write_b128 v5, v[48:51] offset:0
    s_waitcnt vmcnt(2)
    v_lshlrev_b32 v8, 16, v68
    v_and_b32 v9, 0xffff0000, v68
    v_lshlrev_b32 v10, 16, v69
    v_and_b32 v11, 0xffff0000, v69
    v_lshlrev_b32 v12, 16, v70
    v_and_b32 v13, 0xffff0000, v70
    v_lshlrev_b32 v14, 16, v71
    v_and_b32 v15, 0xffff0000, v71
    v_add_f32 v36, v8, v9
    v_add_f32 v36, v36, v10
    v_add_f32 v36, v36, v11
    v_add_f32 v36, v36, v12
    v_add_f32 v36, v36, v13
    v_add_f32 v36, v36, v14
    v_add_f32 v36, v36, v15
    s_nop 1
    v_add_f32_dpp v36, v36, v36 quad_perm:[1,0,3,2] row_mask:0xf bank_mask:0xf
    s_nop 1
    v_add_f32_dpp v36, v36, v36 quad_perm:[2,3,0,1] row_mask:0xf bank_mask:0xf
    s_nop 1
    v_add_f32_dpp v36, v36, v36 row_half_mirror row_mask:0xf bank_mask:0xf
    s_nop 1
    v_add_f32_dpp v36, v36, v36 row_mirror row_mask:0xf bank_mask:0xf
    v_mov_b32 v37, v36
    s_nop 1
    v_permlane16_swap_b32 v36, v37
    s_nop 0
    v_add_f32 v36, v36, v37
    v_mov_b32 v37, v36
    s_nop 1
    v_permlane32_swap_b32 v36, v37
    s_nop 0
    v_add_f32 v36, v36, v37
    v_mul_f32 v38, 0x3b000000, v36
    v_sub_f32 v39, v8, v38
    v_sub_f32 v40, v9, v38
    v_sub_f32 v41, v10, v38
    v_sub_f32 v42, v11, v38
    v_sub_f32 v43, v12, v38
    v_sub_f32 v44, v13, v38
    v_sub_f32 v45, v14, v38
    v_sub_f32 v46, v15, v38
    v_mul_f32 v36, v39, v39
    v_fmac_f32 v36, v40, v40
    v_fmac_f32 v36, v41, v41
    v_fmac_f32 v36, v42, v42
    v_fmac_f32 v36, v43, v43
    v_fmac_f32 v36, v44, v44
    v_fmac_f32 v36, v45, v45
    v_fmac_f32 v36, v46, v46
    s_nop 1
    v_add_f32_dpp v36, v36, v36 quad_perm:[1,0,3,2] row_mask:0xf bank_mask:0xf
    s_nop 1
    v_add_f32_dpp v36, v36, v36 quad_perm:[2,3,0,1] row_mask:0xf bank_mask:0xf
    s_nop 1
    v_add_f32_dpp v36, v36, v36 row_half_mirror row_mask:0xf bank_mask:0xf
    s_nop 1
    v_add_f32_dpp v36, v36, v36 row_mirror row_mask:0xf bank_mask:0xf
    v_mov_b32 v37, v36
    s_nop 1
    v_permlane16_swap_b32 v36, v37
    s_nop 0
    v_add_f32 v36, v36, v37
    v_mov_b32 v37, v36
    s_nop 1
    v_permlane32_swap_b32 v36, v37
    s_nop 0
    v_add_f32 v36, v36, v37
    v_mul_f32 v36, 0x3b000000, v36
    v_cvt_pk_bf16_f32 v37, v38, v36
    v_lshlrev_b32 v38, 16, v37
    v_and_b32 v36, 0xffff0000, v37
    v_add_f32 v36, 0x3727c5ac, v36
    v_cvt_pk_bf16_f32 v36, v36, v36
    v_and_b32 v36, 0xffff0000, v36
    v_sqrt_f32 v36, v36
    s_nop 0
    v_cvt_pk_bf16_f32 v36, v36, v36
    v_and_b32 v36, 0xffff0000, v36
    v_rcp_f32 v36, v36
    v_sub_f32 v8, v8, v38
    v_sub_f32 v9, v9, v38
    v_sub_f32 v10, v10, v38
    v_sub_f32 v11, v11, v38
    v_sub_f32 v12, v12, v38
    v_sub_f32 v13, v13, v38
    v_sub_f32 v14, v14, v38
    v_sub_f32 v15, v15, v38
    v_cvt_pk_bf16_f32 v37, v8, v9
    v_lshlrev_b32 v8, 16, v37
    v_and_b32 v9, 0xffff0000, v37
    v_cvt_pk_bf16_f32 v37, v10, v11
    v_lshlrev_b32 v10, 16, v37
    v_and_b32 v11, 0xffff0000, v37
    v_cvt_pk_bf16_f32 v37, v12, v13
    v_lshlrev_b32 v12, 16, v37
    v_and_b32 v13, 0xffff0000, v37
    v_cvt_pk_bf16_f32 v37, v14, v15
    v_lshlrev_b32 v14, 16, v37
    v_and_b32 v15, 0xffff0000, v37
    v_mul_f32 v8, v8, v36
    v_mul_f32 v9, v9, v36
    v_mul_f32 v10, v10, v36
    v_mul_f32 v11, v11, v36
    v_mul_f32 v12, v12, v36
    v_mul_f32 v13, v13, v36
    v_mul_f32 v14, v14, v36
    v_mul_f32 v15, v15, v36
    v_cvt_pk_bf16_f32 v37, v8, v9
    v_lshlrev_b32 v8, 16, v37
    v_and_b32 v9, 0xffff0000, v37
    v_cvt_pk_bf16_f32 v37, v10, v11
    v_lshlrev_b32 v10, 16, v37
    v_and_b32 v11, 0xffff0000, v37
    v_cvt_pk_bf16_f32 v37, v12, v13
    v_lshlrev_b32 v12, 16, v37
    v_and_b32 v13, 0xffff0000, v37
    v_cvt_pk_bf16_f32 v37, v14, v15
    v_lshlrev_b32 v14, 16, v37
    v_and_b32 v15, 0xffff0000, v37
    v_mul_f32 v8, v8, v16
    v_mul_f32 v9, v9, v17
    v_mul_f32 v10, v10, v18
    v_mul_f32 v11, v11, v19
    v_mul_f32 v12, v12, v20
    v_mul_f32 v13, v13, v21
    v_mul_f32 v14, v14, v22
    v_mul_f32 v15, v15, v23
    v_cvt_pk_bf16_f32 v37, v8, v9
    v_lshlrev_b32 v8, 16, v37
    v_and_b32 v9, 0xffff0000, v37
    v_cvt_pk_bf16_f32 v37, v10, v11
    v_lshlrev_b32 v10, 16, v37
    v_and_b32 v11, 0xffff0000, v37
    v_cvt_pk_bf16_f32 v37, v12, v13
    v_lshlrev_b32 v12, 16, v37
    v_and_b32 v13, 0xffff0000, v37
    v_cvt_pk_bf16_f32 v37, v14, v15
    v_lshlrev_b32 v14, 16, v37
    v_and_b32 v15, 0xffff0000, v37
    v_add_f32 v8, v8, v24
    v_add_f32 v9, v9, v25
    v_add_f32 v10, v10, v26
    v_add_f32 v11, v11, v27
    v_add_f32 v12, v12, v28
    v_add_f32 v13, v13, v29
    v_add_f32 v14, v14, v30
    v_add_f32 v15, v15, v31
    v_cvt_pk_bf16_f32 v48, v8, v9
    v_cvt_pk_bf16_f32 v49, v10, v11
    v_cvt_pk_bf16_f32 v50, v12, v13
    v_cvt_pk_bf16_f32 v51, v14, v15
    ds_write_b128 v5, v[48:51] offset:1040
    s_waitcnt vmcnt(1)
    v_lshlrev_b32 v8, 16, v72
    v_and_b32 v9, 0xffff0000, v72
    v_lshlrev_b32 v10, 16, v73
    v_and_b32 v11, 0xffff0000, v73
    v_lshlrev_b32 v12, 16, v74
    v_and_b32 v13, 0xffff0000, v74
    v_lshlrev_b32 v14, 16, v75
    v_and_b32 v15, 0xffff0000, v75
    v_add_f32 v36, v8, v9
    v_add_f32 v36, v36, v10
    v_add_f32 v36, v36, v11
    v_add_f32 v36, v36, v12
    v_add_f32 v36, v36, v13
    v_add_f32 v36, v36, v14
    v_add_f32 v36, v36, v15
    s_nop 1
    v_add_f32_dpp v36, v36, v36 quad_perm:[1,0,3,2] row_mask:0xf bank_mask:0xf
    s_nop 1
    v_add_f32_dpp v36, v36, v36 quad_perm:[2,3,0,1] row_mask:0xf bank_mask:0xf
    s_nop 1
    v_add_f32_dpp v36, v36, v36 row_half_mirror row_mask:0xf bank_mask:0xf
    s_nop 1
    v_add_f32_dpp v36, v36, v36 row_mirror row_mask:0xf bank_mask:0xf
    v_mov_b32 v37, v36
    s_nop 1
    v_permlane16_swap_b32 v36, v37
    s_nop 0
    v_add_f32 v36, v36, v37
    v_mov_b32 v37, v36
    s_nop 1
    v_permlane32_swap_b32 v36, v37
    s_nop 0
    v_add_f32 v36, v36, v37
    v_mul_f32 v38, 0x3b000000, v36
    v_sub_f32 v39, v8, v38
    v_sub_f32 v40, v9, v38
    v_sub_f32 v41, v10, v38
    v_sub_f32 v42, v11, v38
    v_sub_f32 v43, v12, v38
    v_sub_f32 v44, v13, v38
    v_sub_f32 v45, v14, v38
    v_sub_f32 v46, v15, v38
    v_mul_f32 v36, v39, v39
    v_fmac_f32 v36, v40, v40
    v_fmac_f32 v36, v41, v41
    v_fmac_f32 v36, v42, v42
    v_fmac_f32 v36, v43, v43
    v_fmac_f32 v36, v44, v44
    v_fmac_f32 v36, v45, v45
    v_fmac_f32 v36, v46, v46
    s_nop 1
    v_add_f32_dpp v36, v36, v36 quad_perm:[1,0,3,2] row_mask:0xf bank_mask:0xf
    s_nop 1
    v_add_f32_dpp v36, v36, v36 quad_perm:[2,3,0,1] row_mask:0xf bank_mask:0xf
    s_nop 1
    v_add_f32_dpp v36, v36, v36 row_half_mirror row_mask:0xf bank_mask:0xf
    s_nop 1
    v_add_f32_dpp v36, v36, v36 row_mirror row_mask:0xf bank_mask:0xf
    v_mov_b32 v37, v36
    s_nop 1
    v_permlane16_swap_b32 v36, v37
    s_nop 0
    v_add_f32 v36, v36, v37
    v_mov_b32 v37, v36
    s_nop 1
    v_permlane32_swap_b32 v36, v37
    s_nop 0
    v_add_f32 v36, v36, v37
    v_mul_f32 v36, 0x3b000000, v36
    v_cvt_pk_bf16_f32 v37, v38, v36
    v_lshlrev_b32 v38, 16, v37
    v_and_b32 v36, 0xffff0000, v37
    v_add_f32 v36, 0x3727c5ac, v36
    v_cvt_pk_bf16_f32 v36, v36, v36
    v_and_b32 v36, 0xffff0000, v36
    v_sqrt_f32 v36, v36
    s_nop 0
    v_cvt_pk_bf16_f32 v36, v36, v36
    v_and_b32 v36, 0xffff0000, v36
    v_rcp_f32 v36, v36
    v_sub_f32 v8, v8, v38
    v_sub_f32 v9, v9, v38
    v_sub_f32 v10, v10, v38
    v_sub_f32 v11, v11, v38
    v_sub_f32 v12, v12, v38
    v_sub_f32 v13, v13, v38
    v_sub_f32 v14, v14, v38
    v_sub_f32 v15, v15, v38
    v_cvt_pk_bf16_f32 v37, v8, v9
    v_lshlrev_b32 v8, 16, v37
    v_and_b32 v9, 0xffff0000, v37
    v_cvt_pk_bf16_f32 v37, v10, v11
    v_lshlrev_b32 v10, 16, v37
    v_and_b32 v11, 0xffff0000, v37
    v_cvt_pk_bf16_f32 v37, v12, v13
    v_lshlrev_b32 v12, 16, v37
    v_and_b32 v13, 0xffff0000, v37
    v_cvt_pk_bf16_f32 v37, v14, v15
    v_lshlrev_b32 v14, 16, v37
    v_and_b32 v15, 0xffff0000, v37
    v_mul_f32 v8, v8, v36
    v_mul_f32 v9, v9, v36
    v_mul_f32 v10, v10, v36
    v_mul_f32 v11, v11, v36
    v_mul_f32 v12, v12, v36
    v_mul_f32 v13, v13, v36
    v_mul_f32 v14, v14, v36
    v_mul_f32 v15, v15, v36
    v_cvt_pk_bf16_f32 v37, v8, v9
    v_lshlrev_b32 v8, 16, v37
    v_and_b32 v9, 0xffff0000, v37
    v_cvt_pk_bf16_f32 v37, v10, v11
    v_lshlrev_b32 v10, 16, v37
    v_and_b32 v11, 0xffff0000, v37
    v_cvt_pk_bf16_f32 v37, v12, v13
    v_lshlrev_b32 v12, 16, v37
    v_and_b32 v13, 0xffff0000, v37
    v_cvt_pk_bf16_f32 v37, v14, v15
    v_lshlrev_b32 v14, 16, v37
    v_and_b32 v15, 0xffff0000, v37
    v_mul_f32 v8, v8, v16
    v_mul_f32 v9, v9, v17
    v_mul_f32 v10, v10, v18
    v_mul_f32 v11, v11, v19
    v_mul_f32 v12, v12, v20
    v_mul_f32 v13, v13, v21
    v_mul_f32 v14, v14, v22
    v_mul_f32 v15, v15, v23
    v_cvt_pk_bf16_f32 v37, v8, v9
    v_lshlrev_b32 v8, 16, v37
    v_and_b32 v9, 0xffff0000, v37
    v_cvt_pk_bf16_f32 v37, v10, v11
    v_lshlrev_b32 v10, 16, v37
    v_and_b32 v11, 0xffff0000, v37
    v_cvt_pk_bf16_f32 v37, v12, v13
    v_lshlrev_b32 v12, 16, v37
    v_and_b32 v13, 0xffff0000, v37
    v_cvt_pk_bf16_f32 v37, v14, v15
    v_lshlrev_b32 v14, 16, v37
    v_and_b32 v15, 0xffff0000, v37
    v_add_f32 v8, v8, v24
    v_add_f32 v9, v9, v25
    v_add_f32 v10, v10, v26
    v_add_f32 v11, v11, v27
    v_add_f32 v12, v12, v28
    v_add_f32 v13, v13, v29
    v_add_f32 v14, v14, v30
    v_add_f32 v15, v15, v31
    v_cvt_pk_bf16_f32 v48, v8, v9
    v_cvt_pk_bf16_f32 v49, v10, v11
    v_cvt_pk_bf16_f32 v50, v12, v13
    v_cvt_pk_bf16_f32 v51, v14, v15
    ds_write_b128 v5, v[48:51] offset:2080
    s_waitcnt vmcnt(0)
    v_lshlrev_b32 v8, 16, v76
    v_and_b32 v9, 0xffff0000, v76
    v_lshlrev_b32 v10, 16, v77
    v_and_b32 v11, 0xffff0000, v77
    v_lshlrev_b32 v12, 16, v78
    v_and_b32 v13, 0xffff0000, v78
    v_lshlrev_b32 v14, 16, v79
    v_and_b32 v15, 0xffff0000, v79
    v_add_f32 v36, v8, v9
    v_add_f32 v36, v36, v10
    v_add_f32 v36, v36, v11
    v_add_f32 v36, v36, v12
    v_add_f32 v36, v36, v13
    v_add_f32 v36, v36, v14
    v_add_f32 v36, v36, v15
    s_nop 1
    v_add_f32_dpp v36, v36, v36 quad_perm:[1,0,3,2] row_mask:0xf bank_mask:0xf
    s_nop 1
    v_add_f32_dpp v36, v36, v36 quad_perm:[2,3,0,1] row_mask:0xf bank_mask:0xf
    s_nop 1
    v_add_f32_dpp v36, v36, v36 row_half_mirror row_mask:0xf bank_mask:0xf
    s_nop 1
    v_add_f32_dpp v36, v36, v36 row_mirror row_mask:0xf bank_mask:0xf
    v_mov_b32 v37, v36
    s_nop 1
    v_permlane16_swap_b32 v36, v37
    s_nop 0
    v_add_f32 v36, v36, v37
    v_mov_b32 v37, v36
    s_nop 1
    v_permlane32_swap_b32 v36, v37
    s_nop 0
    v_add_f32 v36, v36, v37
    v_mul_f32 v38, 0x3b000000, v36
    v_sub_f32 v39, v8, v38
    v_sub_f32 v40, v9, v38
    v_sub_f32 v41, v10, v38
    v_sub_f32 v42, v11, v38
    v_sub_f32 v43, v12, v38
    v_sub_f32 v44, v13, v38
    v_sub_f32 v45, v14, v38
    v_sub_f32 v46, v15, v38
    v_mul_f32 v36, v39, v39
    v_fmac_f32 v36, v40, v40
    v_fmac_f32 v36, v41, v41
    v_fmac_f32 v36, v42, v42
    v_fmac_f32 v36, v43, v43
    v_fmac_f32 v36, v44, v44
    v_fmac_f32 v36, v45, v45
    v_fmac_f32 v36, v46, v46
    s_nop 1
    v_add_f32_dpp v36, v36, v36 quad_perm:[1,0,3,2] row_mask:0xf bank_mask:0xf
    s_nop 1
    v_add_f32_dpp v36, v36, v36 quad_perm:[2,3,0,1] row_mask:0xf bank_mask:0xf
    s_nop 1
    v_add_f32_dpp v36, v36, v36 row_half_mirror row_mask:0xf bank_mask:0xf
    s_nop 1
    v_add_f32_dpp v36, v36, v36 row_mirror row_mask:0xf bank_mask:0xf
    v_mov_b32 v37, v36
    s_nop 1
    v_permlane16_swap_b32 v36, v37
    s_nop 0
    v_add_f32 v36, v36, v37
    v_mov_b32 v37, v36
    s_nop 1
    v_permlane32_swap_b32 v36, v37
    s_nop 0
    v_add_f32 v36, v36, v37
    v_mul_f32 v36, 0x3b000000, v36
    v_cvt_pk_bf16_f32 v37, v38, v36
    v_lshlrev_b32 v38, 16, v37
    v_and_b32 v36, 0xffff0000, v37
    v_add_f32 v36, 0x3727c5ac, v36
    v_cvt_pk_bf16_f32 v36, v36, v36
    v_and_b32 v36, 0xffff0000, v36
    v_sqrt_f32 v36, v36
    s_nop 0
    v_cvt_pk_bf16_f32 v36, v36, v36
    v_and_b32 v36, 0xffff0000, v36
    v_rcp_f32 v36, v36
    v_sub_f32 v8, v8, v38
    v_sub_f32 v9, v9, v38
    v_sub_f32 v10, v10, v38
    v_sub_f32 v11, v11, v38
    v_sub_f32 v12, v12, v38
    v_sub_f32 v13, v13, v38
    v_sub_f32 v14, v14, v38
    v_sub_f32 v15, v15, v38
    v_cvt_pk_bf16_f32 v37, v8, v9
    v_lshlrev_b32 v8, 16, v37
    v_and_b32 v9, 0xffff0000, v37
    v_cvt_pk_bf16_f32 v37, v10, v11
    v_lshlrev_b32 v10, 16, v37
    v_and_b32 v11, 0xffff0000, v37
    v_cvt_pk_bf16_f32 v37, v12, v13
    v_lshlrev_b32 v12, 16, v37
    v_and_b32 v13, 0xffff0000, v37
    v_cvt_pk_bf16_f32 v37, v14, v15
    v_lshlrev_b32 v14, 16, v37
    v_and_b32 v15, 0xffff0000, v37
    v_mul_f32 v8, v8, v36
    v_mul_f32 v9, v9, v36
    v_mul_f32 v10, v10, v36
    v_mul_f32 v11, v11, v36
    v_mul_f32 v12, v12, v36
    v_mul_f32 v13, v13, v36
    v_mul_f32 v14, v14, v36
    v_mul_f32 v15, v15, v36
    v_cvt_pk_bf16_f32 v37, v8, v9
    v_lshlrev_b32 v8, 16, v37
    v_and_b32 v9, 0xffff0000, v37
    v_cvt_pk_bf16_f32 v37, v10, v11
    v_lshlrev_b32 v10, 16, v37
    v_and_b32 v11, 0xffff0000, v37
    v_cvt_pk_bf16_f32 v37, v12, v13
    v_lshlrev_b32 v12, 16, v37
    v_and_b32 v13, 0xffff0000, v37
    v_cvt_pk_bf16_f32 v37, v14, v15
    v_lshlrev_b32 v14, 16, v37
    v_and_b32 v15, 0xffff0000, v37
    v_mul_f32 v8, v8, v16
    v_mul_f32 v9, v9, v17
    v_mul_f32 v10, v10, v18
    v_mul_f32 v11, v11, v19
    v_mul_f32 v12, v12, v20
    v_mul_f32 v13, v13, v21
    v_mul_f32 v14, v14, v22
    v_mul_f32 v15, v15, v23
    v_cvt_pk_bf16_f32 v37, v8, v9
    v_lshlrev_b32 v8, 16, v37
    v_and_b32 v9, 0xffff0000, v37
    v_cvt_pk_bf16_f32 v37, v10, v11
    v_lshlrev_b32 v10, 16, v37
    v_and_b32 v11, 0xffff0000, v37
    v_cvt_pk_bf16_f32 v37, v12, v13
    v_lshlrev_b32 v12, 16, v37
    v_and_b32 v13, 0xffff0000, v37
    v_cvt_pk_bf16_f32 v37, v14, v15
    v_lshlrev_b32 v14, 16, v37
    v_and_b32 v15, 0xffff0000, v37
    v_add_f32 v8, v8, v24
    v_add_f32 v9, v9, v25
    v_add_f32 v10, v10, v26
    v_add_f32 v11, v11, v27
    v_add_f32 v12, v12, v28
    v_add_f32 v13, v13, v29
    v_add_f32 v14, v14, v30
    v_add_f32 v15, v15, v31
    v_cvt_pk_bf16_f32 v48, v8, v9
    v_cvt_pk_bf16_f32 v49, v10, v11
    v_cvt_pk_bf16_f32 v50, v12, v13
    v_cvt_pk_bf16_f32 v51, v14, v15
    ds_write_b128 v5, v[48:51] offset:3120
    s_waitcnt lgkmcnt(0)
    s_barrier
    v_mul_u32_u24 v5, 1040, v6
    v_lshl_add_u32 v5, v7, 4, v5
    ds_read_b128 v[64:67], v5 offset:0
    ds_read_b128 v[68:71], v5 offset:64
    ds_read_b128 v[72:75], v5 offset:128
    ds_read_b128 v[76:79], v5 offset:192
    ds_read_b128 v[80:83], v5 offset:256
    ds_read_b128 v[84:87], v5 offset:320
    ds_read_b128 v[88:91], v5 offset:384
    ds_read_b128 v[92:95], v5 offset:448
    ds_read_b128 v[96:99], v5 offset:512
    ds_read_b128 v[100:103], v5 offset:576
    ds_read_b128 v[104:107], v5 offset:640
    ds_read_b128 v[108:111], v5 offset:704
    ds_read_b128 v[112:115], v5 offset:768
    ds_read_b128 v[116:119], v5 offset:832
    ds_read_b128 v[120:123], v5 offset:896
    ds_read_b128 v[124:127], v5 offset:960
    s_waitcnt lgkmcnt(0)
    v_add_u32 v60, s50, v3
    s_cmp_eq_u32 s33, 1
    s_cbranch_scc1 win_z2
    ds_read_b128 v[128:131], v60 offset:32768
    ds_read_b128 v[132:135], v60 offset:33792
    ds_read_b128 v[136:139], v60 offset:0
    v_mov_b32 v10, s48
    s_waitcnt lgkmcnt(2)
    v_mfma_f32_16x16x32_bf16 v[40:43], v[128:131], v[64:67], 0
    ds_read_b128 v[140:143], v60 offset:1024
    s_waitcnt lgkmcnt(2)
    v_mfma_f32_16x16x32_bf16 v[40:43], v[132:135], v[68:71], v[40:43]
    ds_read_b128 v[128:131], v60 offset:2048
    v_mfma_f32_16x16x32_bf16 v[40:43], v[144:147], v[72:75], v[40:43]
    s_add_u32 s46, s47, 471040
    buffer_load_dwordx4 v[144:147], v3, s[20:23], s46 offen offset:2048
    v_mfma_f32_16x16x32_bf16 v[40:43], v[148:151], v[76:79], v[40:43]
    s_add_u32 s46, s47, 471040
    buffer_load_dwordx4 v[148:151], v3, s[20:23], s46 offen offset:3072
    v_mfma_f32_16x16x32_bf16 v[40:43], v[152:155], v[80:83], v[40:43]
    s_add_u32 s46, s47, 524288
    buffer_load_dwordx4 v[152:155], v3, s[20:23], s46 offen offset:0
    v_mfma_f32_16x16x32_bf16 v[40:43], v[156:159], v[84:87], v[40:43]
    s_add_u32 s46, s47, 524288
    buffer_load_dwordx4 v[156:159], v3, s[20:23], s46 offen offset:1024
    v_mfma_f32_16x16x32_bf16 v[40:43], v[160:163], v[88:91], v[40:43]
    s_add_u32 s46, s47, 524288
    buffer_load_dwordx4 v[160:163], v3, s[20:23], s46 offen offset:2048
    v_mfma_f32_16x16x32_bf16 v[40:43], v[164:167], v[92:95], v[40:43]
    s_add_u32 s46, s47, 524288
    buffer_load_dwordx4 v[164:167], v3, s[20:23], s46 offen offset:3072
    v_mfma_f32_16x16x32_bf16 v[40:43], v[168:171], v[96:99], v[40:43]
    s_add_u32 s46, s47, 528384
    buffer_load_dwordx4 v[168:171], v3, s[20:23], s46 offen offset:0
    v_mfma_f32_16x16x32_bf16 v[40:43], v[172:175], v[100:103], v[40:43]
    s_add_u32 s46, s47, 528384
    buffer_load_dwordx4 v[172:175], v3, s[20:23], s46 offen offset:1024
    v_mfma_f32_16x16x32_bf16 v[40:43], v[176:179], v[104:107], v[40:43]
    s_add_u32 s46, s47, 528384
    buffer_load_dwordx4 v[176:179], v3, s[20:23], s46 offen offset:2048
    v_mfma_f32_16x16x32_bf16 v[40:43], v[180:183], v[108:111], v[40:43]
    s_add_u32 s46, s47, 528384
    buffer_load_dwordx4 v[180:183], v3, s[20:23], s46 offen offset:3072
    v_mfma_f32_16x16x32_bf16 v[40:43], v[184:187], v[112:115], v[40:43]
    s_add_u32 s46, s47, 532480
    buffer_load_dwordx4 v[184:187], v3, s[20:23], s46 offen offset:0
    v_mfma_f32_16x16x32_bf16 v[40:43], v[188:191], v[116:119], v[40:43]
    s_add_u32 s46, s47, 532480
    buffer_load_dwordx4 v[188:191], v3, s[20:23], s46 offen offset:1024
    v_mfma_f32_16x16x32_bf16 v[40:43], v[192:195], v[120:123], v[40:43]
    s_add_u32 s46, s47, 532480
    buffer_load_dwordx4 v[192:195], v3, s[20:23], s46 offen offset:2048
    v_mfma_f32_16x16x32_bf16 v[40:43], v[196:199], v[124:127], v[40:43]
    s_add_u32 s46, s47, 532480
    buffer_load_dwordx4 v[196:199], v3, s[20:23], s46 offen offset:3072
    v_mfma_f32_16x16x32_bf16 v[16:19], a[0:3], v[64:67], 0
    v_mfma_f32_16x16x32_bf16 v[16:19], a[4:7], v[68:71], v[16:19]
    v_mfma_f32_16x16x32_bf16 v[16:19], a[8:11], v[72:75], v[16:19]
    v_mfma_f32_16x16x32_bf16 v[16:19], a[12:15], v[76:79], v[16:19]
    v_mfma_f32_16x16x32_bf16 v[16:19], a[16:19], v[80:83], v[16:19]
    v_mfma_f32_16x16x32_bf16 v[16:19], a[20:23], v[84:87], v[16:19]
    v_mfma_f32_16x16x32_bf16 v[16:19], a[24:27], v[88:91], v[16:19]
    v_mfma_f32_16x16x32_bf16 v[16:19], a[28:31], v[92:95], v[16:19]
    v_cvt_pk_bf16_f32 v8, v40, v41
    v_lshlrev_b32 v40, 16, v8
    v_mfma_f32_16x16x32_bf16 v[16:19], a[32:35], v[96:99], v[16:19]
    v_and_b32 v41, 0xffff0000, v8
    v_cvt_pk_bf16_f32 v9, v42, v43
    v_mfma_f32_16x16x32_bf16 v[16:19], a[36:39], v[100:103], v[16:19]
    v_lshlrev_b32 v42, 16, v9
    v_and_b32 v43, 0xffff0000, v9
    v_mfma_f32_16x16x32_bf16 v[16:19], a[40:43], v[104:107], v[16:19]
    v_mul_f32 v12, v40, v40
    v_mul_f32 v13, v41, v41
    v_mfma_f32_16x16x32_bf16 v[16:19], a[44:47], v[108:111], v[16:19]
    v_mul_f32 v14, v42, v42
    v_mul_f32 v15, v43, v43
    v_mfma_f32_16x16x32_bf16 v[16:19], a[48:51], v[112:115], v[16:19]
    v_fma_f32 v12, v12, s49, v10
    v_fma_f32 v13, v13, s49, v10
    v_mfma_f32_16x16x32_bf16 v[16:19], a[52:55], v[116:119], v[16:19]
    v_fma_f32 v14, v14, s49, v10
    v_fma_f32 v15, v15, s49, v10
    v_mfma_f32_16x16x32_bf16 v[16:19], a[56:59], v[120:123], v[16:19]
    v_mul_f32 v12, v12, v40
    v_mul_f32 v13, v13, v41
    v_mfma_f32_16x16x32_bf16 v[16:19], a[60:63], v[124:127], v[16:19]
    v_mul_f32 v14, v14, v42
    v_mul_f32 v15, v15, v43
    v_mfma_f32_16x16x32_bf16 v[44:47], v[200:203], v[64:67], 0
    s_add_u32 s46, s47, 536576
    buffer_load_dwordx4 v[200:203], v3, s[20:23], s46 offen offset:0
    v_exp_f32 v12, v12
    v_mfma_f32_16x16x32_bf16 v[44:47], v[204:207], v[68:71], v[44:47]
    s_add_u32 s46, s47, 536576
    buffer_load_dwordx4 v[204:207], v3, s[20:23], s46 offen offset:1024
    v_exp_f32 v13, v13
    v_mfma_f32_16x16x32_bf16 v[44:47], v[208:211], v[72:75], v[44:47]
    s_add_u32 s46, s47, 536576
    buffer_load_dwordx4 v[208:211], v3, s[20:23], s46 offen offset:2048
    v_exp_f32 v14, v14
    v_mfma_f32_16x16x32_bf16 v[44:47], v[212:215], v[76:79], v[44:47]
    s_add_u32 s46, s47, 536576
    buffer_load_dwordx4 v[212:215], v3, s[20:23], s46 offen offset:3072
    v_exp_f32 v15, v15
    v_mfma_f32_16x16x32_bf16 v[44:47], v[216:219], v[80:83], v[44:47]
    s_add_u32 s46, s47, 589824
    buffer_load_dwordx4 v[216:219], v3, s[20:23], s46 offen offset:0
    v_add_f32 v12, 1.0, v12
    v_add_f32 v13, 1.0, v13
    v_mfma_f32_16x16x32_bf16 v[44:47], v[220:223], v[84:87], v[44:47]
    s_add_u32 s46, s47, 589824
    buffer_load_dwordx4 v[220:223], v3, s[20:23], s46 offen offset:1024
    v_add_f32 v14, 1.0, v14
    v_add_f32 v15, 1.0, v15
    v_mfma_f32_16x16x32_bf16 v[44:47], v[224:227], v[88:91], v[44:47]
    s_add_u32 s46, s47, 589824
    buffer_load_dwordx4 v[224:227], v3, s[20:23], s46 offen offset:2048
    v_rcp_f32 v12, v12
    v_mfma_f32_16x16x32_bf16 v[44:47], v[228:231], v[92:95], v[44:47]
    s_add_u32 s46, s47, 589824
    buffer_load_dwordx4 v[228:231], v3, s[20:23], s46 offen offset:3072
    v_rcp_f32 v13, v13
    v_mfma_f32_16x16x32_bf16 v[44:47], v[232:235], v[96:99], v[44:47]
    s_add_u32 s46, s47, 593920
    buffer_load_dwordx4 v[232:235], v3, s[20:23], s46 offen offset:0
    v_rcp_f32 v14, v14
    v_mfma_f32_16x16x32_bf16 v[44:47], v[236:239], v[100:103], v[44:47]
    s_add_u32 s46, s47, 593920
    buffer_load_dwordx4 v[236:239], v3, s[20:23], s46 offen offset:1024
    v_rcp_f32 v15, v15
    v_mfma_f32_16x16x32_bf16 v[44:47], v[240:243], v[104:107], v[44:47]
    s_add_u32 s46, s47, 593920
    buffer_load_dwordx4 v[240:243], v3, s[20:23], s46 offen offset:2048
    v_mul_f32 v40, v40, v12
    v_mul_f32 v41, v41, v13
    v_mfma_f32_16x16x32_bf16 v[44:47], v[244:247], v[108:111], v[44:47]
    s_add_u32 s46, s47, 593920
    buffer_load_dwordx4 v[244:247], v3, s[20:23], s46 offen offset:3072
    v_mul_f32 v42, v42, v14
    v_mul_f32 v43, v43, v15
    v_mfma_f32_16x16x32_bf16 v[44:47], v[248:251], v[112:115], v[44:47]
    s_add_u32 s46, s47, 598016
    buffer_load_dwordx4 v[248:251], v3, s[20:23], s46 offen offset:0
    v_cvt_pk_bf16_f32 v8, v16, v17
    v_lshlrev_b32 v16, 16, v8
    v_mfma_f32_16x16x32_bf16 v[44:47], v[252:255], v[116:119], v[44:47]
    s_add_u32 s46, s47, 598016
    buffer_load_dwordx4 v[252:255], v3, s[20:23], s46 offen offset:1024
    v_and_b32 v17, 0xffff0000, v8
    v_cvt_pk_bf16_f32 v9, v18, v19
    s_waitcnt vmcnt(27)
    v_mfma_f32_16x16x32_bf16 v[44:47], v[144:147], v[120:123], v[44:47]
    s_add_u32 s46, s47, 598016
    buffer_load_dwordx4 v[144:147], v3, s[20:23], s46 offen offset:2048
    v_lshlrev_b32 v18, 16, v9
    v_and_b32 v19, 0xffff0000, v9
    s_waitcnt vmcnt(27)
    v_mfma_f32_16x16x32_bf16 v[44:47], v[148:151], v[124:127], v[44:47]
    s_add_u32 s46, s47, 598016
    buffer_load_dwordx4 v[148:151], v3, s[20:23], s46 offen offset:3072
    v_mul_f32 v12, v16, v16
    v_mul_f32 v13, v17, v17
    v_mfma_f32_16x16x32_bf16 v[20:23], a[64:67], v[64:67], 0
    v_mul_f32 v14, v18, v18
    v_mul_f32 v15, v19, v19
    v_mfma_f32_16x16x32_bf16 v[20:23], a[68:71], v[68:71], v[20:23]
    v_fma_f32 v12, v12, s49, v10
    v_fma_f32 v13, v13, s49, v10
    v_mfma_f32_16x16x32_bf16 v[20:23], a[72:75], v[72:75], v[20:23]
    v_fma_f32 v14, v14, s49, v10
    v_fma_f32 v15, v15, s49, v10
    v_mfma_f32_16x16x32_bf16 v[20:23], a[76:79], v[76:79], v[20:23]
    v_mul_f32 v12, v12, v16
    v_mul_f32 v13, v13, v17
    v_mfma_f32_16x16x32_bf16 v[20:23], a[80:83], v[80:83], v[20:23]
    v_mul_f32 v14, v14, v18
    v_mul_f32 v15, v15, v19
    v_mfma_f32_16x16x32_bf16 v[20:23], a[84:87], v[84:87], v[20:23]
    v_exp_f32 v12, v12
    v_mfma_f32_16x16x32_bf16 v[20:23], a[88:91], v[88:91], v[20:23]
    v_exp_f32 v13, v13
    v_mfma_f32_16x16x32_bf16 v[20:23], a[92:95], v[92:95], v[20:23]
    v_exp_f32 v14, v14
    v_mfma_f32_16x16x32_bf16 v[20:23], a[96:99], v[96:99], v[20:23]
    v_exp_f32 v15, v15
    v_mfma_f32_16x16x32_bf16 v[20:23], a[100:103], v[100:103], v[20:23]
    v_add_f32 v12, 1.0, v12
    v_add_f32 v13, 1.0, v13
    v_mfma_f32_16x16x32_bf16 v[20:23], a[104:107], v[104:107], v[20:23]
    v_add_f32 v14, 1.0, v14
    v_add_f32 v15, 1.0, v15
    v_mfma_f32_16x16x32_bf16 v[20:23], a[108:111], v[108:111], v[20:23]
    v_rcp_f32 v12, v12
    v_mfma_f32_16x16x32_bf16 v[20:23], a[112:115], v[112:115], v[20:23]
    v_rcp_f32 v13, v13
    v_mfma_f32_16x16x32_bf16 v[20:23], a[116:119], v[116:119], v[20:23]
    v_rcp_f32 v14, v14
    v_mfma_f32_16x16x32_bf16 v[20:23], a[120:123], v[120:123], v[20:23]
    v_rcp_f32 v15, v15
    v_mfma_f32_16x16x32_bf16 v[20:23], a[124:127], v[124:127], v[20:23]
    v_mul_f32 v16, v16, v12
    v_mul_f32 v17, v17, v13
    s_waitcnt vmcnt(27)
    v_mfma_f32_16x16x32_bf16 v[48:51], v[152:155], v[64:67], 0
    s_add_u32 s46, s47, 602112
    buffer_load_dwordx4 v[152:155], v3, s[20:23], s46 offen offset:0
    v_mul_f32 v18, v18, v14
    v_mul_f32 v19, v19, v15
    s_waitcnt vmcnt(27)
    v_mfma_f32_16x16x32_bf16 v[48:51], v[156:159], v[68:71], v[48:51]
    s_add_u32 s46, s47, 602112
    buffer_load_dwordx4 v[156:159], v3, s[20:23], s46 offen offset:1024
    v_cvt_pk_bf16_f32 v8, v44, v45
    v_lshlrev_b32 v44, 16, v8
    s_waitcnt vmcnt(27)
    v_mfma_f32_16x16x32_bf16 v[48:51], v[160:163], v[72:75], v[48:51]
    s_add_u32 s46, s47, 602112
    buffer_load_dwordx4 v[160:163], v3, s[20:23], s46 offen offset:2048
    v_and_b32 v45, 0xffff0000, v8
    v_cvt_pk_bf16_f32 v9, v46, v47
    s_waitcnt vmcnt(27)
    v_mfma_f32_16x16x32_bf16 v[48:51], v[164:167], v[76:79], v[48:51]
    s_add_u32 s46, s47, 602112
    buffer_load_dwordx4 v[164:167], v3, s[20:23], s46 offen offset:3072
    v_lshlrev_b32 v46, 16, v9
    v_and_b32 v47, 0xffff0000, v9
    s_waitcnt vmcnt(27)
    v_mfma_f32_16x16x32_bf16 v[48:51], v[168:171], v[80:83], v[48:51]
    s_add_u32 s46, s47, 655360
    buffer_load_dwordx4 v[168:171], v3, s[20:23], s46 offen offset:0
    v_mul_f32 v12, v44, v44
    v_mul_f32 v13, v45, v45
    s_waitcnt vmcnt(27)
    v_mfma_f32_16x16x32_bf16 v[48:51], v[172:175], v[84:87], v[48:51]
    s_add_u32 s46, s47, 655360
    buffer_load_dwordx4 v[172:175], v3, s[20:23], s46 offen offset:1024
    v_mul_f32 v14, v46, v46
    v_mul_f32 v15, v47, v47
    s_waitcnt vmcnt(27)
    v_mfma_f32_16x16x32_bf16 v[48:51], v[176:179], v[88:91], v[48:51]
    s_add_u32 s46, s47, 655360
    buffer_load_dwordx4 v[176:179], v3, s[20:23], s46 offen offset:2048
    v_fma_f32 v12, v12, s49, v10
    v_fma_f32 v13, v13, s49, v10
    s_waitcnt vmcnt(27)
    v_mfma_f32_16x16x32_bf16 v[48:51], v[180:183], v[92:95], v[48:51]
    s_add_u32 s46, s47, 655360
    buffer_load_dwordx4 v[180:183], v3, s[20:23], s46 offen offset:3072
    v_fma_f32 v14, v14, s49, v10
    v_fma_f32 v15, v15, s49, v10
    s_waitcnt vmcnt(27)
    v_mfma_f32_16x16x32_bf16 v[48:51], v[184:187], v[96:99], v[48:51]
    s_add_u32 s46, s47, 659456
    buffer_load_dwordx4 v[184:187], v3, s[20:23], s46 offen offset:0
    v_mul_f32 v12, v12, v44
    v_mul_f32 v13, v13, v45
    s_waitcnt vmcnt(27)
    v_mfma_f32_16x16x32_bf16 v[48:51], v[188:191], v[100:103], v[48:51]
    s_add_u32 s46, s47, 659456
    buffer_load_dwordx4 v[188:191], v3, s[20:23], s46 offen offset:1024
    v_mul_f32 v14, v14, v46
    v_mul_f32 v15, v15, v47
    s_waitcnt vmcnt(27)
    v_mfma_f32_16x16x32_bf16 v[48:51], v[192:195], v[104:107], v[48:51]
    s_add_u32 s46, s47, 659456
    buffer_load_dwordx4 v[192:195], v3, s[20:23], s46 offen offset:2048
    v_exp_f32 v12, v12
    s_waitcnt vmcnt(27)
    v_mfma_f32_16x16x32_bf16 v[48:51], v[196:199], v[108:111], v[48:51]
    s_add_u32 s46, s47, 659456
    buffer_load_dwordx4 v[196:199], v3, s[20:23], s46 offen offset:3072
    v_exp_f32 v13, v13
    s_waitcnt vmcnt(27)
    v_mfma_f32_16x16x32_bf16 v[48:51], v[200:203], v[112:115], v[48:51]
    s_add_u32 s46, s47, 663552
    buffer_load_dwordx4 v[200:203], v3, s[20:23], s46 offen offset:0
    v_exp_f32 v14, v14
    s_waitcnt vmcnt(27)
    v_mfma_f32_16x16x32_bf16 v[48:51], v[204:207], v[116:119], v[48:51]
    s_add_u32 s46, s47, 663552
    buffer_load_dwordx4 v[204:207], v3, s[20:23], s46 offen offset:1024
    v_exp_f32 v15, v15
    s_waitcnt vmcnt(27)
    v_mfma_f32_16x16x32_bf16 v[48:51], v[208:211], v[120:123], v[48:51]
    s_add_u32 s46, s47, 663552
    buffer_load_dwordx4 v[208:211], v3, s[20:23], s46 offen offset:2048
    v_add_f32 v12, 1.0, v12
    v_add_f32 v13, 1.0, v13
    s_waitcnt vmcnt(27)
    v_mfma_f32_16x16x32_bf16 v[48:51], v[212:215], v[124:127], v[48:51]
    s_add_u32 s46, s47, 663552
    buffer_load_dwordx4 v[212:215], v3, s[20:23], s46 offen offset:3072
    v_add_f32 v14, 1.0, v14
    v_add_f32 v15, 1.0, v15
    v_mfma_f32_16x16x32_bf16 v[24:27], a[128:131], v[64:67], 0
    v_rcp_f32 v12, v12
    v_mfma_f32_16x16x32_bf16 v[24:27], a[132:135], v[68:71], v[24:27]
    v_rcp_f32 v13, v13
    v_mfma_f32_16x16x32_bf16 v[24:27], a[136:139], v[72:75], v[24:27]
    v_rcp_f32 v14, v14
    v_mfma_f32_16x16x32_bf16 v[24:27], a[140:143], v[76:79], v[24:27]
    v_rcp_f32 v15, v15
    v_mfma_f32_16x16x32_bf16 v[24:27], a[144:147], v[80:83], v[24:27]
    v_mul_f32 v44, v44, v12
    v_mul_f32 v45, v45, v13
    v_mfma_f32_16x16x32_bf16 v[24:27], a[148:151], v[84:87], v[24:27]
    v_mul_f32 v46, v46, v14
    v_mul_f32 v47, v47, v15
    v_mfma_f32_16x16x32_bf16 v[24:27], a[152:155], v[88:91], v[24:27]
    v_cvt_pk_bf16_f32 v8, v20, v21
    v_lshlrev_b32 v20, 16, v8
    v_mfma_f32_16x16x32_bf16 v[24:27], a[156:159], v[92:95], v[24:27]
    v_and_b32 v21, 0xffff0000, v8
    v_cvt_pk_bf16_f32 v9, v22, v23
    v_mfma_f32_16x16x32_bf16 v[24:27], a[160:163], v[96:99], v[24:27]
    v_lshlrev_b32 v22, 16, v9
    v_and_b32 v23, 0xffff0000, v9
    v_mfma_f32_16x16x32_bf16 v[24:27], a[164:167], v[100:103], v[24:27]
    v_mul_f32 v12, v20, v20
    v_mul_f32 v13, v21, v21
    v_mfma_f32_16x16x32_bf16 v[24:27], a[168:171], v[104:107], v[24:27]
    v_mul_f32 v14, v22, v22
    v_mul_f32 v15, v23, v23
    v_mfma_f32_16x16x32_bf16 v[24:27], a[172:175], v[108:111], v[24:27]
    v_fma_f32 v12, v12, s49, v10
    v_fma_f32 v13, v13, s49, v10
    v_mfma_f32_16x16x32_bf16 v[24:27], a[176:179], v[112:115], v[24:27]
    v_fma_f32 v14, v14, s49, v10
    v_fma_f32 v15, v15, s49, v10
    v_mfma_f32_16x16x32_bf16 v[24:27], a[180:183], v[116:119], v[24:27]
    v_mul_f32 v12, v12, v20
    v_mul_f32 v13, v13, v21
    v_mfma_f32_16x16x32_bf16 v[24:27], a[184:187], v[120:123], v[24:27]
    v_mul_f32 v14, v14, v22
    v_mul_f32 v15, v15, v23
    v_mfma_f32_16x16x32_bf16 v[24:27], a[188:191], v[124:127], v[24:27]
    v_exp_f32 v12, v12
    s_waitcnt vmcnt(27)
    v_mfma_f32_16x16x32_bf16 v[52:55], v[216:219], v[64:67], 0
    s_add_u32 s46, s47, 667648
    buffer_load_dwordx4 v[216:219], v3, s[20:23], s46 offen offset:0
    v_exp_f32 v13, v13
    s_waitcnt vmcnt(27)
    v_mfma_f32_16x16x32_bf16 v[52:55], v[220:223], v[68:71], v[52:55]
    s_add_u32 s46, s47, 667648
    buffer_load_dwordx4 v[220:223], v3, s[20:23], s46 offen offset:1024
    v_exp_f32 v14, v14
    s_waitcnt vmcnt(27)
    v_mfma_f32_16x16x32_bf16 v[52:55], v[224:227], v[72:75], v[52:55]
    s_add_u32 s46, s47, 667648
    buffer_load_dwordx4 v[224:227], v3, s[20:23], s46 offen offset:2048
    v_exp_f32 v15, v15
    s_waitcnt vmcnt(27)
    v_mfma_f32_16x16x32_bf16 v[52:55], v[228:231], v[76:79], v[52:55]
    s_add_u32 s46, s47, 667648
    buffer_load_dwordx4 v[228:231], v3, s[20:23], s46 offen offset:3072
    v_add_f32 v12, 1.0, v12
    v_add_f32 v13, 1.0, v13
    s_waitcnt vmcnt(27)
    v_mfma_f32_16x16x32_bf16 v[52:55], v[232:235], v[80:83], v[52:55]
    v_add_f32 v14, 1.0, v14
    v_add_f32 v15, 1.0, v15
    s_waitcnt vmcnt(26)
    v_mfma_f32_16x16x32_bf16 v[52:55], v[236:239], v[84:87], v[52:55]
    v_rcp_f32 v12, v12
    s_waitcnt vmcnt(25)
    v_mfma_f32_16x16x32_bf16 v[52:55], v[240:243], v[88:91], v[52:55]
    v_rcp_f32 v13, v13
    s_waitcnt vmcnt(24)
    v_mfma_f32_16x16x32_bf16 v[52:55], v[244:247], v[92:95], v[52:55]
    v_rcp_f32 v14, v14
    s_waitcnt vmcnt(23)
    v_mfma_f32_16x16x32_bf16 v[52:55], v[248:251], v[96:99], v[52:55]
    v_rcp_f32 v15, v15
    s_waitcnt vmcnt(22)
    v_mfma_f32_16x16x32_bf16 v[52:55], v[252:255], v[100:103], v[52:55]
    v_mul_f32 v20, v20, v12
    v_mul_f32 v21, v21, v13
    s_waitcnt vmcnt(21)
    v_mfma_f32_16x16x32_bf16 v[52:55], v[144:147], v[104:107], v[52:55]
    v_mul_f32 v22, v22, v14
    v_mul_f32 v23, v23, v15
    s_waitcnt vmcnt(20)
    v_mfma_f32_16x16x32_bf16 v[52:55], v[148:151], v[108:111], v[52:55]
    v_cvt_pk_bf16_f32 v8, v48, v49
    v_lshlrev_b32 v48, 16, v8
    s_waitcnt vmcnt(19)
    v_mfma_f32_16x16x32_bf16 v[52:55], v[152:155], v[112:115], v[52:55]
    v_and_b32 v49, 0xffff0000, v8
    v_cvt_pk_bf16_f32 v9, v50, v51
    s_waitcnt vmcnt(18)
    v_mfma_f32_16x16x32_bf16 v[52:55], v[156:159], v[116:119], v[52:55]
    v_lshlrev_b32 v50, 16, v9
    v_and_b32 v51, 0xffff0000, v9
    s_waitcnt vmcnt(17)
    v_mfma_f32_16x16x32_bf16 v[52:55], v[160:163], v[120:123], v[52:55]
    v_mul_f32 v12, v48, v48
    v_mul_f32 v13, v49, v49
    s_waitcnt vmcnt(16)
    v_mfma_f32_16x16x32_bf16 v[52:55], v[164:167], v[124:127], v[52:55]
    v_mul_f32 v14, v50, v50
    v_mul_f32 v15, v51, v51
    v_mfma_f32_16x16x32_bf16 v[28:31], a[192:195], v[64:67], 0
    v_fma_f32 v12, v12, s49, v10
    v_fma_f32 v13, v13, s49, v10
    v_mfma_f32_16x16x32_bf16 v[28:31], a[196:199], v[68:71], v[28:31]
    v_fma_f32 v14, v14, s49, v10
    v_fma_f32 v15, v15, s49, v10
    v_mfma_f32_16x16x32_bf16 v[28:31], a[200:203], v[72:75], v[28:31]
    v_mul_f32 v12, v12, v48
    v_mul_f32 v13, v13, v49
    v_mfma_f32_16x16x32_bf16 v[28:31], a[204:207], v[76:79], v[28:31]
    v_mul_f32 v14, v14, v50
    v_mul_f32 v15, v15, v51
    v_mfma_f32_16x16x32_bf16 v[28:31], a[208:211], v[80:83], v[28:31]
    v_exp_f32 v12, v12
    v_mfma_f32_16x16x32_bf16 v[28:31], a[212:215], v[84:87], v[28:31]
    v_exp_f32 v13, v13
    v_mfma_f32_16x16x32_bf16 v[28:31], a[216:219], v[88:91], v[28:31]
    v_exp_f32 v14, v14
    v_mfma_f32_16x16x32_bf16 v[28:31], a[220:223], v[92:95], v[28:31]
    v_exp_f32 v15, v15
    v_mfma_f32_16x16x32_bf16 v[28:31], a[224:227], v[96:99], v[28:31]
    v_add_f32 v12, 1.0, v12
    v_add_f32 v13, 1.0, v13
    v_mfma_f32_16x16x32_bf16 v[28:31], a[228:231], v[100:103], v[28:31]
    v_add_f32 v14, 1.0, v14
    v_add_f32 v15, 1.0, v15
    v_mfma_f32_16x16x32_bf16 v[28:31], a[232:235], v[104:107], v[28:31]
    v_rcp_f32 v12, v12
    v_mfma_f32_16x16x32_bf16 v[28:31], a[236:239], v[108:111], v[28:31]
    v_rcp_f32 v13, v13
    v_mfma_f32_16x16x32_bf16 v[28:31], a[240:243], v[112:115], v[28:31]
    v_rcp_f32 v14, v14
    v_mfma_f32_16x16x32_bf16 v[28:31], a[244:247], v[116:119], v[28:31]
    v_rcp_f32 v15, v15
    v_mfma_f32_16x16x32_bf16 v[28:31], a[248:251], v[120:123], v[28:31]
    v_mul_f32 v48, v48, v12
    v_mul_f32 v49, v49, v13
    v_mfma_f32_16x16x32_bf16 v[28:31], a[252:255], v[124:127], v[28:31]
    v_mul_f32 v50, v50, v14
    v_mul_f32 v51, v51, v15
    s_waitcnt vmcnt(15)
    v_mfma_f32_16x16x32_bf16 v[56:59], v[168:171], v[64:67], 0
    v_cvt_pk_bf16_f32 v8, v24, v25
    v_lshlrev_b32 v24, 16, v8
    s_waitcnt vmcnt(14)
    v_mfma_f32_16x16x32_bf16 v[56:59], v[172:175], v[68:71], v[56:59]
    v_and_b32 v25, 0xffff0000, v8
    v_cvt_pk_bf16_f32 v9, v26, v27
    s_waitcnt vmcnt(13)
    v_mfma_f32_16x16x32_bf16 v[56:59], v[176:179], v[72:75], v[56:59]
    v_lshlrev_b32 v26, 16, v9
    v_and_b32 v27, 0xffff0000, v9
    s_waitcnt vmcnt(12)
    v_mfma_f32_16x16x32_bf16 v[56:59], v[180:183], v[76:79], v[56:59]
    v_mul_f32 v12, v24, v24
    v_mul_f32 v13, v25, v25
    s_waitcnt vmcnt(11)
    v_mfma_f32_16x16x32_bf16 v[56:59], v[184:187], v[80:83], v[56:59]
    v_mul_f32 v14, v26, v26
    v_mul_f32 v15, v27, v27
    s_waitcnt vmcnt(10)
    v_mfma_f32_16x16x32_bf16 v[56:59], v[188:191], v[84:87], v[56:59]
    v_fma_f32 v12, v12, s49, v10
    v_fma_f32 v13, v13, s49, v10
    s_waitcnt vmcnt(9)
    v_mfma_f32_16x16x32_bf16 v[56:59], v[192:195], v[88:91], v[56:59]
    v_fma_f32 v14, v14, s49, v10
    v_fma_f32 v15, v15, s49, v10
    s_waitcnt vmcnt(8)
    v_mfma_f32_16x16x32_bf16 v[56:59], v[196:199], v[92:95], v[56:59]
    v_mul_f32 v12, v12, v24
    v_mul_f32 v13, v13, v25
    s_waitcnt vmcnt(7)
    v_mfma_f32_16x16x32_bf16 v[56:59], v[200:203], v[96:99], v[56:59]
    v_mul_f32 v14, v14, v26
    v_mul_f32 v15, v15, v27
    s_waitcnt vmcnt(6)
    v_mfma_f32_16x16x32_bf16 v[56:59], v[204:207], v[100:103], v[56:59]
    v_exp_f32 v12, v12
    s_waitcnt vmcnt(5)
    v_mfma_f32_16x16x32_bf16 v[56:59], v[208:211], v[104:107], v[56:59]
    v_exp_f32 v13, v13
    s_waitcnt vmcnt(4)
    v_mfma_f32_16x16x32_bf16 v[56:59], v[212:215], v[108:111], v[56:59]
    v_exp_f32 v14, v14
    s_waitcnt vmcnt(3)
    v_mfma_f32_16x16x32_bf16 v[56:59], v[216:219], v[112:115], v[56:59]
    v_exp_f32 v15, v15
    s_waitcnt vmcnt(2)
    v_mfma_f32_16x16x32_bf16 v[56:59], v[220:223], v[116:119], v[56:59]
    v_add_f32 v12, 1.0, v12
    v_add_f32 v13, 1.0, v13
    s_waitcnt vmcnt(1)
    v_mfma_f32_16x16x32_bf16 v[56:59], v[224:227], v[120:123], v[56:59]
    v_add_f32 v14, 1.0, v14
    v_add_f32 v15, 1.0, v15
    s_waitcnt vmcnt(0)
    v_mfma_f32_16x16x32_bf16 v[56:59], v[228:231], v[124:127], v[56:59]
    v_rcp_f32 v12, v12
    s_waitcnt lgkmcnt(2)
    v_mfma_f32_16x16x32_bf16 v[32:35], v[136:139], v[64:67], 0
    ds_read_b128 v[132:135], v60 offset:3072
    v_rcp_f32 v13, v13
    s_waitcnt lgkmcnt(2)
    v_mfma_f32_16x16x32_bf16 v[32:35], v[140:143], v[68:71], v[32:35]
    ds_read_b128 v[136:139], v60 offset:4096
    v_rcp_f32 v14, v14
    s_waitcnt lgkmcnt(2)
    v_mfma_f32_16x16x32_bf16 v[32:35], v[128:131], v[72:75], v[32:35]
    ds_read_b128 v[140:143], v60 offset:5120
    v_rcp_f32 v15, v15
    s_waitcnt lgkmcnt(2)
    v_mfma_f32_16x16x32_bf16 v[32:35], v[132:135], v[76:79], v[32:35]
    ds_read_b128 v[128:131], v60 offset:6144
    v_mul_f32 v24, v24, v12
    v_mul_f32 v25, v25, v13
    s_waitcnt lgkmcnt(2)
    v_mfma_f32_16x16x32_bf16 v[32:35], v[136:139], v[80:83], v[32:35]
    ds_read_b128 v[132:135], v60 offset:7168
    v_mul_f32 v26, v26, v14
    v_mul_f32 v27, v27, v15
    s_waitcnt lgkmcnt(2)
    v_mfma_f32_16x16x32_bf16 v[32:35], v[140:143], v[84:87], v[32:35]
    ds_read_b128 v[136:139], v60 offset:8192
    v_cvt_pk_bf16_f32 v8, v52, v53
    v_lshlrev_b32 v52, 16, v8
    s_waitcnt lgkmcnt(2)
    v_mfma_f32_16x16x32_bf16 v[32:35], v[128:131], v[88:91], v[32:35]
    ds_read_b128 v[140:143], v60 offset:9216
    v_and_b32 v53, 0xffff0000, v8
    v_cvt_pk_bf16_f32 v9, v54, v55
    s_waitcnt lgkmcnt(2)
    v_mfma_f32_16x16x32_bf16 v[32:35], v[132:135], v[92:95], v[32:35]
    ds_read_b128 v[128:131], v60 offset:10240
    v_lshlrev_b32 v54, 16, v9
    v_and_b32 v55, 0xffff0000, v9
    s_waitcnt lgkmcnt(2)
    v_mfma_f32_16x16x32_bf16 v[32:35], v[136:139], v[96:99], v[32:35]
    ds_read_b128 v[132:135], v60 offset:11264
    v_mul_f32 v12, v52, v52
    v_mul_f32 v13, v53, v53
    s_waitcnt lgkmcnt(2)
    v_mfma_f32_16x16x32_bf16 v[32:35], v[140:143], v[100:103], v[32:35]
    ds_read_b128 v[136:139], v60 offset:12288
    v_mul_f32 v14, v54, v54
    v_mul_f32 v15, v55, v55
    s_waitcnt lgkmcnt(2)
    v_mfma_f32_16x16x32_bf16 v[32:35], v[128:131], v[104:107], v[32:35]
    ds_read_b128 v[140:143], v60 offset:13312
    v_fma_f32 v12, v12, s49, v10
    v_fma_f32 v13, v13, s49, v10
    s_waitcnt lgkmcnt(2)
    v_mfma_f32_16x16x32_bf16 v[32:35], v[132:135], v[108:111], v[32:35]
    ds_read_b128 v[128:131], v60 offset:14336
    v_fma_f32 v14, v14, s49, v10
    v_fma_f32 v15, v15, s49, v10
    s_waitcnt lgkmcnt(2)
    v_mfma_f32_16x16x32_bf16 v[32:35], v[136:139], v[112:115], v[32:35]
    ds_read_b128 v[132:135], v60 offset:15360
    v_mul_f32 v12, v12, v52
    v_mul_f32 v13, v13, v53
    s_waitcnt lgkmcnt(2)
    v_mfma_f32_16x16x32_bf16 v[32:35], v[140:143], v[116:119], v[32:35]
    ds_read_b128 v[136:139], v60 offset:16384
    v_mul_f32 v14, v14, v54
    v_mul_f32 v15, v15, v55
    s_waitcnt lgkmcnt(2)
    v_mfma_f32_16x16x32_bf16 v[32:35], v[128:131], v[120:123], v[32:35]
    ds_read_b128 v[140:143], v60 offset:17408
    v_exp_f32 v12, v12
    s_waitcnt lgkmcnt(2)
    v_mfma_f32_16x16x32_bf16 v[32:35], v[132:135], v[124:127], v[32:35]
    ds_read_b128 v[128:131], v60 offset:18432
    v_exp_f32 v13, v13
    s_waitcnt lgkmcnt(2)
    v_mfma_f32_16x16x32_bf16 v[36:39], v[136:139], v[64:67], 0
    ds_read_b128 v[132:135], v60 offset:19456
    v_exp_f32 v14, v14
    s_waitcnt lgkmcnt(2)
    v_mfma_f32_16x16x32_bf16 v[36:39], v[140:143], v[68:71], v[36:39]
    ds_read_b128 v[136:139], v60 offset:20480
    v_exp_f32 v15, v15
    s_waitcnt lgkmcnt(2)
    v_mfma_f32_16x16x32_bf16 v[36:39], v[128:131], v[72:75], v[36:39]
    ds_read_b128 v[140:143], v60 offset:21504
    v_add_f32 v12, 1.0, v12
    v_add_f32 v13, 1.0, v13
    s_waitcnt lgkmcnt(2)
    v_mfma_f32_16x16x32_bf16 v[36:39], v[132:135], v[76:79], v[36:39]
    ds_read_b128 v[128:131], v60 offset:22528
    v_add_f32 v14, 1.0, v14
    v_add_f32 v15, 1.0, v15
    s_waitcnt lgkmcnt(2)
    v_mfma_f32_16x16x32_bf16 v[36:39], v[136:139], v[80:83], v[36:39]
    ds_read_b128 v[132:135], v60 offset:23552
    v_rcp_f32 v12, v12
    s_waitcnt lgkmcnt(2)
    v_mfma_f32_16x16x32_bf16 v[36:39], v[140:143], v[84:87], v[36:39]
    ds_read_b128 v[136:139], v60 offset:24576
    v_rcp_f32 v13, v13
    s_waitcnt lgkmcnt(2)
    v_mfma_f32_16x16x32_bf16 v[36:39], v[128:131], v[88:91], v[36:39]
    ds_read_b128 v[140:143], v60 offset:25600
    v_rcp_f32 v14, v14
    s_waitcnt lgkmcnt(2)
    v_mfma_f32_16x16x32_bf16 v[36:39], v[132:135], v[92:95], v[36:39]
    ds_read_b128 v[128:131], v60 offset:26624
    v_rcp_f32 v15, v15
    s_waitcnt lgkmcnt(2)
    v_mfma_f32_16x16x32_bf16 v[36:39], v[136:139], v[96:99], v[36:39]
    ds_read_b128 v[132:135], v60 offset:27648
    v_mul_f32 v52, v52, v12
    v_mul_f32 v53, v53, v13
    s_waitcnt lgkmcnt(2)
    v_mfma_f32_16x16x32_bf16 v[36:39], v[140:143], v[100:103], v[36:39]
    ds_read_b128 v[136:139], v60 offset:28672
    v_mul_f32 v54, v54, v14
    v_mul_f32 v55, v55, v15
    s_waitcnt lgkmcnt(2)
    v_mfma_f32_16x16x32_bf16 v[36:39], v[128:131], v[104:107], v[36:39]
    ds_read_b128 v[140:143], v60 offset:29696
    v_cvt_pk_bf16_f32 v8, v28, v29
    v_lshlrev_b32 v28, 16, v8
    s_waitcnt lgkmcnt(2)
    v_mfma_f32_16x16x32_bf16 v[36:39], v[132:135], v[108:111], v[36:39]
    ds_read_b128 v[128:131], v60 offset:30720
    v_and_b32 v29, 0xffff0000, v8
    v_cvt_pk_bf16_f32 v9, v30, v31
    s_waitcnt lgkmcnt(2)
    v_mfma_f32_16x16x32_bf16 v[36:39], v[136:139], v[112:115], v[36:39]
    ds_read_b128 v[132:135], v60 offset:31744
    v_lshlrev_b32 v30, 16, v9
    v_and_b32 v31, 0xffff0000, v9
    s_waitcnt lgkmcnt(2)
    v_mfma_f32_16x16x32_bf16 v[36:39], v[140:143], v[116:119], v[36:39]
    v_mul_f32 v12, v28, v28
    v_mul_f32 v13, v29, v29
    s_waitcnt lgkmcnt(1)
    v_mfma_f32_16x16x32_bf16 v[36:39], v[128:131], v[120:123], v[36:39]
    v_mul_f32 v14, v30, v30
    v_mul_f32 v15, v31, v31
    s_waitcnt lgkmcnt(0)
    v_mfma_f32_16x16x32_bf16 v[36:39], v[132:135], v[124:127], v[36:39]
    v_fma_f32 v12, v12, s49, v10
    v_fma_f32 v13, v13, s49, v10
    s_nop 7
    v_fma_f32 v14, v14, s49, v10
    v_fma_f32 v15, v15, s49, v10
    v_mul_f32 v12, v12, v28
    v_mul_f32 v13, v13, v29
    v_mul_f32 v14, v14, v30
    v_mul_f32 v15, v15, v31
    v_exp_f32 v12, v12
    v_exp_f32 v13, v13
    v_exp_f32 v14, v14
    v_exp_f32 v15, v15
    v_add_f32 v12, 1.0, v12
    v_add_f32 v13, 1.0, v13
    v_add_f32 v14, 1.0, v14
    v_add_f32 v15, 1.0, v15
    v_rcp_f32 v12, v12
    v_rcp_f32 v13, v13
    v_rcp_f32 v14, v14
    v_rcp_f32 v15, v15
    v_mul_f32 v28, v28, v12
    v_mul_f32 v29, v29, v13
    v_mul_f32 v30, v30, v14
    v_mul_f32 v31, v31, v15
    v_cvt_pk_bf16_f32 v8, v56, v57
    v_lshlrev_b32 v56, 16, v8
    v_and_b32 v57, 0xffff0000, v8
    v_cvt_pk_bf16_f32 v9, v58, v59
    v_lshlrev_b32 v58, 16, v9
    v_and_b32 v59, 0xffff0000, v9
    v_mul_f32 v12, v56, v56
    v_mul_f32 v13, v57, v57
    v_mul_f32 v14, v58, v58
    v_mul_f32 v15, v59, v59
    v_fma_f32 v12, v12, s49, v10
    v_fma_f32 v13, v13, s49, v10
    v_fma_f32 v14, v14, s49, v10
    v_fma_f32 v15, v15, s49, v10
    v_mul_f32 v12, v12, v56
    v_mul_f32 v13, v13, v57
    v_mul_f32 v14, v14, v58
    v_mul_f32 v15, v15, v59
    v_exp_f32 v12, v12
    v_exp_f32 v13, v13
    v_exp_f32 v14, v14
    v_exp_f32 v15, v15
    v_add_f32 v12, 1.0, v12
    v_add_f32 v13, 1.0, v13
    v_add_f32 v14, 1.0, v14
    v_add_f32 v15, 1.0, v15
    v_rcp_f32 v12, v12
    v_rcp_f32 v13, v13
    v_rcp_f32 v14, v14
    v_rcp_f32 v15, v15
    v_mul_f32 v56, v56, v12
    v_mul_f32 v57, v57, v13
    v_mul_f32 v58, v58, v14
    v_mul_f32 v59, v59, v15
    v_cvt_pk_bf16_f32 v8, v32, v33
    v_lshlrev_b32 v32, 16, v8
    v_and_b32 v33, 0xffff0000, v8
    v_cvt_pk_bf16_f32 v9, v34, v35
    v_lshlrev_b32 v34, 16, v9
    v_and_b32 v35, 0xffff0000, v9
    v_mul_f32 v12, v32, v32
    v_mul_f32 v13, v33, v33
    v_mul_f32 v14, v34, v34
    v_mul_f32 v15, v35, v35
    v_fma_f32 v12, v12, s49, v10
    v_fma_f32 v13, v13, s49, v10
    v_fma_f32 v14, v14, s49, v10
    v_fma_f32 v15, v15, s49, v10
    v_mul_f32 v12, v12, v32
    v_mul_f32 v13, v13, v33
    v_mul_f32 v14, v14, v34
    v_mul_f32 v15, v15, v35
    v_exp_f32 v12, v12
    v_exp_f32 v13, v13
    v_exp_f32 v14, v14
    v_exp_f32 v15, v15
    v_add_f32 v12, 1.0, v12
    v_add_f32 v13, 1.0, v13
    v_add_f32 v14, 1.0, v14
    v_add_f32 v15, 1.0, v15
    v_rcp_f32 v12, v12
    v_rcp_f32 v13, v13
    v_rcp_f32 v14, v14
    v_rcp_f32 v15, v15
    v_mul_f32 v32, v32, v12
    v_mul_f32 v33, v33, v13
    v_mul_f32 v34, v34, v14
    v_mul_f32 v35, v35, v15
    v_cvt_pk_bf16_f32 v8, v36, v37
    v_lshlrev_b32 v36, 16, v8
    v_and_b32 v37, 0xffff0000, v8
    v_cvt_pk_bf16_f32 v9, v38, v39
    v_lshlrev_b32 v38, 16, v9
    v_and_b32 v39, 0xffff0000, v9
    v_mul_f32 v12, v36, v36
    v_mul_f32 v13, v37, v37
    v_mul_f32 v14, v38, v38
    v_mul_f32 v15, v39, v39
    v_fma_f32 v12, v12, s49, v10
    v_fma_f32 v13, v13, s49, v10
    v_fma_f32 v14, v14, s49, v10
    v_fma_f32 v15, v15, s49, v10
    v_mul_f32 v12, v12, v36
    v_mul_f32 v13, v13, v37
    v_mul_f32 v14, v14, v38
    v_mul_f32 v15, v15, v39
    v_exp_f32 v12, v12
    v_exp_f32 v13, v13
    v_exp_f32 v14, v14
    v_exp_f32 v15, v15
    v_add_f32 v12, 1.0, v12
    v_add_f32 v13, 1.0, v13
    v_add_f32 v14, 1.0, v14
    v_add_f32 v15, 1.0, v15
    v_rcp_f32 v12, v12
    v_rcp_f32 v13, v13
    v_rcp_f32 v14, v14
    v_rcp_f32 v15, v15
    v_mul_f32 v36, v36, v12
    v_mul_f32 v37, v37, v13
    v_mul_f32 v38, v38, v14
    v_mul_f32 v39, v39, v15
    s_lshr_b32 s44, s32, 1
    s_mul_i32 s44, s44, 45056
    s_and_b32 s45, s32, 1
    s_lshl_b32 s45, s45, 8
    s_add_u32 s44, s44, s45
    s_lshl_b32 s45, s3, 10
    s_add_u32 s44, s44, s45
    v_and_b32 v8, 1, v7
    v_lshlrev_b32 v8, 9, v8
    v_lshl_add_u32 v8, v6, 4, v8
    v_lshrrev_b32 v9, 1, v7
    v_lshl_add_u32 v8, v9, 3, v8
    v_cvt_pk_bf16_f32 v16, v16, v17
    v_cvt_pk_bf16_f32 v17, v18, v19
    buffer_store_dwordx2 v[16:17], v8, s[24:27], s44 offen sc1
    s_add_u32 s44, s44, 4096
    v_cvt_pk_bf16_f32 v20, v20, v21
    v_cvt_pk_bf16_f32 v21, v22, v23
    buffer_store_dwordx2 v[20:21], v8, s[24:27], s44 offen sc1
    s_add_u32 s44, s44, 4096
    v_cvt_pk_bf16_f32 v24, v24, v25
    v_cvt_pk_bf16_f32 v25, v26, v27
    buffer_store_dwordx2 v[24:25], v8, s[24:27], s44 offen sc1
    s_add_u32 s44, s44, 4096
    v_cvt_pk_bf16_f32 v28, v28, v29
    v_cvt_pk_bf16_f32 v29, v30, v31
    buffer_store_dwordx2 v[28:29], v8, s[24:27], s44 offen sc1
    s_add_u32 s44, s44, 4096
    v_cvt_pk_bf16_f32 v32, v32, v33
    v_cvt_pk_bf16_f32 v33, v34, v35
    buffer_store_dwordx2 v[32:33], v8, s[24:27], s44 offen sc1
    s_add_u32 s44, s44, 4096
    v_cvt_pk_bf16_f32 v36, v36, v37
    v_cvt_pk_bf16_f32 v37, v38, v39
    buffer_store_dwordx2 v[36:37], v8, s[24:27], s44 offen sc1
    s_add_u32 s44, s44, 4096
    v_cvt_pk_bf16_f32 v40, v40, v41
    v_cvt_pk_bf16_f32 v41, v42, v43
    buffer_store_dwordx2 v[40:41], v8, s[24:27], s44 offen sc1
    s_add_u32 s44, s44, 4096
    v_cvt_pk_bf16_f32 v44, v44, v45
    v_cvt_pk_bf16_f32 v45, v46, v47
    buffer_store_dwordx2 v[44:45], v8, s[24:27], s44 offen sc1
    s_add_u32 s44, s44, 4096
    v_cvt_pk_bf16_f32 v48, v48, v49
    v_cvt_pk_bf16_f32 v49, v50, v51
    buffer_store_dwordx2 v[48:49], v8, s[24:27], s44 offen sc1
    s_add_u32 s44, s44, 4096
    v_cvt_pk_bf16_f32 v52, v52, v53
    v_cvt_pk_bf16_f32 v53, v54, v55
    buffer_store_dwordx2 v[52:53], v8, s[24:27], s44 offen sc1
    s_add_u32 s44, s44, 4096
    v_cvt_pk_bf16_f32 v56, v56, v57
    v_cvt_pk_bf16_f32 v57, v58, v59
    buffer_store_dwordx2 v[56:57], v8, s[24:27], s44 offen sc1
    s_add_u32 s44, s44, 4096
    s_branch wi_next
win_z2:
    ds_read_b128 v[128:131], v60 offset:32768
    ds_read_b128 v[132:135], v60 offset:33792
    ds_read_b128 v[136:139], v60 offset:0
    v_mov_b32 v10, s48
    s_waitcnt lgkmcnt(2)
    v_mfma_f32_16x16x32_bf16 v[40:43], v[64:67], v[128:131], 0
    ds_read_b128 v[140:143], v60 offset:1024
    s_waitcnt lgkmcnt(2)
    v_mfma_f32_16x16x32_bf16 v[40:43], v[68:71], v[132:135], v[40:43]
    ds_read_b128 v[128:131], v60 offset:2048
    v_mfma_f32_16x16x32_bf16 v[40:43], v[72:75], v[144:147], v[40:43]
    s_add_u32 s46, s47, 471040
    buffer_load_dwordx4 v[144:147], v3, s[20:23], s46 offen offset:2048
    v_mfma_f32_16x16x32_bf16 v[40:43], v[76:79], v[148:151], v[40:43]
    s_add_u32 s46, s47, 471040
    buffer_load_dwordx4 v[148:151], v3, s[20:23], s46 offen offset:3072
    v_mfma_f32_16x16x32_bf16 v[40:43], v[80:83], v[152:155], v[40:43]
    s_add_u32 s46, s47, 524288
    buffer_load_dwordx4 v[152:155], v3, s[20:23], s46 offen offset:0
    v_mfma_f32_16x16x32_bf16 v[40:43], v[84:87], v[156:159], v[40:43]
    s_add_u32 s46, s47, 524288
    buffer_load_dwordx4 v[156:159], v3, s[20:23], s46 offen offset:1024
    v_mfma_f32_16x16x32_bf16 v[40:43], v[88:91], v[160:163], v[40:43]
    s_add_u32 s46, s47, 524288
    buffer_load_dwordx4 v[160:163], v3, s[20:23], s46 offen offset:2048
    v_mfma_f32_16x16x32_bf16 v[40:43], v[92:95], v[164:167], v[40:43]
    s_add_u32 s46, s47, 524288
    buffer_load_dwordx4 v[164:167], v3, s[20:23], s46 offen offset:3072
    v_mfma_f32_16x16x32_bf16 v[40:43], v[96:99], v[168:171], v[40:43]
    s_add_u32 s46, s47, 528384
    buffer_load_dwordx4 v[168:171], v3, s[20:23], s46 offen offset:0
    v_mfma_f32_16x16x32_bf16 v[40:43], v[100:103], v[172:175], v[40:43]
    s_add_u32 s46, s47, 528384
    buffer_load_dwordx4 v[172:175], v3, s[20:23], s46 offen offset:1024
    v_mfma_f32_16x16x32_bf16 v[40:43], v[104:107], v[176:179], v[40:43]
    s_add_u32 s46, s47, 528384
    buffer_load_dwordx4 v[176:179], v3, s[20:23], s46 offen offset:2048
    v_mfma_f32_16x16x32_bf16 v[40:43], v[108:111], v[180:183], v[40:43]
    s_add_u32 s46, s47, 528384
    buffer_load_dwordx4 v[180:183], v3, s[20:23], s46 offen offset:3072
    v_mfma_f32_16x16x32_bf16 v[40:43], v[112:115], v[184:187], v[40:43]
    s_add_u32 s46, s47, 532480
    buffer_load_dwordx4 v[184:187], v3, s[20:23], s46 offen offset:0
    v_mfma_f32_16x16x32_bf16 v[40:43], v[116:119], v[188:191], v[40:43]
    s_add_u32 s46, s47, 532480
    buffer_load_dwordx4 v[188:191], v3, s[20:23], s46 offen offset:1024
    v_mfma_f32_16x16x32_bf16 v[40:43], v[120:123], v[192:195], v[40:43]
    s_add_u32 s46, s47, 532480
    buffer_load_dwordx4 v[192:195], v3, s[20:23], s46 offen offset:2048
    v_mfma_f32_16x16x32_bf16 v[40:43], v[124:127], v[196:199], v[40:43]
    s_add_u32 s46, s47, 532480
    buffer_load_dwordx4 v[196:199], v3, s[20:23], s46 offen offset:3072
    v_mfma_f32_16x16x32_bf16 v[16:19], v[64:67], a[0:3], 0
    v_mfma_f32_16x16x32_bf16 v[16:19], v[68:71], a[4:7], v[16:19]
    v_mfma_f32_16x16x32_bf16 v[16:19], v[72:75], a[8:11], v[16:19]
    v_mfma_f32_16x16x32_bf16 v[16:19], v[76:79], a[12:15], v[16:19]
    v_mfma_f32_16x16x32_bf16 v[16:19], v[80:83], a[16:19], v[16:19]
    v_mfma_f32_16x16x32_bf16 v[16:19], v[84:87], a[20:23], v[16:19]
    v_mfma_f32_16x16x32_bf16 v[16:19], v[88:91], a[24:27], v[16:19]
    v_mfma_f32_16x16x32_bf16 v[16:19], v[92:95], a[28:31], v[16:19]
    v_cvt_pk_bf16_f32 v8, v40, v41
    v_lshlrev_b32 v40, 16, v8
    v_mfma_f32_16x16x32_bf16 v[16:19], v[96:99], a[32:35], v[16:19]
    v_and_b32 v41, 0xffff0000, v8
    v_cvt_pk_bf16_f32 v9, v42, v43
    v_mfma_f32_16x16x32_bf16 v[16:19], v[100:103], a[36:39], v[16:19]
    v_lshlrev_b32 v42, 16, v9
    v_and_b32 v43, 0xffff0000, v9
    v_mfma_f32_16x16x32_bf16 v[16:19], v[104:107], a[40:43], v[16:19]
    v_mul_f32 v12, v40, v40
    v_mul_f32 v13, v41, v41
    v_mfma_f32_16x16x32_bf16 v[16:19], v[108:111], a[44:47], v[16:19]
    v_mul_f32 v14, v42, v42
    v_mul_f32 v15, v43, v43
    v_mfma_f32_16x16x32_bf16 v[16:19], v[112:115], a[48:51], v[16:19]
    v_fma_f32 v12, v12, s49, v10
    v_fma_f32 v13, v13, s49, v10
    v_mfma_f32_16x16x32_bf16 v[16:19], v[116:119], a[52:55], v[16:19]
    v_fma_f32 v14, v14, s49, v10
    v_fma_f32 v15, v15, s49, v10
    v_mfma_f32_16x16x32_bf16 v[16:19], v[120:123], a[56:59], v[16:19]
    v_mul_f32 v12, v12, v40
    v_mul_f32 v13, v13, v41
    v_mfma_f32_16x16x32_bf16 v[16:19], v[124:127], a[60:63], v[16:19]
    v_mul_f32 v14, v14, v42
    v_mul_f32 v15, v15, v43
    v_mfma_f32_16x16x32_bf16 v[44:47], v[64:67], v[200:203], 0
    s_add_u32 s46, s47, 536576
    buffer_load_dwordx4 v[200:203], v3, s[20:23], s46 offen offset:0
    v_exp_f32 v12, v12
    v_mfma_f32_16x16x32_bf16 v[44:47], v[68:71], v[204:207], v[44:47]
    s_add_u32 s46, s47, 536576
    buffer_load_dwordx4 v[204:207], v3, s[20:23], s46 offen offset:1024
    v_exp_f32 v13, v13
    v_mfma_f32_16x16x32_bf16 v[44:47], v[72:75], v[208:211], v[44:47]
    s_add_u32 s46, s47, 536576
    buffer_load_dwordx4 v[208:211], v3, s[20:23], s46 offen offset:2048
    v_exp_f32 v14, v14
    v_mfma_f32_16x16x32_bf16 v[44:47], v[76:79], v[212:215], v[44:47]
    s_add_u32 s46, s47, 536576
    buffer_load_dwordx4 v[212:215], v3, s[20:23], s46 offen offset:3072
    v_exp_f32 v15, v15
    v_mfma_f32_16x16x32_bf16 v[44:47], v[80:83], v[216:219], v[44:47]
    s_add_u32 s46, s47, 589824
    buffer_load_dwordx4 v[216:219], v3, s[20:23], s46 offen offset:0
    v_add_f32 v12, 1.0, v12
    v_add_f32 v13, 1.0, v13
    v_mfma_f32_16x16x32_bf16 v[44:47], v[84:87], v[220:223], v[44:47]
    s_add_u32 s46, s47, 589824
    buffer_load_dwordx4 v[220:223], v3, s[20:23], s46 offen offset:1024
    v_add_f32 v14, 1.0, v14
    v_add_f32 v15, 1.0, v15
    v_mfma_f32_16x16x32_bf16 v[44:47], v[88:91], v[224:227], v[44:47]
    s_add_u32 s46, s47, 589824
    buffer_load_dwordx4 v[224:227], v3, s[20:23], s46 offen offset:2048
    v_rcp_f32 v12, v12
    v_mfma_f32_16x16x32_bf16 v[44:47], v[92:95], v[228:231], v[44:47]
    s_add_u32 s46, s47, 589824
    buffer_load_dwordx4 v[228:231], v3, s[20:23], s46 offen offset:3072
    v_rcp_f32 v13, v13
    v_mfma_f32_16x16x32_bf16 v[44:47], v[96:99], v[232:235], v[44:47]
    s_add_u32 s46, s47, 593920
    buffer_load_dwordx4 v[232:235], v3, s[20:23], s46 offen offset:0
    v_rcp_f32 v14, v14
    v_mfma_f32_16x16x32_bf16 v[44:47], v[100:103], v[236:239], v[44:47]
    s_add_u32 s46, s47, 593920
    buffer_load_dwordx4 v[236:239], v3, s[20:23], s46 offen offset:1024
    v_rcp_f32 v15, v15
    v_mfma_f32_16x16x32_bf16 v[44:47], v[104:107], v[240:243], v[44:47]
    s_add_u32 s46, s47, 593920
    buffer_load_dwordx4 v[240:243], v3, s[20:23], s46 offen offset:2048
    v_mul_f32 v40, v40, v12
    v_mul_f32 v41, v41, v13
    v_mfma_f32_16x16x32_bf16 v[44:47], v[108:111], v[244:247], v[44:47]
    s_add_u32 s46, s47, 593920
    buffer_load_dwordx4 v[244:247], v3, s[20:23], s46 offen offset:3072
    v_mul_f32 v42, v42, v14
    v_mul_f32 v43, v43, v15
    v_mfma_f32_16x16x32_bf16 v[44:47], v[112:115], v[248:251], v[44:47]
    s_add_u32 s46, s47, 598016
    buffer_load_dwordx4 v[248:251], v3, s[20:23], s46 offen offset:0
    v_cvt_pk_bf16_f32 v8, v16, v17
    v_lshlrev_b32 v16, 16, v8
    v_mfma_f32_16x16x32_bf16 v[44:47], v[116:119], v[252:255], v[44:47]
    s_add_u32 s46, s47, 598016
    buffer_load_dwordx4 v[252:255], v3, s[20:23], s46 offen offset:1024
    v_and_b32 v17, 0xffff0000, v8
    v_cvt_pk_bf16_f32 v9, v18, v19
    s_waitcnt vmcnt(27)
    v_mfma_f32_16x16x32_bf16 v[44:47], v[120:123], v[144:147], v[44:47]
    s_add_u32 s46, s47, 598016
    buffer_load_dwordx4 v[144:147], v3, s[20:23], s46 offen offset:2048
    v_lshlrev_b32 v18, 16, v9
    v_and_b32 v19, 0xffff0000, v9
    s_waitcnt vmcnt(27)
    v_mfma_f32_16x16x32_bf16 v[44:47], v[124:127], v[148:151], v[44:47]
    s_add_u32 s46, s47, 598016
    buffer_load_dwordx4 v[148:151], v3, s[20:23], s46 offen offset:3072
    v_mul_f32 v12, v16, v16
    v_mul_f32 v13, v17, v17
    v_mfma_f32_16x16x32_bf16 v[20:23], v[64:67], a[64:67], 0
    v_mul_f32 v14, v18, v18
    v_mul_f32 v15, v19, v19
    v_mfma_f32_16x16x32_bf16 v[20:23], v[68:71], a[68:71], v[20:23]
    v_fma_f32 v12, v12, s49, v10
    v_fma_f32 v13, v13, s49, v10
    v_mfma_f32_16x16x32_bf16 v[20:23], v[72:75], a[72:75], v[20:23]
    v_fma_f32 v14, v14, s49, v10
    v_fma_f32 v15, v15, s49, v10
    v_mfma_f32_16x16x32_bf16 v[20:23], v[76:79], a[76:79], v[20:23]
    v_mul_f32 v12, v12, v16
    v_mul_f32 v13, v13, v17
    v_mfma_f32_16x16x32_bf16 v[20:23], v[80:83], a[80:83], v[20:23]
    v_mul_f32 v14, v14, v18
    v_mul_f32 v15, v15, v19
    v_mfma_f32_16x16x32_bf16 v[20:23], v[84:87], a[84:87], v[20:23]
    v_exp_f32 v12, v12
    v_mfma_f32_16x16x32_bf16 v[20:23], v[88:91], a[88:91], v[20:23]
    v_exp_f32 v13, v13
    v_mfma_f32_16x16x32_bf16 v[20:23], v[92:95], a[92:95], v[20:23]
    v_exp_f32 v14, v14
    v_mfma_f32_16x16x32_bf16 v[20:23], v[96:99], a[96:99], v[20:23]
    v_exp_f32 v15, v15
    v_mfma_f32_16x16x32_bf16 v[20:23], v[100:103], a[100:103], v[20:23]
    v_add_f32 v12, 1.0, v12
    v_add_f32 v13, 1.0, v13
    v_mfma_f32_16x16x32_bf16 v[20:23], v[104:107], a[104:107], v[20:23]
    v_add_f32 v14, 1.0, v14
    v_add_f32 v15, 1.0, v15
    v_mfma_f32_16x16x32_bf16 v[20:23], v[108:111], a[108:111], v[20:23]
    v_rcp_f32 v12, v12
    v_mfma_f32_16x16x32_bf16 v[20:23], v[112:115], a[112:115], v[20:23]
    v_rcp_f32 v13, v13
    v_mfma_f32_16x16x32_bf16 v[20:23], v[116:119], a[116:119], v[20:23]
    v_rcp_f32 v14, v14
    v_mfma_f32_16x16x32_bf16 v[20:23], v[120:123], a[120:123], v[20:23]
    v_rcp_f32 v15, v15
    v_mfma_f32_16x16x32_bf16 v[20:23], v[124:127], a[124:127], v[20:23]
    v_mul_f32 v16, v16, v12
    v_mul_f32 v17, v17, v13
    s_waitcnt vmcnt(27)
    v_mfma_f32_16x16x32_bf16 v[48:51], v[64:67], v[152:155], 0
    s_add_u32 s46, s47, 602112
    buffer_load_dwordx4 v[152:155], v3, s[20:23], s46 offen offset:0
    v_mul_f32 v18, v18, v14
    v_mul_f32 v19, v19, v15
    s_waitcnt vmcnt(27)
    v_mfma_f32_16x16x32_bf16 v[48:51], v[68:71], v[156:159], v[48:51]
    s_add_u32 s46, s47, 602112
    buffer_load_dwordx4 v[156:159], v3, s[20:23], s46 offen offset:1024
    v_cvt_pk_bf16_f32 v8, v44, v45
    v_lshlrev_b32 v44, 16, v8
    s_waitcnt vmcnt(27)
    v_mfma_f32_16x16x32_bf16 v[48:51], v[72:75], v[160:163], v[48:51]
    s_add_u32 s46, s47, 602112
    buffer_load_dwordx4 v[160:163], v3, s[20:23], s46 offen offset:2048
    v_and_b32 v45, 0xffff0000, v8
    v_cvt_pk_bf16_f32 v9, v46, v47
    s_waitcnt vmcnt(27)
    v_mfma_f32_16x16x32_bf16 v[48:51], v[76:79], v[164:167], v[48:51]
    s_add_u32 s46, s47, 602112
    buffer_load_dwordx4 v[164:167], v3, s[20:23], s46 offen offset:3072
    v_lshlrev_b32 v46, 16, v9
    v_and_b32 v47, 0xffff0000, v9
    s_waitcnt vmcnt(27)
    v_mfma_f32_16x16x32_bf16 v[48:51], v[80:83], v[168:171], v[48:51]
    s_add_u32 s46, s47, 655360
    buffer_load_dwordx4 v[168:171], v3, s[20:23], s46 offen offset:0
    v_mul_f32 v12, v44, v44
    v_mul_f32 v13, v45, v45
    s_waitcnt vmcnt(27)
    v_mfma_f32_16x16x32_bf16 v[48:51], v[84:87], v[172:175], v[48:51]
    s_add_u32 s46, s47, 655360
    buffer_load_dwordx4 v[172:175], v3, s[20:23], s46 offen offset:1024
    v_mul_f32 v14, v46, v46
    v_mul_f32 v15, v47, v47
    s_waitcnt vmcnt(27)
    v_mfma_f32_16x16x32_bf16 v[48:51], v[88:91], v[176:179], v[48:51]
    s_add_u32 s46, s47, 655360
    buffer_load_dwordx4 v[176:179], v3, s[20:23], s46 offen offset:2048
    v_fma_f32 v12, v12, s49, v10
    v_fma_f32 v13, v13, s49, v10
    s_waitcnt vmcnt(27)
    v_mfma_f32_16x16x32_bf16 v[48:51], v[92:95], v[180:183], v[48:51]
    s_add_u32 s46, s47, 655360
    buffer_load_dwordx4 v[180:183], v3, s[20:23], s46 offen offset:3072
    v_fma_f32 v14, v14, s49, v10
    v_fma_f32 v15, v15, s49, v10
    s_waitcnt vmcnt(27)
    v_mfma_f32_16x16x32_bf16 v[48:51], v[96:99], v[184:187], v[48:51]
    s_add_u32 s46, s47, 659456
    buffer_load_dwordx4 v[184:187], v3, s[20:23], s46 offen offset:0
    v_mul_f32 v12, v12, v44
    v_mul_f32 v13, v13, v45
    s_waitcnt vmcnt(27)
    v_mfma_f32_16x16x32_bf16 v[48:51], v[100:103], v[188:191], v[48:51]
    s_add_u32 s46, s47, 659456
    buffer_load_dwordx4 v[188:191], v3, s[20:23], s46 offen offset:1024
    v_mul_f32 v14, v14, v46
    v_mul_f32 v15, v15, v47
    s_waitcnt vmcnt(27)
    v_mfma_f32_16x16x32_bf16 v[48:51], v[104:107], v[192:195], v[48:51]
    s_add_u32 s46, s47, 659456
    buffer_load_dwordx4 v[192:195], v3, s[20:23], s46 offen offset:2048
    v_exp_f32 v12, v12
    s_waitcnt vmcnt(27)
    v_mfma_f32_16x16x32_bf16 v[48:51], v[108:111], v[196:199], v[48:51]
    s_add_u32 s46, s47, 659456
    buffer_load_dwordx4 v[196:199], v3, s[20:23], s46 offen offset:3072
    v_exp_f32 v13, v13
    s_waitcnt vmcnt(27)
    v_mfma_f32_16x16x32_bf16 v[48:51], v[112:115], v[200:203], v[48:51]
    s_add_u32 s46, s47, 663552
    buffer_load_dwordx4 v[200:203], v3, s[20:23], s46 offen offset:0
    v_exp_f32 v14, v14
    s_waitcnt vmcnt(27)
    v_mfma_f32_16x16x32_bf16 v[48:51], v[116:119], v[204:207], v[48:51]
    s_add_u32 s46, s47, 663552
    buffer_load_dwordx4 v[204:207], v3, s[20:23], s46 offen offset:1024
    v_exp_f32 v15, v15
    s_waitcnt vmcnt(27)
    v_mfma_f32_16x16x32_bf16 v[48:51], v[120:123], v[208:211], v[48:51]
    s_add_u32 s46, s47, 663552
    buffer_load_dwordx4 v[208:211], v3, s[20:23], s46 offen offset:2048
    v_add_f32 v12, 1.0, v12
    v_add_f32 v13, 1.0, v13
    s_waitcnt vmcnt(27)
    v_mfma_f32_16x16x32_bf16 v[48:51], v[124:127], v[212:215], v[48:51]
    s_add_u32 s46, s47, 663552
    buffer_load_dwordx4 v[212:215], v3, s[20:23], s46 offen offset:3072
    v_add_f32 v14, 1.0, v14
    v_add_f32 v15, 1.0, v15
    v_mfma_f32_16x16x32_bf16 v[24:27], v[64:67], a[128:131], 0
    v_rcp_f32 v12, v12
    v_mfma_f32_16x16x32_bf16 v[24:27], v[68:71], a[132:135], v[24:27]
    v_rcp_f32 v13, v13
    v_mfma_f32_16x16x32_bf16 v[24:27], v[72:75], a[136:139], v[24:27]
    v_rcp_f32 v14, v14
    v_mfma_f32_16x16x32_bf16 v[24:27], v[76:79], a[140:143], v[24:27]
    v_rcp_f32 v15, v15
    v_mfma_f32_16x16x32_bf16 v[24:27], v[80:83], a[144:147], v[24:27]
    v_mul_f32 v44, v44, v12
    v_mul_f32 v45, v45, v13
    v_mfma_f32_16x16x32_bf16 v[24:27], v[84:87], a[148:151], v[24:27]
    v_mul_f32 v46, v46, v14
    v_mul_f32 v47, v47, v15
    v_mfma_f32_16x16x32_bf16 v[24:27], v[88:91], a[152:155], v[24:27]
    v_cvt_pk_bf16_f32 v8, v20, v21
    v_lshlrev_b32 v20, 16, v8
    v_mfma_f32_16x16x32_bf16 v[24:27], v[92:95], a[156:159], v[24:27]
    v_and_b32 v21, 0xffff0000, v8
    v_cvt_pk_bf16_f32 v9, v22, v23
    v_mfma_f32_16x16x32_bf16 v[24:27], v[96:99], a[160:163], v[24:27]
    v_lshlrev_b32 v22, 16, v9
    v_and_b32 v23, 0xffff0000, v9
    v_mfma_f32_16x16x32_bf16 v[24:27], v[100:103], a[164:167], v[24:27]
    v_mul_f32 v12, v20, v20
    v_mul_f32 v13, v21, v21
    v_mfma_f32_16x16x32_bf16 v[24:27], v[104:107], a[168:171], v[24:27]
    v_mul_f32 v14, v22, v22
    v_mul_f32 v15, v23, v23
    v_mfma_f32_16x16x32_bf16 v[24:27], v[108:111], a[172:175], v[24:27]
    v_fma_f32 v12, v12, s49, v10
    v_fma_f32 v13, v13, s49, v10
    v_mfma_f32_16x16x32_bf16 v[24:27], v[112:115], a[176:179], v[24:27]
    v_fma_f32 v14, v14, s49, v10
    v_fma_f32 v15, v15, s49, v10
    v_mfma_f32_16x16x32_bf16 v[24:27], v[116:119], a[180:183], v[24:27]
    v_mul_f32 v12, v12, v20
    v_mul_f32 v13, v13, v21
    v_mfma_f32_16x16x32_bf16 v[24:27], v[120:123], a[184:187], v[24:27]
    v_mul_f32 v14, v14, v22
    v_mul_f32 v15, v15, v23
    v_mfma_f32_16x16x32_bf16 v[24:27], v[124:127], a[188:191], v[24:27]
    v_exp_f32 v12, v12
    s_waitcnt vmcnt(27)
    v_mfma_f32_16x16x32_bf16 v[52:55], v[64:67], v[216:219], 0
    s_add_u32 s46, s47, 667648
    buffer_load_dwordx4 v[216:219], v3, s[20:23], s46 offen offset:0
    v_exp_f32 v13, v13
    s_waitcnt vmcnt(27)
    v_mfma_f32_16x16x32_bf16 v[52:55], v[68:71], v[220:223], v[52:55]
    s_add_u32 s46, s47, 667648
    buffer_load_dwordx4 v[220:223], v3, s[20:23], s46 offen offset:1024
    v_exp_f32 v14, v14
    s_waitcnt vmcnt(27)
    v_mfma_f32_16x16x32_bf16 v[52:55], v[72:75], v[224:227], v[52:55]
    s_add_u32 s46, s47, 667648
    buffer_load_dwordx4 v[224:227], v3, s[20:23], s46 offen offset:2048
    v_exp_f32 v15, v15
    s_waitcnt vmcnt(27)
    v_mfma_f32_16x16x32_bf16 v[52:55], v[76:79], v[228:231], v[52:55]
    s_add_u32 s46, s47, 667648
    buffer_load_dwordx4 v[228:231], v3, s[20:23], s46 offen offset:3072
    v_add_f32 v12, 1.0, v12
    v_add_f32 v13, 1.0, v13
    s_waitcnt vmcnt(27)
    v_mfma_f32_16x16x32_bf16 v[52:55], v[80:83], v[232:235], v[52:55]
    v_add_f32 v14, 1.0, v14
    v_add_f32 v15, 1.0, v15
    s_waitcnt vmcnt(26)
    v_mfma_f32_16x16x32_bf16 v[52:55], v[84:87], v[236:239], v[52:55]
    v_rcp_f32 v12, v12
    s_waitcnt vmcnt(25)
    v_mfma_f32_16x16x32_bf16 v[52:55], v[88:91], v[240:243], v[52:55]
    v_rcp_f32 v13, v13
    s_waitcnt vmcnt(24)
    v_mfma_f32_16x16x32_bf16 v[52:55], v[92:95], v[244:247], v[52:55]
    v_rcp_f32 v14, v14
    s_waitcnt vmcnt(23)
    v_mfma_f32_16x16x32_bf16 v[52:55], v[96:99], v[248:251], v[52:55]
    v_rcp_f32 v15, v15
    s_waitcnt vmcnt(22)
    v_mfma_f32_16x16x32_bf16 v[52:55], v[100:103], v[252:255], v[52:55]
    v_mul_f32 v20, v20, v12
    v_mul_f32 v21, v21, v13
    s_waitcnt vmcnt(21)
    v_mfma_f32_16x16x32_bf16 v[52:55], v[104:107], v[144:147], v[52:55]
    v_mul_f32 v22, v22, v14
    v_mul_f32 v23, v23, v15
    s_waitcnt vmcnt(20)
    v_mfma_f32_16x16x32_bf16 v[52:55], v[108:111], v[148:151], v[52:55]
    v_cvt_pk_bf16_f32 v8, v48, v49
    v_lshlrev_b32 v48, 16, v8
    s_waitcnt vmcnt(19)
    v_mfma_f32_16x16x32_bf16 v[52:55], v[112:115], v[152:155], v[52:55]
    v_and_b32 v49, 0xffff0000, v8
    v_cvt_pk_bf16_f32 v9, v50, v51
    s_waitcnt vmcnt(18)
    v_mfma_f32_16x16x32_bf16 v[52:55], v[116:119], v[156:159], v[52:55]
    v_lshlrev_b32 v50, 16, v9
    v_and_b32 v51, 0xffff0000, v9
    s_waitcnt vmcnt(17)
    v_mfma_f32_16x16x32_bf16 v[52:55], v[120:123], v[160:163], v[52:55]
    v_mul_f32 v12, v48, v48
    v_mul_f32 v13, v49, v49
    s_waitcnt vmcnt(16)
    v_mfma_f32_16x16x32_bf16 v[52:55], v[124:127], v[164:167], v[52:55]
    v_mul_f32 v14, v50, v50
    v_mul_f32 v15, v51, v51
    v_mfma_f32_16x16x32_bf16 v[28:31], v[64:67], a[192:195], 0
    v_fma_f32 v12, v12, s49, v10
    v_fma_f32 v13, v13, s49, v10
    v_mfma_f32_16x16x32_bf16 v[28:31], v[68:71], a[196:199], v[28:31]
    v_fma_f32 v14, v14, s49, v10
    v_fma_f32 v15, v15, s49, v10
    v_mfma_f32_16x16x32_bf16 v[28:31], v[72:75], a[200:203], v[28:31]
    v_mul_f32 v12, v12, v48
    v_mul_f32 v13, v13, v49
    v_mfma_f32_16x16x32_bf16 v[28:31], v[76:79], a[204:207], v[28:31]
    v_mul_f32 v14, v14, v50
    v_mul_f32 v15, v15, v51
    v_mfma_f32_16x16x32_bf16 v[28:31], v[80:83], a[208:211], v[28:31]
    v_exp_f32 v12, v12
    v_mfma_f32_16x16x32_bf16 v[28:31], v[84:87], a[212:215], v[28:31]
    v_exp_f32 v13, v13
    v_mfma_f32_16x16x32_bf16 v[28:31], v[88:91], a[216:219], v[28:31]
    v_exp_f32 v14, v14
    v_mfma_f32_16x16x32_bf16 v[28:31], v[92:95], a[220:223], v[28:31]
    v_exp_f32 v15, v15
    v_mfma_f32_16x16x32_bf16 v[28:31], v[96:99], a[224:227], v[28:31]
    v_add_f32 v12, 1.0, v12
    v_add_f32 v13, 1.0, v13
    v_mfma_f32_16x16x32_bf16 v[28:31], v[100:103], a[228:231], v[28:31]
    v_add_f32 v14, 1.0, v14
    v_add_f32 v15, 1.0, v15
    v_mfma_f32_16x16x32_bf16 v[28:31], v[104:107], a[232:235], v[28:31]
    v_rcp_f32 v12, v12
    v_mfma_f32_16x16x32_bf16 v[28:31], v[108:111], a[236:239], v[28:31]
    v_rcp_f32 v13, v13
    v_mfma_f32_16x16x32_bf16 v[28:31], v[112:115], a[240:243], v[28:31]
    v_rcp_f32 v14, v14
    v_mfma_f32_16x16x32_bf16 v[28:31], v[116:119], a[244:247], v[28:31]
    v_rcp_f32 v15, v15
    v_mfma_f32_16x16x32_bf16 v[28:31], v[120:123], a[248:251], v[28:31]
    v_mul_f32 v48, v48, v12
    v_mul_f32 v49, v49, v13
    v_mfma_f32_16x16x32_bf16 v[28:31], v[124:127], a[252:255], v[28:31]
    v_mul_f32 v50, v50, v14
    v_mul_f32 v51, v51, v15
    s_waitcnt vmcnt(15)
    v_mfma_f32_16x16x32_bf16 v[56:59], v[64:67], v[168:171], 0
    v_cvt_pk_bf16_f32 v8, v24, v25
    v_lshlrev_b32 v24, 16, v8
    s_waitcnt vmcnt(14)
    v_mfma_f32_16x16x32_bf16 v[56:59], v[68:71], v[172:175], v[56:59]
    v_and_b32 v25, 0xffff0000, v8
    v_cvt_pk_bf16_f32 v9, v26, v27
    s_waitcnt vmcnt(13)
    v_mfma_f32_16x16x32_bf16 v[56:59], v[72:75], v[176:179], v[56:59]
    v_lshlrev_b32 v26, 16, v9
    v_and_b32 v27, 0xffff0000, v9
    s_waitcnt vmcnt(12)
    v_mfma_f32_16x16x32_bf16 v[56:59], v[76:79], v[180:183], v[56:59]
    v_mul_f32 v12, v24, v24
    v_mul_f32 v13, v25, v25
    s_waitcnt vmcnt(11)
    v_mfma_f32_16x16x32_bf16 v[56:59], v[80:83], v[184:187], v[56:59]
    v_mul_f32 v14, v26, v26
    v_mul_f32 v15, v27, v27
    s_waitcnt vmcnt(10)
    v_mfma_f32_16x16x32_bf16 v[56:59], v[84:87], v[188:191], v[56:59]
    v_fma_f32 v12, v12, s49, v10
    v_fma_f32 v13, v13, s49, v10
    s_waitcnt vmcnt(9)
    v_mfma_f32_16x16x32_bf16 v[56:59], v[88:91], v[192:195], v[56:59]
    v_fma_f32 v14, v14, s49, v10
    v_fma_f32 v15, v15, s49, v10
    s_waitcnt vmcnt(8)
    v_mfma_f32_16x16x32_bf16 v[56:59], v[92:95], v[196:199], v[56:59]
    v_mul_f32 v12, v12, v24
    v_mul_f32 v13, v13, v25
    s_waitcnt vmcnt(7)
    v_mfma_f32_16x16x32_bf16 v[56:59], v[96:99], v[200:203], v[56:59]
    v_mul_f32 v14, v14, v26
    v_mul_f32 v15, v15, v27
    s_waitcnt vmcnt(6)
    v_mfma_f32_16x16x32_bf16 v[56:59], v[100:103], v[204:207], v[56:59]
    v_exp_f32 v12, v12
    s_waitcnt vmcnt(5)
    v_mfma_f32_16x16x32_bf16 v[56:59], v[104:107], v[208:211], v[56:59]
    v_exp_f32 v13, v13
    s_waitcnt vmcnt(4)
    v_mfma_f32_16x16x32_bf16 v[56:59], v[108:111], v[212:215], v[56:59]
    v_exp_f32 v14, v14
    s_waitcnt vmcnt(3)
    v_mfma_f32_16x16x32_bf16 v[56:59], v[112:115], v[216:219], v[56:59]
    v_exp_f32 v15, v15
    s_waitcnt vmcnt(2)
    v_mfma_f32_16x16x32_bf16 v[56:59], v[116:119], v[220:223], v[56:59]
    v_add_f32 v12, 1.0, v12
    v_add_f32 v13, 1.0, v13
    s_waitcnt vmcnt(1)
    v_mfma_f32_16x16x32_bf16 v[56:59], v[120:123], v[224:227], v[56:59]
    v_add_f32 v14, 1.0, v14
    v_add_f32 v15, 1.0, v15
    s_waitcnt vmcnt(0)
    v_mfma_f32_16x16x32_bf16 v[56:59], v[124:127], v[228:231], v[56:59]
    v_rcp_f32 v12, v12
    s_waitcnt lgkmcnt(2)
    v_mfma_f32_16x16x32_bf16 v[32:35], v[64:67], v[136:139], 0
    ds_read_b128 v[132:135], v60 offset:3072
    v_rcp_f32 v13, v13
    s_waitcnt lgkmcnt(2)
    v_mfma_f32_16x16x32_bf16 v[32:35], v[68:71], v[140:143], v[32:35]
    ds_read_b128 v[136:139], v60 offset:4096
    v_rcp_f32 v14, v14
    s_waitcnt lgkmcnt(2)
    v_mfma_f32_16x16x32_bf16 v[32:35], v[72:75], v[128:131], v[32:35]
    ds_read_b128 v[140:143], v60 offset:5120
    v_rcp_f32 v15, v15
    s_waitcnt lgkmcnt(2)
    v_mfma_f32_16x16x32_bf16 v[32:35], v[76:79], v[132:135], v[32:35]
    ds_read_b128 v[128:131], v60 offset:6144
    v_mul_f32 v24, v24, v12
    v_mul_f32 v25, v25, v13
    s_waitcnt lgkmcnt(2)
    v_mfma_f32_16x16x32_bf16 v[32:35], v[80:83], v[136:139], v[32:35]
    ds_read_b128 v[132:135], v60 offset:7168
    v_mul_f32 v26, v26, v14
    v_mul_f32 v27, v27, v15
    s_waitcnt lgkmcnt(2)
    v_mfma_f32_16x16x32_bf16 v[32:35], v[84:87], v[140:143], v[32:35]
    ds_read_b128 v[136:139], v60 offset:8192
    v_cvt_pk_bf16_f32 v8, v52, v53
    v_lshlrev_b32 v52, 16, v8
    s_waitcnt lgkmcnt(2)
    v_mfma_f32_16x16x32_bf16 v[32:35], v[88:91], v[128:131], v[32:35]
    ds_read_b128 v[140:143], v60 offset:9216
    v_and_b32 v53, 0xffff0000, v8
    v_cvt_pk_bf16_f32 v9, v54, v55
    s_waitcnt lgkmcnt(2)
    v_mfma_f32_16x16x32_bf16 v[32:35], v[92:95], v[132:135], v[32:35]
    ds_read_b128 v[128:131], v60 offset:10240
    v_lshlrev_b32 v54, 16, v9
    v_and_b32 v55, 0xffff0000, v9
    s_waitcnt lgkmcnt(2)
    v_mfma_f32_16x16x32_bf16 v[32:35], v[96:99], v[136:139], v[32:35]
    ds_read_b128 v[132:135], v60 offset:11264
    v_mul_f32 v12, v52, v52
    v_mul_f32 v13, v53, v53
    s_waitcnt lgkmcnt(2)
    v_mfma_f32_16x16x32_bf16 v[32:35], v[100:103], v[140:143], v[32:35]
    ds_read_b128 v[136:139], v60 offset:12288
    v_mul_f32 v14, v54, v54
    v_mul_f32 v15, v55, v55
    s_waitcnt lgkmcnt(2)
    v_mfma_f32_16x16x32_bf16 v[32:35], v[104:107], v[128:131], v[32:35]
    ds_read_b128 v[140:143], v60 offset:13312
    v_fma_f32 v12, v12, s49, v10
    v_fma_f32 v13, v13, s49, v10
    s_waitcnt lgkmcnt(2)
    v_mfma_f32_16x16x32_bf16 v[32:35], v[108:111], v[132:135], v[32:35]
    ds_read_b128 v[128:131], v60 offset:14336
    v_fma_f32 v14, v14, s49, v10
    v_fma_f32 v15, v15, s49, v10
    s_waitcnt lgkmcnt(2)
    v_mfma_f32_16x16x32_bf16 v[32:35], v[112:115], v[136:139], v[32:35]
    ds_read_b128 v[132:135], v60 offset:15360
    v_mul_f32 v12, v12, v52
    v_mul_f32 v13, v13, v53
    s_waitcnt lgkmcnt(2)
    v_mfma_f32_16x16x32_bf16 v[32:35], v[116:119], v[140:143], v[32:35]
    ds_read_b128 v[136:139], v60 offset:16384
    v_mul_f32 v14, v14, v54
    v_mul_f32 v15, v15, v55
    s_waitcnt lgkmcnt(2)
    v_mfma_f32_16x16x32_bf16 v[32:35], v[120:123], v[128:131], v[32:35]
    ds_read_b128 v[140:143], v60 offset:17408
    v_exp_f32 v12, v12
    s_waitcnt lgkmcnt(2)
    v_mfma_f32_16x16x32_bf16 v[32:35], v[124:127], v[132:135], v[32:35]
    ds_read_b128 v[128:131], v60 offset:18432
    v_exp_f32 v13, v13
    s_waitcnt lgkmcnt(2)
    v_mfma_f32_16x16x32_bf16 v[36:39], v[64:67], v[136:139], 0
    ds_read_b128 v[132:135], v60 offset:19456
    v_exp_f32 v14, v14
    s_waitcnt lgkmcnt(2)
    v_mfma_f32_16x16x32_bf16 v[36:39], v[68:71], v[140:143], v[36:39]
    ds_read_b128 v[136:139], v60 offset:20480
    v_exp_f32 v15, v15
    s_waitcnt lgkmcnt(2)
    v_mfma_f32_16x16x32_bf16 v[36:39], v[72:75], v[128:131], v[36:39]
    ds_read_b128 v[140:143], v60 offset:21504
    v_add_f32 v12, 1.0, v12
    v_add_f32 v13, 1.0, v13
    s_waitcnt lgkmcnt(2)
    v_mfma_f32_16x16x32_bf16 v[36:39], v[76:79], v[132:135], v[36:39]
    ds_read_b128 v[128:131], v60 offset:22528
    v_add_f32 v14, 1.0, v14
    v_add_f32 v15, 1.0, v15
    s_waitcnt lgkmcnt(2)
    v_mfma_f32_16x16x32_bf16 v[36:39], v[80:83], v[136:139], v[36:39]
    ds_read_b128 v[132:135], v60 offset:23552
    v_rcp_f32 v12, v12
    s_waitcnt lgkmcnt(2)
    v_mfma_f32_16x16x32_bf16 v[36:39], v[84:87], v[140:143], v[36:39]
    ds_read_b128 v[136:139], v60 offset:24576
    v_rcp_f32 v13, v13
    s_waitcnt lgkmcnt(2)
    v_mfma_f32_16x16x32_bf16 v[36:39], v[88:91], v[128:131], v[36:39]
    ds_read_b128 v[140:143], v60 offset:25600
    v_rcp_f32 v14, v14
    s_waitcnt lgkmcnt(2)
    v_mfma_f32_16x16x32_bf16 v[36:39], v[92:95], v[132:135], v[36:39]
    ds_read_b128 v[128:131], v60 offset:26624
    v_rcp_f32 v15, v15
    s_waitcnt lgkmcnt(2)
    v_mfma_f32_16x16x32_bf16 v[36:39], v[96:99], v[136:139], v[36:39]
    ds_read_b128 v[132:135], v60 offset:27648
    v_mul_f32 v52, v52, v12
    v_mul_f32 v53, v53, v13
    s_waitcnt lgkmcnt(2)
    v_mfma_f32_16x16x32_bf16 v[36:39], v[100:103], v[140:143], v[36:39]
    ds_read_b128 v[136:139], v60 offset:28672
    v_mul_f32 v54, v54, v14
    v_mul_f32 v55, v55, v15
    s_waitcnt lgkmcnt(2)
    v_mfma_f32_16x16x32_bf16 v[36:39], v[104:107], v[128:131], v[36:39]
    ds_read_b128 v[140:143], v60 offset:29696
    v_cvt_pk_bf16_f32 v8, v28, v29
    v_lshlrev_b32 v28, 16, v8
    s_waitcnt lgkmcnt(2)
    v_mfma_f32_16x16x32_bf16 v[36:39], v[108:111], v[132:135], v[36:39]
    ds_read_b128 v[128:131], v60 offset:30720
    v_and_b32 v29, 0xffff0000, v8
    v_cvt_pk_bf16_f32 v9, v30, v31
    s_waitcnt lgkmcnt(2)
    v_mfma_f32_16x16x32_bf16 v[36:39], v[112:115], v[136:139], v[36:39]
    ds_read_b128 v[132:135], v60 offset:31744
    v_lshlrev_b32 v30, 16, v9
    v_and_b32 v31, 0xffff0000, v9
    s_waitcnt lgkmcnt(2)
    v_mfma_f32_16x16x32_bf16 v[36:39], v[116:119], v[140:143], v[36:39]
    v_mul_f32 v12, v28, v28
    v_mul_f32 v13, v29, v29
    s_waitcnt lgkmcnt(1)
    v_mfma_f32_16x16x32_bf16 v[36:39], v[120:123], v[128:131], v[36:39]
    v_mul_f32 v14, v30, v30
    v_mul_f32 v15, v31, v31
    s_waitcnt lgkmcnt(0)
    v_mfma_f32_16x16x32_bf16 v[36:39], v[124:127], v[132:135], v[36:39]
    v_fma_f32 v12, v12, s49, v10
    v_fma_f32 v13, v13, s49, v10
    s_nop 7
    v_fma_f32 v14, v14, s49, v10
    v_fma_f32 v15, v15, s49, v10
    v_mul_f32 v12, v12, v28
    v_mul_f32 v13, v13, v29
    v_mul_f32 v14, v14, v30
    v_mul_f32 v15, v15, v31
    v_exp_f32 v12, v12
    v_exp_f32 v13, v13
    v_exp_f32 v14, v14
    v_exp_f32 v15, v15
    v_add_f32 v12, 1.0, v12
    v_add_f32 v13, 1.0, v13
    v_add_f32 v14, 1.0, v14
    v_add_f32 v15, 1.0, v15
    v_rcp_f32 v12, v12
    v_rcp_f32 v13, v13
    v_rcp_f32 v14, v14
    v_rcp_f32 v15, v15
    v_mul_f32 v28, v28, v12
    v_mul_f32 v29, v29, v13
    v_mul_f32 v30, v30, v14
    v_mul_f32 v31, v31, v15
    v_cvt_pk_bf16_f32 v8, v56, v57
    v_lshlrev_b32 v56, 16, v8
    v_and_b32 v57, 0xffff0000, v8
    v_cvt_pk_bf16_f32 v9, v58, v59
    v_lshlrev_b32 v58, 16, v9
    v_and_b32 v59, 0xffff0000, v9
    v_mul_f32 v12, v56, v56
    v_mul_f32 v13, v57, v57
    v_mul_f32 v14, v58, v58
    v_mul_f32 v15, v59, v59
    v_fma_f32 v12, v12, s49, v10
    v_fma_f32 v13, v13, s49, v10
    v_fma_f32 v14, v14, s49, v10
    v_fma_f32 v15, v15, s49, v10
    v_mul_f32 v12, v12, v56
    v_mul_f32 v13, v13, v57
    v_mul_f32 v14, v14, v58
    v_mul_f32 v15, v15, v59
    v_exp_f32 v12, v12
    v_exp_f32 v13, v13
    v_exp_f32 v14, v14
    v_exp_f32 v15, v15
    v_add_f32 v12, 1.0, v12
    v_add_f32 v13, 1.0, v13
    v_add_f32 v14, 1.0, v14
    v_add_f32 v15, 1.0, v15
    v_rcp_f32 v12, v12
    v_rcp_f32 v13, v13
    v_rcp_f32 v14, v14
    v_rcp_f32 v15, v15
    v_mul_f32 v56, v56, v12
    v_mul_f32 v57, v57, v13
    v_mul_f32 v58, v58, v14
    v_mul_f32 v59, v59, v15
    v_cvt_pk_bf16_f32 v8, v32, v33
    v_lshlrev_b32 v32, 16, v8
    v_and_b32 v33, 0xffff0000, v8
    v_cvt_pk_bf16_f32 v9, v34, v35
    v_lshlrev_b32 v34, 16, v9
    v_and_b32 v35, 0xffff0000, v9
    v_mul_f32 v12, v32, v32
    v_mul_f32 v13, v33, v33
    v_mul_f32 v14, v34, v34
    v_mul_f32 v15, v35, v35
    v_fma_f32 v12, v12, s49, v10
    v_fma_f32 v13, v13, s49, v10
    v_fma_f32 v14, v14, s49, v10
    v_fma_f32 v15, v15, s49, v10
    v_mul_f32 v12, v12, v32
    v_mul_f32 v13, v13, v33
    v_mul_f32 v14, v14, v34
    v_mul_f32 v15, v15, v35
    v_exp_f32 v12, v12
    v_exp_f32 v13, v13
    v_exp_f32 v14, v14
    v_exp_f32 v15, v15
    v_add_f32 v12, 1.0, v12
    v_add_f32 v13, 1.0, v13
    v_add_f32 v14, 1.0, v14
    v_add_f32 v15, 1.0, v15
    v_rcp_f32 v12, v12
    v_rcp_f32 v13, v13
    v_rcp_f32 v14, v14
    v_rcp_f32 v15, v15
    v_mul_f32 v32, v32, v12
    v_mul_f32 v33, v33, v13
    v_mul_f32 v34, v34, v14
    v_mul_f32 v35, v35, v15
    v_cvt_pk_bf16_f32 v8, v36, v37
    v_lshlrev_b32 v36, 16, v8
    v_and_b32 v37, 0xffff0000, v8
    v_cvt_pk_bf16_f32 v9, v38, v39
    v_lshlrev_b32 v38, 16, v9
    v_and_b32 v39, 0xffff0000, v9
    v_mul_f32 v12, v36, v36
    v_mul_f32 v13, v37, v37
    v_mul_f32 v14, v38, v38
    v_mul_f32 v15, v39, v39
    v_fma_f32 v12, v12, s49, v10
    v_fma_f32 v13, v13, s49, v10
    v_fma_f32 v14, v14, s49, v10
    v_fma_f32 v15, v15, s49, v10
    v_mul_f32 v12, v12, v36
    v_mul_f32 v13, v13, v37
    v_mul_f32 v14, v14, v38
    v_mul_f32 v15, v15, v39
    v_exp_f32 v12, v12
    v_exp_f32 v13, v13
    v_exp_f32 v14, v14
    v_exp_f32 v15, v15
    v_add_f32 v12, 1.0, v12
    v_add_f32 v13, 1.0, v13
    v_add_f32 v14, 1.0, v14
    v_add_f32 v15, 1.0, v15
    v_rcp_f32 v12, v12
    v_rcp_f32 v13, v13
    v_rcp_f32 v14, v14
    v_rcp_f32 v15, v15
    v_mul_f32 v36, v36, v12
    v_mul_f32 v37, v37, v13
    v_mul_f32 v38, v38, v14
    v_mul_f32 v39, v39, v15
    v_cvt_pk_bf16_f32 v8, v16, v17
    v_lshlrev_b32 v16, 16, v8
    v_and_b32 v17, 0xffff0000, v8
    v_cvt_pk_bf16_f32 v8, v18, v19
    v_lshlrev_b32 v18, 16, v8
    v_and_b32 v19, 0xffff0000, v8
    v_cvt_pk_bf16_f32 v8, v20, v21
    v_lshlrev_b32 v20, 16, v8
    v_and_b32 v21, 0xffff0000, v8
    v_cvt_pk_bf16_f32 v8, v22, v23
    v_lshlrev_b32 v22, 16, v8
    v_and_b32 v23, 0xffff0000, v8
    v_cvt_pk_bf16_f32 v8, v24, v25
    v_lshlrev_b32 v24, 16, v8
    v_and_b32 v25, 0xffff0000, v8
    v_cvt_pk_bf16_f32 v8, v26, v27
    v_lshlrev_b32 v26, 16, v8
    v_and_b32 v27, 0xffff0000, v8
    v_cvt_pk_bf16_f32 v8, v28, v29
    v_lshlrev_b32 v28, 16, v8
    v_and_b32 v29, 0xffff0000, v8
    v_cvt_pk_bf16_f32 v8, v30, v31
    v_lshlrev_b32 v30, 16, v8
    v_and_b32 v31, 0xffff0000, v8
    v_cvt_pk_bf16_f32 v8, v32, v33
    v_lshlrev_b32 v32, 16, v8
    v_and_b32 v33, 0xffff0000, v8
    v_cvt_pk_bf16_f32 v8, v34, v35
    v_lshlrev_b32 v34, 16, v8
    v_and_b32 v35, 0xffff0000, v8
    v_cvt_pk_bf16_f32 v8, v36, v37
    v_lshlrev_b32 v36, 16, v8
    v_and_b32 v37, 0xffff0000, v8
    v_cvt_pk_bf16_f32 v8, v38, v39
    v_lshlrev_b32 v38, 16, v8
    v_and_b32 v39, 0xffff0000, v8
    v_cvt_pk_bf16_f32 v8, v40, v41
    v_lshlrev_b32 v40, 16, v8
    v_and_b32 v41, 0xffff0000, v8
    v_cvt_pk_bf16_f32 v8, v42, v43
    v_lshlrev_b32 v42, 16, v8
    v_and_b32 v43, 0xffff0000, v8
    v_cvt_pk_bf16_f32 v8, v44, v45
    v_lshlrev_b32 v44, 16, v8
    v_and_b32 v45, 0xffff0000, v8
    v_cvt_pk_bf16_f32 v8, v46, v47
    v_lshlrev_b32 v46, 16, v8
    v_and_b32 v47, 0xffff0000, v8
    v_cvt_pk_bf16_f32 v8, v48, v49
    v_lshlrev_b32 v48, 16, v8
    v_and_b32 v49, 0xffff0000, v8
    v_cvt_pk_bf16_f32 v8, v50, v51
    v_lshlrev_b32 v50, 16, v8
    v_and_b32 v51, 0xffff0000, v8
    v_cvt_pk_bf16_f32 v8, v52, v53
    v_lshlrev_b32 v52, 16, v8
    v_and_b32 v53, 0xffff0000, v8
    v_cvt_pk_bf16_f32 v8, v54, v55
    v_lshlrev_b32 v54, 16, v8
    v_and_b32 v55, 0xffff0000, v8
    v_cvt_pk_bf16_f32 v8, v56, v57
    v_lshlrev_b32 v56, 16, v8
    v_and_b32 v57, 0xffff0000, v8
    v_cvt_pk_bf16_f32 v8, v58, v59
    v_lshlrev_b32 v58, 16, v8
    v_and_b32 v59, 0xffff0000, v8
    s_lshl_b32 s44, s3, 6
    v_lshlrev_b32 v8, 4, v7
    v_add_u32 v9, s44, v8
    s_cmp_eq_u32 s3, 3
    s_cselect_b32 s45, 0, 1.0
    v_add_f32 v60, v16, v20
    v_add_f32 v61, v17, v21
    v_add_f32 v62, v18, v22
    v_add_f32 v63, v19, v23
    v_add_f32 v60, v60, v24
    v_add_f32 v61, v61, v25
    v_add_f32 v62, v62, v26
    v_add_f32 v63, v63, v27
    v_add_f32 v60, v60, v28
    v_add_f32 v61, v61, v29
    v_add_f32 v62, v62, v30
    v_add_f32 v63, v63, v31
    v_add_f32 v60, v60, v32
    v_add_f32 v61, v61, v33
    v_add_f32 v62, v62, v34
    v_add_f32 v63, v63, v35
    v_add_f32 v60, v60, v36
    v_add_f32 v61, v61, v37
    v_add_f32 v62, v62, v38
    v_add_f32 v63, v63, v39
    v_add_f32 v60, v60, v40
    v_add_f32 v61, v61, v41
    v_add_f32 v62, v62, v42
    v_add_f32 v63, v63, v43
    v_add_f32 v60, v60, v44
    v_add_f32 v61, v61, v45
    v_add_f32 v62, v62, v46
    v_add_f32 v63, v63, v47
    v_add_f32 v60, v60, v48
    v_add_f32 v61, v61, v49
    v_add_f32 v62, v62, v50
    v_add_f32 v63, v63, v51
    v_add_f32 v60, v60, v52
    v_add_f32 v61, v61, v53
    v_add_f32 v62, v62, v54
    v_add_f32 v63, v63, v55
    v_add_f32 v60, v60, v56
    v_add_f32 v61, v61, v57
    v_add_f32 v62, v62, v58
    v_add_f32 v63, v63, v59
    v_add_f32_dpp v60, v60, v60 quad_perm:[1,0,3,2] row_mask:0xf bank_mask:0xf
    v_add_f32_dpp v61, v61, v61 quad_perm:[1,0,3,2] row_mask:0xf bank_mask:0xf
    v_add_f32_dpp v62, v62, v62 quad_perm:[1,0,3,2] row_mask:0xf bank_mask:0xf
    v_add_f32_dpp v63, v63, v63 quad_perm:[1,0,3,2] row_mask:0xf bank_mask:0xf
    v_add_f32_dpp v60, v60, v60 quad_perm:[2,3,0,1] row_mask:0xf bank_mask:0xf
    v_add_f32_dpp v61, v61, v61 quad_perm:[2,3,0,1] row_mask:0xf bank_mask:0xf
    v_add_f32_dpp v62, v62, v62 quad_perm:[2,3,0,1] row_mask:0xf bank_mask:0xf
    v_add_f32_dpp v63, v63, v63 quad_perm:[2,3,0,1] row_mask:0xf bank_mask:0xf
    v_add_f32_dpp v60, v60, v60 row_half_mirror row_mask:0xf bank_mask:0xf
    v_add_f32_dpp v61, v61, v61 row_half_mirror row_mask:0xf bank_mask:0xf
    v_add_f32_dpp v62, v62, v62 row_half_mirror row_mask:0xf bank_mask:0xf
    v_add_f32_dpp v63, v63, v63 row_half_mirror row_mask:0xf bank_mask:0xf
    v_add_f32_dpp v60, v60, v60 row_mirror row_mask:0xf bank_mask:0xf
    v_add_f32_dpp v61, v61, v61 row_mirror row_mask:0xf bank_mask:0xf
    v_add_f32_dpp v62, v62, v62 row_mirror row_mask:0xf bank_mask:0xf
    v_add_f32_dpp v63, v63, v63 row_mirror row_mask:0xf bank_mask:0xf
    ds_write_b128 v9, v[60:63] offset:16640
    s_waitcnt lgkmcnt(0)
    s_barrier
    ds_read_b128 v[64:67], v8 offset:16640
    ds_read_b128 v[68:71], v8 offset:16704
    ds_read_b128 v[72:75], v8 offset:16768
    ds_read_b128 v[76:79], v8 offset:16832
    s_waitcnt lgkmcnt(0)
    v_add_f32 v60, v64, v68
    v_add_f32 v72, v72, v76
    v_add_f32 v61, v65, v69
    v_add_f32 v73, v73, v77
    v_add_f32 v62, v66, v70
    v_add_f32 v74, v74, v78
    v_add_f32 v63, v67, v71
    v_add_f32 v75, v75, v79
    v_add_f32 v60, v60, v72
    v_add_f32 v61, v61, v73
    v_add_f32 v62, v62, v74
    v_add_f32 v63, v63, v75
    v_mul_f32 v60, 0x3abe82fa, v60
    v_mul_f32 v61, 0x3abe82fa, v61
    v_mul_f32 v62, 0x3abe82fa, v62
    v_mul_f32 v63, 0x3abe82fa, v63
    v_mov_b32 v80, v60
    v_mov_b32 v81, v61
    v_mov_b32 v82, v62
    v_mov_b32 v83, v63
    v_sub_f32 v84, v56, v80
    v_sub_f32 v85, v57, v81
    v_sub_f32 v86, v58, v82
    v_sub_f32 v87, v59, v83
    v_mul_f32 v60, v84, v84
    v_mul_f32 v61, v85, v85
    v_mul_f32 v62, v86, v86
    v_mul_f32 v63, v87, v87
    v_mul_f32 v60, s45, v60
    v_mul_f32 v61, s45, v61
    v_mul_f32 v62, s45, v62
    v_mul_f32 v63, s45, v63
    v_sub_f32 v84, v52, v80
    v_sub_f32 v85, v53, v81
    v_sub_f32 v86, v54, v82
    v_sub_f32 v87, v55, v83
    v_fmac_f32 v60, v84, v84
    v_fmac_f32 v61, v85, v85
    v_fmac_f32 v62, v86, v86
    v_fmac_f32 v63, v87, v87
    v_sub_f32 v84, v48, v80
    v_sub_f32 v85, v49, v81
    v_sub_f32 v86, v50, v82
    v_sub_f32 v87, v51, v83
    v_fmac_f32 v60, v84, v84
    v_fmac_f32 v61, v85, v85
    v_fmac_f32 v62, v86, v86
    v_fmac_f32 v63, v87, v87
    v_sub_f32 v84, v44, v80
    v_sub_f32 v85, v45, v81
    v_sub_f32 v86, v46, v82
    v_sub_f32 v87, v47, v83
    v_fmac_f32 v60, v84, v84
    v_fmac_f32 v61, v85, v85
    v_fmac_f32 v62, v86, v86
    v_fmac_f32 v63, v87, v87
    v_sub_f32 v84, v40, v80
    v_sub_f32 v85, v41, v81
    v_sub_f32 v86, v42, v82
    v_sub_f32 v87, v43, v83
    v_fmac_f32 v60, v84, v84
    v_fmac_f32 v61, v85, v85
    v_fmac_f32 v62, v86, v86
    v_fmac_f32 v63, v87, v87
    v_sub_f32 v84, v36, v80
    v_sub_f32 v85, v37, v81
    v_sub_f32 v86, v38, v82
    v_sub_f32 v87, v39, v83
    v_fmac_f32 v60, v84, v84
    v_fmac_f32 v61, v85, v85
    v_fmac_f32 v62, v86, v86
    v_fmac_f32 v63, v87, v87
    v_sub_f32 v84, v32, v80
    v_sub_f32 v85, v33, v81
    v_sub_f32 v86, v34, v82
    v_sub_f32 v87, v35, v83
    v_fmac_f32 v60, v84, v84
    v_fmac_f32 v61, v85, v85
    v_fmac_f32 v62, v86, v86
    v_fmac_f32 v63, v87, v87
    v_sub_f32 v84, v28, v80
    v_sub_f32 v85, v29, v81
    v_sub_f32 v86, v30, v82
    v_sub_f32 v87, v31, v83
    v_fmac_f32 v60, v84, v84
    v_fmac_f32 v61, v85, v85
    v_fmac_f32 v62, v86, v86
    v_fmac_f32 v63, v87, v87
    v_sub_f32 v84, v24, v80
    v_sub_f32 v85, v25, v81
    v_sub_f32 v86, v26, v82
    v_sub_f32 v87, v27, v83
    v_fmac_f32 v60, v84, v84
    v_fmac_f32 v61, v85, v85
    v_fmac_f32 v62, v86, v86
    v_fmac_f32 v63, v87, v87
    v_sub_f32 v84, v20, v80
    v_sub_f32 v85, v21, v81
    v_sub_f32 v86, v22, v82
    v_sub_f32 v87, v23, v83
    v_fmac_f32 v60, v84, v84
    v_fmac_f32 v61, v85, v85
    v_fmac_f32 v62, v86, v86
    v_fmac_f32 v63, v87, v87
    v_sub_f32 v84, v16, v80
    v_sub_f32 v85, v17, v81
    v_sub_f32 v86, v18, v82
    v_sub_f32 v87, v19, v83
    v_fmac_f32 v60, v84, v84
    v_fmac_f32 v61, v85, v85
    v_fmac_f32 v62, v86, v86
    v_fmac_f32 v63, v87, v87
    s_nop 1
    v_add_f32_dpp v60, v60, v60 quad_perm:[1,0,3,2] row_mask:0xf bank_mask:0xf
    v_add_f32_dpp v61, v61, v61 quad_perm:[1,0,3,2] row_mask:0xf bank_mask:0xf
    v_add_f32_dpp v62, v62, v62 quad_perm:[1,0,3,2] row_mask:0xf bank_mask:0xf
    v_add_f32_dpp v63, v63, v63 quad_perm:[1,0,3,2] row_mask:0xf bank_mask:0xf
    v_add_f32_dpp v60, v60, v60 quad_perm:[2,3,0,1] row_mask:0xf bank_mask:0xf
    v_add_f32_dpp v61, v61, v61 quad_perm:[2,3,0,1] row_mask:0xf bank_mask:0xf
    v_add_f32_dpp v62, v62, v62 quad_perm:[2,3,0,1] row_mask:0xf bank_mask:0xf
    v_add_f32_dpp v63, v63, v63 quad_perm:[2,3,0,1] row_mask:0xf bank_mask:0xf
    v_add_f32_dpp v60, v60, v60 row_half_mirror row_mask:0xf bank_mask:0xf
    v_add_f32_dpp v61, v61, v61 row_half_mirror row_mask:0xf bank_mask:0xf
    v_add_f32_dpp v62, v62, v62 row_half_mirror row_mask:0xf bank_mask:0xf
    v_add_f32_dpp v63, v63, v63 row_half_mirror row_mask:0xf bank_mask:0xf
    v_add_f32_dpp v60, v60, v60 row_mirror row_mask:0xf bank_mask:0xf
    v_add_f32_dpp v61, v61, v61 row_mirror row_mask:0xf bank_mask:0xf
    v_add_f32_dpp v62, v62, v62 row_mirror row_mask:0xf bank_mask:0xf
    v_add_f32_dpp v63, v63, v63 row_mirror row_mask:0xf bank_mask:0xf
    ds_write_b128 v9, v[60:63] offset:16896
    s_waitcnt lgkmcnt(0)
    s_barrier
    ds_read_b128 v[64:67], v8 offset:16896
    ds_read_b128 v[68:71], v8 offset:16960
    ds_read_b128 v[72:75], v8 offset:17024
    ds_read_b128 v[76:79], v8 offset:17088
    s_waitcnt lgkmcnt(0)
    v_add_f32 v60, v64, v68
    v_add_f32 v72, v72, v76
    v_add_f32 v61, v65, v69
    v_add_f32 v73, v73, v77
    v_add_f32 v62, v66, v70
    v_add_f32 v74, v74, v78
    v_add_f32 v63, v67, v71
    v_add_f32 v75, v75, v79
    v_add_f32 v60, v60, v72
    v_add_f32 v61, v61, v73
    v_add_f32 v62, v62, v74
    v_add_f32 v63, v63, v75
    v_mul_f32 v60, 0x3abe82fa, v60
    v_mul_f32 v61, 0x3abe82fa, v61
    v_mul_f32 v62, 0x3abe82fa, v62
    v_mul_f32 v63, 0x3abe82fa, v63
    v_cvt_pk_bf16_f32 v10, v80, v81
    v_lshlrev_b32 v80, 16, v10
    v_and_b32 v81, 0xffff0000, v10
    v_cvt_pk_bf16_f32 v10, v82, v83
    v_lshlrev_b32 v82, 16, v10
    v_and_b32 v83, 0xffff0000, v10
    v_cvt_pk_bf16_f32 v10, v60, v61
    v_lshlrev_b32 v60, 16, v10
    v_and_b32 v61, 0xffff0000, v10
    v_cvt_pk_bf16_f32 v10, v62, v63
    v_lshlrev_b32 v62, 16, v10
    v_and_b32 v63, 0xffff0000, v10
    v_add_f32 v60, 0x3727c5ac, v60
    v_add_f32 v61, 0x3727c5ac, v61
    v_add_f32 v62, 0x3727c5ac, v62
    v_add_f32 v63, 0x3727c5ac, v63
    v_cvt_pk_bf16_f32 v10, v60, v61
    v_lshlrev_b32 v60, 16, v10
    v_and_b32 v61, 0xffff0000, v10
    v_cvt_pk_bf16_f32 v10, v62, v63
    v_lshlrev_b32 v62, 16, v10
    v_and_b32 v63, 0xffff0000, v10
    v_sqrt_f32 v60, v60
    v_sqrt_f32 v61, v61
    v_sqrt_f32 v62, v62
    v_sqrt_f32 v63, v63
    s_nop 0
    v_cvt_pk_bf16_f32 v10, v60, v61
    v_lshlrev_b32 v60, 16, v10
    v_and_b32 v61, 0xffff0000, v10
    v_cvt_pk_bf16_f32 v10, v62, v63
    v_lshlrev_b32 v62, 16, v10
    v_and_b32 v63, 0xffff0000, v10
    v_rcp_f32 v60, v60
    v_rcp_f32 v61, v61
    v_rcp_f32 v62, v62
    v_rcp_f32 v63, v63
    s_mul_i32 s44, s32, 22528
    s_lshr_b32 s45, s3, 1
    s_lshl_b32 s45, s45, 10
    s_add_u32 s44, s44, s45
    s_and_b32 s45, s3, 1
    s_lshl_b32 s45, s45, 8
    s_add_u32 s44, s44, s45
    v_lshrrev_b32 v8, 1, v7
    v_lshlrev_b32 v8, 9, v8
    v_lshl_add_u32 v8, v6, 4, v8
    v_and_b32 v9, 1, v7
    v_lshl_add_u32 v8, v9, 3, v8
    v_sub_f32 v16, v16, v80
    v_sub_f32 v17, v17, v81
    v_sub_f32 v18, v18, v82
    v_sub_f32 v19, v19, v83
    v_cvt_pk_bf16_f32 v10, v16, v17
    v_lshlrev_b32 v16, 16, v10
    v_and_b32 v17, 0xffff0000, v10
    v_cvt_pk_bf16_f32 v10, v18, v19
    v_lshlrev_b32 v18, 16, v10
    v_and_b32 v19, 0xffff0000, v10
    v_mul_f32 v16, v16, v60
    v_mul_f32 v17, v17, v61
    v_mul_f32 v18, v18, v62
    v_mul_f32 v19, v19, v63
    v_cvt_pk_bf16_f32 v16, v16, v17
    v_cvt_pk_bf16_f32 v17, v18, v19
    buffer_store_dwordx2 v[16:17], v8, s[24:27], s44 offen sc1
    s_add_u32 s44, s44, 2048
    v_sub_f32 v20, v20, v80
    v_sub_f32 v21, v21, v81
    v_sub_f32 v22, v22, v82
    v_sub_f32 v23, v23, v83
    v_cvt_pk_bf16_f32 v10, v20, v21
    v_lshlrev_b32 v20, 16, v10
    v_and_b32 v21, 0xffff0000, v10
    v_cvt_pk_bf16_f32 v10, v22, v23
    v_lshlrev_b32 v22, 16, v10
    v_and_b32 v23, 0xffff0000, v10
    v_mul_f32 v20, v20, v60
    v_mul_f32 v21, v21, v61
    v_mul_f32 v22, v22, v62
    v_mul_f32 v23, v23, v63
    v_cvt_pk_bf16_f32 v20, v20, v21
    v_cvt_pk_bf16_f32 v21, v22, v23
    buffer_store_dwordx2 v[20:21], v8, s[24:27], s44 offen sc1
    s_add_u32 s44, s44, 2048
    v_sub_f32 v24, v24, v80
    v_sub_f32 v25, v25, v81
    v_sub_f32 v26, v26, v82
    v_sub_f32 v27, v27, v83
    v_cvt_pk_bf16_f32 v10, v24, v25
    v_lshlrev_b32 v24, 16, v10
    v_and_b32 v25, 0xffff0000, v10
    v_cvt_pk_bf16_f32 v10, v26, v27
    v_lshlrev_b32 v26, 16, v10
    v_and_b32 v27, 0xffff0000, v10
    v_mul_f32 v24, v24, v60
    v_mul_f32 v25, v25, v61
    v_mul_f32 v26, v26, v62
    v_mul_f32 v27, v27, v63
    v_cvt_pk_bf16_f32 v24, v24, v25
    v_cvt_pk_bf16_f32 v25, v26, v27
    buffer_store_dwordx2 v[24:25], v8, s[24:27], s44 offen sc1
    s_add_u32 s44, s44, 2048
    v_sub_f32 v28, v28, v80
    v_sub_f32 v29, v29, v81
    v_sub_f32 v30, v30, v82
    v_sub_f32 v31, v31, v83
    v_cvt_pk_bf16_f32 v10, v28, v29
    v_lshlrev_b32 v28, 16, v10
    v_and_b32 v29, 0xffff0000, v10
    v_cvt_pk_bf16_f32 v10, v30, v31
    v_lshlrev_b32 v30, 16, v10
    v_and_b32 v31, 0xffff0000, v10
    v_mul_f32 v28, v28, v60
    v_mul_f32 v29, v29, v61
    v_mul_f32 v30, v30, v62
    v_mul_f32 v31, v31, v63
    v_cvt_pk_bf16_f32 v28, v28, v29
    v_cvt_pk_bf16_f32 v29, v30, v31
    buffer_store_dwordx2 v[28:29], v8, s[24:27], s44 offen sc1
    s_add_u32 s44, s44, 2048
    v_sub_f32 v32, v32, v80
    v_sub_f32 v33, v33, v81
    v_sub_f32 v34, v34, v82
    v_sub_f32 v35, v35, v83
    v_cvt_pk_bf16_f32 v10, v32, v33
    v_lshlrev_b32 v32, 16, v10
    v_and_b32 v33, 0xffff0000, v10
    v_cvt_pk_bf16_f32 v10, v34, v35
    v_lshlrev_b32 v34, 16, v10
    v_and_b32 v35, 0xffff0000, v10
    v_mul_f32 v32, v32, v60
    v_mul_f32 v33, v33, v61
    v_mul_f32 v34, v34, v62
    v_mul_f32 v35, v35, v63
    v_cvt_pk_bf16_f32 v32, v32, v33
    v_cvt_pk_bf16_f32 v33, v34, v35
    buffer_store_dwordx2 v[32:33], v8, s[24:27], s44 offen sc1
    s_add_u32 s44, s44, 2048
    v_sub_f32 v36, v36, v80
    v_sub_f32 v37, v37, v81
    v_sub_f32 v38, v38, v82
    v_sub_f32 v39, v39, v83
    v_cvt_pk_bf16_f32 v10, v36, v37
    v_lshlrev_b32 v36, 16, v10
    v_and_b32 v37, 0xffff0000, v10
    v_cvt_pk_bf16_f32 v10, v38, v39
    v_lshlrev_b32 v38, 16, v10
    v_and_b32 v39, 0xffff0000, v10
    v_mul_f32 v36, v36, v60
    v_mul_f32 v37, v37, v61
    v_mul_f32 v38, v38, v62
    v_mul_f32 v39, v39, v63
    v_cvt_pk_bf16_f32 v36, v36, v37
    v_cvt_pk_bf16_f32 v37, v38, v39
    buffer_store_dwordx2 v[36:37], v8, s[24:27], s44 offen sc1
    s_add_u32 s44, s44, 2048
    v_sub_f32 v40, v40, v80
    v_sub_f32 v41, v41, v81
    v_sub_f32 v42, v42, v82
    v_sub_f32 v43, v43, v83
    v_cvt_pk_bf16_f32 v10, v40, v41
    v_lshlrev_b32 v40, 16, v10
    v_and_b32 v41, 0xffff0000, v10
    v_cvt_pk_bf16_f32 v10, v42, v43
    v_lshlrev_b32 v42, 16, v10
    v_and_b32 v43, 0xffff0000, v10
    v_mul_f32 v40, v40, v60
    v_mul_f32 v41, v41, v61
    v_mul_f32 v42, v42, v62
    v_mul_f32 v43, v43, v63
    v_cvt_pk_bf16_f32 v40, v40, v41
    v_cvt_pk_bf16_f32 v41, v42, v43
    buffer_store_dwordx2 v[40:41], v8, s[24:27], s44 offen sc1
    s_add_u32 s44, s44, 2048
    v_sub_f32 v44, v44, v80
    v_sub_f32 v45, v45, v81
    v_sub_f32 v46, v46, v82
    v_sub_f32 v47, v47, v83
    v_cvt_pk_bf16_f32 v10, v44, v45
    v_lshlrev_b32 v44, 16, v10
    v_and_b32 v45, 0xffff0000, v10
    v_cvt_pk_bf16_f32 v10, v46, v47
    v_lshlrev_b32 v46, 16, v10
    v_and_b32 v47, 0xffff0000, v10
    v_mul_f32 v44, v44, v60
    v_mul_f32 v45, v45, v61
    v_mul_f32 v46, v46, v62
    v_mul_f32 v47, v47, v63
    v_cvt_pk_bf16_f32 v44, v44, v45
    v_cvt_pk_bf16_f32 v45, v46, v47
    buffer_store_dwordx2 v[44:45], v8, s[24:27], s44 offen sc1
    s_add_u32 s44, s44, 2048
    v_sub_f32 v48, v48, v80
    v_sub_f32 v49, v49, v81
    v_sub_f32 v50, v50, v82
    v_sub_f32 v51, v51, v83
    v_cvt_pk_bf16_f32 v10, v48, v49
    v_lshlrev_b32 v48, 16, v10
    v_and_b32 v49, 0xffff0000, v10
    v_cvt_pk_bf16_f32 v10, v50, v51
    v_lshlrev_b32 v50, 16, v10
    v_and_b32 v51, 0xffff0000, v10
    v_mul_f32 v48, v48, v60
    v_mul_f32 v49, v49, v61
    v_mul_f32 v50, v50, v62
    v_mul_f32 v51, v51, v63
    v_cvt_pk_bf16_f32 v48, v48, v49
    v_cvt_pk_bf16_f32 v49, v50, v51
    buffer_store_dwordx2 v[48:49], v8, s[24:27], s44 offen sc1
    s_add_u32 s44, s44, 2048
    v_sub_f32 v52, v52, v80
    v_sub_f32 v53, v53, v81
    v_sub_f32 v54, v54, v82
    v_sub_f32 v55, v55, v83
    v_cvt_pk_bf16_f32 v10, v52, v53
    v_lshlrev_b32 v52, 16, v10
    v_and_b32 v53, 0xffff0000, v10
    v_cvt_pk_bf16_f32 v10, v54, v55
    v_lshlrev_b32 v54, 16, v10
    v_and_b32 v55, 0xffff0000, v10
    v_mul_f32 v52, v52, v60
    v_mul_f32 v53, v53, v61
    v_mul_f32 v54, v54, v62
    v_mul_f32 v55, v55, v63
    v_cvt_pk_bf16_f32 v52, v52, v53
    v_cvt_pk_bf16_f32 v53, v54, v55
    buffer_store_dwordx2 v[52:53], v8, s[24:27], s44 offen sc1
    s_add_u32 s44, s44, 2048
    v_sub_f32 v56, v56, v80
    v_sub_f32 v57, v57, v81
    v_sub_f32 v58, v58, v82
    v_sub_f32 v59, v59, v83
    v_cvt_pk_bf16_f32 v10, v56, v57
    v_lshlrev_b32 v56, 16, v10
    v_and_b32 v57, 0xffff0000, v10
    v_cvt_pk_bf16_f32 v10, v58, v59
    v_lshlrev_b32 v58, 16, v10
    v_and_b32 v59, 0xffff0000, v10
    v_mul_f32 v56, v56, v60
    v_mul_f32 v57, v57, v61
    v_mul_f32 v58, v58, v62
    v_mul_f32 v59, v59, v63
    v_cvt_pk_bf16_f32 v56, v56, v57
    v_cvt_pk_bf16_f32 v57, v58, v59
    buffer_store_dwordx2 v[56:57], v8, s[24:27], s44 offen sc1
    s_add_u32 s44, s44, 2048
wi_next:
    s_lshl_b32 s44, s33, 9
    s_lshl_b32 s45, s32, 2
    s_add_u32 s44, s44, s45
    s_add_u32 s44, s44, 28672
    v_mov_b32 v8, 0
    s_waitcnt vmcnt(0)
    s_barrier
    s_cmp_lg_u32 s3, 0
    s_cbranch_scc1 wi_nf
    s_add_u32 s97, s101, 0
    v_mov_b32 v9, s97
    buffer_store_dword v9, v8, s[40:43], s44 offen sc1
wi_nf:
    s_add_u32 s32, s32, 16
    s_cmp_lt_u32 s32, 128
    s_cbranch_scc1 wi_loop
    s_branch xs_entry
hp_pool6:
    s_sub_u32 s4, s100, 192
    s_lshl_b32 s34, s4, 2
    s_add_u32 s34, s34, 24576
    v_mov_b32 v64, 0
    s_cmp_lg_u32 s3, 0
    s_cbranch_scc1 wo_nm
    s_add_u32 s97, s101, 1
    v_mov_b32 v65, s97
    buffer_store_dword v65, v64, s[40:43], s34 offen sc1
wo_nm:
    s_mov_b32 s16, s80
    s_mov_b32 s17, s81
    s_mov_b32 s18, 0x158000
    s_mov_b32 s19, 0x20000
    s_add_u32 s20, s10, 0x6400000
    s_addc_u32 s21, s11, 0
    s_mov_b32 s22, 0x158000
    s_mov_b32 s23, 0x20000
    v_and_b32 v3, 15, v1
    v_lshrrev_b32 v4, 4, v1
    s_mov_b32 s5, s4
wo_winf:
    s_mul_i32 s32, s3, 352256
    s_lshl_b32 s33, s5, 5
    s_add_u32 s32, s32, s33
    v_mul_u32_u24 v6, 22016, v4
    v_lshl_add_u32 v6, v3, 1, v6
    v_add_u32 v6, s32, v6
    s_lshl_b32 s32, s5, 14
    s_lshl_b32 s33, s3, 12
    s_add_u32 s32, s32, s33
    v_lshlrev_b32 v7, 4, v1
    v_add_u32 v7, s32, v7
    s_mov_b32 s24, 0
    buffer_load_ushort v16, v6, s[16:19], s24 offen
    s_mov_b32 s25, 2752
    buffer_load_ushort v17, v6, s[16:19], s25 offen
    s_mov_b32 s26, 5504
    buffer_load_ushort v18, v6, s[16:19], s26 offen
    s_mov_b32 s27, 8256
    buffer_load_ushort v19, v6, s[16:19], s27 offen
    s_mov_b32 s28, 11008
    buffer_load_ushort v20, v6, s[16:19], s28 offen
    s_mov_b32 s29, 13760
    buffer_load_ushort v21, v6, s[16:19], s29 offen
    s_mov_b32 s30, 16512
    buffer_load_ushort v22, v6, s[16:19], s30 offen
    s_mov_b32 s31, 19264
    buffer_load_ushort v23, v6, s[16:19], s31 offen
    s_mov_b32 s24, 88064
    buffer_load_ushort v24, v6, s[16:19], s24 offen
    s_mov_b32 s25, 90816
    buffer_load_ushort v25, v6, s[16:19], s25 offen
    s_mov_b32 s26, 93568
    buffer_load_ushort v26, v6, s[16:19], s26 offen
    s_mov_b32 s27, 96320
    buffer_load_ushort v27, v6, s[16:19], s27 offen
    s_mov_b32 s28, 99072
    buffer_load_ushort v28, v6, s[16:19], s28 offen
    s_mov_b32 s29, 101824
    buffer_load_ushort v29, v6, s[16:19], s29 offen
    s_mov_b32 s30, 104576
    buffer_load_ushort v30, v6, s[16:19], s30 offen
    s_mov_b32 s31, 107328
    buffer_load_ushort v31, v6, s[16:19], s31 offen
    s_mov_b32 s24, 176128
    buffer_load_ushort v32, v6, s[16:19], s24 offen
    s_mov_b32 s25, 178880
    buffer_load_ushort v33, v6, s[16:19], s25 offen
    s_mov_b32 s26, 181632
    buffer_load_ushort v34, v6, s[16:19], s26 offen
    s_mov_b32 s27, 184384
    buffer_load_ushort v35, v6, s[16:19], s27 offen
    s_mov_b32 s28, 187136
    buffer_load_ushort v36, v6, s[16:19], s28 offen
    s_mov_b32 s29, 189888
    buffer_load_ushort v37, v6, s[16:19], s29 offen
    s_mov_b32 s30, 192640
    buffer_load_ushort v38, v6, s[16:19], s30 offen
    s_mov_b32 s31, 195392
    buffer_load_ushort v39, v6, s[16:19], s31 offen
    s_mov_b32 s24, 264192
    buffer_load_ushort v40, v6, s[16:19], s24 offen
    s_mov_b32 s25, 266944
    buffer_load_ushort v41, v6, s[16:19], s25 offen
    s_mov_b32 s26, 269696
    buffer_load_ushort v42, v6, s[16:19], s26 offen
    s_mov_b32 s27, 272448
    buffer_load_ushort v43, v6, s[16:19], s27 offen
    s_mov_b32 s28, 275200
    buffer_load_ushort v44, v6, s[16:19], s28 offen
    s_mov_b32 s29, 277952
    buffer_load_ushort v45, v6, s[16:19], s29 offen
    s_mov_b32 s30, 280704
    buffer_load_ushort v46, v6, s[16:19], s30 offen
    s_mov_b32 s31, 283456
    buffer_load_ushort v47, v6, s[16:19], s31 offen
    s_waitcnt vmcnt(24)
    v_lshl_or_b32 v48, v17, 16, v16
    v_lshl_or_b32 v49, v19, 16, v18
    v_lshl_or_b32 v50, v21, 16, v20
    v_lshl_or_b32 v51, v23, 16, v22
    buffer_store_dwordx4 v[48:51], v7, s[20:23], 0 offen offset:0 sc1
    s_waitcnt vmcnt(17)
    v_lshl_or_b32 v52, v25, 16, v24
    v_lshl_or_b32 v53, v27, 16, v26
    v_lshl_or_b32 v54, v29, 16, v28
    v_lshl_or_b32 v55, v31, 16, v30
    buffer_store_dwordx4 v[52:55], v7, s[20:23], 0 offen offset:1024 sc1
    s_waitcnt vmcnt(10)
    v_lshl_or_b32 v56, v33, 16, v32
    v_lshl_or_b32 v57, v35, 16, v34
    v_lshl_or_b32 v58, v37, 16, v36
    v_lshl_or_b32 v59, v39, 16, v38
    buffer_store_dwordx4 v[56:59], v7, s[20:23], 0 offen offset:2048 sc1
    s_waitcnt vmcnt(3)
    v_lshl_or_b32 v60, v41, 16, v40
    v_lshl_or_b32 v61, v43, 16, v42
    v_lshl_or_b32 v62, v45, 16, v44
    v_lshl_or_b32 v63, v47, 16, v46
    buffer_store_dwordx4 v[60:63], v7, s[20:23], 0 offen offset:3072 sc1
    s_add_u32 s5, s5, 32
    s_cmp_lt_u32 s5, 86
    s_cbranch_scc1 wo_winf
    s_waitcnt vmcnt(0)
    s_barrier
    s_cmp_lg_u32 s3, 0
    s_cbranch_scc1 wo_nw
    s_add_u32 s97, s101, 2
    v_mov_b32 v65, s97
    buffer_store_dword v65, v64, s[40:43], s34 offen sc1
wo_nw:
hp_ogroup:
    s_mov_b32 s16, s74
    s_mov_b32 s17, s75
    s_mov_b32 s18, 0x400000
    s_mov_b32 s19, 0x20000
    s_and_b32 s6, s4, 15
    s_lshr_b32 s7, s4, 4
    v_and_b32 v3, 31, v1
    v_lshrrev_b32 v4, 5, v1
    v_lshlrev_b32 v6, 14, v4
    v_lshl_add_u32 v6, v3, 1, v6
    s_lshl_b32 s32, s3, 20
    s_lshl_b32 s33, s6, 6
    s_add_u32 s32, s32, s33
    s_add_u32 s24, s32, 0
    buffer_load_ushort v16, v6, s[16:19], s24 offen
    s_add_u32 s25, s32, 1024
    buffer_load_ushort v17, v6, s[16:19], s25 offen
    s_add_u32 s26, s32, 2048
    buffer_load_ushort v18, v6, s[16:19], s26 offen
    s_add_u32 s27, s32, 3072
    buffer_load_ushort v19, v6, s[16:19], s27 offen
    s_add_u32 s28, s32, 8192
    buffer_load_ushort v20, v6, s[16:19], s28 offen
    s_add_u32 s29, s32, 9216
    buffer_load_ushort v21, v6, s[16:19], s29 offen
    s_add_u32 s30, s32, 10240
    buffer_load_ushort v22, v6, s[16:19], s30 offen
    s_add_u32 s31, s32, 11264
    buffer_load_ushort v23, v6, s[16:19], s31 offen
    s_add_u32 s24, s32, 4096
    buffer_load_ushort v24, v6, s[16:19], s24 offen
    s_add_u32 s25, s32, 5120
    buffer_load_ushort v25, v6, s[16:19], s25 offen
    s_add_u32 s26, s32, 6144
    buffer_load_ushort v26, v6, s[16:19], s26 offen
    s_add_u32 s27, s32, 7168
    buffer_load_ushort v27, v6, s[16:19], s27 offen
    s_add_u32 s28, s32, 12288
    buffer_load_ushort v28, v6, s[16:19], s28 offen
    s_add_u32 s29, s32, 13312
    buffer_load_ushort v29, v6, s[16:19], s29 offen
    s_add_u32 s30, s32, 14336
    buffer_load_ushort v30, v6, s[16:19], s30 offen
    s_add_u32 s31, s32, 15360
    buffer_load_ushort v31, v6, s[16:19], s31 offen
    s_add_u32 s24, s32, 32768
    buffer_load_ushort v32, v6, s[16:19], s24 offen
    s_add_u32 s25, s32, 33792
    buffer_load_ushort v33, v6, s[16:19], s25 offen
    s_add_u32 s26, s32, 34816
    buffer_load_ushort v34, v6, s[16:19], s26 offen
    s_add_u32 s27, s32, 35840
    buffer_load_ushort v35, v6, s[16:19], s27 offen
    s_add_u32 s28, s32, 40960
    buffer_load_ushort v36, v6, s[16:19], s28 offen
    s_add_u32 s29, s32, 41984
    buffer_load_ushort v37, v6, s[16:19], s29 offen
    s_add_u32 s30, s32, 43008
    buffer_load_ushort v38, v6, s[16:19], s30 offen
    s_add_u32 s31, s32, 44032
    buffer_load_ushort v39, v6, s[16:19], s31 offen
    s_add_u32 s24, s32, 36864
    buffer_load_ushort v40, v6, s[16:19], s24 offen
    s_add_u32 s25, s32, 37888
    buffer_load_ushort v41, v6, s[16:19], s25 offen
    s_add_u32 s26, s32, 38912
    buffer_load_ushort v42, v6, s[16:19], s26 offen
    s_add_u32 s27, s32, 39936
    buffer_load_ushort v43, v6, s[16:19], s27 offen
    s_add_u32 s28, s32, 45056
    buffer_load_ushort v44, v6, s[16:19], s28 offen
    s_add_u32 s29, s32, 46080
    buffer_load_ushort v45, v6, s[16:19], s29 offen
    s_add_u32 s30, s32, 47104
    buffer_load_ushort v46, v6, s[16:19], s30 offen
    s_add_u32 s31, s32, 48128
    buffer_load_ushort v47, v6, s[16:19], s31 offen
    s_add_u32 s24, s32, 65536
    buffer_load_ushort v48, v6, s[16:19], s24 offen
    s_add_u32 s25, s32, 66560
    buffer_load_ushort v49, v6, s[16:19], s25 offen
    s_add_u32 s26, s32, 67584
    buffer_load_ushort v50, v6, s[16:19], s26 offen
    s_add_u32 s27, s32, 68608
    buffer_load_ushort v51, v6, s[16:19], s27 offen
    s_add_u32 s28, s32, 73728
    buffer_load_ushort v52, v6, s[16:19], s28 offen
    s_add_u32 s29, s32, 74752
    buffer_load_ushort v53, v6, s[16:19], s29 offen
    s_add_u32 s30, s32, 75776
    buffer_load_ushort v54, v6, s[16:19], s30 offen
    s_add_u32 s31, s32, 76800
    buffer_load_ushort v55, v6, s[16:19], s31 offen
    s_add_u32 s24, s32, 69632
    buffer_load_ushort v56, v6, s[16:19], s24 offen
    s_add_u32 s25, s32, 70656
    buffer_load_ushort v57, v6, s[16:19], s25 offen
    s_add_u32 s26, s32, 71680
    buffer_load_ushort v58, v6, s[16:19], s26 offen
    s_add_u32 s27, s32, 72704
    buffer_load_ushort v59, v6, s[16:19], s27 offen
    s_add_u32 s28, s32, 77824
    buffer_load_ushort v60, v6, s[16:19], s28 offen
    s_add_u32 s29, s32, 78848
    buffer_load_ushort v61, v6, s[16:19], s29 offen
    s_add_u32 s30, s32, 79872
    buffer_load_ushort v62, v6, s[16:19], s30 offen
    s_add_u32 s31, s32, 80896
    buffer_load_ushort v63, v6, s[16:19], s31 offen
    s_waitcnt vmcnt(40)
    v_lshl_or_b32 v8, v17, 16, v16
    v_lshl_or_b32 v9, v19, 16, v18
    v_lshl_or_b32 v10, v21, 16, v20
    v_lshl_or_b32 v11, v23, 16, v22
    v_accvgpr_write_b32 a0, v8
    v_accvgpr_write_b32 a1, v9
    v_accvgpr_write_b32 a2, v10
    v_accvgpr_write_b32 a3, v11
    s_add_u32 s24, s32, 98304
    buffer_load_ushort v16, v6, s[16:19], s24 offen
    s_add_u32 s25, s32, 99328
    buffer_load_ushort v17, v6, s[16:19], s25 offen
    s_add_u32 s26, s32, 100352
    buffer_load_ushort v18, v6, s[16:19], s26 offen
    s_add_u32 s27, s32, 101376
    buffer_load_ushort v19, v6, s[16:19], s27 offen
    s_add_u32 s28, s32, 106496
    buffer_load_ushort v20, v6, s[16:19], s28 offen
    s_add_u32 s29, s32, 107520
    buffer_load_ushort v21, v6, s[16:19], s29 offen
    s_add_u32 s30, s32, 108544
    buffer_load_ushort v22, v6, s[16:19], s30 offen
    s_add_u32 s31, s32, 109568
    buffer_load_ushort v23, v6, s[16:19], s31 offen
    s_waitcnt vmcnt(40)
    v_lshl_or_b32 v8, v25, 16, v24
    v_lshl_or_b32 v9, v27, 16, v26
    v_lshl_or_b32 v10, v29, 16, v28
    v_lshl_or_b32 v11, v31, 16, v30
    v_accvgpr_write_b32 a4, v8
    v_accvgpr_write_b32 a5, v9
    v_accvgpr_write_b32 a6, v10
    v_accvgpr_write_b32 a7, v11
    s_add_u32 s24, s32, 102400
    buffer_load_ushort v24, v6, s[16:19], s24 offen
    s_add_u32 s25, s32, 103424
    buffer_load_ushort v25, v6, s[16:19], s25 offen
    s_add_u32 s26, s32, 104448
    buffer_load_ushort v26, v6, s[16:19], s26 offen
    s_add_u32 s27, s32, 105472
    buffer_load_ushort v27, v6, s[16:19], s27 offen
    s_add_u32 s28, s32, 110592
    buffer_load_ushort v28, v6, s[16:19], s28 offen
    s_add_u32 s29, s32, 111616
    buffer_load_ushort v29, v6, s[16:19], s29 offen
    s_add_u32 s30, s32, 112640
    buffer_load_ushort v30, v6, s[16:19], s30 offen
    s_add_u32 s31, s32, 113664
    buffer_load_ushort v31, v6, s[16:19], s31 offen
    s_waitcnt vmcnt(40)
    v_lshl_or_b32 v8, v33, 16, v32
    v_lshl_or_b32 v9, v35, 16, v34
    v_lshl_or_b32 v10, v37, 16, v36
    v_lshl_or_b32 v11, v39, 16, v38
    v_accvgpr_write_b32 a8, v8
    v_accvgpr_write_b32 a9, v9
    v_accvgpr_write_b32 a10, v10
    v_accvgpr_write_b32 a11, v11
    s_add_u32 s24, s32, 131072
    buffer_load_ushort v32, v6, s[16:19], s24 offen
    s_add_u32 s25, s32, 132096
    buffer_load_ushort v33, v6, s[16:19], s25 offen
    s_add_u32 s26, s32, 133120
    buffer_load_ushort v34, v6, s[16:19], s26 offen
    s_add_u32 s27, s32, 134144
    buffer_load_ushort v35, v6, s[16:19], s27 offen
    s_add_u32 s28, s32, 139264
    buffer_load_ushort v36, v6, s[16:19], s28 offen
    s_add_u32 s29, s32, 140288
    buffer_load_ushort v37, v6, s[16:19], s29 offen
    s_add_u32 s30, s32, 141312
    buffer_load_ushort v38, v6, s[16:19], s30 offen
    s_add_u32 s31, s32, 142336
    buffer_load_ushort v39, v6, s[16:19], s31 offen
    s_waitcnt vmcnt(40)
    v_lshl_or_b32 v8, v41, 16, v40
    v_lshl_or_b32 v9, v43, 16, v42
    v_lshl_or_b32 v10, v45, 16, v44
    v_lshl_or_b32 v11, v47, 16, v46
    v_accvgpr_write_b32 a12, v8
    v_accvgpr_write_b32 a13, v9
    v_accvgpr_write_b32 a14, v10
    v_accvgpr_write_b32 a15, v11
    s_add_u32 s24, s32, 135168
    buffer_load_ushort v40, v6, s[16:19], s24 offen
    s_add_u32 s25, s32, 136192
    buffer_load_ushort v41, v6, s[16:19], s25 offen
    s_add_u32 s26, s32, 137216
    buffer_load_ushort v42, v6, s[16:19], s26 offen
    s_add_u32 s27, s32, 138240
    buffer_load_ushort v43, v6, s[16:19], s27 offen
    s_add_u32 s28, s32, 143360
    buffer_load_ushort v44, v6, s[16:19], s28 offen
    s_add_u32 s29, s32, 144384
    buffer_load_ushort v45, v6, s[16:19], s29 offen
    s_add_u32 s30, s32, 145408
    buffer_load_ushort v46, v6, s[16:19], s30 offen
    s_add_u32 s31, s32, 146432
    buffer_load_ushort v47, v6, s[16:19], s31 offen
    s_waitcnt vmcnt(40)
    v_lshl_or_b32 v8, v49, 16, v48
    v_lshl_or_b32 v9, v51, 16, v50
    v_lshl_or_b32 v10, v53, 16, v52
    v_lshl_or_b32 v11, v55, 16, v54
    v_accvgpr_write_b32 a16, v8
    v_accvgpr_write_b32 a17, v9
    v_accvgpr_write_b32 a18, v10
    v_accvgpr_write_b32 a19, v11
    s_add_u32 s24, s32, 163840
    buffer_load_ushort v48, v6, s[16:19], s24 offen
    s_add_u32 s25, s32, 164864
    buffer_load_ushort v49, v6, s[16:19], s25 offen
    s_add_u32 s26, s32, 165888
    buffer_load_ushort v50, v6, s[16:19], s26 offen
    s_add_u32 s27, s32, 166912
    buffer_load_ushort v51, v6, s[16:19], s27 offen
    s_add_u32 s28, s32, 172032
    buffer_load_ushort v52, v6, s[16:19], s28 offen
    s_add_u32 s29, s32, 173056
    buffer_load_ushort v53, v6, s[16:19], s29 offen
    s_add_u32 s30, s32, 174080
    buffer_load_ushort v54, v6, s[16:19], s30 offen
    s_add_u32 s31, s32, 175104
    buffer_load_ushort v55, v6, s[16:19], s31 offen
    s_waitcnt vmcnt(40)
    v_lshl_or_b32 v8, v57, 16, v56
    v_lshl_or_b32 v9, v59, 16, v58
    v_lshl_or_b32 v10, v61, 16, v60
    v_lshl_or_b32 v11, v63, 16, v62
    v_accvgpr_write_b32 a20, v8
    v_accvgpr_write_b32 a21, v9
    v_accvgpr_write_b32 a22, v10
    v_accvgpr_write_b32 a23, v11
    s_add_u32 s24, s32, 167936
    buffer_load_ushort v56, v6, s[16:19], s24 offen
    s_add_u32 s25, s32, 168960
    buffer_load_ushort v57, v6, s[16:19], s25 offen
    s_add_u32 s26, s32, 169984
    buffer_load_ushort v58, v6, s[16:19], s26 offen
    s_add_u32 s27, s32, 171008
    buffer_load_ushort v59, v6, s[16:19], s27 offen
    s_add_u32 s28, s32, 176128
    buffer_load_ushort v60, v6, s[16:19], s28 offen
    s_add_u32 s29, s32, 177152
    buffer_load_ushort v61, v6, s[16:19], s29 offen
    s_add_u32 s30, s32, 178176
    buffer_load_ushort v62, v6, s[16:19], s30 offen
    s_add_u32 s31, s32, 179200
    buffer_load_ushort v63, v6, s[16:19], s31 offen
    s_waitcnt vmcnt(40)
    v_lshl_or_b32 v8, v17, 16, v16
    v_lshl_or_b32 v9, v19, 16, v18
    v_lshl_or_b32 v10, v21, 16, v20
    v_lshl_or_b32 v11, v23, 16, v22
    v_accvgpr_write_b32 a24, v8
    v_accvgpr_write_b32 a25, v9
    v_accvgpr_write_b32 a26, v10
    v_accvgpr_write_b32 a27, v11
    s_add_u32 s24, s32, 196608
    buffer_load_ushort v16, v6, s[16:19], s24 offen
    s_add_u32 s25, s32, 197632
    buffer_load_ushort v17, v6, s[16:19], s25 offen
    s_add_u32 s26, s32, 198656
    buffer_load_ushort v18, v6, s[16:19], s26 offen
    s_add_u32 s27, s32, 199680
    buffer_load_ushort v19, v6, s[16:19], s27 offen
    s_add_u32 s28, s32, 204800
    buffer_load_ushort v20, v6, s[16:19], s28 offen
    s_add_u32 s29, s32, 205824
    buffer_load_ushort v21, v6, s[16:19], s29 offen
    s_add_u32 s30, s32, 206848
    buffer_load_ushort v22, v6, s[16:19], s30 offen
    s_add_u32 s31, s32, 207872
    buffer_load_ushort v23, v6, s[16:19], s31 offen
    s_waitcnt vmcnt(40)
    v_lshl_or_b32 v8, v25, 16, v24
    v_lshl_or_b32 v9, v27, 16, v26
    v_lshl_or_b32 v10, v29, 16, v28
    v_lshl_or_b32 v11, v31, 16, v30
    v_accvgpr_write_b32 a28, v8
    v_accvgpr_write_b32 a29, v9
    v_accvgpr_write_b32 a30, v10
    v_accvgpr_write_b32 a31, v11
    s_add_u32 s24, s32, 200704
    buffer_load_ushort v24, v6, s[16:19], s24 offen
    s_add_u32 s25, s32, 201728
    buffer_load_ushort v25, v6, s[16:19], s25 offen
    s_add_u32 s26, s32, 202752
    buffer_load_ushort v26, v6, s[16:19], s26 offen
    s_add_u32 s27, s32, 203776
    buffer_load_ushort v27, v6, s[16:19], s27 offen
    s_add_u32 s28, s32, 208896
    buffer_load_ushort v28, v6, s[16:19], s28 offen
    s_add_u32 s29, s32, 209920
    buffer_load_ushort v29, v6, s[16:19], s29 offen
    s_add_u32 s30, s32, 210944
    buffer_load_ushort v30, v6, s[16:19], s30 offen
    s_add_u32 s31, s32, 211968
    buffer_load_ushort v31, v6, s[16:19], s31 offen
    s_waitcnt vmcnt(40)
    v_lshl_or_b32 v8, v33, 16, v32
    v_lshl_or_b32 v9, v35, 16, v34
    v_lshl_or_b32 v10, v37, 16, v36
    v_lshl_or_b32 v11, v39, 16, v38
    v_accvgpr_write_b32 a32, v8
    v_accvgpr_write_b32 a33, v9
    v_accvgpr_write_b32 a34, v10
    v_accvgpr_write_b32 a35, v11
    s_add_u32 s24, s32, 229376
    buffer_load_ushort v32, v6, s[16:19], s24 offen
    s_add_u32 s25, s32, 230400
    buffer_load_ushort v33, v6, s[16:19], s25 offen
    s_add_u32 s26, s32, 231424
    buffer_load_ushort v34, v6, s[16:19], s26 offen
    s_add_u32 s27, s32, 232448
    buffer_load_ushort v35, v6, s[16:19], s27 offen
    s_add_u32 s28, s32, 237568
    buffer_load_ushort v36, v6, s[16:19], s28 offen
    s_add_u32 s29, s32, 238592
    buffer_load_ushort v37, v6, s[16:19], s29 offen
    s_add_u32 s30, s32, 239616
    buffer_load_ushort v38, v6, s[16:19], s30 offen
    s_add_u32 s31, s32, 240640
    buffer_load_ushort v39, v6, s[16:19], s31 offen
    s_waitcnt vmcnt(40)
    v_lshl_or_b32 v8, v41, 16, v40
    v_lshl_or_b32 v9, v43, 16, v42
    v_lshl_or_b32 v10, v45, 16, v44
    v_lshl_or_b32 v11, v47, 16, v46
    v_accvgpr_write_b32 a36, v8
    v_accvgpr_write_b32 a37, v9
    v_accvgpr_write_b32 a38, v10
    v_accvgpr_write_b32 a39, v11
    s_add_u32 s24, s32, 233472
    buffer_load_ushort v40, v6, s[16:19], s24 offen
    s_add_u32 s25, s32, 234496
    buffer_load_ushort v41, v6, s[16:19], s25 offen
    s_add_u32 s26, s32, 235520
    buffer_load_ushort v42, v6, s[16:19], s26 offen
    s_add_u32 s27, s32, 236544
    buffer_load_ushort v43, v6, s[16:19], s27 offen
    s_add_u32 s28, s32, 241664
    buffer_load_ushort v44, v6, s[16:19], s28 offen
    s_add_u32 s29, s32, 242688
    buffer_load_ushort v45, v6, s[16:19], s29 offen
    s_add_u32 s30, s32, 243712
    buffer_load_ushort v46, v6, s[16:19], s30 offen
    s_add_u32 s31, s32, 244736
    buffer_load_ushort v47, v6, s[16:19], s31 offen
    s_waitcnt vmcnt(40)
    v_lshl_or_b32 v8, v49, 16, v48
    v_lshl_or_b32 v9, v51, 16, v50
    v_lshl_or_b32 v10, v53, 16, v52
    v_lshl_or_b32 v11, v55, 16, v54
    v_accvgpr_write_b32 a40, v8
    v_accvgpr_write_b32 a41, v9
    v_accvgpr_write_b32 a42, v10
    v_accvgpr_write_b32 a43, v11
    s_add_u32 s24, s32, 262144
    buffer_load_ushort v48, v6, s[16:19], s24 offen
    s_add_u32 s25, s32, 263168
    buffer_load_ushort v49, v6, s[16:19], s25 offen
    s_add_u32 s26, s32, 264192
    buffer_load_ushort v50, v6, s[16:19], s26 offen
    s_add_u32 s27, s32, 265216
    buffer_load_ushort v51, v6, s[16:19], s27 offen
    s_add_u32 s28, s32, 270336
    buffer_load_ushort v52, v6, s[16:19], s28 offen
    s_add_u32 s29, s32, 271360
    buffer_load_ushort v53, v6, s[16:19], s29 offen
    s_add_u32 s30, s32, 272384
    buffer_load_ushort v54, v6, s[16:19], s30 offen
    s_add_u32 s31, s32, 273408
    buffer_load_ushort v55, v6, s[16:19], s31 offen
    s_waitcnt vmcnt(40)
    v_lshl_or_b32 v8, v57, 16, v56
    v_lshl_or_b32 v9, v59, 16, v58
    v_lshl_or_b32 v10, v61, 16, v60
    v_lshl_or_b32 v11, v63, 16, v62
    v_accvgpr_write_b32 a44, v8
    v_accvgpr_write_b32 a45, v9
    v_accvgpr_write_b32 a46, v10
    v_accvgpr_write_b32 a47, v11
    s_add_u32 s24, s32, 266240
    buffer_load_ushort v56, v6, s[16:19], s24 offen
    s_add_u32 s25, s32, 267264
    buffer_load_ushort v57, v6, s[16:19], s25 offen
    s_add_u32 s26, s32, 268288
    buffer_load_ushort v58, v6, s[16:19], s26 offen
    s_add_u32 s27, s32, 269312
    buffer_load_ushort v59, v6, s[16:19], s27 offen
    s_add_u32 s28, s32, 274432
    buffer_load_ushort v60, v6, s[16:19], s28 offen
    s_add_u32 s29, s32, 275456
    buffer_load_ushort v61, v6, s[16:19], s29 offen
    s_add_u32 s30, s32, 276480
    buffer_load_ushort v62, v6, s[16:19], s30 offen
    s_add_u32 s31, s32, 277504
    buffer_load_ushort v63, v6, s[16:19], s31 offen
    s_waitcnt vmcnt(40)
    v_lshl_or_b32 v8, v17, 16, v16
    v_lshl_or_b32 v9, v19, 16, v18
    v_lshl_or_b32 v10, v21, 16, v20
    v_lshl_or_b32 v11, v23, 16, v22
    v_accvgpr_write_b32 a48, v8
    v_accvgpr_write_b32 a49, v9
    v_accvgpr_write_b32 a50, v10
    v_accvgpr_write_b32 a51, v11
    s_add_u32 s24, s32, 294912
    buffer_load_ushort v16, v6, s[16:19], s24 offen
    s_add_u32 s25, s32, 295936
    buffer_load_ushort v17, v6, s[16:19], s25 offen
    s_add_u32 s26, s32, 296960
    buffer_load_ushort v18, v6, s[16:19], s26 offen
    s_add_u32 s27, s32, 297984
    buffer_load_ushort v19, v6, s[16:19], s27 offen
    s_add_u32 s28, s32, 303104
    buffer_load_ushort v20, v6, s[16:19], s28 offen
    s_add_u32 s29, s32, 304128
    buffer_load_ushort v21, v6, s[16:19], s29 offen
    s_add_u32 s30, s32, 305152
    buffer_load_ushort v22, v6, s[16:19], s30 offen
    s_add_u32 s31, s32, 306176
    buffer_load_ushort v23, v6, s[16:19], s31 offen
    s_waitcnt vmcnt(40)
    v_lshl_or_b32 v8, v25, 16, v24
    v_lshl_or_b32 v9, v27, 16, v26
    v_lshl_or_b32 v10, v29, 16, v28
    v_lshl_or_b32 v11, v31, 16, v30
    v_accvgpr_write_b32 a52, v8
    v_accvgpr_write_b32 a53, v9
    v_accvgpr_write_b32 a54, v10
    v_accvgpr_write_b32 a55, v11
    s_add_u32 s24, s32, 299008
    buffer_load_ushort v24, v6, s[16:19], s24 offen
    s_add_u32 s25, s32, 300032
    buffer_load_ushort v25, v6, s[16:19], s25 offen
    s_add_u32 s26, s32, 301056
    buffer_load_ushort v26, v6, s[16:19], s26 offen
    s_add_u32 s27, s32, 302080
    buffer_load_ushort v27, v6, s[16:19], s27 offen
    s_add_u32 s28, s32, 307200
    buffer_load_ushort v28, v6, s[16:19], s28 offen
    s_add_u32 s29, s32, 308224
    buffer_load_ushort v29, v6, s[16:19], s29 offen
    s_add_u32 s30, s32, 309248
    buffer_load_ushort v30, v6, s[16:19], s30 offen
    s_add_u32 s31, s32, 310272
    buffer_load_ushort v31, v6, s[16:19], s31 offen
    s_waitcnt vmcnt(40)
    v_lshl_or_b32 v8, v33, 16, v32
    v_lshl_or_b32 v9, v35, 16, v34
    v_lshl_or_b32 v10, v37, 16, v36
    v_lshl_or_b32 v11, v39, 16, v38
    v_accvgpr_write_b32 a56, v8
    v_accvgpr_write_b32 a57, v9
    v_accvgpr_write_b32 a58, v10
    v_accvgpr_write_b32 a59, v11
    s_add_u32 s24, s32, 327680
    buffer_load_ushort v32, v6, s[16:19], s24 offen
    s_add_u32 s25, s32, 328704
    buffer_load_ushort v33, v6, s[16:19], s25 offen
    s_add_u32 s26, s32, 329728
    buffer_load_ushort v34, v6, s[16:19], s26 offen
    s_add_u32 s27, s32, 330752
    buffer_load_ushort v35, v6, s[16:19], s27 offen
    s_add_u32 s28, s32, 335872
    buffer_load_ushort v36, v6, s[16:19], s28 offen
    s_add_u32 s29, s32, 336896
    buffer_load_ushort v37, v6, s[16:19], s29 offen
    s_add_u32 s30, s32, 337920
    buffer_load_ushort v38, v6, s[16:19], s30 offen
    s_add_u32 s31, s32, 338944
    buffer_load_ushort v39, v6, s[16:19], s31 offen
    s_waitcnt vmcnt(40)
    v_lshl_or_b32 v8, v41, 16, v40
    v_lshl_or_b32 v9, v43, 16, v42
    v_lshl_or_b32 v10, v45, 16, v44
    v_lshl_or_b32 v11, v47, 16, v46
    v_accvgpr_write_b32 a60, v8
    v_accvgpr_write_b32 a61, v9
    v_accvgpr_write_b32 a62, v10
    v_accvgpr_write_b32 a63, v11
    s_add_u32 s24, s32, 331776
    buffer_load_ushort v40, v6, s[16:19], s24 offen
    s_add_u32 s25, s32, 332800
    buffer_load_ushort v41, v6, s[16:19], s25 offen
    s_add_u32 s26, s32, 333824
    buffer_load_ushort v42, v6, s[16:19], s26 offen
    s_add_u32 s27, s32, 334848
    buffer_load_ushort v43, v6, s[16:19], s27 offen
    s_add_u32 s28, s32, 339968
    buffer_load_ushort v44, v6, s[16:19], s28 offen
    s_add_u32 s29, s32, 340992
    buffer_load_ushort v45, v6, s[16:19], s29 offen
    s_add_u32 s30, s32, 342016
    buffer_load_ushort v46, v6, s[16:19], s30 offen
    s_add_u32 s31, s32, 343040
    buffer_load_ushort v47, v6, s[16:19], s31 offen
    s_waitcnt vmcnt(40)
    v_lshl_or_b32 v8, v49, 16, v48
    v_lshl_or_b32 v9, v51, 16, v50
    v_lshl_or_b32 v10, v53, 16, v52
    v_lshl_or_b32 v11, v55, 16, v54
    v_accvgpr_write_b32 a64, v8
    v_accvgpr_write_b32 a65, v9
    v_accvgpr_write_b32 a66, v10
    v_accvgpr_write_b32 a67, v11
    s_add_u32 s24, s32, 360448
    buffer_load_ushort v48, v6, s[16:19], s24 offen
    s_add_u32 s25, s32, 361472
    buffer_load_ushort v49, v6, s[16:19], s25 offen
    s_add_u32 s26, s32, 362496
    buffer_load_ushort v50, v6, s[16:19], s26 offen
    s_add_u32 s27, s32, 363520
    buffer_load_ushort v51, v6, s[16:19], s27 offen
    s_add_u32 s28, s32, 368640
    buffer_load_ushort v52, v6, s[16:19], s28 offen
    s_add_u32 s29, s32, 369664
    buffer_load_ushort v53, v6, s[16:19], s29 offen
    s_add_u32 s30, s32, 370688
    buffer_load_ushort v54, v6, s[16:19], s30 offen
    s_add_u32 s31, s32, 371712
    buffer_load_ushort v55, v6, s[16:19], s31 offen
    s_waitcnt vmcnt(40)
    v_lshl_or_b32 v8, v57, 16, v56
    v_lshl_or_b32 v9, v59, 16, v58
    v_lshl_or_b32 v10, v61, 16, v60
    v_lshl_or_b32 v11, v63, 16, v62
    v_accvgpr_write_b32 a68, v8
    v_accvgpr_write_b32 a69, v9
    v_accvgpr_write_b32 a70, v10
    v_accvgpr_write_b32 a71, v11
    s_add_u32 s24, s32, 364544
    buffer_load_ushort v56, v6, s[16:19], s24 offen
    s_add_u32 s25, s32, 365568
    buffer_load_ushort v57, v6, s[16:19], s25 offen
    s_add_u32 s26, s32, 366592
    buffer_load_ushort v58, v6, s[16:19], s26 offen
    s_add_u32 s27, s32, 367616
    buffer_load_ushort v59, v6, s[16:19], s27 offen
    s_add_u32 s28, s32, 372736
    buffer_load_ushort v60, v6, s[16:19], s28 offen
    s_add_u32 s29, s32, 373760
    buffer_load_ushort v61, v6, s[16:19], s29 offen
    s_add_u32 s30, s32, 374784
    buffer_load_ushort v62, v6, s[16:19], s30 offen
    s_add_u32 s31, s32, 375808
    buffer_load_ushort v63, v6, s[16:19], s31 offen
    s_waitcnt vmcnt(40)
    v_lshl_or_b32 v8, v17, 16, v16
    v_lshl_or_b32 v9, v19, 16, v18
    v_lshl_or_b32 v10, v21, 16, v20
    v_lshl_or_b32 v11, v23, 16, v22
    v_accvgpr_write_b32 a72, v8
    v_accvgpr_write_b32 a73, v9
    v_accvgpr_write_b32 a74, v10
    v_accvgpr_write_b32 a75, v11
    s_add_u32 s24, s32, 393216
    buffer_load_ushort v16, v6, s[16:19], s24 offen
    s_add_u32 s25, s32, 394240
    buffer_load_ushort v17, v6, s[16:19], s25 offen
    s_add_u32 s26, s32, 395264
    buffer_load_ushort v18, v6, s[16:19], s26 offen
    s_add_u32 s27, s32, 396288
    buffer_load_ushort v19, v6, s[16:19], s27 offen
    s_add_u32 s28, s32, 401408
    buffer_load_ushort v20, v6, s[16:19], s28 offen
    s_add_u32 s29, s32, 402432
    buffer_load_ushort v21, v6, s[16:19], s29 offen
    s_add_u32 s30, s32, 403456
    buffer_load_ushort v22, v6, s[16:19], s30 offen
    s_add_u32 s31, s32, 404480
    buffer_load_ushort v23, v6, s[16:19], s31 offen
    s_waitcnt vmcnt(40)
    v_lshl_or_b32 v8, v25, 16, v24
    v_lshl_or_b32 v9, v27, 16, v26
    v_lshl_or_b32 v10, v29, 16, v28
    v_lshl_or_b32 v11, v31, 16, v30
    v_accvgpr_write_b32 a76, v8
    v_accvgpr_write_b32 a77, v9
    v_accvgpr_write_b32 a78, v10
    v_accvgpr_write_b32 a79, v11
    s_add_u32 s24, s32, 397312
    buffer_load_ushort v24, v6, s[16:19], s24 offen
    s_add_u32 s25, s32, 398336
    buffer_load_ushort v25, v6, s[16:19], s25 offen
    s_add_u32 s26, s32, 399360
    buffer_load_ushort v26, v6, s[16:19], s26 offen
    s_add_u32 s27, s32, 400384
    buffer_load_ushort v27, v6, s[16:19], s27 offen
    s_add_u32 s28, s32, 405504
    buffer_load_ushort v28, v6, s[16:19], s28 offen
    s_add_u32 s29, s32, 406528
    buffer_load_ushort v29, v6, s[16:19], s29 offen
    s_add_u32 s30, s32, 407552
    buffer_load_ushort v30, v6, s[16:19], s30 offen
    s_add_u32 s31, s32, 408576
    buffer_load_ushort v31, v6, s[16:19], s31 offen
    s_waitcnt vmcnt(40)
    v_lshl_or_b32 v8, v33, 16, v32
    v_lshl_or_b32 v9, v35, 16, v34
    v_lshl_or_b32 v10, v37, 16, v36
    v_lshl_or_b32 v11, v39, 16, v38
    v_accvgpr_write_b32 a80, v8
    v_accvgpr_write_b32 a81, v9
    v_accvgpr_write_b32 a82, v10
    v_accvgpr_write_b32 a83, v11
    s_add_u32 s24, s32, 425984
    buffer_load_ushort v32, v6, s[16:19], s24 offen
    s_add_u32 s25, s32, 427008
    buffer_load_ushort v33, v6, s[16:19], s25 offen
    s_add_u32 s26, s32, 428032
    buffer_load_ushort v34, v6, s[16:19], s26 offen
    s_add_u32 s27, s32, 429056
    buffer_load_ushort v35, v6, s[16:19], s27 offen
    s_add_u32 s28, s32, 434176
    buffer_load_ushort v36, v6, s[16:19], s28 offen
    s_add_u32 s29, s32, 435200
    buffer_load_ushort v37, v6, s[16:19], s29 offen
    s_add_u32 s30, s32, 436224
    buffer_load_ushort v38, v6, s[16:19], s30 offen
    s_add_u32 s31, s32, 437248
    buffer_load_ushort v39, v6, s[16:19], s31 offen
    s_waitcnt vmcnt(40)
    v_lshl_or_b32 v8, v41, 16, v40
    v_lshl_or_b32 v9, v43, 16, v42
    v_lshl_or_b32 v10, v45, 16, v44
    v_lshl_or_b32 v11, v47, 16, v46
    v_accvgpr_write_b32 a84, v8
    v_accvgpr_write_b32 a85, v9
    v_accvgpr_write_b32 a86, v10
    v_accvgpr_write_b32 a87, v11
    s_add_u32 s24, s32, 430080
    buffer_load_ushort v40, v6, s[16:19], s24 offen
    s_add_u32 s25, s32, 431104
    buffer_load_ushort v41, v6, s[16:19], s25 offen
    s_add_u32 s26, s32, 432128
    buffer_load_ushort v42, v6, s[16:19], s26 offen
    s_add_u32 s27, s32, 433152
    buffer_load_ushort v43, v6, s[16:19], s27 offen
    s_add_u32 s28, s32, 438272
    buffer_load_ushort v44, v6, s[16:19], s28 offen
    s_add_u32 s29, s32, 439296
    buffer_load_ushort v45, v6, s[16:19], s29 offen
    s_add_u32 s30, s32, 440320
    buffer_load_ushort v46, v6, s[16:19], s30 offen
    s_add_u32 s31, s32, 441344
    buffer_load_ushort v47, v6, s[16:19], s31 offen
    s_waitcnt vmcnt(40)
    v_lshl_or_b32 v8, v49, 16, v48
    v_lshl_or_b32 v9, v51, 16, v50
    v_lshl_or_b32 v10, v53, 16, v52
    v_lshl_or_b32 v11, v55, 16, v54
    v_accvgpr_write_b32 a88, v8
    v_accvgpr_write_b32 a89, v9
    v_accvgpr_write_b32 a90, v10
    v_accvgpr_write_b32 a91, v11
    s_add_u32 s24, s32, 458752
    buffer_load_ushort v48, v6, s[16:19], s24 offen
    s_add_u32 s25, s32, 459776
    buffer_load_ushort v49, v6, s[16:19], s25 offen
    s_add_u32 s26, s32, 460800
    buffer_load_ushort v50, v6, s[16:19], s26 offen
    s_add_u32 s27, s32, 461824
    buffer_load_ushort v51, v6, s[16:19], s27 offen
    s_add_u32 s28, s32, 466944
    buffer_load_ushort v52, v6, s[16:19], s28 offen
    s_add_u32 s29, s32, 467968
    buffer_load_ushort v53, v6, s[16:19], s29 offen
    s_add_u32 s30, s32, 468992
    buffer_load_ushort v54, v6, s[16:19], s30 offen
    s_add_u32 s31, s32, 470016
    buffer_load_ushort v55, v6, s[16:19], s31 offen
    s_waitcnt vmcnt(40)
    v_lshl_or_b32 v8, v57, 16, v56
    v_lshl_or_b32 v9, v59, 16, v58
    v_lshl_or_b32 v10, v61, 16, v60
    v_lshl_or_b32 v11, v63, 16, v62
    v_accvgpr_write_b32 a92, v8
    v_accvgpr_write_b32 a93, v9
    v_accvgpr_write_b32 a94, v10
    v_accvgpr_write_b32 a95, v11
    s_add_u32 s24, s32, 462848
    buffer_load_ushort v56, v6, s[16:19], s24 offen
    s_add_u32 s25, s32, 463872
    buffer_load_ushort v57, v6, s[16:19], s25 offen
    s_add_u32 s26, s32, 464896
    buffer_load_ushort v58, v6, s[16:19], s26 offen
    s_add_u32 s27, s32, 465920
    buffer_load_ushort v59, v6, s[16:19], s27 offen
    s_add_u32 s28, s32, 471040
    buffer_load_ushort v60, v6, s[16:19], s28 offen
    s_add_u32 s29, s32, 472064
    buffer_load_ushort v61, v6, s[16:19], s29 offen
    s_add_u32 s30, s32, 473088
    buffer_load_ushort v62, v6, s[16:19], s30 offen
    s_add_u32 s31, s32, 474112
    buffer_load_ushort v63, v6, s[16:19], s31 offen
    s_waitcnt vmcnt(40)
    v_lshl_or_b32 v8, v17, 16, v16
    v_lshl_or_b32 v9, v19, 16, v18
    v_lshl_or_b32 v10, v21, 16, v20
    v_lshl_or_b32 v11, v23, 16, v22
    v_accvgpr_write_b32 a96, v8
    v_accvgpr_write_b32 a97, v9
    v_accvgpr_write_b32 a98, v10
    v_accvgpr_write_b32 a99, v11
    s_add_u32 s24, s32, 491520
    buffer_load_ushort v16, v6, s[16:19], s24 offen
    s_add_u32 s25, s32, 492544
    buffer_load_ushort v17, v6, s[16:19], s25 offen
    s_add_u32 s26, s32, 493568
    buffer_load_ushort v18, v6, s[16:19], s26 offen
    s_add_u32 s27, s32, 494592
    buffer_load_ushort v19, v6, s[16:19], s27 offen
    s_add_u32 s28, s32, 499712
    buffer_load_ushort v20, v6, s[16:19], s28 offen
    s_add_u32 s29, s32, 500736
    buffer_load_ushort v21, v6, s[16:19], s29 offen
    s_add_u32 s30, s32, 501760
    buffer_load_ushort v22, v6, s[16:19], s30 offen
    s_add_u32 s31, s32, 502784
    buffer_load_ushort v23, v6, s[16:19], s31 offen
    s_waitcnt vmcnt(40)
    v_lshl_or_b32 v8, v25, 16, v24
    v_lshl_or_b32 v9, v27, 16, v26
    v_lshl_or_b32 v10, v29, 16, v28
    v_lshl_or_b32 v11, v31, 16, v30
    v_accvgpr_write_b32 a100, v8
    v_accvgpr_write_b32 a101, v9
    v_accvgpr_write_b32 a102, v10
    v_accvgpr_write_b32 a103, v11
    s_add_u32 s24, s32, 495616
    buffer_load_ushort v24, v6, s[16:19], s24 offen
    s_add_u32 s25, s32, 496640
    buffer_load_ushort v25, v6, s[16:19], s25 offen
    s_add_u32 s26, s32, 497664
    buffer_load_ushort v26, v6, s[16:19], s26 offen
    s_add_u32 s27, s32, 498688
    buffer_load_ushort v27, v6, s[16:19], s27 offen
    s_add_u32 s28, s32, 503808
    buffer_load_ushort v28, v6, s[16:19], s28 offen
    s_add_u32 s29, s32, 504832
    buffer_load_ushort v29, v6, s[16:19], s29 offen
    s_add_u32 s30, s32, 505856
    buffer_load_ushort v30, v6, s[16:19], s30 offen
    s_add_u32 s31, s32, 506880
    buffer_load_ushort v31, v6, s[16:19], s31 offen
    s_waitcnt vmcnt(40)
    v_lshl_or_b32 v8, v33, 16, v32
    v_lshl_or_b32 v9, v35, 16, v34
    v_lshl_or_b32 v10, v37, 16, v36
    v_lshl_or_b32 v11, v39, 16, v38
    v_accvgpr_write_b32 a104, v8
    v_accvgpr_write_b32 a105, v9
    v_accvgpr_write_b32 a106, v10
    v_accvgpr_write_b32 a107, v11
    s_add_u32 s24, s32, 524288
    buffer_load_ushort v32, v6, s[16:19], s24 offen
    s_add_u32 s25, s32, 525312
    buffer_load_ushort v33, v6, s[16:19], s25 offen
    s_add_u32 s26, s32, 526336
    buffer_load_ushort v34, v6, s[16:19], s26 offen
    s_add_u32 s27, s32, 527360
    buffer_load_ushort v35, v6, s[16:19], s27 offen
    s_add_u32 s28, s32, 532480
    buffer_load_ushort v36, v6, s[16:19], s28 offen
    s_add_u32 s29, s32, 533504
    buffer_load_ushort v37, v6, s[16:19], s29 offen
    s_add_u32 s30, s32, 534528
    buffer_load_ushort v38, v6, s[16:19], s30 offen
    s_add_u32 s31, s32, 535552
    buffer_load_ushort v39, v6, s[16:19], s31 offen
    s_waitcnt vmcnt(40)
    v_lshl_or_b32 v8, v41, 16, v40
    v_lshl_or_b32 v9, v43, 16, v42
    v_lshl_or_b32 v10, v45, 16, v44
    v_lshl_or_b32 v11, v47, 16, v46
    v_accvgpr_write_b32 a108, v8
    v_accvgpr_write_b32 a109, v9
    v_accvgpr_write_b32 a110, v10
    v_accvgpr_write_b32 a111, v11
    s_add_u32 s24, s32, 528384
    buffer_load_ushort v40, v6, s[16:19], s24 offen
    s_add_u32 s25, s32, 529408
    buffer_load_ushort v41, v6, s[16:19], s25 offen
    s_add_u32 s26, s32, 530432
    buffer_load_ushort v42, v6, s[16:19], s26 offen
    s_add_u32 s27, s32, 531456
    buffer_load_ushort v43, v6, s[16:19], s27 offen
    s_add_u32 s28, s32, 536576
    buffer_load_ushort v44, v6, s[16:19], s28 offen
    s_add_u32 s29, s32, 537600
    buffer_load_ushort v45, v6, s[16:19], s29 offen
    s_add_u32 s30, s32, 538624
    buffer_load_ushort v46, v6, s[16:19], s30 offen
    s_add_u32 s31, s32, 539648
    buffer_load_ushort v47, v6, s[16:19], s31 offen
    s_waitcnt vmcnt(40)
    v_lshl_or_b32 v8, v49, 16, v48
    v_lshl_or_b32 v9, v51, 16, v50
    v_lshl_or_b32 v10, v53, 16, v52
    v_lshl_or_b32 v11, v55, 16, v54
    v_accvgpr_write_b32 a112, v8
    v_accvgpr_write_b32 a113, v9
    v_accvgpr_write_b32 a114, v10
    v_accvgpr_write_b32 a115, v11
    s_add_u32 s24, s32, 557056
    buffer_load_ushort v48, v6, s[16:19], s24 offen
    s_add_u32 s25, s32, 558080
    buffer_load_ushort v49, v6, s[16:19], s25 offen
    s_add_u32 s26, s32, 559104
    buffer_load_ushort v50, v6, s[16:19], s26 offen
    s_add_u32 s27, s32, 560128
    buffer_load_ushort v51, v6, s[16:19], s27 offen
    s_add_u32 s28, s32, 565248
    buffer_load_ushort v52, v6, s[16:19], s28 offen
    s_add_u32 s29, s32, 566272
    buffer_load_ushort v53, v6, s[16:19], s29 offen
    s_add_u32 s30, s32, 567296
    buffer_load_ushort v54, v6, s[16:19], s30 offen
    s_add_u32 s31, s32, 568320
    buffer_load_ushort v55, v6, s[16:19], s31 offen
    s_waitcnt vmcnt(40)
    v_lshl_or_b32 v8, v57, 16, v56
    v_lshl_or_b32 v9, v59, 16, v58
    v_lshl_or_b32 v10, v61, 16, v60
    v_lshl_or_b32 v11, v63, 16, v62
    v_accvgpr_write_b32 a116, v8
    v_accvgpr_write_b32 a117, v9
    v_accvgpr_write_b32 a118, v10
    v_accvgpr_write_b32 a119, v11
    s_add_u32 s24, s32, 561152
    buffer_load_ushort v56, v6, s[16:19], s24 offen
    s_add_u32 s25, s32, 562176
    buffer_load_ushort v57, v6, s[16:19], s25 offen
    s_add_u32 s26, s32, 563200
    buffer_load_ushort v58, v6, s[16:19], s26 offen
    s_add_u32 s27, s32, 564224
    buffer_load_ushort v59, v6, s[16:19], s27 offen
    s_add_u32 s28, s32, 569344
    buffer_load_ushort v60, v6, s[16:19], s28 offen
    s_add_u32 s29, s32, 570368
    buffer_load_ushort v61, v6, s[16:19], s29 offen
    s_add_u32 s30, s32, 571392
    buffer_load_ushort v62, v6, s[16:19], s30 offen
    s_add_u32 s31, s32, 572416
    buffer_load_ushort v63, v6, s[16:19], s31 offen
    s_waitcnt vmcnt(40)
    v_lshl_or_b32 v8, v17, 16, v16
    v_lshl_or_b32 v9, v19, 16, v18
    v_lshl_or_b32 v10, v21, 16, v20
    v_lshl_or_b32 v11, v23, 16, v22
    v_accvgpr_write_b32 a120, v8
    v_accvgpr_write_b32 a121, v9
    v_accvgpr_write_b32 a122, v10
    v_accvgpr_write_b32 a123, v11
    s_add_u32 s24, s32, 589824
    buffer_load_ushort v16, v6, s[16:19], s24 offen
    s_add_u32 s25, s32, 590848
    buffer_load_ushort v17, v6, s[16:19], s25 offen
    s_add_u32 s26, s32, 591872
    buffer_load_ushort v18, v6, s[16:19], s26 offen
    s_add_u32 s27, s32, 592896
    buffer_load_ushort v19, v6, s[16:19], s27 offen
    s_add_u32 s28, s32, 598016
    buffer_load_ushort v20, v6, s[16:19], s28 offen
    s_add_u32 s29, s32, 599040
    buffer_load_ushort v21, v6, s[16:19], s29 offen
    s_add_u32 s30, s32, 600064
    buffer_load_ushort v22, v6, s[16:19], s30 offen
    s_add_u32 s31, s32, 601088
    buffer_load_ushort v23, v6, s[16:19], s31 offen
    s_waitcnt vmcnt(40)
    v_lshl_or_b32 v8, v25, 16, v24
    v_lshl_or_b32 v9, v27, 16, v26
    v_lshl_or_b32 v10, v29, 16, v28
    v_lshl_or_b32 v11, v31, 16, v30
    v_accvgpr_write_b32 a124, v8
    v_accvgpr_write_b32 a125, v9
    v_accvgpr_write_b32 a126, v10
    v_accvgpr_write_b32 a127, v11
    s_add_u32 s24, s32, 593920
    buffer_load_ushort v24, v6, s[16:19], s24 offen
    s_add_u32 s25, s32, 594944
    buffer_load_ushort v25, v6, s[16:19], s25 offen
    s_add_u32 s26, s32, 595968
    buffer_load_ushort v26, v6, s[16:19], s26 offen
    s_add_u32 s27, s32, 596992
    buffer_load_ushort v27, v6, s[16:19], s27 offen
    s_add_u32 s28, s32, 602112
    buffer_load_ushort v28, v6, s[16:19], s28 offen
    s_add_u32 s29, s32, 603136
    buffer_load_ushort v29, v6, s[16:19], s29 offen
    s_add_u32 s30, s32, 604160
    buffer_load_ushort v30, v6, s[16:19], s30 offen
    s_add_u32 s31, s32, 605184
    buffer_load_ushort v31, v6, s[16:19], s31 offen
    s_waitcnt vmcnt(40)
    v_lshl_or_b32 v8, v33, 16, v32
    v_lshl_or_b32 v9, v35, 16, v34
    v_lshl_or_b32 v10, v37, 16, v36
    v_lshl_or_b32 v11, v39, 16, v38
    v_accvgpr_write_b32 a128, v8
    v_accvgpr_write_b32 a129, v9
    v_accvgpr_write_b32 a130, v10
    v_accvgpr_write_b32 a131, v11
    s_add_u32 s24, s32, 622592
    buffer_load_ushort v32, v6, s[16:19], s24 offen
    s_add_u32 s25, s32, 623616
    buffer_load_ushort v33, v6, s[16:19], s25 offen
    s_add_u32 s26, s32, 624640
    buffer_load_ushort v34, v6, s[16:19], s26 offen
    s_add_u32 s27, s32, 625664
    buffer_load_ushort v35, v6, s[16:19], s27 offen
    s_add_u32 s28, s32, 630784
    buffer_load_ushort v36, v6, s[16:19], s28 offen
    s_add_u32 s29, s32, 631808
    buffer_load_ushort v37, v6, s[16:19], s29 offen
    s_add_u32 s30, s32, 632832
    buffer_load_ushort v38, v6, s[16:19], s30 offen
    s_add_u32 s31, s32, 633856
    buffer_load_ushort v39, v6, s[16:19], s31 offen
    s_waitcnt vmcnt(40)
    v_lshl_or_b32 v8, v41, 16, v40
    v_lshl_or_b32 v9, v43, 16, v42
    v_lshl_or_b32 v10, v45, 16, v44
    v_lshl_or_b32 v11, v47, 16, v46
    v_accvgpr_write_b32 a132, v8
    v_accvgpr_write_b32 a133, v9
    v_accvgpr_write_b32 a134, v10
    v_accvgpr_write_b32 a135, v11
    s_add_u32 s24, s32, 626688
    buffer_load_ushort v40, v6, s[16:19], s24 offen
    s_add_u32 s25, s32, 627712
    buffer_load_ushort v41, v6, s[16:19], s25 offen
    s_add_u32 s26, s32, 628736
    buffer_load_ushort v42, v6, s[16:19], s26 offen
    s_add_u32 s27, s32, 629760
    buffer_load_ushort v43, v6, s[16:19], s27 offen
    s_add_u32 s28, s32, 634880
    buffer_load_ushort v44, v6, s[16:19], s28 offen
    s_add_u32 s29, s32, 635904
    buffer_load_ushort v45, v6, s[16:19], s29 offen
    s_add_u32 s30, s32, 636928
    buffer_load_ushort v46, v6, s[16:19], s30 offen
    s_add_u32 s31, s32, 637952
    buffer_load_ushort v47, v6, s[16:19], s31 offen
    s_waitcnt vmcnt(40)
    v_lshl_or_b32 v8, v49, 16, v48
    v_lshl_or_b32 v9, v51, 16, v50
    v_lshl_or_b32 v10, v53, 16, v52
    v_lshl_or_b32 v11, v55, 16, v54
    v_accvgpr_write_b32 a136, v8
    v_accvgpr_write_b32 a137, v9
    v_accvgpr_write_b32 a138, v10
    v_accvgpr_write_b32 a139, v11
    s_add_u32 s24, s32, 655360
    buffer_load_ushort v48, v6, s[16:19], s24 offen
    s_add_u32 s25, s32, 656384
    buffer_load_ushort v49, v6, s[16:19], s25 offen
    s_add_u32 s26, s32, 657408
    buffer_load_ushort v50, v6, s[16:19], s26 offen
    s_add_u32 s27, s32, 658432
    buffer_load_ushort v51, v6, s[16:19], s27 offen
    s_add_u32 s28, s32, 663552
    buffer_load_ushort v52, v6, s[16:19], s28 offen
    s_add_u32 s29, s32, 664576
    buffer_load_ushort v53, v6, s[16:19], s29 offen
    s_add_u32 s30, s32, 665600
    buffer_load_ushort v54, v6, s[16:19], s30 offen
    s_add_u32 s31, s32, 666624
    buffer_load_ushort v55, v6, s[16:19], s31 offen
    s_waitcnt vmcnt(40)
    v_lshl_or_b32 v8, v57, 16, v56
    v_lshl_or_b32 v9, v59, 16, v58
    v_lshl_or_b32 v10, v61, 16, v60
    v_lshl_or_b32 v11, v63, 16, v62
    v_accvgpr_write_b32 a140, v8
    v_accvgpr_write_b32 a141, v9
    v_accvgpr_write_b32 a142, v10
    v_accvgpr_write_b32 a143, v11
    s_add_u32 s24, s32, 659456
    buffer_load_ushort v56, v6, s[16:19], s24 offen
    s_add_u32 s25, s32, 660480
    buffer_load_ushort v57, v6, s[16:19], s25 offen
    s_add_u32 s26, s32, 661504
    buffer_load_ushort v58, v6, s[16:19], s26 offen
    s_add_u32 s27, s32, 662528
    buffer_load_ushort v59, v6, s[16:19], s27 offen
    s_add_u32 s28, s32, 667648
    buffer_load_ushort v60, v6, s[16:19], s28 offen
    s_add_u32 s29, s32, 668672
    buffer_load_ushort v61, v6, s[16:19], s29 offen
    s_add_u32 s30, s32, 669696
    buffer_load_ushort v62, v6, s[16:19], s30 offen
    s_add_u32 s31, s32, 670720
    buffer_load_ushort v63, v6, s[16:19], s31 offen
    s_waitcnt vmcnt(40)
    v_lshl_or_b32 v8, v17, 16, v16
    v_lshl_or_b32 v9, v19, 16, v18
    v_lshl_or_b32 v10, v21, 16, v20
    v_lshl_or_b32 v11, v23, 16, v22
    v_accvgpr_write_b32 a144, v8
    v_accvgpr_write_b32 a145, v9
    v_accvgpr_write_b32 a146, v10
    v_accvgpr_write_b32 a147, v11
    s_add_u32 s24, s32, 688128
    buffer_load_ushort v16, v6, s[16:19], s24 offen
    s_add_u32 s25, s32, 689152
    buffer_load_ushort v17, v6, s[16:19], s25 offen
    s_add_u32 s26, s32, 690176
    buffer_load_ushort v18, v6, s[16:19], s26 offen
    s_add_u32 s27, s32, 691200
    buffer_load_ushort v19, v6, s[16:19], s27 offen
    s_add_u32 s28, s32, 696320
    buffer_load_ushort v20, v6, s[16:19], s28 offen
    s_add_u32 s29, s32, 697344
    buffer_load_ushort v21, v6, s[16:19], s29 offen
    s_add_u32 s30, s32, 698368
    buffer_load_ushort v22, v6, s[16:19], s30 offen
    s_add_u32 s31, s32, 699392
    buffer_load_ushort v23, v6, s[16:19], s31 offen
    s_waitcnt vmcnt(40)
    v_lshl_or_b32 v8, v25, 16, v24
    v_lshl_or_b32 v9, v27, 16, v26
    v_lshl_or_b32 v10, v29, 16, v28
    v_lshl_or_b32 v11, v31, 16, v30
    v_accvgpr_write_b32 a148, v8
    v_accvgpr_write_b32 a149, v9
    v_accvgpr_write_b32 a150, v10
    v_accvgpr_write_b32 a151, v11
    s_add_u32 s24, s32, 692224
    buffer_load_ushort v24, v6, s[16:19], s24 offen
    s_add_u32 s25, s32, 693248
    buffer_load_ushort v25, v6, s[16:19], s25 offen
    s_add_u32 s26, s32, 694272
    buffer_load_ushort v26, v6, s[16:19], s26 offen
    s_add_u32 s27, s32, 695296
    buffer_load_ushort v27, v6, s[16:19], s27 offen
    s_add_u32 s28, s32, 700416
    buffer_load_ushort v28, v6, s[16:19], s28 offen
    s_add_u32 s29, s32, 701440
    buffer_load_ushort v29, v6, s[16:19], s29 offen
    s_add_u32 s30, s32, 702464
    buffer_load_ushort v30, v6, s[16:19], s30 offen
    s_add_u32 s31, s32, 703488
    buffer_load_ushort v31, v6, s[16:19], s31 offen
    s_waitcnt vmcnt(40)
    v_lshl_or_b32 v8, v33, 16, v32
    v_lshl_or_b32 v9, v35, 16, v34
    v_lshl_or_b32 v10, v37, 16, v36
    v_lshl_or_b32 v11, v39, 16, v38
    v_accvgpr_write_b32 a152, v8
    v_accvgpr_write_b32 a153, v9
    v_accvgpr_write_b32 a154, v10
    v_accvgpr_write_b32 a155, v11
    s_add_u32 s24, s32, 720896
    buffer_load_ushort v32, v6, s[16:19], s24 offen
    s_add_u32 s25, s32, 721920
    buffer_load_ushort v33, v6, s[16:19], s25 offen
    s_add_u32 s26, s32, 722944
    buffer_load_ushort v34, v6, s[16:19], s26 offen
    s_add_u32 s27, s32, 723968
    buffer_load_ushort v35, v6, s[16:19], s27 offen
    s_add_u32 s28, s32, 729088
    buffer_load_ushort v36, v6, s[16:19], s28 offen
    s_add_u32 s29, s32, 730112
    buffer_load_ushort v37, v6, s[16:19], s29 offen
    s_add_u32 s30, s32, 731136
    buffer_load_ushort v38, v6, s[16:19], s30 offen
    s_add_u32 s31, s32, 732160
    buffer_load_ushort v39, v6, s[16:19], s31 offen
    s_waitcnt vmcnt(40)
    v_lshl_or_b32 v8, v41, 16, v40
    v_lshl_or_b32 v9, v43, 16, v42
    v_lshl_or_b32 v10, v45, 16, v44
    v_lshl_or_b32 v11, v47, 16, v46
    v_accvgpr_write_b32 a156, v8
    v_accvgpr_write_b32 a157, v9
    v_accvgpr_write_b32 a158, v10
    v_accvgpr_write_b32 a159, v11
    s_add_u32 s24, s32, 724992
    buffer_load_ushort v40, v6, s[16:19], s24 offen
    s_add_u32 s25, s32, 726016
    buffer_load_ushort v41, v6, s[16:19], s25 offen
    s_add_u32 s26, s32, 727040
    buffer_load_ushort v42, v6, s[16:19], s26 offen
    s_add_u32 s27, s32, 728064
    buffer_load_ushort v43, v6, s[16:19], s27 offen
    s_add_u32 s28, s32, 733184
    buffer_load_ushort v44, v6, s[16:19], s28 offen
    s_add_u32 s29, s32, 734208
    buffer_load_ushort v45, v6, s[16:19], s29 offen
    s_add_u32 s30, s32, 735232
    buffer_load_ushort v46, v6, s[16:19], s30 offen
    s_add_u32 s31, s32, 736256
    buffer_load_ushort v47, v6, s[16:19], s31 offen
    s_waitcnt vmcnt(40)
    v_lshl_or_b32 v8, v49, 16, v48
    v_lshl_or_b32 v9, v51, 16, v50
    v_lshl_or_b32 v10, v53, 16, v52
    v_lshl_or_b32 v11, v55, 16, v54
    v_accvgpr_write_b32 a160, v8
    v_accvgpr_write_b32 a161, v9
    v_accvgpr_write_b32 a162, v10
    v_accvgpr_write_b32 a163, v11
    s_add_u32 s24, s32, 753664
    buffer_load_ushort v48, v6, s[16:19], s24 offen
    s_add_u32 s25, s32, 754688
    buffer_load_ushort v49, v6, s[16:19], s25 offen
    s_add_u32 s26, s32, 755712
    buffer_load_ushort v50, v6, s[16:19], s26 offen
    s_add_u32 s27, s32, 756736
    buffer_load_ushort v51, v6, s[16:19], s27 offen
    s_add_u32 s28, s32, 761856
    buffer_load_ushort v52, v6, s[16:19], s28 offen
    s_add_u32 s29, s32, 762880
    buffer_load_ushort v53, v6, s[16:19], s29 offen
    s_add_u32 s30, s32, 763904
    buffer_load_ushort v54, v6, s[16:19], s30 offen
    s_add_u32 s31, s32, 764928
    buffer_load_ushort v55, v6, s[16:19], s31 offen
    s_waitcnt vmcnt(40)
    v_lshl_or_b32 v8, v57, 16, v56
    v_lshl_or_b32 v9, v59, 16, v58
    v_lshl_or_b32 v10, v61, 16, v60
    v_lshl_or_b32 v11, v63, 16, v62
    v_accvgpr_write_b32 a164, v8
    v_accvgpr_write_b32 a165, v9
    v_accvgpr_write_b32 a166, v10
    v_accvgpr_write_b32 a167, v11
    s_add_u32 s24, s32, 757760
    buffer_load_ushort v56, v6, s[16:19], s24 offen
    s_add_u32 s25, s32, 758784
    buffer_load_ushort v57, v6, s[16:19], s25 offen
    s_add_u32 s26, s32, 759808
    buffer_load_ushort v58, v6, s[16:19], s26 offen
    s_add_u32 s27, s32, 760832
    buffer_load_ushort v59, v6, s[16:19], s27 offen
    s_add_u32 s28, s32, 765952
    buffer_load_ushort v60, v6, s[16:19], s28 offen
    s_add_u32 s29, s32, 766976
    buffer_load_ushort v61, v6, s[16:19], s29 offen
    s_add_u32 s30, s32, 768000
    buffer_load_ushort v62, v6, s[16:19], s30 offen
    s_add_u32 s31, s32, 769024
    buffer_load_ushort v63, v6, s[16:19], s31 offen
    s_waitcnt vmcnt(40)
    v_lshl_or_b32 v8, v17, 16, v16
    v_lshl_or_b32 v9, v19, 16, v18
    v_lshl_or_b32 v10, v21, 16, v20
    v_lshl_or_b32 v11, v23, 16, v22
    v_accvgpr_write_b32 a168, v8
    v_accvgpr_write_b32 a169, v9
    v_accvgpr_write_b32 a170, v10
    v_accvgpr_write_b32 a171, v11
    s_add_u32 s24, s32, 786432
    buffer_load_ushort v16, v6, s[16:19], s24 offen
    s_add_u32 s25, s32, 787456
    buffer_load_ushort v17, v6, s[16:19], s25 offen
    s_add_u32 s26, s32, 788480
    buffer_load_ushort v18, v6, s[16:19], s26 offen
    s_add_u32 s27, s32, 789504
    buffer_load_ushort v19, v6, s[16:19], s27 offen
    s_add_u32 s28, s32, 794624
    buffer_load_ushort v20, v6, s[16:19], s28 offen
    s_add_u32 s29, s32, 795648
    buffer_load_ushort v21, v6, s[16:19], s29 offen
    s_add_u32 s30, s32, 796672
    buffer_load_ushort v22, v6, s[16:19], s30 offen
    s_add_u32 s31, s32, 797696
    buffer_load_ushort v23, v6, s[16:19], s31 offen
    s_waitcnt vmcnt(40)
    v_lshl_or_b32 v8, v25, 16, v24
    v_lshl_or_b32 v9, v27, 16, v26
    v_lshl_or_b32 v10, v29, 16, v28
    v_lshl_or_b32 v11, v31, 16, v30
    v_accvgpr_write_b32 a172, v8
    v_accvgpr_write_b32 a173, v9
    v_accvgpr_write_b32 a174, v10
    v_accvgpr_write_b32 a175, v11
    s_add_u32 s24, s32, 790528
    buffer_load_ushort v24, v6, s[16:19], s24 offen
    s_add_u32 s25, s32, 791552
    buffer_load_ushort v25, v6, s[16:19], s25 offen
    s_add_u32 s26, s32, 792576
    buffer_load_ushort v26, v6, s[16:19], s26 offen
    s_add_u32 s27, s32, 793600
    buffer_load_ushort v27, v6, s[16:19], s27 offen
    s_add_u32 s28, s32, 798720
    buffer_load_ushort v28, v6, s[16:19], s28 offen
    s_add_u32 s29, s32, 799744
    buffer_load_ushort v29, v6, s[16:19], s29 offen
    s_add_u32 s30, s32, 800768
    buffer_load_ushort v30, v6, s[16:19], s30 offen
    s_add_u32 s31, s32, 801792
    buffer_load_ushort v31, v6, s[16:19], s31 offen
    s_waitcnt vmcnt(40)
    v_lshl_or_b32 v8, v33, 16, v32
    v_lshl_or_b32 v9, v35, 16, v34
    v_lshl_or_b32 v10, v37, 16, v36
    v_lshl_or_b32 v11, v39, 16, v38
    v_accvgpr_write_b32 a176, v8
    v_accvgpr_write_b32 a177, v9
    v_accvgpr_write_b32 a178, v10
    v_accvgpr_write_b32 a179, v11
    s_add_u32 s24, s32, 819200
    buffer_load_ushort v32, v6, s[16:19], s24 offen
    s_add_u32 s25, s32, 820224
    buffer_load_ushort v33, v6, s[16:19], s25 offen
    s_add_u32 s26, s32, 821248
    buffer_load_ushort v34, v6, s[16:19], s26 offen
    s_add_u32 s27, s32, 822272
    buffer_load_ushort v35, v6, s[16:19], s27 offen
    s_add_u32 s28, s32, 827392
    buffer_load_ushort v36, v6, s[16:19], s28 offen
    s_add_u32 s29, s32, 828416
    buffer_load_ushort v37, v6, s[16:19], s29 offen
    s_add_u32 s30, s32, 829440
    buffer_load_ushort v38, v6, s[16:19], s30 offen
    s_add_u32 s31, s32, 830464
    buffer_load_ushort v39, v6, s[16:19], s31 offen
    s_waitcnt vmcnt(40)
    v_lshl_or_b32 v8, v41, 16, v40
    v_lshl_or_b32 v9, v43, 16, v42
    v_lshl_or_b32 v10, v45, 16, v44
    v_lshl_or_b32 v11, v47, 16, v46
    v_accvgpr_write_b32 a180, v8
    v_accvgpr_write_b32 a181, v9
    v_accvgpr_write_b32 a182, v10
    v_accvgpr_write_b32 a183, v11
    s_add_u32 s24, s32, 823296
    buffer_load_ushort v40, v6, s[16:19], s24 offen
    s_add_u32 s25, s32, 824320
    buffer_load_ushort v41, v6, s[16:19], s25 offen
    s_add_u32 s26, s32, 825344
    buffer_load_ushort v42, v6, s[16:19], s26 offen
    s_add_u32 s27, s32, 826368
    buffer_load_ushort v43, v6, s[16:19], s27 offen
    s_add_u32 s28, s32, 831488
    buffer_load_ushort v44, v6, s[16:19], s28 offen
    s_add_u32 s29, s32, 832512
    buffer_load_ushort v45, v6, s[16:19], s29 offen
    s_add_u32 s30, s32, 833536
    buffer_load_ushort v46, v6, s[16:19], s30 offen
    s_add_u32 s31, s32, 834560
    buffer_load_ushort v47, v6, s[16:19], s31 offen
    s_waitcnt vmcnt(40)
    v_lshl_or_b32 v8, v49, 16, v48
    v_lshl_or_b32 v9, v51, 16, v50
    v_lshl_or_b32 v10, v53, 16, v52
    v_lshl_or_b32 v11, v55, 16, v54
    v_accvgpr_write_b32 a184, v8
    v_accvgpr_write_b32 a185, v9
    v_accvgpr_write_b32 a186, v10
    v_accvgpr_write_b32 a187, v11
    s_add_u32 s24, s32, 851968
    buffer_load_ushort v48, v6, s[16:19], s24 offen
    s_add_u32 s25, s32, 852992
    buffer_load_ushort v49, v6, s[16:19], s25 offen
    s_add_u32 s26, s32, 854016
    buffer_load_ushort v50, v6, s[16:19], s26 offen
    s_add_u32 s27, s32, 855040
    buffer_load_ushort v51, v6, s[16:19], s27 offen
    s_add_u32 s28, s32, 860160
    buffer_load_ushort v52, v6, s[16:19], s28 offen
    s_add_u32 s29, s32, 861184
    buffer_load_ushort v53, v6, s[16:19], s29 offen
    s_add_u32 s30, s32, 862208
    buffer_load_ushort v54, v6, s[16:19], s30 offen
    s_add_u32 s31, s32, 863232
    buffer_load_ushort v55, v6, s[16:19], s31 offen
    s_waitcnt vmcnt(40)
    v_lshl_or_b32 v8, v57, 16, v56
    v_lshl_or_b32 v9, v59, 16, v58
    v_lshl_or_b32 v10, v61, 16, v60
    v_lshl_or_b32 v11, v63, 16, v62
    v_accvgpr_write_b32 a188, v8
    v_accvgpr_write_b32 a189, v9
    v_accvgpr_write_b32 a190, v10
    v_accvgpr_write_b32 a191, v11
    s_add_u32 s24, s32, 856064
    buffer_load_ushort v56, v6, s[16:19], s24 offen
    s_add_u32 s25, s32, 857088
    buffer_load_ushort v57, v6, s[16:19], s25 offen
    s_add_u32 s26, s32, 858112
    buffer_load_ushort v58, v6, s[16:19], s26 offen
    s_add_u32 s27, s32, 859136
    buffer_load_ushort v59, v6, s[16:19], s27 offen
    s_add_u32 s28, s32, 864256
    buffer_load_ushort v60, v6, s[16:19], s28 offen
    s_add_u32 s29, s32, 865280
    buffer_load_ushort v61, v6, s[16:19], s29 offen
    s_add_u32 s30, s32, 866304
    buffer_load_ushort v62, v6, s[16:19], s30 offen
    s_add_u32 s31, s32, 867328
    buffer_load_ushort v63, v6, s[16:19], s31 offen
    s_waitcnt vmcnt(40)
    v_lshl_or_b32 v8, v17, 16, v16
    v_lshl_or_b32 v9, v19, 16, v18
    v_lshl_or_b32 v10, v21, 16, v20
    v_lshl_or_b32 v11, v23, 16, v22
    v_accvgpr_write_b32 a192, v8
    v_accvgpr_write_b32 a193, v9
    v_accvgpr_write_b32 a194, v10
    v_accvgpr_write_b32 a195, v11
    s_add_u32 s24, s32, 884736
    buffer_load_ushort v16, v6, s[16:19], s24 offen
    s_add_u32 s25, s32, 885760
    buffer_load_ushort v17, v6, s[16:19], s25 offen
    s_add_u32 s26, s32, 886784
    buffer_load_ushort v18, v6, s[16:19], s26 offen
    s_add_u32 s27, s32, 887808
    buffer_load_ushort v19, v6, s[16:19], s27 offen
    s_add_u32 s28, s32, 892928
    buffer_load_ushort v20, v6, s[16:19], s28 offen
    s_add_u32 s29, s32, 893952
    buffer_load_ushort v21, v6, s[16:19], s29 offen
    s_add_u32 s30, s32, 894976
    buffer_load_ushort v22, v6, s[16:19], s30 offen
    s_add_u32 s31, s32, 896000
    buffer_load_ushort v23, v6, s[16:19], s31 offen
    s_waitcnt vmcnt(40)
    v_lshl_or_b32 v8, v25, 16, v24
    v_lshl_or_b32 v9, v27, 16, v26
    v_lshl_or_b32 v10, v29, 16, v28
    v_lshl_or_b32 v11, v31, 16, v30
    v_accvgpr_write_b32 a196, v8
    v_accvgpr_write_b32 a197, v9
    v_accvgpr_write_b32 a198, v10
    v_accvgpr_write_b32 a199, v11
    s_add_u32 s24, s32, 888832
    buffer_load_ushort v24, v6, s[16:19], s24 offen
    s_add_u32 s25, s32, 889856
    buffer_load_ushort v25, v6, s[16:19], s25 offen
    s_add_u32 s26, s32, 890880
    buffer_load_ushort v26, v6, s[16:19], s26 offen
    s_add_u32 s27, s32, 891904
    buffer_load_ushort v27, v6, s[16:19], s27 offen
    s_add_u32 s28, s32, 897024
    buffer_load_ushort v28, v6, s[16:19], s28 offen
    s_add_u32 s29, s32, 898048
    buffer_load_ushort v29, v6, s[16:19], s29 offen
    s_add_u32 s30, s32, 899072
    buffer_load_ushort v30, v6, s[16:19], s30 offen
    s_add_u32 s31, s32, 900096
    buffer_load_ushort v31, v6, s[16:19], s31 offen
    s_waitcnt vmcnt(40)
    v_lshl_or_b32 v8, v33, 16, v32
    v_lshl_or_b32 v9, v35, 16, v34
    v_lshl_or_b32 v10, v37, 16, v36
    v_lshl_or_b32 v11, v39, 16, v38
    v_accvgpr_write_b32 a200, v8
    v_accvgpr_write_b32 a201, v9
    v_accvgpr_write_b32 a202, v10
    v_accvgpr_write_b32 a203, v11
    s_add_u32 s24, s32, 917504
    buffer_load_ushort v32, v6, s[16:19], s24 offen
    s_add_u32 s25, s32, 918528
    buffer_load_ushort v33, v6, s[16:19], s25 offen
    s_add_u32 s26, s32, 919552
    buffer_load_ushort v34, v6, s[16:19], s26 offen
    s_add_u32 s27, s32, 920576
    buffer_load_ushort v35, v6, s[16:19], s27 offen
    s_add_u32 s28, s32, 925696
    buffer_load_ushort v36, v6, s[16:19], s28 offen
    s_add_u32 s29, s32, 926720
    buffer_load_ushort v37, v6, s[16:19], s29 offen
    s_add_u32 s30, s32, 927744
    buffer_load_ushort v38, v6, s[16:19], s30 offen
    s_add_u32 s31, s32, 928768
    buffer_load_ushort v39, v6, s[16:19], s31 offen
    s_waitcnt vmcnt(40)
    v_lshl_or_b32 v8, v41, 16, v40
    v_lshl_or_b32 v9, v43, 16, v42
    v_lshl_or_b32 v10, v45, 16, v44
    v_lshl_or_b32 v11, v47, 16, v46
    v_accvgpr_write_b32 a204, v8
    v_accvgpr_write_b32 a205, v9
    v_accvgpr_write_b32 a206, v10
    v_accvgpr_write_b32 a207, v11
    s_add_u32 s24, s32, 921600
    buffer_load_ushort v40, v6, s[16:19], s24 offen
    s_add_u32 s25, s32, 922624
    buffer_load_ushort v41, v6, s[16:19], s25 offen
    s_add_u32 s26, s32, 923648
    buffer_load_ushort v42, v6, s[16:19], s26 offen
    s_add_u32 s27, s32, 924672
    buffer_load_ushort v43, v6, s[16:19], s27 offen
    s_add_u32 s28, s32, 929792
    buffer_load_ushort v44, v6, s[16:19], s28 offen
    s_add_u32 s29, s32, 930816
    buffer_load_ushort v45, v6, s[16:19], s29 offen
    s_add_u32 s30, s32, 931840
    buffer_load_ushort v46, v6, s[16:19], s30 offen
    s_add_u32 s31, s32, 932864
    buffer_load_ushort v47, v6, s[16:19], s31 offen
    s_waitcnt vmcnt(40)
    v_lshl_or_b32 v8, v49, 16, v48
    v_lshl_or_b32 v9, v51, 16, v50
    v_lshl_or_b32 v10, v53, 16, v52
    v_lshl_or_b32 v11, v55, 16, v54
    v_accvgpr_write_b32 a208, v8
    v_accvgpr_write_b32 a209, v9
    v_accvgpr_write_b32 a210, v10
    v_accvgpr_write_b32 a211, v11
    s_add_u32 s24, s32, 950272
    buffer_load_ushort v48, v6, s[16:19], s24 offen
    s_add_u32 s25, s32, 951296
    buffer_load_ushort v49, v6, s[16:19], s25 offen
    s_add_u32 s26, s32, 952320
    buffer_load_ushort v50, v6, s[16:19], s26 offen
    s_add_u32 s27, s32, 953344
    buffer_load_ushort v51, v6, s[16:19], s27 offen
    s_add_u32 s28, s32, 958464
    buffer_load_ushort v52, v6, s[16:19], s28 offen
    s_add_u32 s29, s32, 959488
    buffer_load_ushort v53, v6, s[16:19], s29 offen
    s_add_u32 s30, s32, 960512
    buffer_load_ushort v54, v6, s[16:19], s30 offen
    s_add_u32 s31, s32, 961536
    buffer_load_ushort v55, v6, s[16:19], s31 offen
    s_waitcnt vmcnt(40)
    v_lshl_or_b32 v8, v57, 16, v56
    v_lshl_or_b32 v9, v59, 16, v58
    v_lshl_or_b32 v10, v61, 16, v60
    v_lshl_or_b32 v11, v63, 16, v62
    v_accvgpr_write_b32 a212, v8
    v_accvgpr_write_b32 a213, v9
    v_accvgpr_write_b32 a214, v10
    v_accvgpr_write_b32 a215, v11
    s_add_u32 s24, s32, 954368
    buffer_load_ushort v56, v6, s[16:19], s24 offen
    s_add_u32 s25, s32, 955392
    buffer_load_ushort v57, v6, s[16:19], s25 offen
    s_add_u32 s26, s32, 956416
    buffer_load_ushort v58, v6, s[16:19], s26 offen
    s_add_u32 s27, s32, 957440
    buffer_load_ushort v59, v6, s[16:19], s27 offen
    s_add_u32 s28, s32, 962560
    buffer_load_ushort v60, v6, s[16:19], s28 offen
    s_add_u32 s29, s32, 963584
    buffer_load_ushort v61, v6, s[16:19], s29 offen
    s_add_u32 s30, s32, 964608
    buffer_load_ushort v62, v6, s[16:19], s30 offen
    s_add_u32 s31, s32, 965632
    buffer_load_ushort v63, v6, s[16:19], s31 offen
    s_waitcnt vmcnt(40)
    v_lshl_or_b32 v8, v17, 16, v16
    v_lshl_or_b32 v9, v19, 16, v18
    v_lshl_or_b32 v10, v21, 16, v20
    v_lshl_or_b32 v11, v23, 16, v22
    v_accvgpr_write_b32 a216, v8
    v_accvgpr_write_b32 a217, v9
    v_accvgpr_write_b32 a218, v10
    v_accvgpr_write_b32 a219, v11
    s_add_u32 s24, s32, 983040
    buffer_load_ushort v16, v6, s[16:19], s24 offen
    s_add_u32 s25, s32, 984064
    buffer_load_ushort v17, v6, s[16:19], s25 offen
    s_add_u32 s26, s32, 985088
    buffer_load_ushort v18, v6, s[16:19], s26 offen
    s_add_u32 s27, s32, 986112
    buffer_load_ushort v19, v6, s[16:19], s27 offen
    s_add_u32 s28, s32, 991232
    buffer_load_ushort v20, v6, s[16:19], s28 offen
    s_add_u32 s29, s32, 992256
    buffer_load_ushort v21, v6, s[16:19], s29 offen
    s_add_u32 s30, s32, 993280
    buffer_load_ushort v22, v6, s[16:19], s30 offen
    s_add_u32 s31, s32, 994304
    buffer_load_ushort v23, v6, s[16:19], s31 offen
    s_waitcnt vmcnt(40)
    v_lshl_or_b32 v8, v25, 16, v24
    v_lshl_or_b32 v9, v27, 16, v26
    v_lshl_or_b32 v10, v29, 16, v28
    v_lshl_or_b32 v11, v31, 16, v30
    v_accvgpr_write_b32 a220, v8
    v_accvgpr_write_b32 a221, v9
    v_accvgpr_write_b32 a222, v10
    v_accvgpr_write_b32 a223, v11
    s_add_u32 s24, s32, 987136
    buffer_load_ushort v24, v6, s[16:19], s24 offen
    s_add_u32 s25, s32, 988160
    buffer_load_ushort v25, v6, s[16:19], s25 offen
    s_add_u32 s26, s32, 989184
    buffer_load_ushort v26, v6, s[16:19], s26 offen
    s_add_u32 s27, s32, 990208
    buffer_load_ushort v27, v6, s[16:19], s27 offen
    s_add_u32 s28, s32, 995328
    buffer_load_ushort v28, v6, s[16:19], s28 offen
    s_add_u32 s29, s32, 996352
    buffer_load_ushort v29, v6, s[16:19], s29 offen
    s_add_u32 s30, s32, 997376
    buffer_load_ushort v30, v6, s[16:19], s30 offen
    s_add_u32 s31, s32, 998400
    buffer_load_ushort v31, v6, s[16:19], s31 offen
    s_waitcnt vmcnt(40)
    v_lshl_or_b32 v8, v33, 16, v32
    v_lshl_or_b32 v9, v35, 16, v34
    v_lshl_or_b32 v10, v37, 16, v36
    v_lshl_or_b32 v11, v39, 16, v38
    v_accvgpr_write_b32 a224, v8
    v_accvgpr_write_b32 a225, v9
    v_accvgpr_write_b32 a226, v10
    v_accvgpr_write_b32 a227, v11
    s_add_u32 s24, s32, 1015808
    buffer_load_ushort v32, v6, s[16:19], s24 offen
    s_add_u32 s25, s32, 1016832
    buffer_load_ushort v33, v6, s[16:19], s25 offen
    s_add_u32 s26, s32, 1017856
    buffer_load_ushort v34, v6, s[16:19], s26 offen
    s_add_u32 s27, s32, 1018880
    buffer_load_ushort v35, v6, s[16:19], s27 offen
    s_add_u32 s28, s32, 1024000
    buffer_load_ushort v36, v6, s[16:19], s28 offen
    s_add_u32 s29, s32, 1025024
    buffer_load_ushort v37, v6, s[16:19], s29 offen
    s_add_u32 s30, s32, 1026048
    buffer_load_ushort v38, v6, s[16:19], s30 offen
    s_add_u32 s31, s32, 1027072
    buffer_load_ushort v39, v6, s[16:19], s31 offen
    s_waitcnt vmcnt(40)
    v_lshl_or_b32 v8, v41, 16, v40
    v_lshl_or_b32 v9, v43, 16, v42
    v_lshl_or_b32 v10, v45, 16, v44
    v_lshl_or_b32 v11, v47, 16, v46
    v_accvgpr_write_b32 a228, v8
    v_accvgpr_write_b32 a229, v9
    v_accvgpr_write_b32 a230, v10
    v_accvgpr_write_b32 a231, v11
    s_add_u32 s24, s32, 1019904
    buffer_load_ushort v40, v6, s[16:19], s24 offen
    s_add_u32 s25, s32, 1020928
    buffer_load_ushort v41, v6, s[16:19], s25 offen
    s_add_u32 s26, s32, 1021952
    buffer_load_ushort v42, v6, s[16:19], s26 offen
    s_add_u32 s27, s32, 1022976
    buffer_load_ushort v43, v6, s[16:19], s27 offen
    s_add_u32 s28, s32, 1028096
    buffer_load_ushort v44, v6, s[16:19], s28 offen
    s_add_u32 s29, s32, 1029120
    buffer_load_ushort v45, v6, s[16:19], s29 offen
    s_add_u32 s30, s32, 1030144
    buffer_load_ushort v46, v6, s[16:19], s30 offen
    s_add_u32 s31, s32, 1031168
    buffer_load_ushort v47, v6, s[16:19], s31 offen
    s_waitcnt vmcnt(40)
    v_lshl_or_b32 v8, v49, 16, v48
    v_lshl_or_b32 v9, v51, 16, v50
    v_lshl_or_b32 v10, v53, 16, v52
    v_lshl_or_b32 v11, v55, 16, v54
    v_accvgpr_write_b32 a232, v8
    v_accvgpr_write_b32 a233, v9
    v_accvgpr_write_b32 a234, v10
    v_accvgpr_write_b32 a235, v11
    s_waitcnt vmcnt(32)
    v_lshl_or_b32 v8, v57, 16, v56
    v_lshl_or_b32 v9, v59, 16, v58
    v_lshl_or_b32 v10, v61, 16, v60
    v_lshl_or_b32 v11, v63, 16, v62
    v_accvgpr_write_b32 a236, v8
    v_accvgpr_write_b32 a237, v9
    v_accvgpr_write_b32 a238, v10
    v_accvgpr_write_b32 a239, v11
    s_waitcnt vmcnt(24)
    v_lshl_or_b32 v8, v17, 16, v16
    v_lshl_or_b32 v9, v19, 16, v18
    v_lshl_or_b32 v10, v21, 16, v20
    v_lshl_or_b32 v11, v23, 16, v22
    v_accvgpr_write_b32 a240, v8
    v_accvgpr_write_b32 a241, v9
    v_accvgpr_write_b32 a242, v10
    v_accvgpr_write_b32 a243, v11
    s_waitcnt vmcnt(16)
    v_lshl_or_b32 v8, v25, 16, v24
    v_lshl_or_b32 v9, v27, 16, v26
    v_lshl_or_b32 v10, v29, 16, v28
    v_lshl_or_b32 v11, v31, 16, v30
    v_accvgpr_write_b32 a244, v8
    v_accvgpr_write_b32 a245, v9
    v_accvgpr_write_b32 a246, v10
    v_accvgpr_write_b32 a247, v11
    s_waitcnt vmcnt(8)
    v_lshl_or_b32 v8, v33, 16, v32
    v_lshl_or_b32 v9, v35, 16, v34
    v_lshl_or_b32 v10, v37, 16, v36
    v_lshl_or_b32 v11, v39, 16, v38
    v_accvgpr_write_b32 a248, v8
    v_accvgpr_write_b32 a249, v9
    v_accvgpr_write_b32 a250, v10
    v_accvgpr_write_b32 a251, v11
    s_waitcnt vmcnt(0)
    v_lshl_or_b32 v8, v41, 16, v40
    v_lshl_or_b32 v9, v43, 16, v42
    v_lshl_or_b32 v10, v45, 16, v44
    v_lshl_or_b32 v11, v47, 16, v46
    v_accvgpr_write_b32 a252, v8
    v_accvgpr_write_b32 a253, v9
    v_accvgpr_write_b32 a254, v10
    v_accvgpr_write_b32 a255, v11
    s_add_u32 s12, s10, 0x5000000
    s_addc_u32 s13, s11, 0
    s_mov_b32 s14, 0x1000000
    s_mov_b32 s15, 0x20000
    s_mov_b32 s16, s64
    s_mov_b32 s17, s65
    s_mov_b32 s18, 0x200000
    s_mov_b32 s19, 0x20000
    s_add_u32 s20, s10, 0x700000
    s_addc_u32 s21, s11, 0
    s_mov_b32 s22, 0x200000
    s_mov_b32 s23, 0x20000
    s_mov_b32 s24, s10
    s_mov_b32 s25, s11
    s_mov_b32 s26, 0x3000
    s_mov_b32 s27, 0x20000
    v_lshlrev_b32 v3, 4, v1
    v_and_b32 v7, 31, v1
    v_lshlrev_b32 v7, 10, v7
    v_lshl_add_u32 v7, v4, 3, v7
    s_lshl_b32 s33, s3, 4
    s_lshl_b32 s34, s6, 6
    s_add_u32 s33, s33, s34
    v_lshlrev_b32 v8, 4, v4
    s_lshl_b32 s34, s33, 1
    s_add_u32 s34, s34, 4096
    v_and_b32 v9, 31, v1
    v_lshlrev_b32 v9, 2, v9
    s_movk_i32 s35, 24576
    s_add_u32 s97, s101, 1
    s_mov_b32 s98, 0x40000
wom_pp:
    buffer_load_dword v2, v9, s[40:43], s35 offen offset:0 sc1
    s_waitcnt vmcnt(0)
    v_subrev_u32 v2, s97, v2
    v_cmp_lt_u32 vcc, 1, v2
    s_cbranch_vccz wom_pd
    s_sleep 8
    s_sub_u32 s98, s98, 1
    s_cbranch_scc0 wom_pp
wom_pd:
    buffer_load_dwordx4 v[12:15], v8, s[24:27], s34 offen
    v_and_b32 v9, 7, v1
    v_lshlrev_b32 v9, 2, v9
    s_lshl_b32 s44, s3, 12
    v_add_u32 v5, s44, v3
    s_lshl_b32 s44, s3, 10
    v_add_u32 v6, s44, v3
    v_mov_b32 v10, 0
    v_mov_b32 v11, s101
    v_mov_b32 v16, -1
    v_mov_b32 v17, -1
    s_add_u32 s45, s7, 60
    s_lshl_b32 s44, s45, 15
    s_add_u32 s44, s44, s33
    buffer_store_dwordx2 v[16:17], v7, s[20:23], s44 offen sc1
    s_cmp_lt_u32 s7, 2
    s_cbranch_scc1 wo_np
    s_sub_u32 s44, s44, 131072
    buffer_store_dwordx2 v[16:17], v7, s[20:23], s44 offen sc1
wo_np:
wo_loop:
    s_lshl_b32 s44, s7, 15
    s_add_u32 s44, s44, s33
    buffer_load_dwordx2 v[16:17], v7, s[16:19], s44 offen
    s_lshl_b32 s45, s7, 7
    s_lshl_b32 s46, s3, 5
    s_add_u32 s45, s45, s46
    s_add_u32 s45, s45, 4096
    s_add_u32 s97, s101, 0
    s_mov_b32 s98, 0x40000
    buffer_load_dword v20, v9, s[40:43], s45 offen sc1
    s_waitcnt vmcnt(0)
    v_subrev_u32 v20, s97, v20
    v_cmp_lt_u32 vcc, 0, v20
    s_cbranch_vccz wop_pd
    buffer_load_dword v20, v9, s[40:43], s45 offen sc1
    s_sleep 6
    s_sleep 6
    buffer_load_dword v21, v9, s[40:43], s45 offen sc1
wop_pp:
    s_waitcnt vmcnt(1)
    v_subrev_u32 v20, s97, v20
    v_cmp_lt_u32 vcc, 0, v20
    s_cbranch_vccz wop_pd
    buffer_load_dword v20, v9, s[40:43], s45 offen sc1
    s_waitcnt vmcnt(1)
    v_subrev_u32 v21, s97, v21
    v_cmp_lt_u32 vcc, 0, v21
    s_cbranch_vccz wop_pd
    buffer_load_dword v21, v9, s[40:43], s45 offen sc1
    s_sub_u32 s98, s98, 1
    s_cbranch_scc0 wop_pp
wop_pd:
    s_lshl_b32 s45, s7, 18
    s_lshl_b32 s46, s3, 16
    s_add_u32 s45, s45, s46
    s_add_u32 s46, s45, 0
    buffer_load_dwordx4 v[64:67], v3, s[12:15], s46 offen offset:0
    buffer_load_dwordx4 v[68:71], v3, s[12:15], s46 offen offset:1024
    buffer_load_dwordx4 v[72:75], v3, s[12:15], s46 offen offset:2048
    buffer_load_dwordx4 v[76:79], v3, s[12:15], s46 offen offset:3072
    s_add_u32 s46, s45, 4096
    buffer_load_dwordx4 v[80:83], v3, s[12:15], s46 offen offset:0
    buffer_load_dwordx4 v[84:87], v3, s[12:15], s46 offen offset:1024
    buffer_load_dwordx4 v[88:91], v3, s[12:15], s46 offen offset:2048
    buffer_load_dwordx4 v[92:95], v3, s[12:15], s46 offen offset:3072
    s_add_u32 s46, s45, 8192
    buffer_load_dwordx4 v[96:99], v3, s[12:15], s46 offen offset:0
    buffer_load_dwordx4 v[100:103], v3, s[12:15], s46 offen offset:1024
    buffer_load_dwordx4 v[104:107], v3, s[12:15], s46 offen offset:2048
    buffer_load_dwordx4 v[108:111], v3, s[12:15], s46 offen offset:3072
    s_add_u32 s46, s45, 12288
    buffer_load_dwordx4 v[112:115], v3, s[12:15], s46 offen offset:0
    buffer_load_dwordx4 v[116:119], v3, s[12:15], s46 offen offset:1024
    buffer_load_dwordx4 v[120:123], v3, s[12:15], s46 offen offset:2048
    buffer_load_dwordx4 v[124:127], v3, s[12:15], s46 offen offset:3072
    s_add_u32 s46, s45, 16384
    buffer_load_dwordx4 v[128:131], v3, s[12:15], s46 offen offset:0
    buffer_load_dwordx4 v[132:135], v3, s[12:15], s46 offen offset:1024
    buffer_load_dwordx4 v[136:139], v3, s[12:15], s46 offen offset:2048
    buffer_load_dwordx4 v[140:143], v3, s[12:15], s46 offen offset:3072
    s_add_u32 s46, s45, 20480
    buffer_load_dwordx4 v[144:147], v3, s[12:15], s46 offen offset:0
    buffer_load_dwordx4 v[148:151], v3, s[12:15], s46 offen offset:1024
    buffer_load_dwordx4 v[152:155], v3, s[12:15], s46 offen offset:2048
    buffer_load_dwordx4 v[156:159], v3, s[12:15], s46 offen offset:3072
    s_add_u32 s46, s45, 24576
    buffer_load_dwordx4 v[160:163], v3, s[12:15], s46 offen offset:0
    buffer_load_dwordx4 v[164:167], v3, s[12:15], s46 offen offset:1024
    buffer_load_dwordx4 v[168:171], v3, s[12:15], s46 offen offset:2048
    buffer_load_dwordx4 v[172:175], v3, s[12:15], s46 offen offset:3072
    s_add_u32 s46, s45, 28672
    buffer_load_dwordx4 v[176:179], v3, s[12:15], s46 offen offset:0
    buffer_load_dwordx4 v[180:183], v3, s[12:15], s46 offen offset:1024
    buffer_load_dwordx4 v[184:187], v3, s[12:15], s46 offen offset:2048
    buffer_load_dwordx4 v[188:191], v3, s[12:15], s46 offen offset:3072
    s_add_u32 s46, s45, 32768
    buffer_load_dwordx4 v[192:195], v3, s[12:15], s46 offen offset:0
    buffer_load_dwordx4 v[196:199], v3, s[12:15], s46 offen offset:1024
    buffer_load_dwordx4 v[200:203], v3, s[12:15], s46 offen offset:2048
    buffer_load_dwordx4 v[204:207], v3, s[12:15], s46 offen offset:3072
    s_add_u32 s46, s45, 36864
    buffer_load_dwordx4 v[208:211], v3, s[12:15], s46 offen offset:0
    buffer_load_dwordx4 v[212:215], v3, s[12:15], s46 offen offset:1024
    buffer_load_dwordx4 v[216:219], v3, s[12:15], s46 offen offset:2048
    buffer_load_dwordx4 v[220:223], v3, s[12:15], s46 offen offset:3072
    s_waitcnt vmcnt(39)
    v_mfma_f32_32x32x16_bf16 v[32:47], a[0:3], v[64:67], 0
    s_add_u32 s46, s45, 40960
    buffer_load_dwordx4 v[64:67], v3, s[12:15], s46 offen offset:0
    s_waitcnt vmcnt(39)
    v_mfma_f32_32x32x16_bf16 v[48:63], a[4:7], v[68:71], 0
    buffer_load_dwordx4 v[68:71], v3, s[12:15], s46 offen offset:1024
    s_waitcnt vmcnt(39)
    v_mfma_f32_32x32x16_bf16 v[32:47], a[8:11], v[72:75], v[32:47]
    buffer_load_dwordx4 v[72:75], v3, s[12:15], s46 offen offset:2048
    s_waitcnt vmcnt(39)
    v_mfma_f32_32x32x16_bf16 v[48:63], a[12:15], v[76:79], v[48:63]
    buffer_load_dwordx4 v[76:79], v3, s[12:15], s46 offen offset:3072
    s_waitcnt vmcnt(39)
    v_mfma_f32_32x32x16_bf16 v[32:47], a[16:19], v[80:83], v[32:47]
    s_add_u32 s46, s45, 45056
    buffer_load_dwordx4 v[80:83], v3, s[12:15], s46 offen offset:0
    s_waitcnt vmcnt(39)
    v_mfma_f32_32x32x16_bf16 v[48:63], a[20:23], v[84:87], v[48:63]
    buffer_load_dwordx4 v[84:87], v3, s[12:15], s46 offen offset:1024
    s_waitcnt vmcnt(39)
    v_mfma_f32_32x32x16_bf16 v[32:47], a[24:27], v[88:91], v[32:47]
    buffer_load_dwordx4 v[88:91], v3, s[12:15], s46 offen offset:2048
    s_waitcnt vmcnt(39)
    v_mfma_f32_32x32x16_bf16 v[48:63], a[28:31], v[92:95], v[48:63]
    buffer_load_dwordx4 v[92:95], v3, s[12:15], s46 offen offset:3072
    s_waitcnt vmcnt(39)
    v_mfma_f32_32x32x16_bf16 v[32:47], a[32:35], v[96:99], v[32:47]
    s_add_u32 s46, s45, 49152
    buffer_load_dwordx4 v[96:99], v3, s[12:15], s46 offen offset:0
    s_waitcnt vmcnt(39)
    v_mfma_f32_32x32x16_bf16 v[48:63], a[36:39], v[100:103], v[48:63]
    buffer_load_dwordx4 v[100:103], v3, s[12:15], s46 offen offset:1024
    s_waitcnt vmcnt(39)
    v_mfma_f32_32x32x16_bf16 v[32:47], a[40:43], v[104:107], v[32:47]
    buffer_load_dwordx4 v[104:107], v3, s[12:15], s46 offen offset:2048
    s_waitcnt vmcnt(39)
    v_mfma_f32_32x32x16_bf16 v[48:63], a[44:47], v[108:111], v[48:63]
    buffer_load_dwordx4 v[108:111], v3, s[12:15], s46 offen offset:3072
    s_waitcnt vmcnt(39)
    v_mfma_f32_32x32x16_bf16 v[32:47], a[48:51], v[112:115], v[32:47]
    s_add_u32 s46, s45, 53248
    buffer_load_dwordx4 v[112:115], v3, s[12:15], s46 offen offset:0
    s_waitcnt vmcnt(39)
    v_mfma_f32_32x32x16_bf16 v[48:63], a[52:55], v[116:119], v[48:63]
    buffer_load_dwordx4 v[116:119], v3, s[12:15], s46 offen offset:1024
    s_waitcnt vmcnt(39)
    v_mfma_f32_32x32x16_bf16 v[32:47], a[56:59], v[120:123], v[32:47]
    buffer_load_dwordx4 v[120:123], v3, s[12:15], s46 offen offset:2048
    s_waitcnt vmcnt(39)
    v_mfma_f32_32x32x16_bf16 v[48:63], a[60:63], v[124:127], v[48:63]
    buffer_load_dwordx4 v[124:127], v3, s[12:15], s46 offen offset:3072
    s_waitcnt vmcnt(39)
    v_mfma_f32_32x32x16_bf16 v[32:47], a[64:67], v[128:131], v[32:47]
    s_add_u32 s46, s45, 57344
    buffer_load_dwordx4 v[128:131], v3, s[12:15], s46 offen offset:0
    s_waitcnt vmcnt(39)
    v_mfma_f32_32x32x16_bf16 v[48:63], a[68:71], v[132:135], v[48:63]
    buffer_load_dwordx4 v[132:135], v3, s[12:15], s46 offen offset:1024
    s_waitcnt vmcnt(39)
    v_mfma_f32_32x32x16_bf16 v[32:47], a[72:75], v[136:139], v[32:47]
    buffer_load_dwordx4 v[136:139], v3, s[12:15], s46 offen offset:2048
    s_waitcnt vmcnt(39)
    v_mfma_f32_32x32x16_bf16 v[48:63], a[76:79], v[140:143], v[48:63]
    buffer_load_dwordx4 v[140:143], v3, s[12:15], s46 offen offset:3072
    s_waitcnt vmcnt(39)
    v_mfma_f32_32x32x16_bf16 v[32:47], a[80:83], v[144:147], v[32:47]
    s_add_u32 s46, s45, 61440
    buffer_load_dwordx4 v[144:147], v3, s[12:15], s46 offen offset:0
    s_waitcnt vmcnt(39)
    v_mfma_f32_32x32x16_bf16 v[48:63], a[84:87], v[148:151], v[48:63]
    buffer_load_dwordx4 v[148:151], v3, s[12:15], s46 offen offset:1024
    s_waitcnt vmcnt(39)
    v_mfma_f32_32x32x16_bf16 v[32:47], a[88:91], v[152:155], v[32:47]
    buffer_load_dwordx4 v[152:155], v3, s[12:15], s46 offen offset:2048
    s_waitcnt vmcnt(39)
    v_mfma_f32_32x32x16_bf16 v[48:63], a[92:95], v[156:159], v[48:63]
    buffer_load_dwordx4 v[156:159], v3, s[12:15], s46 offen offset:3072
    s_waitcnt vmcnt(39)
    v_mfma_f32_32x32x16_bf16 v[32:47], a[96:99], v[160:163], v[32:47]
    s_waitcnt vmcnt(38)
    v_mfma_f32_32x32x16_bf16 v[48:63], a[100:103], v[164:167], v[48:63]
    s_waitcnt vmcnt(37)
    v_mfma_f32_32x32x16_bf16 v[32:47], a[104:107], v[168:171], v[32:47]
    s_waitcnt vmcnt(36)
    v_mfma_f32_32x32x16_bf16 v[48:63], a[108:111], v[172:175], v[48:63]
    s_waitcnt vmcnt(35)
    v_mfma_f32_32x32x16_bf16 v[32:47], a[112:115], v[176:179], v[32:47]
    s_waitcnt vmcnt(34)
    v_mfma_f32_32x32x16_bf16 v[48:63], a[116:119], v[180:183], v[48:63]
    s_waitcnt vmcnt(33)
    v_mfma_f32_32x32x16_bf16 v[32:47], a[120:123], v[184:187], v[32:47]
    s_waitcnt vmcnt(32)
    v_mfma_f32_32x32x16_bf16 v[48:63], a[124:127], v[188:191], v[48:63]
    s_waitcnt vmcnt(31)
    v_mfma_f32_32x32x16_bf16 v[32:47], a[128:131], v[192:195], v[32:47]
    s_waitcnt vmcnt(30)
    v_mfma_f32_32x32x16_bf16 v[48:63], a[132:135], v[196:199], v[48:63]
    s_waitcnt vmcnt(29)
    v_mfma_f32_32x32x16_bf16 v[32:47], a[136:139], v[200:203], v[32:47]
    s_waitcnt vmcnt(28)
    v_mfma_f32_32x32x16_bf16 v[48:63], a[140:143], v[204:207], v[48:63]
    s_waitcnt vmcnt(27)
    v_mfma_f32_32x32x16_bf16 v[32:47], a[144:147], v[208:211], v[32:47]
    s_waitcnt vmcnt(26)
    v_mfma_f32_32x32x16_bf16 v[48:63], a[148:151], v[212:215], v[48:63]
    s_waitcnt vmcnt(25)
    v_mfma_f32_32x32x16_bf16 v[32:47], a[152:155], v[216:219], v[32:47]
    s_waitcnt vmcnt(24)
    v_mfma_f32_32x32x16_bf16 v[48:63], a[156:159], v[220:223], v[48:63]
    s_waitcnt vmcnt(23)
    v_mfma_f32_32x32x16_bf16 v[32:47], a[160:163], v[64:67], v[32:47]
    s_waitcnt vmcnt(22)
    v_mfma_f32_32x32x16_bf16 v[48:63], a[164:167], v[68:71], v[48:63]
    s_waitcnt vmcnt(21)
    v_mfma_f32_32x32x16_bf16 v[32:47], a[168:171], v[72:75], v[32:47]
    s_waitcnt vmcnt(20)
    v_mfma_f32_32x32x16_bf16 v[48:63], a[172:175], v[76:79], v[48:63]
    s_waitcnt vmcnt(19)
    v_mfma_f32_32x32x16_bf16 v[32:47], a[176:179], v[80:83], v[32:47]
    s_waitcnt vmcnt(18)
    v_mfma_f32_32x32x16_bf16 v[48:63], a[180:183], v[84:87], v[48:63]
    s_waitcnt vmcnt(17)
    v_mfma_f32_32x32x16_bf16 v[32:47], a[184:187], v[88:91], v[32:47]
    s_waitcnt vmcnt(16)
    v_mfma_f32_32x32x16_bf16 v[48:63], a[188:191], v[92:95], v[48:63]
    s_waitcnt vmcnt(15)
    v_mfma_f32_32x32x16_bf16 v[32:47], a[192:195], v[96:99], v[32:47]
    s_waitcnt vmcnt(14)
    v_mfma_f32_32x32x16_bf16 v[48:63], a[196:199], v[100:103], v[48:63]
    s_waitcnt vmcnt(13)
    v_mfma_f32_32x32x16_bf16 v[32:47], a[200:203], v[104:107], v[32:47]
    s_waitcnt vmcnt(12)
    v_mfma_f32_32x32x16_bf16 v[48:63], a[204:207], v[108:111], v[48:63]
    s_waitcnt vmcnt(11)
    v_mfma_f32_32x32x16_bf16 v[32:47], a[208:211], v[112:115], v[32:47]
    s_waitcnt vmcnt(10)
    v_mfma_f32_32x32x16_bf16 v[48:63], a[212:215], v[116:119], v[48:63]
    s_waitcnt vmcnt(9)
    v_mfma_f32_32x32x16_bf16 v[32:47], a[216:219], v[120:123], v[32:47]
    s_waitcnt vmcnt(8)
    v_mfma_f32_32x32x16_bf16 v[48:63], a[220:223], v[124:127], v[48:63]
    s_waitcnt vmcnt(7)
    v_mfma_f32_32x32x16_bf16 v[32:47], a[224:227], v[128:131], v[32:47]
    s_waitcnt vmcnt(6)
    v_mfma_f32_32x32x16_bf16 v[48:63], a[228:231], v[132:135], v[48:63]
    s_waitcnt vmcnt(5)
    v_mfma_f32_32x32x16_bf16 v[32:47], a[232:235], v[136:139], v[32:47]
    s_waitcnt vmcnt(4)
    v_mfma_f32_32x32x16_bf16 v[48:63], a[236:239], v[140:143], v[48:63]
    s_waitcnt vmcnt(3)
    v_mfma_f32_32x32x16_bf16 v[32:47], a[240:243], v[144:147], v[32:47]
    s_waitcnt vmcnt(2)
    v_mfma_f32_32x32x16_bf16 v[48:63], a[244:247], v[148:151], v[48:63]
    s_waitcnt vmcnt(1)
    v_mfma_f32_32x32x16_bf16 v[32:47], a[248:251], v[152:155], v[32:47]
    s_waitcnt vmcnt(0)
    v_mfma_f32_32x32x16_bf16 v[48:63], a[252:255], v[156:159], v[48:63]
    s_nop 11
    v_pk_add_f32 v[32:33], v[32:33], v[48:49]
    v_pk_add_f32 v[34:35], v[34:35], v[50:51]
    v_pk_add_f32 v[36:37], v[36:37], v[52:53]
    v_pk_add_f32 v[38:39], v[38:39], v[54:55]
    v_pk_add_f32 v[40:41], v[40:41], v[56:57]
    v_pk_add_f32 v[42:43], v[42:43], v[58:59]
    v_pk_add_f32 v[44:45], v[44:45], v[60:61]
    v_pk_add_f32 v[46:47], v[46:47], v[62:63]
    ds_write_b128 v5, v[32:35] offset:0
    ds_write_b128 v5, v[36:39] offset:1024
    ds_write_b128 v5, v[40:43] offset:2048
    ds_write_b128 v5, v[44:47] offset:3072
    s_waitcnt lgkmcnt(0)
    s_barrier
    ds_read_b128 v[32:35], v6 offset:0
    ds_read_b128 v[36:39], v6 offset:4096
    ds_read_b128 v[40:43], v6 offset:8192
    ds_read_b128 v[44:47], v6 offset:12288
    s_waitcnt lgkmcnt(0)
    v_pk_add_f32 v[32:33], v[32:33], v[36:37]
    v_pk_add_f32 v[40:41], v[40:41], v[44:45]
    v_pk_add_f32 v[34:35], v[34:35], v[38:39]
    v_pk_add_f32 v[42:43], v[42:43], v[46:47]
    v_pk_add_f32 v[32:33], v[32:33], v[40:41]
    v_pk_add_f32 v[34:35], v[34:35], v[42:43]
    v_cvt_pk_bf16_f32 v18, v32, v33
    v_lshlrev_b32 v32, 16, v18
    v_and_b32 v33, 0xffff0000, v18
    v_cvt_pk_bf16_f32 v18, v34, v35
    v_lshlrev_b32 v34, 16, v18
    v_and_b32 v35, 0xffff0000, v18
    v_mul_f32 v32, v32, v12
    v_mul_f32 v33, v33, v13
    v_mul_f32 v34, v34, v14
    v_mul_f32 v35, v35, v15
    v_cvt_pk_bf16_f32 v18, v32, v33
    v_lshlrev_b32 v32, 16, v18
    v_and_b32 v33, 0xffff0000, v18
    v_lshlrev_b32 v18, 16, v16
    v_and_b32 v19, 0xffff0000, v16
    v_add_f32 v32, v32, v18
    v_add_f32 v33, v33, v19
    v_cvt_pk_bf16_f32 v16, v32, v33
    v_cvt_pk_bf16_f32 v18, v34, v35
    v_lshlrev_b32 v34, 16, v18
    v_and_b32 v35, 0xffff0000, v18
    v_lshlrev_b32 v18, 16, v17
    v_and_b32 v19, 0xffff0000, v17
    v_add_f32 v34, v34, v18
    v_add_f32 v35, v35, v19
    v_cvt_pk_bf16_f32 v17, v34, v35
    buffer_store_dwordx2 v[16:17], v7, s[20:23], s44 offen sc1
    s_lshl_b32 s45, s7, 6
    s_lshl_b32 s46, s6, 2
    s_add_u32 s45, s45, s46
    s_add_u32 s45, s45, 12288
    s_waitcnt vmcnt(0)
    s_barrier
    s_cmp_lg_u32 s3, 0
    s_cbranch_scc1 wo_nf
    buffer_store_dword v11, v10, s[40:43], s45 offen sc1
wo_nf:
    s_add_u32 s7, s7, 4
    s_cmp_lt_u32 s7, 64
    s_cbranch_scc1 wo_loop
    s_branch xs_entry
ch_code_end:
    .p2align 6
ch_loop_1_0:
    v_lshrrev_b32 v30, 1, v1
    v_mov_b64 v[32:33], v[68:69]
    v_mov_b64 v[34:35], v[70:71]
    v_mov_b64 v[36:37], v[64:65]
    v_mov_b64 v[64:65], 0
    v_mov_b64 v[66:67], 0
    v_mov_b64 v[68:69], 0
    v_mov_b64 v[70:71], 0
    v_mov_b64 v[56:57], 0
    v_mov_b64 v[58:59], 0
    v_mov_b64 v[60:61], 0
    v_mov_b64 v[62:63], 0
    v_mov_b64 v[72:73], 0
    v_mov_b64 v[74:75], 0
    v_mov_b64 v[76:77], 0
    v_mov_b64 v[78:79], 0
    s_nop 13
    buffer_load_dwordx4 v[80:83], v1, s[16:19], 0 offen offset:0 sc1
    buffer_load_dwordx4 v[84:87], v1, s[16:19], 0 offen offset:1024 sc1
    s_nop 15
    s_nop 8
    buffer_load_dwordx4 v[20:23], v1, s[16:19], 0 offen offset:0 sc1
    buffer_load_dwordx4 v[24:27], v1, s[16:19], 0 offen offset:1024 sc1
    s_waitcnt lgkmcnt(0)
ch10_POLL:
    s_waitcnt vmcnt(2)
    v_bitop3_b32 v31, v80, v84, s48 bitop3:0x7e
    v_and_b32 v31, 1, v31
    v_cmp_ne_u32 vcc, 0, v31
    ds_write_b128 v16, v[80:83] offset:20480
    ds_write_b128 v16, v[84:87] offset:21504
    s_cbranch_vccz ch10_H0
    buffer_load_dwordx4 v[80:83], v1, s[16:19], 0 offen offset:0 sc1
    buffer_load_dwordx4 v[84:87], v1, s[16:19], 0 offen offset:1024 sc1
    s_waitcnt vmcnt(2)
    v_bitop3_b32 v31, v20, v24, s48 bitop3:0x7e
    v_and_b32 v31, 1, v31
    v_cmp_ne_u32 vcc, 0, v31
    ds_write_b128 v16, v[20:23] offset:20480
    ds_write_b128 v16, v[24:27] offset:21504
    s_cbranch_vccz ch10_HB
    buffer_load_dwordx4 v[20:23], v1, s[16:19], 0 offen offset:0 sc1
    buffer_load_dwordx4 v[24:27], v1, s[16:19], 0 offen offset:1024 sc1
    s_sub_u32 s51, s51, 1
    s_cbranch_scc0 ch10_POLL
    s_mov_b32 s51, 0
ch10_HB:
    v_mov_b64 v[80:81], v[20:21]
    v_mov_b64 v[82:83], v[22:23]
    v_mov_b64 v[84:85], v[24:25]
    v_mov_b64 v[86:87], v[26:27]
    s_nop 0
ch10_H0:
    v_smfmac_f32_16x16x64_bf16 v[56:59], v[80:83], v[112:119], v0
    ds_read_b128 v[112:115], v17 offset:49152
    v_smfmac_f32_16x16x64_bf16 v[60:63], v[80:83], v[120:127], v0
    ds_read_b128 v[116:119], v17 offset:50176
    v_smfmac_f32_16x16x64_bf16 v[56:59], v[84:87], a[16:23], v0
    ds_read_b128 v[120:123], v17 offset:51200
    v_smfmac_f32_16x16x64_bf16 v[60:63], v[84:87], a[24:31], v0
    ds_read_b128 v[124:127], v17 offset:52224
    s_waitcnt lgkmcnt(4)
    s_barrier
    ds_read_b128 v[88:91], v16 offset:22528
    ds_read_b128 v[92:95], v16 offset:23552
    ds_read_b128 v[96:99], v16 offset:24576
    ds_read_b128 v[100:103], v16 offset:25600
    ds_read_b128 v[104:107], v16 offset:26624
    ds_read_b128 v[108:111], v16 offset:27648
    v_mov_b32 v29, s47
    buffer_store_dword v29, v7, s[96:99], s49 offen sc1
    s_add_u32 s47, s47, 1
    s_cmp_lt_u32 s56, s57
    s_cbranch_scc0 ch10_KVW
ch10_KVOK:
    s_add_u32 s56, s56, 1
    v_smfmac_f32_16x16x64_bf16 v[64:67], v[80:83], a[0:7], v0
    v_smfmac_f32_16x16x64_bf16 v[68:71], v[80:83], a[8:15], v0
    v_smfmac_f32_16x16x64_bf16 v[64:67], v[84:87], v[128:135], v0
    ds_read_b128 v[128:131], v16 offset:0
    v_smfmac_f32_16x16x64_bf16 v[68:71], v[84:87], v[136:143], v0
    ds_read_b128 v[132:135], v16 offset:1024
    s_waitcnt lgkmcnt(7)
    v_smfmac_f32_16x16x64_bf16 v[56:59], v[88:91], a[32:39], v0
    ds_read_b128 v[136:139], v16 offset:2048
    v_smfmac_f32_16x16x64_bf16 v[60:63], v[88:91], a[40:47], v0
    ds_read_b128 v[140:143], v16 offset:3072
    buffer_store_dwordx4 v[32:35], v1, s[28:31], s42 offen sc1
    s_waitcnt lgkmcnt(8)
    v_smfmac_f32_16x16x64_bf16 v[56:59], v[92:95], v[112:119], v0
    ds_read_b128 v[112:115], v1 offset:0
    v_smfmac_f32_16x16x64_bf16 v[60:63], v[92:95], v[120:127], v0
    ds_read_b128 v[116:119], v1 offset:1024
    buffer_store_dwordx2 v[36:37], v30, s[32:35], s43 offen sc1
    s_add_u32 s42, s42, 0x20000
    s_add_u32 s43, s43, 0x10000
    v_smfmac_f32_16x16x64_bf16 v[64:67], v[88:91], a[48:55], v0
    ds_read_b128 v[120:123], v1 offset:2048
    v_smfmac_f32_16x16x64_bf16 v[68:71], v[88:91], a[56:63], v0
    ds_read_b128 v[124:127], v1 offset:3072
    s_waitcnt lgkmcnt(11)
    v_smfmac_f32_16x16x64_bf16 v[56:59], v[96:99], a[80:87], v0
    v_smfmac_f32_16x16x64_bf16 v[60:63], v[96:99], a[88:95], v0
    v_smfmac_f32_16x16x64_bf16 v[64:67], v[92:95], a[64:71], v0
    v_smfmac_f32_16x16x64_bf16 v[68:71], v[92:95], a[72:79], v0
    s_waitcnt lgkmcnt(10)
    v_smfmac_f32_16x16x64_bf16 v[56:59], v[100:103], a[96:103], v0
    v_smfmac_f32_16x16x64_bf16 v[60:63], v[100:103], a[104:111], v0
    s_waitcnt lgkmcnt(4)
    v_smfmac_f32_16x16x64_bf16 v[64:67], v[96:99], v[128:135], v0
    ds_read_b128 v[128:131], v1 offset:16384
    v_smfmac_f32_16x16x64_bf16 v[68:71], v[96:99], v[136:143], v0
    ds_read_b128 v[132:135], v1 offset:17408
    s_waitcnt lgkmcnt(2)
    v_smfmac_f32_16x16x64_bf16 v[56:59], v[104:107], v[112:119], v0
    ds_read_b128 v[136:139], v1 offset:18432
    v_smfmac_f32_16x16x64_bf16 v[60:63], v[104:107], v[120:127], v0
    ds_read_b128 v[140:143], v1 offset:19456
    v_smfmac_f32_16x16x64_bf16 v[64:67], v[100:103], a[112:119], v0
    ds_read_b128 v[112:115], v1 offset:32768
    v_smfmac_f32_16x16x64_bf16 v[68:71], v[100:103], a[120:127], v0
    ds_read_b128 v[116:119], v1 offset:33792
    v_smfmac_f32_16x16x64_bf16 v[56:59], v[108:111], a[144:151], v0
    ds_read_b128 v[120:123], v1 offset:34816
    v_smfmac_f32_16x16x64_bf16 v[60:63], v[108:111], a[152:159], v0
    ds_read_b128 v[124:127], v1 offset:35840
    v_smfmac_f32_16x16x64_bf16 v[64:67], v[104:107], a[128:135], v0
    v_smfmac_f32_16x16x64_bf16 v[68:71], v[104:107], a[136:143], v0
    s_waitcnt lgkmcnt(4)
    v_smfmac_f32_16x16x64_bf16 v[64:67], v[108:111], v[128:135], v0
    ds_read_b128 v[128:131], v1 offset:49152
    v_add_f32 v56, v56, v58
    v_smfmac_f32_16x16x64_bf16 v[68:71], v[108:111], v[136:143], v0
    ds_read_b128 v[132:135], v1 offset:50176
    v_add_f32 v57, v57, v59
ch10_QKOK:
    s_waitcnt vmcnt(3)
    v_add_f32 v60, v60, v62
    v_add_f32 v61, v61, v63
    v_cvt_pk_bf16_f32 v20, v56, v57
    v_cvt_pk_bf16_f32 v22, v60, v61
    v_add_f32 v64, v64, v66
    v_add_f32 v65, v65, v67
    v_cvt_pk_bf16_f32 v21, v64, v65
    v_add_f32 v68, v68, v70
    v_add_f32 v69, v69, v71
    v_mfma_f32_16x16x16_bf16 v[64:67], v[20:21], v[4:5], 0
    v_cvt_pk_bf16_f32 v23, v68, v69
    buffer_load_dwordx4 v[32:35], v1, s[24:27], s41 offen offset:0 sc1
    buffer_load_dwordx4 v[36:39], v1, s[24:27], s41 offen offset:1024 sc1
    v_mfma_f32_16x16x16_bf16 v[68:71], v[22:23], v[4:5], 0
    v_smfmac_f32_16x16x64_bf16 v[72:75], v[80:83], a[160:167], v0
    ds_read_b128 v[136:139], v1 offset:51200
    s_nop 0
    v_cvt_pk_bf16_f32 v56, v64, v65
    v_cvt_pk_bf16_f32 v57, v66, v67
    s_nop 0
    v_cvt_pk_bf16_f32 v58, v68, v69
    v_cvt_pk_bf16_f32 v59, v70, v71
    s_nop 1
    v_mfma_f32_16x16x32_bf16 v[68:71], v[56:59], v[56:59], 0
    v_mfma_f32_16x16x32_bf16 v[64:67], v[52:55], v[56:59], 0
    v_mfma_f32_16x16x32_bf16 v[60:63], v[48:51], v[56:59], 0
    buffer_load_dwordx4 v[48:51], v1, s[20:23], s41 offen offset:0 sc1
    buffer_load_dwordx4 v[52:55], v1, s[20:23], s41 offen offset:1024 sc1
    ds_write_b64 v13, v[70:71]
    v_smfmac_f32_16x16x64_bf16 v[76:79], v[80:83], a[168:175], v0
    ds_read_b128 v[140:143], v1 offset:52224
    s_mov_b32 vcc_lo, 0x33333333
    s_mov_b32 vcc_hi, 0x33333333
    s_nop 1
    v_cndmask_b32_dpp v60, v64, v60, vcc quad_perm:[0,1,0,1] row_mask:0xf bank_mask:0xf
    v_cndmask_b32_dpp v61, v65, v61, vcc quad_perm:[0,1,0,1] row_mask:0xf bank_mask:0xf
    v_cndmask_b32_dpp v62, v66, v62, vcc quad_perm:[0,1,0,1] row_mask:0xf bank_mask:0xf
    v_cndmask_b32_dpp v63, v67, v63, vcc quad_perm:[0,1,0,1] row_mask:0xf bank_mask:0xf
    ds_write_b128 v16, v[60:63] offset:16384
    s_waitcnt lgkmcnt(6)
    v_smfmac_f32_16x16x64_bf16 v[72:75], v[84:87], v[112:119], v0
    ds_read_b128 v[112:115], v17 offset:0
    v_smfmac_f32_16x16x64_bf16 v[76:79], v[84:87], v[120:127], v0
    ds_read_b128 v[116:119], v17 offset:1024
    v_smfmac_f32_16x16x64_bf16 v[72:75], v[88:91], a[176:183], v0
    ds_read_b128 v[120:123], v17 offset:2048
    v_smfmac_f32_16x16x64_bf16 v[76:79], v[88:91], a[184:191], v0
    ds_read_b128 v[124:127], v17 offset:3072
    v_smfmac_f32_16x16x64_bf16 v[72:75], v[92:95], a[192:199], v0
    v_smfmac_f32_16x16x64_bf16 v[76:79], v[92:95], a[200:207], v0
    s_waitcnt lgkmcnt(0)
    s_barrier
    ds_read_b128 v[20:23], v16 offset:17408
    ds_read_b128 v[24:27], v16 offset:18432
    ds_read_b128 v[64:67], v16 offset:19456
    ds_read2st64_b32 v[68:69], v14 offset0:0 offset1:1
    ds_read2st64_b32 v[70:71], v14 offset0:2 offset1:3
    v_smfmac_f32_16x16x64_bf16 v[72:75], v[96:99], v[128:135], v0
    v_smfmac_f32_16x16x64_bf16 v[76:79], v[96:99], v[136:143], v0
    v_smfmac_f32_16x16x64_bf16 v[72:75], v[100:103], a[208:215], v0
    v_smfmac_f32_16x16x64_bf16 v[76:79], v[100:103], a[216:223], v0
    s_waitcnt lgkmcnt(3)
    v_add_f32 v60, v60, v20
    v_add_f32 v61, v61, v21
    v_add_f32 v62, v62, v22
    v_add_f32 v63, v63, v23
    s_waitcnt lgkmcnt(2)
    v_pk_add_f32 v[24:25], v[24:25], v[64:65]
    v_pk_add_f32 v[26:27], v[26:27], v[66:67]
    s_waitcnt lgkmcnt(0)
    v_pk_add_f32 v[68:69], v[68:69], v[70:71]
    v_pk_add_f32 v[60:61], v[60:61], v[24:25]
    v_pk_add_f32 v[62:63], v[62:63], v[26:27]
    v_add_f32 v68, v68, v69
    v_max3_f32 v20, v60, v61, v62
    v_max3_f32 v20, v20, v63, v68
    v_smfmac_f32_16x16x64_bf16 v[72:75], v[104:107], a[224:231], v0
    s_nop 0
    v_max_f32_dpp v22, v20, v20 quad_perm:[2,3,0,1] row_mask:0xf bank_mask:0xf
    v_max_f32_dpp v23, v20, v20 quad_perm:[2,3,0,1] row_mask:0xf bank_mask:0xf
    v_smfmac_f32_16x16x64_bf16 v[76:79], v[104:107], a[232:239], v0
    s_nop 0
    v_permlane16_swap_b32 v22, v23
    v_max_f32 v20, v22, v23
    v_max_f32 v21, v22, v23
    v_smfmac_f32_16x16x64_bf16 v[72:75], v[108:111], v[112:119], v0
    s_nop 0
    v_permlane32_swap_b32 v20, v21
    v_max_f32 v20, v20, v21
    v_smfmac_f32_16x16x64_bf16 v[76:79], v[108:111], v[120:127], v0
    v_mul_f32 v20, s60, v20
    v_fma_f32 v60, v60, s60, -v20
    v_fma_f32 v61, v61, s60, -v20
    v_fma_f32 v62, v62, s60, -v20
    v_fma_f32 v63, v63, s60, -v20
    v_fma_f32 v68, v68, s60, -v20
    v_exp_f32 v60, v60
    v_exp_f32 v61, v61
    v_exp_f32 v62, v62
    v_exp_f32 v63, v63
    v_exp_f32 v68, v68
    v_cvt_pk_bf16_f32 v20, v60, v61
    v_cvt_pk_bf16_f32 v21, v62, v63
    v_pk_add_f32 v[28:29], v[60:61], v[62:63]
    v_mov_b32_dpp v24, v20 quad_perm:[0,1,0,1] row_mask:0xf bank_mask:0xf
    v_mov_b32_dpp v25, v21 quad_perm:[0,1,0,1] row_mask:0xf bank_mask:0xf
    v_mov_b32_dpp v26, v20 quad_perm:[2,3,2,3] row_mask:0xf bank_mask:0xf
    v_mov_b32_dpp v27, v21 quad_perm:[2,3,2,3] row_mask:0xf bank_mask:0xf
    v_pk_add_f32 v[72:73], v[72:73], v[74:75]
    v_pk_add_f32 v[76:77], v[76:77], v[78:79]
    v_mfma_f32_16x16x32_bf16 v[60:63], v[40:43], v[24:27], 0
    v_mov_b32_dpp v30, v68 quad_perm:[0,1,0,1] row_mask:0xf bank_mask:0xf
    v_mov_b32_dpp v31, v68 quad_perm:[2,3,2,3] row_mask:0xf bank_mask:0xf
    v_mfma_f32_16x16x32_bf16 v[20:23], v[44:47], v[24:27], 0
    v_add_f32 v28, v28, v29
    v_cvt_pk_bf16_f32 v6, v30, v31
    v_add_f32 v68, v68, v28
    v_cvt_pk_bf16_f32 v64, v72, v73
    v_cvt_pk_bf16_f32 v65, v76, v77
    v_add_f32_dpp v28, v68, v68 quad_perm:[2,3,0,1] row_mask:0xf bank_mask:0xf
    v_add_f32_dpp v29, v68, v68 quad_perm:[2,3,0,1] row_mask:0xf bank_mask:0xf
    v_mfma_f32_16x16x16_bf16 v[60:63], v[64:65], v[6:7], v[60:63]
    v_cvt_pk_bf16_f32 v66, v76, v77
    v_mov_b32 v67, 0
    v_permlane16_swap_b32 v28, v29
    v_add_f32 v68, v28, v29
    v_mfma_f32_16x16x16_bf16 v[20:23], v[66:67], v[6:7], v[20:23]
    v_add_f32 v69, v28, v29
    v_mov_b64 v[80:81], 0
    v_mov_b64 v[82:83], 0
    v_permlane32_swap_b32 v68, v69
    v_add_f32 v68, v68, v69
    v_rcp_f32 v68, v68
    v_mov_b64 v[84:85], 0
    v_pk_mul_f32 v[60:61], v[60:61], v[68:69] op_sel_hi:[1,0]
    v_pk_mul_f32 v[62:63], v[62:63], v[68:69] op_sel_hi:[1,0]
    v_pk_mul_f32 v[20:21], v[20:21], v[68:69] op_sel_hi:[1,0]
    v_pk_mul_f32 v[22:23], v[22:23], v[68:69] op_sel_hi:[1,0]
    v_cvt_pk_bf16_f32 v24, v60, v61
    v_cvt_pk_bf16_f32 v25, v62, v63
    v_cvt_pk_bf16_f32 v26, v20, v21
    v_cvt_pk_bf16_f32 v27, v22, v23
    ds_write_b128 v15, v[24:27] offset:0
    v_mov_b64 v[86:87], 0
    v_smfmac_f32_16x16x64_bf16 v[80:83], v[24:27], a[240:247], v0
    v_mov_b64 v[88:89], 0
    v_mov_b64 v[90:91], 0
    v_smfmac_f32_16x16x64_bf16 v[84:87], v[24:27], v[160:167], v0
    v_mov_b64 v[92:93], 0
    v_mov_b64 v[94:95], 0
    v_mov_b64 v[68:69], v[56:57]
    v_smfmac_f32_16x16x64_bf16 v[88:91], v[24:27], v[192:199], v0
    v_mov_b64 v[70:71], v[58:59]
    s_sub_u32 s40, s40, 1
    s_cbranch_scc1 ch_fin
    s_waitcnt lgkmcnt(0)
    s_barrier
    ds_read_b128 v[72:75], v15 offset:512
    ds_read_b128 v[76:79], v15 offset:1024
    ds_read_b128 v[60:63], v15 offset:1536
    v_smfmac_f32_16x16x64_bf16 v[92:95], v[24:27], v[224:231], v0
    s_add_u32 s41, s41, 0x40000
    s_not_b32 s63, s48
    s_waitcnt lgkmcnt(2)
    v_smfmac_f32_16x16x64_bf16 v[80:83], v[72:75], a[248:255], v0
    s_waitcnt lgkmcnt(1)
    v_smfmac_f32_16x16x64_bf16 v[80:83], v[76:79], v[144:151], v0
    s_waitcnt lgkmcnt(0)
    v_smfmac_f32_16x16x64_bf16 v[80:83], v[60:63], v[152:159], v0
    v_smfmac_f32_16x16x64_bf16 v[84:87], v[72:75], v[168:175], v0
    v_smfmac_f32_16x16x64_bf16 v[84:87], v[76:79], v[176:183], v0
    v_cvt_pk_bf16_f32 v80, v80, v81
    v_bfi_b32 v80, v18, s63, v80
    buffer_store_dword v80, v2, s[12:15], s52 offen offset:0 sc1
    v_smfmac_f32_16x16x64_bf16 v[84:87], v[60:63], v[184:191], v0
    v_cvt_pk_bf16_f32 v82, v82, v83
    v_bfi_b32 v82, v18, s63, v82
    buffer_store_dword v82, v2, s[12:15], s52 offen offset:2048 sc1
    v_smfmac_f32_16x16x64_bf16 v[88:91], v[72:75], v[200:207], v0
    v_smfmac_f32_16x16x64_bf16 v[88:91], v[76:79], v[208:215], v0
    v_cvt_pk_bf16_f32 v84, v84, v85
    v_bfi_b32 v84, v18, s63, v84
    buffer_store_dword v84, v2, s[12:15], s53 offen offset:0 sc1
    v_smfmac_f32_16x16x64_bf16 v[88:91], v[60:63], v[216:223], v0
    v_cvt_pk_bf16_f32 v86, v86, v87
    v_bfi_b32 v86, v18, s63, v86
    buffer_store_dword v86, v2, s[12:15], s53 offen offset:2048 sc1
    v_smfmac_f32_16x16x64_bf16 v[92:95], v[72:75], v[232:239], v0
    v_smfmac_f32_16x16x64_bf16 v[92:95], v[76:79], v[240:247], v0
    v_cvt_pk_bf16_f32 v88, v88, v89
    v_bfi_b32 v88, v18, s63, v88
    buffer_store_dword v88, v2, s[12:15], s54 offen offset:0 sc1
    v_smfmac_f32_16x16x64_bf16 v[92:95], v[60:63], v[248:255], v0
    v_cvt_pk_bf16_f32 v90, v90, v91
    v_bfi_b32 v90, v18, s63, v90
    buffer_store_dword v90, v2, s[12:15], s54 offen offset:2048 sc1
    s_nop 3
    v_cvt_pk_bf16_f32 v92, v92, v93
    v_bfi_b32 v92, v18, s63, v92
    buffer_store_dword v92, v2, s[12:15], s55 offen offset:0 sc1
    v_cvt_pk_bf16_f32 v94, v94, v95
    v_bfi_b32 v94, v18, s63, v94
    buffer_store_dword v94, v2, s[12:15], s55 offen offset:2048 sc1
    s_waitcnt vmcnt(0)
    v_bfi_b32 v80, v18, s48, v80
    buffer_store_dword v80, v2, s[12:15], s52 offen offset:0 sc1
    v_bfi_b32 v82, v18, s48, v82
    buffer_store_dword v82, v2, s[12:15], s52 offen offset:2048 sc1
    v_bfi_b32 v84, v18, s48, v84
    buffer_store_dword v84, v2, s[12:15], s53 offen offset:0 sc1
    v_bfi_b32 v86, v18, s48, v86
    buffer_store_dword v86, v2, s[12:15], s53 offen offset:2048 sc1
    v_bfi_b32 v88, v18, s48, v88
    buffer_store_dword v88, v2, s[12:15], s54 offen offset:0 sc1
    v_bfi_b32 v90, v18, s48, v90
    buffer_store_dword v90, v2, s[12:15], s54 offen offset:2048 sc1
    v_bfi_b32 v92, v18, s48, v92
    buffer_store_dword v92, v2, s[12:15], s55 offen offset:0 sc1
    v_bfi_b32 v94, v18, s48, v94
    buffer_store_dword v94, v2, s[12:15], s55 offen offset:2048 sc1
    ds_read_b128 v[112:115], v17 offset:16384
    ds_read_b128 v[116:119], v17 offset:17408
    ds_read_b128 v[120:123], v17 offset:18432
    ds_read_b128 v[124:127], v17 offset:19456
    ds_read_b128 v[128:131], v17 offset:32768
    ds_read_b128 v[132:135], v17 offset:33792
    ds_read_b128 v[136:139], v17 offset:34816
    ds_read_b128 v[140:143], v17 offset:35840
    s_nop 15
    s_nop 0
    buffer_load_dwordx4 v[56:59], v12, s[12:15], s50 offen offset:0 sc1
    buffer_load_dwordx4 v[60:63], v12, s[12:15], s50 offen offset:1024 sc1
ch10_RC:
    s_waitcnt vmcnt(1)
    v_mfma_f32_16x16x32_bf16 v[28:31], v[56:59], v[8:11], 0
    s_waitcnt vmcnt(0)
    v_mfma_f32_16x16x32_bf16 v[28:31], v[60:63], v[8:11], v[28:31]
    v_bitop3_b32 v24, v56, v60, s48 bitop3:0x7e
    v_and_b32 v24, 1, v24
    v_cmp_ne_u32 vcc, 0, v24
    s_nop 3
    s_cbranch_vccz ch10_ROK
    buffer_load_dwordx4 v[56:59], v12, s[12:15], s50 offen offset:0 sc1
    buffer_load_dwordx4 v[60:63], v12, s[12:15], s50 offen offset:1024 sc1
    s_sub_u32 s51, s51, 1
    s_cbranch_scc0 ch10_RC
    s_mov_b32 s51, 0
    s_waitcnt vmcnt(0)
ch10_ROK:
    v_pk_add_f32 v[28:29], v[28:29], v[30:31]
    s_not_b32 s48, s48
    v_add_f32 v28, v28, v29
    v_cvt_pk_bf16_f32 v28, v28, v28
    s_not_b32 s63, s48
    v_bfi_b32 v28, v19, s63, v28
    buffer_store_short v28, v3, s[16:19], 0 offen sc1
    s_waitcnt vmcnt(0)
    v_bfi_b32 v28, v19, s48, v28
    buffer_store_short v28, v3, s[16:19], 0 offen sc1
    v_mov_b64 v[40:41], v[32:33]
    v_mov_b64 v[42:43], v[34:35]
    v_mov_b64 v[44:45], v[36:37]
    v_mov_b64 v[46:47], v[38:39]
    s_branch ch_loop_1_0
ch_ent_1_0:
    ds_read_b128 v[112:115], v17 offset:16384
    ds_read_b128 v[116:119], v17 offset:17408
    ds_read_b128 v[120:123], v17 offset:18432
    ds_read_b128 v[124:127], v17 offset:19456
    ds_read_b128 v[128:131], v17 offset:32768
    ds_read_b128 v[132:135], v17 offset:33792
    ds_read_b128 v[136:139], v17 offset:34816
    ds_read_b128 v[140:143], v17 offset:35840
    s_branch ch_loop_1_0
ch10_KVW:
    s_cmp_ge_u32 s56, 64
    s_cbranch_scc1 ch10_KVOK
    s_mov_b32 s59, 0x40000
ch10_kp:
    v_lshrrev_b32 v20, 2, v1
    v_and_b32 v20, 63, v20
    buffer_load_dword v21, v20, s[96:99], s58 offen sc1
    s_waitcnt vmcnt(0)
    v_subrev_u32 v21, s101, v21
    v_cmp_lt_u32 vcc, 16, v21
    s_nop 1
    v_cndmask_b32 v21, v21, 0, vcc
    s_nop 1
    v_min_u32_dpp v21, v21, v21 quad_perm:[1,0,3,2] row_mask:0xf bank_mask:0xf
    s_nop 1
    v_min_u32_dpp v21, v21, v21 quad_perm:[2,3,0,1] row_mask:0xf bank_mask:0xf
    s_nop 1
    v_min_u32_dpp v21, v21, v21 row_half_mirror row_mask:0xf bank_mask:0xf
    s_nop 1
    v_min_u32_dpp v21, v21, v21 row_mirror row_mask:0xf bank_mask:0xf
    s_nop 0
    v_readfirstlane_b32 s57, v21
    s_lshl_b32 s57, s57, 2
    s_sub_u32 s59, s59, 1
    s_cbranch_scc1 ch10_kd
    s_cmp_ge_u32 s56, s57
    s_cbranch_scc1 ch10_kp
ch10_kd:
    s_branch ch10_KVOK
    .p2align 6
ch_loop_1_1:
    v_lshrrev_b32 v30, 1, v1
    v_mov_b64 v[32:33], v[68:69]
    v_mov_b64 v[34:35], v[70:71]
    v_mov_b64 v[36:37], v[64:65]
    v_mov_b64 v[64:65], 0
    v_mov_b64 v[66:67], 0
    v_mov_b64 v[68:69], 0
    v_mov_b64 v[70:71], 0
    v_mov_b64 v[56:57], 0
    v_mov_b64 v[58:59], 0
    v_mov_b64 v[60:61], 0
    v_mov_b64 v[62:63], 0
    v_mov_b64 v[72:73], 0
    v_mov_b64 v[74:75], 0
    v_mov_b64 v[76:77], 0
    v_mov_b64 v[78:79], 0
    s_nop 13
    buffer_load_dwordx4 v[88:91], v1, s[16:19], 0 offen offset:2048 sc1
    buffer_load_dwordx4 v[92:95], v1, s[16:19], 0 offen offset:3072 sc1
    s_nop 15
    s_nop 8
    buffer_load_dwordx4 v[20:23], v1, s[16:19], 0 offen offset:2048 sc1
    buffer_load_dwordx4 v[24:27], v1, s[16:19], 0 offen offset:3072 sc1
    s_waitcnt lgkmcnt(0)
ch11_POLL:
    s_waitcnt vmcnt(2)
    v_bitop3_b32 v31, v88, v92, s48 bitop3:0x7e
    v_and_b32 v31, 1, v31
    v_cmp_ne_u32 vcc, 0, v31
    ds_write_b128 v16, v[88:91] offset:22528
    ds_write_b128 v16, v[92:95] offset:23552
    s_cbranch_vccz ch11_H0
    buffer_load_dwordx4 v[88:91], v1, s[16:19], 0 offen offset:2048 sc1
    buffer_load_dwordx4 v[92:95], v1, s[16:19], 0 offen offset:3072 sc1
    s_waitcnt vmcnt(2)
    v_bitop3_b32 v31, v20, v24, s48 bitop3:0x7e
    v_and_b32 v31, 1, v31
    v_cmp_ne_u32 vcc, 0, v31
    ds_write_b128 v16, v[20:23] offset:22528
    ds_write_b128 v16, v[24:27] offset:23552
    s_cbranch_vccz ch11_HB
    buffer_load_dwordx4 v[20:23], v1, s[16:19], 0 offen offset:2048 sc1
    buffer_load_dwordx4 v[24:27], v1, s[16:19], 0 offen offset:3072 sc1
    s_sub_u32 s51, s51, 1
    s_cbranch_scc0 ch11_POLL
    s_mov_b32 s51, 0
ch11_HB:
    v_mov_b64 v[88:89], v[20:21]
    v_mov_b64 v[90:91], v[22:23]
    v_mov_b64 v[92:93], v[24:25]
    v_mov_b64 v[94:95], v[26:27]
    s_nop 0
ch11_H0:
    v_smfmac_f32_16x16x64_bf16 v[56:59], v[88:91], a[32:39], v0
    v_smfmac_f32_16x16x64_bf16 v[60:63], v[88:91], a[40:47], v0
    v_smfmac_f32_16x16x64_bf16 v[56:59], v[92:95], v[112:119], v0
    ds_read_b128 v[112:115], v17 offset:36864
    v_smfmac_f32_16x16x64_bf16 v[60:63], v[92:95], v[120:127], v0
    ds_read_b128 v[116:119], v17 offset:37888
    s_waitcnt lgkmcnt(2)
    s_barrier
    ds_read_b128 v[80:83], v16 offset:20480
    ds_read_b128 v[84:87], v16 offset:21504
    ds_read_b128 v[96:99], v16 offset:24576
    ds_read_b128 v[100:103], v16 offset:25600
    ds_read_b128 v[104:107], v16 offset:26624
    ds_read_b128 v[108:111], v16 offset:27648
    s_cmp_lt_u32 s56, s57
    s_cbranch_scc0 ch11_KVW
ch11_KVOK:
    s_add_u32 s56, s56, 1
    v_smfmac_f32_16x16x64_bf16 v[64:67], v[88:91], a[48:55], v0
    ds_read_b128 v[120:123], v17 offset:38912
    v_smfmac_f32_16x16x64_bf16 v[68:71], v[88:91], a[56:63], v0
    ds_read_b128 v[124:127], v17 offset:39936
    v_smfmac_f32_16x16x64_bf16 v[64:67], v[92:95], a[64:71], v0
    v_smfmac_f32_16x16x64_bf16 v[68:71], v[92:95], a[72:79], v0
    s_waitcnt lgkmcnt(7)
    v_smfmac_f32_16x16x64_bf16 v[56:59], v[80:83], v[128:135], v0
    ds_read_b128 v[128:131], v16 offset:4096
    v_smfmac_f32_16x16x64_bf16 v[60:63], v[80:83], v[136:143], v0
    ds_read_b128 v[132:135], v16 offset:5120
    s_waitcnt lgkmcnt(8)
    v_smfmac_f32_16x16x64_bf16 v[56:59], v[84:87], a[16:23], v0
    ds_read_b128 v[136:139], v16 offset:6144
    v_smfmac_f32_16x16x64_bf16 v[60:63], v[84:87], a[24:31], v0
    ds_read_b128 v[140:143], v16 offset:7168
    v_smfmac_f32_16x16x64_bf16 v[64:67], v[80:83], a[0:7], v0
    v_smfmac_f32_16x16x64_bf16 v[68:71], v[80:83], a[8:15], v0
    buffer_store_dwordx4 v[32:35], v1, s[28:31], s42 offen sc1
    s_waitcnt lgkmcnt(9)
    v_smfmac_f32_16x16x64_bf16 v[56:59], v[96:99], a[80:87], v0
    v_smfmac_f32_16x16x64_bf16 v[60:63], v[96:99], a[88:95], v0
    buffer_store_dwordx2 v[36:37], v30, s[32:35], s43 offen sc1
    s_add_u32 s42, s42, 0x20000
    s_add_u32 s43, s43, 0x10000
    s_waitcnt lgkmcnt(4)
    v_smfmac_f32_16x16x64_bf16 v[64:67], v[84:87], v[112:119], v0
    ds_read_b128 v[112:115], v1 offset:4096
    v_smfmac_f32_16x16x64_bf16 v[68:71], v[84:87], v[120:127], v0
    ds_read_b128 v[116:119], v1 offset:5120
    v_smfmac_f32_16x16x64_bf16 v[56:59], v[100:103], a[96:103], v0
    ds_read_b128 v[120:123], v1 offset:6144
    v_smfmac_f32_16x16x64_bf16 v[60:63], v[100:103], a[104:111], v0
    ds_read_b128 v[124:127], v1 offset:7168
    s_waitcnt lgkmcnt(4)
    v_smfmac_f32_16x16x64_bf16 v[64:67], v[96:99], v[128:135], v0
    ds_read_b128 v[128:131], v1 offset:20480
    v_smfmac_f32_16x16x64_bf16 v[68:71], v[96:99], v[136:143], v0
    ds_read_b128 v[132:135], v1 offset:21504
    s_waitcnt lgkmcnt(2)
    v_smfmac_f32_16x16x64_bf16 v[56:59], v[104:107], v[112:119], v0
    ds_read_b128 v[136:139], v1 offset:22528
    v_smfmac_f32_16x16x64_bf16 v[60:63], v[104:107], v[120:127], v0
    ds_read_b128 v[140:143], v1 offset:23552
    v_smfmac_f32_16x16x64_bf16 v[64:67], v[100:103], a[112:119], v0
    ds_read_b128 v[112:115], v1 offset:36864
    v_smfmac_f32_16x16x64_bf16 v[68:71], v[100:103], a[120:127], v0
    ds_read_b128 v[116:119], v1 offset:37888
    v_smfmac_f32_16x16x64_bf16 v[56:59], v[108:111], a[144:151], v0
    ds_read_b128 v[120:123], v1 offset:38912
    v_smfmac_f32_16x16x64_bf16 v[60:63], v[108:111], a[152:159], v0
    ds_read_b128 v[124:127], v1 offset:39936
    v_smfmac_f32_16x16x64_bf16 v[64:67], v[104:107], a[128:135], v0
    v_smfmac_f32_16x16x64_bf16 v[68:71], v[104:107], a[136:143], v0
    s_waitcnt lgkmcnt(4)
    v_smfmac_f32_16x16x64_bf16 v[64:67], v[108:111], v[128:135], v0
    ds_read_b128 v[128:131], v1 offset:53248
    v_add_f32 v56, v56, v58
    v_smfmac_f32_16x16x64_bf16 v[68:71], v[108:111], v[136:143], v0
    ds_read_b128 v[132:135], v1 offset:54272
    v_add_f32 v57, v57, v59
ch11_QKOK:
    s_waitcnt vmcnt(2)
    v_add_f32 v60, v60, v62
    v_add_f32 v61, v61, v63
    v_cvt_pk_bf16_f32 v20, v56, v57
    v_cvt_pk_bf16_f32 v22, v60, v61
    v_add_f32 v64, v64, v66
    v_add_f32 v65, v65, v67
    v_cvt_pk_bf16_f32 v21, v64, v65
    v_add_f32 v68, v68, v70
    v_add_f32 v69, v69, v71
    v_mfma_f32_16x16x16_bf16 v[64:67], v[20:21], v[4:5], 0
    v_cvt_pk_bf16_f32 v23, v68, v69
    buffer_load_dwordx4 v[32:35], v1, s[24:27], s41 offen offset:0 sc1
    buffer_load_dwordx4 v[36:39], v1, s[24:27], s41 offen offset:1024 sc1
    v_mfma_f32_16x16x16_bf16 v[68:71], v[22:23], v[4:5], 0
    v_smfmac_f32_16x16x64_bf16 v[72:75], v[80:83], a[160:167], v0
    ds_read_b128 v[136:139], v1 offset:55296
    s_nop 0
    v_cvt_pk_bf16_f32 v56, v64, v65
    v_cvt_pk_bf16_f32 v57, v66, v67
    s_nop 0
    v_cvt_pk_bf16_f32 v58, v68, v69
    v_cvt_pk_bf16_f32 v59, v70, v71
    s_nop 1
    v_mfma_f32_16x16x32_bf16 v[68:71], v[56:59], v[56:59], 0
    v_mfma_f32_16x16x32_bf16 v[64:67], v[52:55], v[56:59], 0
    v_mfma_f32_16x16x32_bf16 v[60:63], v[48:51], v[56:59], 0
    buffer_load_dwordx4 v[48:51], v1, s[20:23], s41 offen offset:0 sc1
    buffer_load_dwordx4 v[52:55], v1, s[20:23], s41 offen offset:1024 sc1
    ds_write_b64 v13, v[70:71]
    v_smfmac_f32_16x16x64_bf16 v[76:79], v[80:83], a[168:175], v0
    ds_read_b128 v[140:143], v1 offset:56320
    s_mov_b32 vcc_lo, 0x33333333
    s_mov_b32 vcc_hi, 0x33333333
    s_nop 1
    v_cndmask_b32_dpp v60, v64, v60, vcc quad_perm:[0,1,0,1] row_mask:0xf bank_mask:0xf
    v_cndmask_b32_dpp v61, v65, v61, vcc quad_perm:[0,1,0,1] row_mask:0xf bank_mask:0xf
    v_cndmask_b32_dpp v62, v66, v62, vcc quad_perm:[0,1,0,1] row_mask:0xf bank_mask:0xf
    v_cndmask_b32_dpp v63, v67, v63, vcc quad_perm:[0,1,0,1] row_mask:0xf bank_mask:0xf
    ds_write_b128 v16, v[60:63] offset:17408
    s_waitcnt lgkmcnt(6)
    v_smfmac_f32_16x16x64_bf16 v[72:75], v[84:87], v[112:119], v0
    ds_read_b128 v[112:115], v17 offset:4096
    v_smfmac_f32_16x16x64_bf16 v[76:79], v[84:87], v[120:127], v0
    ds_read_b128 v[116:119], v17 offset:5120
    v_smfmac_f32_16x16x64_bf16 v[72:75], v[88:91], a[176:183], v0
    ds_read_b128 v[120:123], v17 offset:6144
    v_smfmac_f32_16x16x64_bf16 v[76:79], v[88:91], a[184:191], v0
    ds_read_b128 v[124:127], v17 offset:7168
    v_smfmac_f32_16x16x64_bf16 v[72:75], v[92:95], a[192:199], v0
    v_smfmac_f32_16x16x64_bf16 v[76:79], v[92:95], a[200:207], v0
    s_waitcnt lgkmcnt(0)
    s_barrier
    ds_read_b128 v[20:23], v16 offset:16384
    ds_read_b128 v[24:27], v16 offset:18432
    ds_read_b128 v[64:67], v16 offset:19456
    ds_read2st64_b32 v[68:69], v14 offset0:0 offset1:1
    ds_read2st64_b32 v[70:71], v14 offset0:2 offset1:3
    v_smfmac_f32_16x16x64_bf16 v[72:75], v[96:99], v[128:135], v0
    v_smfmac_f32_16x16x64_bf16 v[76:79], v[96:99], v[136:143], v0
    v_smfmac_f32_16x16x64_bf16 v[72:75], v[100:103], a[208:215], v0
    v_smfmac_f32_16x16x64_bf16 v[76:79], v[100:103], a[216:223], v0
    s_waitcnt lgkmcnt(3)
    v_add_f32 v60, v60, v20
    v_add_f32 v61, v61, v21
    v_add_f32 v62, v62, v22
    v_add_f32 v63, v63, v23
    s_waitcnt lgkmcnt(2)
    v_pk_add_f32 v[24:25], v[24:25], v[64:65]
    v_pk_add_f32 v[26:27], v[26:27], v[66:67]
    s_waitcnt lgkmcnt(0)
    v_pk_add_f32 v[68:69], v[68:69], v[70:71]
    v_pk_add_f32 v[60:61], v[60:61], v[24:25]
    v_pk_add_f32 v[62:63], v[62:63], v[26:27]
    v_add_f32 v68, v68, v69
    v_max3_f32 v20, v60, v61, v62
    v_max3_f32 v20, v20, v63, v68
    v_smfmac_f32_16x16x64_bf16 v[72:75], v[104:107], a[224:231], v0
    s_nop 0
    v_max_f32_dpp v22, v20, v20 quad_perm:[2,3,0,1] row_mask:0xf bank_mask:0xf
    v_max_f32_dpp v23, v20, v20 quad_perm:[2,3,0,1] row_mask:0xf bank_mask:0xf
    v_smfmac_f32_16x16x64_bf16 v[76:79], v[104:107], a[232:239], v0
    s_nop 0
    v_permlane16_swap_b32 v22, v23
    v_max_f32 v20, v22, v23
    v_max_f32 v21, v22, v23
    v_smfmac_f32_16x16x64_bf16 v[72:75], v[108:111], v[112:119], v0
    s_nop 0
    v_permlane32_swap_b32 v20, v21
    v_max_f32 v20, v20, v21
    v_smfmac_f32_16x16x64_bf16 v[76:79], v[108:111], v[120:127], v0
    v_mul_f32 v20, s60, v20
    v_fma_f32 v60, v60, s60, -v20
    v_fma_f32 v61, v61, s60, -v20
    v_fma_f32 v62, v62, s60, -v20
    v_fma_f32 v63, v63, s60, -v20
    v_fma_f32 v68, v68, s60, -v20
    v_exp_f32 v60, v60
    v_exp_f32 v61, v61
    v_exp_f32 v62, v62
    v_exp_f32 v63, v63
    v_exp_f32 v68, v68
    v_cvt_pk_bf16_f32 v20, v60, v61
    v_cvt_pk_bf16_f32 v21, v62, v63
    v_pk_add_f32 v[28:29], v[60:61], v[62:63]
    v_mov_b32_dpp v24, v20 quad_perm:[0,1,0,1] row_mask:0xf bank_mask:0xf
    v_mov_b32_dpp v25, v21 quad_perm:[0,1,0,1] row_mask:0xf bank_mask:0xf
    v_mov_b32_dpp v26, v20 quad_perm:[2,3,2,3] row_mask:0xf bank_mask:0xf
    v_mov_b32_dpp v27, v21 quad_perm:[2,3,2,3] row_mask:0xf bank_mask:0xf
    v_pk_add_f32 v[72:73], v[72:73], v[74:75]
    v_pk_add_f32 v[76:77], v[76:77], v[78:79]
    v_mfma_f32_16x16x32_bf16 v[60:63], v[40:43], v[24:27], 0
    v_mov_b32_dpp v30, v68 quad_perm:[0,1,0,1] row_mask:0xf bank_mask:0xf
    v_mov_b32_dpp v31, v68 quad_perm:[2,3,2,3] row_mask:0xf bank_mask:0xf
    v_mfma_f32_16x16x32_bf16 v[20:23], v[44:47], v[24:27], 0
    v_add_f32 v28, v28, v29
    v_cvt_pk_bf16_f32 v6, v30, v31
    v_add_f32 v68, v68, v28
    v_cvt_pk_bf16_f32 v64, v72, v73
    v_cvt_pk_bf16_f32 v65, v76, v77
    v_add_f32_dpp v28, v68, v68 quad_perm:[2,3,0,1] row_mask:0xf bank_mask:0xf
    v_add_f32_dpp v29, v68, v68 quad_perm:[2,3,0,1] row_mask:0xf bank_mask:0xf
    v_mfma_f32_16x16x16_bf16 v[60:63], v[64:65], v[6:7], v[60:63]
    v_cvt_pk_bf16_f32 v66, v76, v77
    v_mov_b32 v67, 0
    v_permlane16_swap_b32 v28, v29
    v_add_f32 v68, v28, v29
    v_mfma_f32_16x16x16_bf16 v[20:23], v[66:67], v[6:7], v[20:23]
    v_add_f32 v69, v28, v29
    v_mov_b64 v[80:81], 0
    v_mov_b64 v[82:83], 0
    v_permlane32_swap_b32 v68, v69
    v_add_f32 v68, v68, v69
    v_rcp_f32 v68, v68
    v_mov_b64 v[84:85], 0
    v_pk_mul_f32 v[60:61], v[60:61], v[68:69] op_sel_hi:[1,0]
    v_pk_mul_f32 v[62:63], v[62:63], v[68:69] op_sel_hi:[1,0]
    v_pk_mul_f32 v[20:21], v[20:21], v[68:69] op_sel_hi:[1,0]
    v_pk_mul_f32 v[22:23], v[22:23], v[68:69] op_sel_hi:[1,0]
    v_cvt_pk_bf16_f32 v24, v60, v61
    v_cvt_pk_bf16_f32 v25, v62, v63
    v_cvt_pk_bf16_f32 v26, v20, v21
    v_cvt_pk_bf16_f32 v27, v22, v23
    ds_write_b128 v15, v[24:27] offset:512
    v_mov_b64 v[86:87], 0
    v_smfmac_f32_16x16x64_bf16 v[80:83], v[24:27], a[248:255], v0
    v_mov_b64 v[88:89], 0
    v_mov_b64 v[90:91], 0
    v_smfmac_f32_16x16x64_bf16 v[84:87], v[24:27], v[168:175], v0
    v_mov_b64 v[92:93], 0
    v_mov_b64 v[94:95], 0
    v_mov_b64 v[68:69], v[56:57]
    v_smfmac_f32_16x16x64_bf16 v[88:91], v[24:27], v[200:207], v0
    v_mov_b64 v[70:71], v[58:59]
    s_sub_u32 s40, s40, 1
    s_cbranch_scc1 ch_fin
    s_waitcnt lgkmcnt(0)
    s_barrier
    ds_read_b128 v[72:75], v15 offset:0
    ds_read_b128 v[76:79], v15 offset:1024
    ds_read_b128 v[60:63], v15 offset:1536
    v_smfmac_f32_16x16x64_bf16 v[92:95], v[24:27], v[232:239], v0
    s_add_u32 s41, s41, 0x40000
    s_not_b32 s63, s48
    s_waitcnt lgkmcnt(2)
    v_smfmac_f32_16x16x64_bf16 v[80:83], v[72:75], a[240:247], v0
    s_waitcnt lgkmcnt(1)
    v_smfmac_f32_16x16x64_bf16 v[80:83], v[76:79], v[144:151], v0
    s_waitcnt lgkmcnt(0)
    v_smfmac_f32_16x16x64_bf16 v[80:83], v[60:63], v[152:159], v0
    v_smfmac_f32_16x16x64_bf16 v[84:87], v[72:75], v[160:167], v0
    v_smfmac_f32_16x16x64_bf16 v[84:87], v[76:79], v[176:183], v0
    v_cvt_pk_bf16_f32 v80, v80, v81
    v_bfi_b32 v80, v18, s63, v80
    buffer_store_dword v80, v2, s[12:15], s52 offen offset:0 sc1
    v_smfmac_f32_16x16x64_bf16 v[84:87], v[60:63], v[184:191], v0
    v_cvt_pk_bf16_f32 v82, v82, v83
    v_bfi_b32 v82, v18, s63, v82
    buffer_store_dword v82, v2, s[12:15], s52 offen offset:2048 sc1
    v_smfmac_f32_16x16x64_bf16 v[88:91], v[72:75], v[192:199], v0
    v_smfmac_f32_16x16x64_bf16 v[88:91], v[76:79], v[208:215], v0
    v_cvt_pk_bf16_f32 v84, v84, v85
    v_bfi_b32 v84, v18, s63, v84
    buffer_store_dword v84, v2, s[12:15], s53 offen offset:0 sc1
    v_smfmac_f32_16x16x64_bf16 v[88:91], v[60:63], v[216:223], v0
    v_cvt_pk_bf16_f32 v86, v86, v87
    v_bfi_b32 v86, v18, s63, v86
    buffer_store_dword v86, v2, s[12:15], s53 offen offset:2048 sc1
    v_smfmac_f32_16x16x64_bf16 v[92:95], v[72:75], v[224:231], v0
    v_smfmac_f32_16x16x64_bf16 v[92:95], v[76:79], v[240:247], v0
    v_cvt_pk_bf16_f32 v88, v88, v89
    v_bfi_b32 v88, v18, s63, v88
    buffer_store_dword v88, v2, s[12:15], s54 offen offset:0 sc1
    v_smfmac_f32_16x16x64_bf16 v[92:95], v[60:63], v[248:255], v0
    v_cvt_pk_bf16_f32 v90, v90, v91
    v_bfi_b32 v90, v18, s63, v90
    buffer_store_dword v90, v2, s[12:15], s54 offen offset:2048 sc1
    s_nop 3
    v_cvt_pk_bf16_f32 v92, v92, v93
    v_bfi_b32 v92, v18, s63, v92
    buffer_store_dword v92, v2, s[12:15], s55 offen offset:0 sc1
    v_cvt_pk_bf16_f32 v94, v94, v95
    v_bfi_b32 v94, v18, s63, v94
    buffer_store_dword v94, v2, s[12:15], s55 offen offset:2048 sc1
    s_waitcnt vmcnt(0)
    v_bfi_b32 v80, v18, s48, v80
    buffer_store_dword v80, v2, s[12:15], s52 offen offset:0 sc1
    v_bfi_b32 v82, v18, s48, v82
    buffer_store_dword v82, v2, s[12:15], s52 offen offset:2048 sc1
    v_bfi_b32 v84, v18, s48, v84
    buffer_store_dword v84, v2, s[12:15], s53 offen offset:0 sc1
    v_bfi_b32 v86, v18, s48, v86
    buffer_store_dword v86, v2, s[12:15], s53 offen offset:2048 sc1
    v_bfi_b32 v88, v18, s48, v88
    buffer_store_dword v88, v2, s[12:15], s54 offen offset:0 sc1
    v_bfi_b32 v90, v18, s48, v90
    buffer_store_dword v90, v2, s[12:15], s54 offen offset:2048 sc1
    v_bfi_b32 v92, v18, s48, v92
    buffer_store_dword v92, v2, s[12:15], s55 offen offset:0 sc1
    v_bfi_b32 v94, v18, s48, v94
    buffer_store_dword v94, v2, s[12:15], s55 offen offset:2048 sc1
    ds_read_b128 v[112:115], v17 offset:53248
    ds_read_b128 v[116:119], v17 offset:54272
    ds_read_b128 v[120:123], v17 offset:55296
    ds_read_b128 v[124:127], v17 offset:56320
    ds_read_b128 v[128:131], v17 offset:20480
    ds_read_b128 v[132:135], v17 offset:21504
    ds_read_b128 v[136:139], v17 offset:22528
    ds_read_b128 v[140:143], v17 offset:23552
    s_nop 15
    s_nop 15
    buffer_load_dwordx4 v[56:59], v12, s[12:15], s50 offen offset:0 sc1
    buffer_load_dwordx4 v[60:63], v12, s[12:15], s50 offen offset:1024 sc1
ch11_RC:
    s_waitcnt vmcnt(1)
    v_mfma_f32_16x16x32_bf16 v[28:31], v[56:59], v[8:11], 0
    s_waitcnt vmcnt(0)
    v_mfma_f32_16x16x32_bf16 v[28:31], v[60:63], v[8:11], v[28:31]
    v_bitop3_b32 v24, v56, v60, s48 bitop3:0x7e
    v_and_b32 v24, 1, v24
    v_cmp_ne_u32 vcc, 0, v24
    s_nop 3
    s_cbranch_vccz ch11_ROK
    buffer_load_dwordx4 v[56:59], v12, s[12:15], s50 offen offset:0 sc1
    buffer_load_dwordx4 v[60:63], v12, s[12:15], s50 offen offset:1024 sc1
    s_sub_u32 s51, s51, 1
    s_cbranch_scc0 ch11_RC
    s_mov_b32 s51, 0
    s_waitcnt vmcnt(0)
ch11_ROK:
    v_pk_add_f32 v[28:29], v[28:29], v[30:31]
    s_not_b32 s48, s48
    v_add_f32 v28, v28, v29
    v_cvt_pk_bf16_f32 v28, v28, v28
    s_not_b32 s63, s48
    v_bfi_b32 v28, v19, s63, v28
    buffer_store_short v28, v3, s[16:19], 0 offen sc1
    s_waitcnt vmcnt(0)
    v_bfi_b32 v28, v19, s48, v28
    buffer_store_short v28, v3, s[16:19], 0 offen sc1
    v_mov_b64 v[40:41], v[32:33]
    v_mov_b64 v[42:43], v[34:35]
    v_mov_b64 v[44:45], v[36:37]
    v_mov_b64 v[46:47], v[38:39]
    s_branch ch_loop_1_1
ch_ent_1_1:
    ds_read_b128 v[112:115], v17 offset:53248
    ds_read_b128 v[116:119], v17 offset:54272
    ds_read_b128 v[120:123], v17 offset:55296
    ds_read_b128 v[124:127], v17 offset:56320
    ds_read_b128 v[128:131], v17 offset:20480
    ds_read_b128 v[132:135], v17 offset:21504
    ds_read_b128 v[136:139], v17 offset:22528
    ds_read_b128 v[140:143], v17 offset:23552
    s_branch ch_loop_1_1
ch11_KVW:
    s_cmp_ge_u32 s56, 64
    s_cbranch_scc1 ch11_KVOK
    s_mov_b32 s59, 0x40000
ch11_kp:
    v_lshrrev_b32 v20, 2, v1
    v_and_b32 v20, 63, v20
    buffer_load_dword v21, v20, s[96:99], s58 offen sc1
    s_waitcnt vmcnt(0)
    v_subrev_u32 v21, s101, v21
    v_cmp_lt_u32 vcc, 16, v21
    s_nop 1
    v_cndmask_b32 v21, v21, 0, vcc
    s_nop 1
    v_min_u32_dpp v21, v21, v21 quad_perm:[1,0,3,2] row_mask:0xf bank_mask:0xf
    s_nop 1
    v_min_u32_dpp v21, v21, v21 quad_perm:[2,3,0,1] row_mask:0xf bank_mask:0xf
    s_nop 1
    v_min_u32_dpp v21, v21, v21 row_half_mirror row_mask:0xf bank_mask:0xf
    s_nop 1
    v_min_u32_dpp v21, v21, v21 row_mirror row_mask:0xf bank_mask:0xf
    s_nop 0
    v_readfirstlane_b32 s57, v21
    s_lshl_b32 s57, s57, 2
    s_sub_u32 s59, s59, 1
    s_cbranch_scc1 ch11_kd
    s_cmp_ge_u32 s56, s57
    s_cbranch_scc1 ch11_kp
ch11_kd:
    s_branch ch11_KVOK
    .p2align 6
ch_loop_1_2:
    v_lshrrev_b32 v30, 1, v1
    v_mov_b64 v[32:33], v[68:69]
    v_mov_b64 v[34:35], v[70:71]
    v_mov_b64 v[36:37], v[64:65]
    v_mov_b64 v[64:65], 0
    v_mov_b64 v[66:67], 0
    v_mov_b64 v[68:69], 0
    v_mov_b64 v[70:71], 0
    v_mov_b64 v[56:57], 0
    v_mov_b64 v[58:59], 0
    v_mov_b64 v[60:61], 0
    v_mov_b64 v[62:63], 0
    v_mov_b64 v[72:73], 0
    v_mov_b64 v[74:75], 0
    v_mov_b64 v[76:77], 0
    v_mov_b64 v[78:79], 0
    s_nop 13
    buffer_load_dwordx4 v[96:99], v1, s[16:19], s45 offen offset:0 sc1
    buffer_load_dwordx4 v[100:103], v1, s[16:19], s45 offen offset:1024 sc1
    s_nop 15
    s_nop 8
    buffer_load_dwordx4 v[20:23], v1, s[16:19], s45 offen offset:0 sc1
    buffer_load_dwordx4 v[24:27], v1, s[16:19], s45 offen offset:1024 sc1
    s_waitcnt lgkmcnt(0)
ch12_POLL:
    s_waitcnt vmcnt(2)
    v_bitop3_b32 v31, v96, v100, s48 bitop3:0x7e
    v_and_b32 v31, 1, v31
    v_cmp_ne_u32 vcc, 0, v31
    ds_write_b128 v16, v[96:99] offset:24576
    ds_write_b128 v16, v[100:103] offset:25600
    s_cbranch_vccz ch12_H0
    buffer_load_dwordx4 v[96:99], v1, s[16:19], s45 offen offset:0 sc1
    buffer_load_dwordx4 v[100:103], v1, s[16:19], s45 offen offset:1024 sc1
    s_waitcnt vmcnt(2)
    v_bitop3_b32 v31, v20, v24, s48 bitop3:0x7e
    v_and_b32 v31, 1, v31
    v_cmp_ne_u32 vcc, 0, v31
    ds_write_b128 v16, v[20:23] offset:24576
    ds_write_b128 v16, v[24:27] offset:25600
    s_cbranch_vccz ch12_HB
    buffer_load_dwordx4 v[20:23], v1, s[16:19], s45 offen offset:0 sc1
    buffer_load_dwordx4 v[24:27], v1, s[16:19], s45 offen offset:1024 sc1
    s_sub_u32 s51, s51, 1
    s_cbranch_scc0 ch12_POLL
    s_mov_b32 s51, 0
ch12_HB:
    v_mov_b64 v[96:97], v[20:21]
    v_mov_b64 v[98:99], v[22:23]
    v_mov_b64 v[100:101], v[24:25]
    v_mov_b64 v[102:103], v[26:27]
    s_nop 0
ch12_H0:
    v_smfmac_f32_16x16x64_bf16 v[56:59], v[96:99], a[80:87], v0
    v_smfmac_f32_16x16x64_bf16 v[60:63], v[96:99], a[88:95], v0
    v_smfmac_f32_16x16x64_bf16 v[56:59], v[100:103], a[96:103], v0
    v_smfmac_f32_16x16x64_bf16 v[60:63], v[100:103], a[104:111], v0
    s_waitcnt lgkmcnt(0)
    s_barrier
    ds_read_b128 v[80:83], v16 offset:20480
    ds_read_b128 v[84:87], v16 offset:21504
    ds_read_b128 v[88:91], v16 offset:22528
    ds_read_b128 v[92:95], v16 offset:23552
    ds_read_b128 v[104:107], v16 offset:26624
    ds_read_b128 v[108:111], v16 offset:27648
    s_cmp_lt_u32 s56, s57
    s_cbranch_scc0 ch12_KVW
ch12_KVOK:
    s_add_u32 s56, s56, 1
    v_smfmac_f32_16x16x64_bf16 v[64:67], v[96:99], v[112:119], v0
    ds_read_b128 v[112:115], v17 offset:40960
    v_smfmac_f32_16x16x64_bf16 v[68:71], v[96:99], v[120:127], v0
    ds_read_b128 v[116:119], v17 offset:41984
    v_smfmac_f32_16x16x64_bf16 v[64:67], v[100:103], a[112:119], v0
    ds_read_b128 v[120:123], v17 offset:43008
    v_smfmac_f32_16x16x64_bf16 v[68:71], v[100:103], a[120:127], v0
    ds_read_b128 v[124:127], v17 offset:44032
    s_waitcnt lgkmcnt(9)
    v_smfmac_f32_16x16x64_bf16 v[56:59], v[80:83], v[128:135], v0
    ds_read_b128 v[128:131], v17 offset:57344
    v_smfmac_f32_16x16x64_bf16 v[60:63], v[80:83], v[136:143], v0
    ds_read_b128 v[132:135], v17 offset:58368
    s_waitcnt lgkmcnt(10)
    v_smfmac_f32_16x16x64_bf16 v[56:59], v[84:87], a[16:23], v0
    ds_read_b128 v[136:139], v17 offset:59392
    v_smfmac_f32_16x16x64_bf16 v[60:63], v[84:87], a[24:31], v0
    ds_read_b128 v[140:143], v17 offset:60416
    v_smfmac_f32_16x16x64_bf16 v[64:67], v[80:83], a[0:7], v0
    v_smfmac_f32_16x16x64_bf16 v[68:71], v[80:83], a[8:15], v0
    s_waitcnt lgkmcnt(11)
    v_smfmac_f32_16x16x64_bf16 v[56:59], v[88:91], a[32:39], v0
    v_smfmac_f32_16x16x64_bf16 v[60:63], v[88:91], a[40:47], v0
    s_waitcnt lgkmcnt(4)
    v_smfmac_f32_16x16x64_bf16 v[64:67], v[84:87], v[112:119], v0
    ds_read_b128 v[112:115], v1 offset:8192
    v_smfmac_f32_16x16x64_bf16 v[68:71], v[84:87], v[120:127], v0
    ds_read_b128 v[116:119], v1 offset:9216
    buffer_store_dwordx4 v[32:35], v1, s[28:31], s42 offen sc1
    s_waitcnt lgkmcnt(2)
    v_smfmac_f32_16x16x64_bf16 v[56:59], v[92:95], v[128:135], v0
    ds_read_b128 v[120:123], v1 offset:10240
    v_smfmac_f32_16x16x64_bf16 v[60:63], v[92:95], v[136:143], v0
    ds_read_b128 v[124:127], v1 offset:11264
    buffer_store_dwordx2 v[36:37], v30, s[32:35], s43 offen sc1
    s_add_u32 s42, s42, 0x20000
    s_add_u32 s43, s43, 0x10000
    v_smfmac_f32_16x16x64_bf16 v[64:67], v[88:91], a[48:55], v0
    ds_read_b128 v[128:131], v1 offset:24576
    v_smfmac_f32_16x16x64_bf16 v[68:71], v[88:91], a[56:63], v0
    ds_read_b128 v[132:135], v1 offset:25600
    s_waitcnt lgkmcnt(2)
    v_smfmac_f32_16x16x64_bf16 v[56:59], v[104:107], v[112:119], v0
    ds_read_b128 v[136:139], v1 offset:26624
    v_smfmac_f32_16x16x64_bf16 v[60:63], v[104:107], v[120:127], v0
    ds_read_b128 v[140:143], v1 offset:27648
    v_smfmac_f32_16x16x64_bf16 v[64:67], v[92:95], a[64:71], v0
    ds_read_b128 v[112:115], v1 offset:40960
    v_smfmac_f32_16x16x64_bf16 v[68:71], v[92:95], a[72:79], v0
    ds_read_b128 v[116:119], v1 offset:41984
    v_smfmac_f32_16x16x64_bf16 v[56:59], v[108:111], a[144:151], v0
    ds_read_b128 v[120:123], v1 offset:43008
    v_smfmac_f32_16x16x64_bf16 v[60:63], v[108:111], a[152:159], v0
    ds_read_b128 v[124:127], v1 offset:44032
    v_smfmac_f32_16x16x64_bf16 v[64:67], v[104:107], a[128:135], v0
    v_smfmac_f32_16x16x64_bf16 v[68:71], v[104:107], a[136:143], v0
    s_waitcnt lgkmcnt(4)
    v_smfmac_f32_16x16x64_bf16 v[64:67], v[108:111], v[128:135], v0
    ds_read_b128 v[128:131], v1 offset:57344
    v_add_f32 v56, v56, v58
    v_smfmac_f32_16x16x64_bf16 v[68:71], v[108:111], v[136:143], v0
    ds_read_b128 v[132:135], v1 offset:58368
    v_add_f32 v57, v57, v59
ch12_QKOK:
    s_waitcnt vmcnt(2)
    v_add_f32 v60, v60, v62
    v_add_f32 v61, v61, v63
    v_cvt_pk_bf16_f32 v20, v56, v57
    v_cvt_pk_bf16_f32 v22, v60, v61
    v_add_f32 v64, v64, v66
    v_add_f32 v65, v65, v67
    v_cvt_pk_bf16_f32 v21, v64, v65
    v_add_f32 v68, v68, v70
    v_add_f32 v69, v69, v71
    v_mfma_f32_16x16x16_bf16 v[64:67], v[20:21], v[4:5], 0
    v_cvt_pk_bf16_f32 v23, v68, v69
    buffer_load_dwordx4 v[32:35], v1, s[24:27], s41 offen offset:0 sc1
    buffer_load_dwordx4 v[36:39], v1, s[24:27], s41 offen offset:1024 sc1
    v_mfma_f32_16x16x16_bf16 v[68:71], v[22:23], v[4:5], 0
    v_smfmac_f32_16x16x64_bf16 v[72:75], v[80:83], a[160:167], v0
    ds_read_b128 v[136:139], v1 offset:59392
    s_nop 0
    v_cvt_pk_bf16_f32 v56, v64, v65
    v_cvt_pk_bf16_f32 v57, v66, v67
    s_nop 0
    v_cvt_pk_bf16_f32 v58, v68, v69
    v_cvt_pk_bf16_f32 v59, v70, v71
    s_nop 1
    v_mfma_f32_16x16x32_bf16 v[68:71], v[56:59], v[56:59], 0
    v_mfma_f32_16x16x32_bf16 v[64:67], v[52:55], v[56:59], 0
    v_mfma_f32_16x16x32_bf16 v[60:63], v[48:51], v[56:59], 0
    buffer_load_dwordx4 v[48:51], v1, s[20:23], s41 offen offset:0 sc1
    buffer_load_dwordx4 v[52:55], v1, s[20:23], s41 offen offset:1024 sc1
    ds_write_b64 v13, v[70:71]
    v_smfmac_f32_16x16x64_bf16 v[76:79], v[80:83], a[168:175], v0
    ds_read_b128 v[140:143], v1 offset:60416
    s_mov_b32 vcc_lo, 0x33333333
    s_mov_b32 vcc_hi, 0x33333333
    s_nop 1
    v_cndmask_b32_dpp v60, v64, v60, vcc quad_perm:[0,1,0,1] row_mask:0xf bank_mask:0xf
    v_cndmask_b32_dpp v61, v65, v61, vcc quad_perm:[0,1,0,1] row_mask:0xf bank_mask:0xf
    v_cndmask_b32_dpp v62, v66, v62, vcc quad_perm:[0,1,0,1] row_mask:0xf bank_mask:0xf
    v_cndmask_b32_dpp v63, v67, v63, vcc quad_perm:[0,1,0,1] row_mask:0xf bank_mask:0xf
    ds_write_b128 v16, v[60:63] offset:18432
    s_waitcnt lgkmcnt(6)
    v_smfmac_f32_16x16x64_bf16 v[72:75], v[84:87], v[112:119], v0
    ds_read_b128 v[112:115], v17 offset:8192
    v_smfmac_f32_16x16x64_bf16 v[76:79], v[84:87], v[120:127], v0
    ds_read_b128 v[116:119], v17 offset:9216
    v_smfmac_f32_16x16x64_bf16 v[72:75], v[88:91], a[176:183], v0
    ds_read_b128 v[120:123], v17 offset:10240
    v_smfmac_f32_16x16x64_bf16 v[76:79], v[88:91], a[184:191], v0
    ds_read_b128 v[124:127], v17 offset:11264
    v_smfmac_f32_16x16x64_bf16 v[72:75], v[92:95], a[192:199], v0
    v_smfmac_f32_16x16x64_bf16 v[76:79], v[92:95], a[200:207], v0
    s_waitcnt lgkmcnt(0)
    s_barrier
    ds_read_b128 v[20:23], v16 offset:16384
    ds_read_b128 v[24:27], v16 offset:17408
    ds_read_b128 v[64:67], v16 offset:19456
    ds_read2st64_b32 v[68:69], v14 offset0:0 offset1:1
    ds_read2st64_b32 v[70:71], v14 offset0:2 offset1:3
    v_smfmac_f32_16x16x64_bf16 v[72:75], v[96:99], v[128:135], v0
    v_smfmac_f32_16x16x64_bf16 v[76:79], v[96:99], v[136:143], v0
    v_smfmac_f32_16x16x64_bf16 v[72:75], v[100:103], a[208:215], v0
    v_smfmac_f32_16x16x64_bf16 v[76:79], v[100:103], a[216:223], v0
    s_waitcnt lgkmcnt(3)
    v_add_f32 v60, v60, v20
    v_add_f32 v61, v61, v21
    v_add_f32 v62, v62, v22
    v_add_f32 v63, v63, v23
    s_waitcnt lgkmcnt(2)
    v_pk_add_f32 v[24:25], v[24:25], v[64:65]
    v_pk_add_f32 v[26:27], v[26:27], v[66:67]
    s_waitcnt lgkmcnt(0)
    v_pk_add_f32 v[68:69], v[68:69], v[70:71]
    v_pk_add_f32 v[60:61], v[60:61], v[24:25]
    v_pk_add_f32 v[62:63], v[62:63], v[26:27]
    v_add_f32 v68, v68, v69
    v_max3_f32 v20, v60, v61, v62
    v_max3_f32 v20, v20, v63, v68
    v_smfmac_f32_16x16x64_bf16 v[72:75], v[104:107], a[224:231], v0
    s_nop 0
    v_max_f32_dpp v22, v20, v20 quad_perm:[2,3,0,1] row_mask:0xf bank_mask:0xf
    v_max_f32_dpp v23, v20, v20 quad_perm:[2,3,0,1] row_mask:0xf bank_mask:0xf
    v_smfmac_f32_16x16x64_bf16 v[76:79], v[104:107], a[232:239], v0
    s_nop 0
    v_permlane16_swap_b32 v22, v23
    v_max_f32 v20, v22, v23
    v_max_f32 v21, v22, v23
    v_smfmac_f32_16x16x64_bf16 v[72:75], v[108:111], v[112:119], v0
    s_nop 0
    v_permlane32_swap_b32 v20, v21
    v_max_f32 v20, v20, v21
    v_smfmac_f32_16x16x64_bf16 v[76:79], v[108:111], v[120:127], v0
    v_mul_f32 v20, s60, v20
    v_fma_f32 v60, v60, s60, -v20
    v_fma_f32 v61, v61, s60, -v20
    v_fma_f32 v62, v62, s60, -v20
    v_fma_f32 v63, v63, s60, -v20
    v_fma_f32 v68, v68, s60, -v20
    v_exp_f32 v60, v60
    v_exp_f32 v61, v61
    v_exp_f32 v62, v62
    v_exp_f32 v63, v63
    v_exp_f32 v68, v68
    v_cvt_pk_bf16_f32 v20, v60, v61
    v_cvt_pk_bf16_f32 v21, v62, v63
    v_pk_add_f32 v[28:29], v[60:61], v[62:63]
    v_mov_b32_dpp v24, v20 quad_perm:[0,1,0,1] row_mask:0xf bank_mask:0xf
    v_mov_b32_dpp v25, v21 quad_perm:[0,1,0,1] row_mask:0xf bank_mask:0xf
    v_mov_b32_dpp v26, v20 quad_perm:[2,3,2,3] row_mask:0xf bank_mask:0xf
    v_mov_b32_dpp v27, v21 quad_perm:[2,3,2,3] row_mask:0xf bank_mask:0xf
    v_pk_add_f32 v[72:73], v[72:73], v[74:75]
    v_pk_add_f32 v[76:77], v[76:77], v[78:79]
    v_mfma_f32_16x16x32_bf16 v[60:63], v[40:43], v[24:27], 0
    v_mov_b32_dpp v30, v68 quad_perm:[0,1,0,1] row_mask:0xf bank_mask:0xf
    v_mov_b32_dpp v31, v68 quad_perm:[2,3,2,3] row_mask:0xf bank_mask:0xf
    v_mfma_f32_16x16x32_bf16 v[20:23], v[44:47], v[24:27], 0
    v_add_f32 v28, v28, v29
    v_cvt_pk_bf16_f32 v6, v30, v31
    v_add_f32 v68, v68, v28
    v_cvt_pk_bf16_f32 v64, v72, v73
    v_cvt_pk_bf16_f32 v65, v76, v77
    v_add_f32_dpp v28, v68, v68 quad_perm:[2,3,0,1] row_mask:0xf bank_mask:0xf
    v_add_f32_dpp v29, v68, v68 quad_perm:[2,3,0,1] row_mask:0xf bank_mask:0xf
    v_mfma_f32_16x16x16_bf16 v[60:63], v[64:65], v[6:7], v[60:63]
    v_cvt_pk_bf16_f32 v66, v76, v77
    v_mov_b32 v67, 0
    v_permlane16_swap_b32 v28, v29
    v_add_f32 v68, v28, v29
    v_mfma_f32_16x16x16_bf16 v[20:23], v[66:67], v[6:7], v[20:23]
    v_add_f32 v69, v28, v29
    v_mov_b64 v[80:81], 0
    v_mov_b64 v[82:83], 0
    v_permlane32_swap_b32 v68, v69
    v_add_f32 v68, v68, v69
    v_rcp_f32 v68, v68
    v_mov_b64 v[84:85], 0
    v_pk_mul_f32 v[60:61], v[60:61], v[68:69] op_sel_hi:[1,0]
    v_pk_mul_f32 v[62:63], v[62:63], v[68:69] op_sel_hi:[1,0]
    v_pk_mul_f32 v[20:21], v[20:21], v[68:69] op_sel_hi:[1,0]
    v_pk_mul_f32 v[22:23], v[22:23], v[68:69] op_sel_hi:[1,0]
    v_cvt_pk_bf16_f32 v24, v60, v61
    v_cvt_pk_bf16_f32 v25, v62, v63
    v_cvt_pk_bf16_f32 v26, v20, v21
    v_cvt_pk_bf16_f32 v27, v22, v23
    ds_write_b128 v15, v[24:27] offset:1024
    v_mov_b64 v[86:87], 0
    v_smfmac_f32_16x16x64_bf16 v[80:83], v[24:27], v[144:151], v0
    v_mov_b64 v[88:89], 0
    v_mov_b64 v[90:91], 0
    v_smfmac_f32_16x16x64_bf16 v[84:87], v[24:27], v[176:183], v0
    v_mov_b64 v[92:93], 0
    v_mov_b64 v[94:95], 0
    v_mov_b64 v[68:69], v[56:57]
    v_smfmac_f32_16x16x64_bf16 v[88:91], v[24:27], v[208:215], v0
    v_mov_b64 v[70:71], v[58:59]
    s_sub_u32 s40, s40, 1
    s_cbranch_scc1 ch_fin
    s_waitcnt lgkmcnt(0)
    s_barrier
    ds_read_b128 v[72:75], v15 offset:0
    ds_read_b128 v[76:79], v15 offset:512
    ds_read_b128 v[60:63], v15 offset:1536
    v_smfmac_f32_16x16x64_bf16 v[92:95], v[24:27], v[240:247], v0
    s_add_u32 s41, s41, 0x40000
    s_not_b32 s63, s48
    s_waitcnt lgkmcnt(2)
    v_smfmac_f32_16x16x64_bf16 v[80:83], v[72:75], a[240:247], v0
    s_waitcnt lgkmcnt(1)
    v_smfmac_f32_16x16x64_bf16 v[80:83], v[76:79], a[248:255], v0
    s_waitcnt lgkmcnt(0)
    v_smfmac_f32_16x16x64_bf16 v[80:83], v[60:63], v[152:159], v0
    v_smfmac_f32_16x16x64_bf16 v[84:87], v[72:75], v[160:167], v0
    v_smfmac_f32_16x16x64_bf16 v[84:87], v[76:79], v[168:175], v0
    v_cvt_pk_bf16_f32 v80, v80, v81
    v_bfi_b32 v80, v18, s63, v80
    buffer_store_dword v80, v2, s[12:15], s52 offen offset:0 sc1
    v_smfmac_f32_16x16x64_bf16 v[84:87], v[60:63], v[184:191], v0
    v_cvt_pk_bf16_f32 v82, v82, v83
    v_bfi_b32 v82, v18, s63, v82
    buffer_store_dword v82, v2, s[12:15], s52 offen offset:2048 sc1
    v_smfmac_f32_16x16x64_bf16 v[88:91], v[72:75], v[192:199], v0
    v_smfmac_f32_16x16x64_bf16 v[88:91], v[76:79], v[200:207], v0
    v_cvt_pk_bf16_f32 v84, v84, v85
    v_bfi_b32 v84, v18, s63, v84
    buffer_store_dword v84, v2, s[12:15], s53 offen offset:0 sc1
    v_smfmac_f32_16x16x64_bf16 v[88:91], v[60:63], v[216:223], v0
    v_cvt_pk_bf16_f32 v86, v86, v87
    v_bfi_b32 v86, v18, s63, v86
    buffer_store_dword v86, v2, s[12:15], s53 offen offset:2048 sc1
    v_smfmac_f32_16x16x64_bf16 v[92:95], v[72:75], v[224:231], v0
    v_smfmac_f32_16x16x64_bf16 v[92:95], v[76:79], v[232:239], v0
    v_cvt_pk_bf16_f32 v88, v88, v89
    v_bfi_b32 v88, v18, s63, v88
    buffer_store_dword v88, v2, s[12:15], s54 offen offset:0 sc1
    v_smfmac_f32_16x16x64_bf16 v[92:95], v[60:63], v[248:255], v0
    v_cvt_pk_bf16_f32 v90, v90, v91
    v_bfi_b32 v90, v18, s63, v90
    buffer_store_dword v90, v2, s[12:15], s54 offen offset:2048 sc1
    s_nop 3
    v_cvt_pk_bf16_f32 v92, v92, v93
    v_bfi_b32 v92, v18, s63, v92
    buffer_store_dword v92, v2, s[12:15], s55 offen offset:0 sc1
    v_cvt_pk_bf16_f32 v94, v94, v95
    v_bfi_b32 v94, v18, s63, v94
    buffer_store_dword v94, v2, s[12:15], s55 offen offset:2048 sc1
    s_waitcnt vmcnt(0)
    v_bfi_b32 v80, v18, s48, v80
    buffer_store_dword v80, v2, s[12:15], s52 offen offset:0 sc1
    v_bfi_b32 v82, v18, s48, v82
    buffer_store_dword v82, v2, s[12:15], s52 offen offset:2048 sc1
    v_bfi_b32 v84, v18, s48, v84
    buffer_store_dword v84, v2, s[12:15], s53 offen offset:0 sc1
    v_bfi_b32 v86, v18, s48, v86
    buffer_store_dword v86, v2, s[12:15], s53 offen offset:2048 sc1
    v_bfi_b32 v88, v18, s48, v88
    buffer_store_dword v88, v2, s[12:15], s54 offen offset:0 sc1
    v_bfi_b32 v90, v18, s48, v90
    buffer_store_dword v90, v2, s[12:15], s54 offen offset:2048 sc1
    v_bfi_b32 v92, v18, s48, v92
    buffer_store_dword v92, v2, s[12:15], s55 offen offset:0 sc1
    v_bfi_b32 v94, v18, s48, v94
    buffer_store_dword v94, v2, s[12:15], s55 offen offset:2048 sc1
    ds_read_b128 v[112:115], v16 offset:8192
    ds_read_b128 v[116:119], v16 offset:9216
    ds_read_b128 v[120:123], v16 offset:10240
    ds_read_b128 v[124:127], v16 offset:11264
    ds_read_b128 v[128:131], v17 offset:24576
    ds_read_b128 v[132:135], v17 offset:25600
    ds_read_b128 v[136:139], v17 offset:26624
    ds_read_b128 v[140:143], v17 offset:27648
    s_nop 15
    s_nop 15
    s_nop 14
    buffer_load_dwordx4 v[56:59], v12, s[12:15], s50 offen offset:0 sc1
    buffer_load_dwordx4 v[60:63], v12, s[12:15], s50 offen offset:1024 sc1
ch12_RC:
    s_waitcnt vmcnt(1)
    v_mfma_f32_16x16x32_bf16 v[28:31], v[56:59], v[8:11], 0
    s_waitcnt vmcnt(0)
    v_mfma_f32_16x16x32_bf16 v[28:31], v[60:63], v[8:11], v[28:31]
    v_bitop3_b32 v24, v56, v60, s48 bitop3:0x7e
    v_and_b32 v24, 1, v24
    v_cmp_ne_u32 vcc, 0, v24
    s_nop 3
    s_cbranch_vccz ch12_ROK
    buffer_load_dwordx4 v[56:59], v12, s[12:15], s50 offen offset:0 sc1
    buffer_load_dwordx4 v[60:63], v12, s[12:15], s50 offen offset:1024 sc1
    s_sub_u32 s51, s51, 1
    s_cbranch_scc0 ch12_RC
    s_mov_b32 s51, 0
    s_waitcnt vmcnt(0)
ch12_ROK:
    v_pk_add_f32 v[28:29], v[28:29], v[30:31]
    s_not_b32 s48, s48
    v_add_f32 v28, v28, v29
    v_cvt_pk_bf16_f32 v28, v28, v28
    s_not_b32 s63, s48
    v_bfi_b32 v28, v19, s63, v28
    buffer_store_short v28, v3, s[16:19], 0 offen sc1
    s_waitcnt vmcnt(0)
    v_bfi_b32 v28, v19, s48, v28
    buffer_store_short v28, v3, s[16:19], 0 offen sc1
    v_mov_b64 v[40:41], v[32:33]
    v_mov_b64 v[42:43], v[34:35]
    v_mov_b64 v[44:45], v[36:37]
    v_mov_b64 v[46:47], v[38:39]
    s_branch ch_loop_1_2
ch_ent_1_2:
    ds_read_b128 v[112:115], v16 offset:8192
    ds_read_b128 v[116:119], v16 offset:9216
    ds_read_b128 v[120:123], v16 offset:10240
    ds_read_b128 v[124:127], v16 offset:11264
    ds_read_b128 v[128:131], v17 offset:24576
    ds_read_b128 v[132:135], v17 offset:25600
    ds_read_b128 v[136:139], v17 offset:26624
    ds_read_b128 v[140:143], v17 offset:27648
    s_branch ch_loop_1_2
ch12_KVW:
    s_cmp_ge_u32 s56, 64
    s_cbranch_scc1 ch12_KVOK
    s_mov_b32 s59, 0x40000
ch12_kp:
    v_lshrrev_b32 v20, 2, v1
    v_and_b32 v20, 63, v20
    buffer_load_dword v21, v20, s[96:99], s58 offen sc1
    s_waitcnt vmcnt(0)
    v_subrev_u32 v21, s101, v21
    v_cmp_lt_u32 vcc, 16, v21
    s_nop 1
    v_cndmask_b32 v21, v21, 0, vcc
    s_nop 1
    v_min_u32_dpp v21, v21, v21 quad_perm:[1,0,3,2] row_mask:0xf bank_mask:0xf
    s_nop 1
    v_min_u32_dpp v21, v21, v21 quad_perm:[2,3,0,1] row_mask:0xf bank_mask:0xf
    s_nop 1
    v_min_u32_dpp v21, v21, v21 row_half_mirror row_mask:0xf bank_mask:0xf
    s_nop 1
    v_min_u32_dpp v21, v21, v21 row_mirror row_mask:0xf bank_mask:0xf
    s_nop 0
    v_readfirstlane_b32 s57, v21
    s_lshl_b32 s57, s57, 2
    s_sub_u32 s59, s59, 1
    s_cbranch_scc1 ch12_kd
    s_cmp_ge_u32 s56, s57
    s_cbranch_scc1 ch12_kp
ch12_kd:
    s_branch ch12_KVOK
    .p2align 6
ch_loop_1_3:
    v_lshrrev_b32 v30, 1, v1
    v_mov_b64 v[32:33], v[68:69]
    v_mov_b64 v[34:35], v[70:71]
    v_mov_b64 v[36:37], v[64:65]
    v_mov_b64 v[64:65], 0
    v_mov_b64 v[66:67], 0
    v_mov_b64 v[68:69], 0
    v_mov_b64 v[70:71], 0
    v_mov_b64 v[56:57], 0
    v_mov_b64 v[58:59], 0
    v_mov_b64 v[60:61], 0
    v_mov_b64 v[62:63], 0
    v_mov_b64 v[72:73], 0
    v_mov_b64 v[74:75], 0
    v_mov_b64 v[76:77], 0
    v_mov_b64 v[78:79], 0
    s_nop 13
    buffer_load_dwordx4 v[104:107], v1, s[16:19], s45 offen offset:2048 sc1
    buffer_load_dwordx4 v[108:111], v1, s[16:19], s45 offen offset:3072 sc1
    s_nop 15
    s_nop 8
    buffer_load_dwordx4 v[20:23], v1, s[16:19], s45 offen offset:2048 sc1
    buffer_load_dwordx4 v[24:27], v1, s[16:19], s45 offen offset:3072 sc1
    s_waitcnt lgkmcnt(0)
ch13_POLL:
    s_waitcnt vmcnt(2)
    v_bitop3_b32 v31, v104, v108, s48 bitop3:0x7e
    v_and_b32 v31, 1, v31
    v_cmp_ne_u32 vcc, 0, v31
    ds_write_b128 v16, v[104:107] offset:26624
    ds_write_b128 v16, v[108:111] offset:27648
    s_cbranch_vccz ch13_H0
    buffer_load_dwordx4 v[104:107], v1, s[16:19], s45 offen offset:2048 sc1
    buffer_load_dwordx4 v[108:111], v1, s[16:19], s45 offen offset:3072 sc1
    s_waitcnt vmcnt(2)
    v_bitop3_b32 v31, v20, v24, s48 bitop3:0x7e
    v_and_b32 v31, 1, v31
    v_cmp_ne_u32 vcc, 0, v31
    ds_write_b128 v16, v[20:23] offset:26624
    ds_write_b128 v16, v[24:27] offset:27648
    s_cbranch_vccz ch13_HB
    buffer_load_dwordx4 v[20:23], v1, s[16:19], s45 offen offset:2048 sc1
    buffer_load_dwordx4 v[24:27], v1, s[16:19], s45 offen offset:3072 sc1
    s_sub_u32 s51, s51, 1
    s_cbranch_scc0 ch13_POLL
    s_mov_b32 s51, 0
ch13_HB:
    v_mov_b64 v[104:105], v[20:21]
    v_mov_b64 v[106:107], v[22:23]
    v_mov_b64 v[108:109], v[24:25]
    v_mov_b64 v[110:111], v[26:27]
    s_nop 0
ch13_H0:
    v_smfmac_f32_16x16x64_bf16 v[56:59], v[104:107], v[112:119], v0
    ds_read_b128 v[112:115], v17 offset:28672
    v_smfmac_f32_16x16x64_bf16 v[60:63], v[104:107], v[120:127], v0
    ds_read_b128 v[116:119], v17 offset:29696
    v_smfmac_f32_16x16x64_bf16 v[56:59], v[108:111], a[144:151], v0
    ds_read_b128 v[120:123], v17 offset:30720
    v_smfmac_f32_16x16x64_bf16 v[60:63], v[108:111], a[152:159], v0
    ds_read_b128 v[124:127], v17 offset:31744
    s_waitcnt lgkmcnt(4)
    s_barrier
    ds_read_b128 v[80:83], v16 offset:20480
    ds_read_b128 v[84:87], v16 offset:21504
    ds_read_b128 v[88:91], v16 offset:22528
    ds_read_b128 v[92:95], v16 offset:23552
    ds_read_b128 v[96:99], v16 offset:24576
    ds_read_b128 v[100:103], v16 offset:25600
    s_cmp_lt_u32 s56, s57
    s_cbranch_scc0 ch13_KVW
ch13_KVOK:
    s_add_u32 s56, s56, 1
    v_smfmac_f32_16x16x64_bf16 v[64:67], v[104:107], a[128:135], v0
    v_smfmac_f32_16x16x64_bf16 v[68:71], v[104:107], a[136:143], v0
    v_smfmac_f32_16x16x64_bf16 v[64:67], v[108:111], v[128:135], v0
    ds_read_b128 v[128:131], v17 offset:45056
    v_smfmac_f32_16x16x64_bf16 v[68:71], v[108:111], v[136:143], v0
    ds_read_b128 v[132:135], v17 offset:46080
    s_waitcnt lgkmcnt(7)
    v_smfmac_f32_16x16x64_bf16 v[56:59], v[80:83], v[112:119], v0
    ds_read_b128 v[136:139], v17 offset:47104
    v_smfmac_f32_16x16x64_bf16 v[60:63], v[80:83], v[120:127], v0
    ds_read_b128 v[140:143], v17 offset:48128
    s_waitcnt lgkmcnt(8)
    v_smfmac_f32_16x16x64_bf16 v[56:59], v[84:87], a[16:23], v0
    ds_read_b128 v[112:115], v17 offset:61440
    v_smfmac_f32_16x16x64_bf16 v[60:63], v[84:87], a[24:31], v0
    ds_read_b128 v[116:119], v17 offset:62464
    v_smfmac_f32_16x16x64_bf16 v[64:67], v[80:83], a[0:7], v0
    ds_read_b128 v[120:123], v17 offset:63488
    v_smfmac_f32_16x16x64_bf16 v[68:71], v[80:83], a[8:15], v0
    ds_read_b128 v[124:127], v17 offset:64512
    s_waitcnt lgkmcnt(11)
    v_smfmac_f32_16x16x64_bf16 v[56:59], v[88:91], a[32:39], v0
    v_smfmac_f32_16x16x64_bf16 v[60:63], v[88:91], a[40:47], v0
    s_waitcnt lgkmcnt(4)
    v_smfmac_f32_16x16x64_bf16 v[64:67], v[84:87], v[128:135], v0
    ds_read_b128 v[128:131], v16 offset:12288
    v_smfmac_f32_16x16x64_bf16 v[68:71], v[84:87], v[136:143], v0
    ds_read_b128 v[132:135], v16 offset:13312
    s_waitcnt lgkmcnt(2)
    v_smfmac_f32_16x16x64_bf16 v[56:59], v[92:95], v[112:119], v0
    ds_read_b128 v[136:139], v16 offset:14336
    v_smfmac_f32_16x16x64_bf16 v[60:63], v[92:95], v[120:127], v0
    ds_read_b128 v[140:143], v16 offset:15360
    v_smfmac_f32_16x16x64_bf16 v[64:67], v[88:91], a[48:55], v0
    ds_read_b128 v[112:115], v1 offset:45056
    v_smfmac_f32_16x16x64_bf16 v[68:71], v[88:91], a[56:63], v0
    ds_read_b128 v[116:119], v1 offset:46080
    buffer_store_dwordx4 v[32:35], v1, s[28:31], s42 offen sc1
    v_smfmac_f32_16x16x64_bf16 v[56:59], v[96:99], a[80:87], v0
    ds_read_b128 v[120:123], v1 offset:47104
    v_smfmac_f32_16x16x64_bf16 v[60:63], v[96:99], a[88:95], v0
    ds_read_b128 v[124:127], v1 offset:48128
    buffer_store_dwordx2 v[36:37], v30, s[32:35], s43 offen sc1
    s_add_u32 s42, s42, 0x20000
    s_add_u32 s43, s43, 0x10000
    v_smfmac_f32_16x16x64_bf16 v[64:67], v[92:95], a[64:71], v0
    v_smfmac_f32_16x16x64_bf16 v[68:71], v[92:95], a[72:79], v0
    v_smfmac_f32_16x16x64_bf16 v[56:59], v[100:103], a[96:103], v0
    v_smfmac_f32_16x16x64_bf16 v[60:63], v[100:103], a[104:111], v0
    s_waitcnt lgkmcnt(4)
    v_smfmac_f32_16x16x64_bf16 v[64:67], v[96:99], v[128:135], v0
    ds_read_b128 v[128:131], v1 offset:61440
    v_smfmac_f32_16x16x64_bf16 v[68:71], v[96:99], v[136:143], v0
    ds_read_b128 v[132:135], v1 offset:62464
    v_smfmac_f32_16x16x64_bf16 v[64:67], v[100:103], a[112:119], v0
    ds_read_b128 v[136:139], v1 offset:63488
    v_add_f32 v56, v56, v58
    v_smfmac_f32_16x16x64_bf16 v[68:71], v[100:103], a[120:127], v0
    ds_read_b128 v[140:143], v1 offset:64512
    v_add_f32 v57, v57, v59
ch13_QKOK:
    s_waitcnt vmcnt(2)
    v_add_f32 v60, v60, v62
    v_add_f32 v61, v61, v63
    v_cvt_pk_bf16_f32 v20, v56, v57
    v_cvt_pk_bf16_f32 v22, v60, v61
    v_add_f32 v64, v64, v66
    v_add_f32 v65, v65, v67
    v_cvt_pk_bf16_f32 v21, v64, v65
    v_add_f32 v68, v68, v70
    v_add_f32 v69, v69, v71
    v_mfma_f32_16x16x16_bf16 v[64:67], v[20:21], v[4:5], 0
    v_cvt_pk_bf16_f32 v23, v68, v69
    buffer_load_dwordx4 v[32:35], v1, s[24:27], s41 offen offset:0 sc1
    buffer_load_dwordx4 v[36:39], v1, s[24:27], s41 offen offset:1024 sc1
    v_mfma_f32_16x16x16_bf16 v[68:71], v[22:23], v[4:5], 0
    v_smfmac_f32_16x16x64_bf16 v[72:75], v[80:83], a[160:167], v0
    s_nop 0
    v_cvt_pk_bf16_f32 v56, v64, v65
    v_cvt_pk_bf16_f32 v57, v66, v67
    s_nop 0
    v_cvt_pk_bf16_f32 v58, v68, v69
    v_cvt_pk_bf16_f32 v59, v70, v71
    s_nop 1
    v_mfma_f32_16x16x32_bf16 v[68:71], v[56:59], v[56:59], 0
    v_mfma_f32_16x16x32_bf16 v[64:67], v[52:55], v[56:59], 0
    v_mfma_f32_16x16x32_bf16 v[60:63], v[48:51], v[56:59], 0
    buffer_load_dwordx4 v[48:51], v1, s[20:23], s41 offen offset:0 sc1
    buffer_load_dwordx4 v[52:55], v1, s[20:23], s41 offen offset:1024 sc1
    ds_write_b64 v13, v[70:71]
    v_smfmac_f32_16x16x64_bf16 v[76:79], v[80:83], a[168:175], v0
    s_mov_b32 vcc_lo, 0x33333333
    s_mov_b32 vcc_hi, 0x33333333
    s_nop 1
    v_cndmask_b32_dpp v60, v64, v60, vcc quad_perm:[0,1,0,1] row_mask:0xf bank_mask:0xf
    v_cndmask_b32_dpp v61, v65, v61, vcc quad_perm:[0,1,0,1] row_mask:0xf bank_mask:0xf
    v_cndmask_b32_dpp v62, v66, v62, vcc quad_perm:[0,1,0,1] row_mask:0xf bank_mask:0xf
    v_cndmask_b32_dpp v63, v67, v63, vcc quad_perm:[0,1,0,1] row_mask:0xf bank_mask:0xf
    ds_write_b128 v16, v[60:63] offset:19456
    s_waitcnt lgkmcnt(6)
    v_smfmac_f32_16x16x64_bf16 v[72:75], v[84:87], v[112:119], v0
    ds_read_b128 v[112:115], v17 offset:12288
    v_smfmac_f32_16x16x64_bf16 v[76:79], v[84:87], v[120:127], v0
    ds_read_b128 v[116:119], v17 offset:13312
    v_smfmac_f32_16x16x64_bf16 v[72:75], v[88:91], a[176:183], v0
    ds_read_b128 v[120:123], v17 offset:14336
    v_smfmac_f32_16x16x64_bf16 v[76:79], v[88:91], a[184:191], v0
    ds_read_b128 v[124:127], v17 offset:15360
    v_smfmac_f32_16x16x64_bf16 v[72:75], v[92:95], a[192:199], v0
    v_smfmac_f32_16x16x64_bf16 v[76:79], v[92:95], a[200:207], v0
    s_waitcnt lgkmcnt(0)
    s_barrier
    ds_read_b128 v[20:23], v16 offset:16384
    ds_read_b128 v[24:27], v16 offset:17408
    ds_read_b128 v[64:67], v16 offset:18432
    ds_read2st64_b32 v[68:69], v14 offset0:0 offset1:1
    ds_read2st64_b32 v[70:71], v14 offset0:2 offset1:3
    v_smfmac_f32_16x16x64_bf16 v[72:75], v[96:99], v[128:135], v0
    v_smfmac_f32_16x16x64_bf16 v[76:79], v[96:99], v[136:143], v0
    v_smfmac_f32_16x16x64_bf16 v[72:75], v[100:103], a[208:215], v0
    v_smfmac_f32_16x16x64_bf16 v[76:79], v[100:103], a[216:223], v0
    s_waitcnt lgkmcnt(3)
    v_add_f32 v60, v60, v20
    v_add_f32 v61, v61, v21
    v_add_f32 v62, v62, v22
    v_add_f32 v63, v63, v23
    s_waitcnt lgkmcnt(2)
    v_pk_add_f32 v[24:25], v[24:25], v[64:65]
    v_pk_add_f32 v[26:27], v[26:27], v[66:67]
    s_waitcnt lgkmcnt(0)
    v_pk_add_f32 v[68:69], v[68:69], v[70:71]
    v_pk_add_f32 v[60:61], v[60:61], v[24:25]
    v_pk_add_f32 v[62:63], v[62:63], v[26:27]
    v_add_f32 v68, v68, v69
    v_max3_f32 v20, v60, v61, v62
    v_max3_f32 v20, v20, v63, v68
    v_smfmac_f32_16x16x64_bf16 v[72:75], v[104:107], a[224:231], v0
    s_nop 0
    v_max_f32_dpp v22, v20, v20 quad_perm:[2,3,0,1] row_mask:0xf bank_mask:0xf
    v_max_f32_dpp v23, v20, v20 quad_perm:[2,3,0,1] row_mask:0xf bank_mask:0xf
    v_smfmac_f32_16x16x64_bf16 v[76:79], v[104:107], a[232:239], v0
    s_nop 0
    v_permlane16_swap_b32 v22, v23
    v_max_f32 v20, v22, v23
    v_max_f32 v21, v22, v23
    v_smfmac_f32_16x16x64_bf16 v[72:75], v[108:111], v[112:119], v0
    s_nop 0
    v_permlane32_swap_b32 v20, v21
    v_max_f32 v20, v20, v21
    v_smfmac_f32_16x16x64_bf16 v[76:79], v[108:111], v[120:127], v0
    v_mul_f32 v20, s60, v20
    v_fma_f32 v60, v60, s60, -v20
    v_fma_f32 v61, v61, s60, -v20
    v_fma_f32 v62, v62, s60, -v20
    v_fma_f32 v63, v63, s60, -v20
    v_fma_f32 v68, v68, s60, -v20
    v_exp_f32 v60, v60
    v_exp_f32 v61, v61
    v_exp_f32 v62, v62
    v_exp_f32 v63, v63
    v_exp_f32 v68, v68
    v_cvt_pk_bf16_f32 v20, v60, v61
    v_cvt_pk_bf16_f32 v21, v62, v63
    v_pk_add_f32 v[28:29], v[60:61], v[62:63]
    v_mov_b32_dpp v24, v20 quad_perm:[0,1,0,1] row_mask:0xf bank_mask:0xf
    v_mov_b32_dpp v25, v21 quad_perm:[0,1,0,1] row_mask:0xf bank_mask:0xf
    v_mov_b32_dpp v26, v20 quad_perm:[2,3,2,3] row_mask:0xf bank_mask:0xf
    v_mov_b32_dpp v27, v21 quad_perm:[2,3,2,3] row_mask:0xf bank_mask:0xf
    v_pk_add_f32 v[72:73], v[72:73], v[74:75]
    v_pk_add_f32 v[76:77], v[76:77], v[78:79]
    v_mfma_f32_16x16x32_bf16 v[60:63], v[40:43], v[24:27], 0
    v_mov_b32_dpp v30, v68 quad_perm:[0,1,0,1] row_mask:0xf bank_mask:0xf
    v_mov_b32_dpp v31, v68 quad_perm:[2,3,2,3] row_mask:0xf bank_mask:0xf
    v_mfma_f32_16x16x32_bf16 v[20:23], v[44:47], v[24:27], 0
    v_add_f32 v28, v28, v29
    v_cvt_pk_bf16_f32 v6, v30, v31
    v_add_f32 v68, v68, v28
    v_cvt_pk_bf16_f32 v64, v72, v73
    v_cvt_pk_bf16_f32 v65, v76, v77
    v_add_f32_dpp v28, v68, v68 quad_perm:[2,3,0,1] row_mask:0xf bank_mask:0xf
    v_add_f32_dpp v29, v68, v68 quad_perm:[2,3,0,1] row_mask:0xf bank_mask:0xf
    v_mfma_f32_16x16x16_bf16 v[60:63], v[64:65], v[6:7], v[60:63]
    v_cvt_pk_bf16_f32 v66, v76, v77
    v_mov_b32 v67, 0
    v_permlane16_swap_b32 v28, v29
    v_add_f32 v68, v28, v29
    v_mfma_f32_16x16x16_bf16 v[20:23], v[66:67], v[6:7], v[20:23]
    v_add_f32 v69, v28, v29
    v_mov_b64 v[80:81], 0
    v_mov_b64 v[82:83], 0
    v_permlane32_swap_b32 v68, v69
    v_add_f32 v68, v68, v69
    v_rcp_f32 v68, v68
    v_mov_b64 v[84:85], 0
    v_pk_mul_f32 v[60:61], v[60:61], v[68:69] op_sel_hi:[1,0]
    v_pk_mul_f32 v[62:63], v[62:63], v[68:69] op_sel_hi:[1,0]
    v_pk_mul_f32 v[20:21], v[20:21], v[68:69] op_sel_hi:[1,0]
    v_pk_mul_f32 v[22:23], v[22:23], v[68:69] op_sel_hi:[1,0]
    v_cvt_pk_bf16_f32 v24, v60, v61
    v_cvt_pk_bf16_f32 v25, v62, v63
    v_cvt_pk_bf16_f32 v26, v20, v21
    v_cvt_pk_bf16_f32 v27, v22, v23
    ds_write_b128 v15, v[24:27] offset:1536
    v_mov_b64 v[86:87], 0
    v_smfmac_f32_16x16x64_bf16 v[80:83], v[24:27], v[152:159], v0
    v_mov_b64 v[88:89], 0
    v_mov_b64 v[90:91], 0
    v_smfmac_f32_16x16x64_bf16 v[84:87], v[24:27], v[184:191], v0
    v_mov_b64 v[92:93], 0
    v_mov_b64 v[94:95], 0
    v_mov_b64 v[68:69], v[56:57]
    v_smfmac_f32_16x16x64_bf16 v[88:91], v[24:27], v[216:223], v0
    v_mov_b64 v[70:71], v[58:59]
    s_sub_u32 s40, s40, 1
    s_cbranch_scc1 ch_fin
    s_waitcnt lgkmcnt(0)
    s_barrier
    ds_read_b128 v[72:75], v15 offset:0
    ds_read_b128 v[76:79], v15 offset:512
    ds_read_b128 v[60:63], v15 offset:1024
    v_smfmac_f32_16x16x64_bf16 v[92:95], v[24:27], v[248:255], v0
    s_add_u32 s41, s41, 0x40000
    s_not_b32 s63, s48
    s_waitcnt lgkmcnt(2)
    v_smfmac_f32_16x16x64_bf16 v[80:83], v[72:75], a[240:247], v0
    s_waitcnt lgkmcnt(1)
    v_smfmac_f32_16x16x64_bf16 v[80:83], v[76:79], a[248:255], v0
    s_waitcnt lgkmcnt(0)
    v_smfmac_f32_16x16x64_bf16 v[80:83], v[60:63], v[144:151], v0
    v_smfmac_f32_16x16x64_bf16 v[84:87], v[72:75], v[160:167], v0
    v_smfmac_f32_16x16x64_bf16 v[84:87], v[76:79], v[168:175], v0
    v_cvt_pk_bf16_f32 v80, v80, v81
    v_bfi_b32 v80, v18, s63, v80
    buffer_store_dword v80, v2, s[12:15], s52 offen offset:0 sc1
    v_smfmac_f32_16x16x64_bf16 v[84:87], v[60:63], v[176:183], v0
    v_cvt_pk_bf16_f32 v82, v82, v83
    v_bfi_b32 v82, v18, s63, v82
    buffer_store_dword v82, v2, s[12:15], s52 offen offset:2048 sc1
    v_smfmac_f32_16x16x64_bf16 v[88:91], v[72:75], v[192:199], v0
    v_smfmac_f32_16x16x64_bf16 v[88:91], v[76:79], v[200:207], v0
    v_cvt_pk_bf16_f32 v84, v84, v85
    v_bfi_b32 v84, v18, s63, v84
    buffer_store_dword v84, v2, s[12:15], s53 offen offset:0 sc1
    v_smfmac_f32_16x16x64_bf16 v[88:91], v[60:63], v[208:215], v0
    v_cvt_pk_bf16_f32 v86, v86, v87
    v_bfi_b32 v86, v18, s63, v86
    buffer_store_dword v86, v2, s[12:15], s53 offen offset:2048 sc1
    v_smfmac_f32_16x16x64_bf16 v[92:95], v[72:75], v[224:231], v0
    v_smfmac_f32_16x16x64_bf16 v[92:95], v[76:79], v[232:239], v0
    v_cvt_pk_bf16_f32 v88, v88, v89
    v_bfi_b32 v88, v18, s63, v88
    buffer_store_dword v88, v2, s[12:15], s54 offen offset:0 sc1
    v_smfmac_f32_16x16x64_bf16 v[92:95], v[60:63], v[240:247], v0
    v_cvt_pk_bf16_f32 v90, v90, v91
    v_bfi_b32 v90, v18, s63, v90
    buffer_store_dword v90, v2, s[12:15], s54 offen offset:2048 sc1
    s_nop 3
    v_cvt_pk_bf16_f32 v92, v92, v93
    v_bfi_b32 v92, v18, s63, v92
    buffer_store_dword v92, v2, s[12:15], s55 offen offset:0 sc1
    v_cvt_pk_bf16_f32 v94, v94, v95
    v_bfi_b32 v94, v18, s63, v94
    buffer_store_dword v94, v2, s[12:15], s55 offen offset:2048 sc1
    s_waitcnt vmcnt(0)
    v_bfi_b32 v80, v18, s48, v80
    buffer_store_dword v80, v2, s[12:15], s52 offen offset:0 sc1
    v_bfi_b32 v82, v18, s48, v82
    buffer_store_dword v82, v2, s[12:15], s52 offen offset:2048 sc1
    v_bfi_b32 v84, v18, s48, v84
    buffer_store_dword v84, v2, s[12:15], s53 offen offset:0 sc1
    v_bfi_b32 v86, v18, s48, v86
    buffer_store_dword v86, v2, s[12:15], s53 offen offset:2048 sc1
    v_bfi_b32 v88, v18, s48, v88
    buffer_store_dword v88, v2, s[12:15], s54 offen offset:0 sc1
    v_bfi_b32 v90, v18, s48, v90
    buffer_store_dword v90, v2, s[12:15], s54 offen offset:2048 sc1
    v_bfi_b32 v92, v18, s48, v92
    buffer_store_dword v92, v2, s[12:15], s55 offen offset:0 sc1
    v_bfi_b32 v94, v18, s48, v94
    buffer_store_dword v94, v2, s[12:15], s55 offen offset:2048 sc1
    ds_read_b128 v[112:115], v1 offset:12288
    ds_read_b128 v[116:119], v1 offset:13312
    ds_read_b128 v[120:123], v1 offset:14336
    ds_read_b128 v[124:127], v1 offset:15360
    ds_read_b128 v[128:131], v1 offset:28672
    ds_read_b128 v[132:135], v1 offset:29696
    ds_read_b128 v[136:139], v1 offset:30720
    ds_read_b128 v[140:143], v1 offset:31744
    s_nop 15
    s_nop 15
    s_nop 15
    s_nop 8
    buffer_load_dwordx4 v[56:59], v12, s[12:15], s50 offen offset:0 sc1
    buffer_load_dwordx4 v[60:63], v12, s[12:15], s50 offen offset:1024 sc1
ch13_RC:
    s_waitcnt vmcnt(1)
    v_mfma_f32_16x16x32_bf16 v[28:31], v[56:59], v[8:11], 0
    s_waitcnt vmcnt(0)
    v_mfma_f32_16x16x32_bf16 v[28:31], v[60:63], v[8:11], v[28:31]
    v_bitop3_b32 v24, v56, v60, s48 bitop3:0x7e
    v_and_b32 v24, 1, v24
    v_cmp_ne_u32 vcc, 0, v24
    s_nop 3
    s_cbranch_vccz ch13_ROK
    buffer_load_dwordx4 v[56:59], v12, s[12:15], s50 offen offset:0 sc1
    buffer_load_dwordx4 v[60:63], v12, s[12:15], s50 offen offset:1024 sc1
    s_sub_u32 s51, s51, 1
    s_cbranch_scc0 ch13_RC
    s_mov_b32 s51, 0
    s_waitcnt vmcnt(0)
ch13_ROK:
    v_pk_add_f32 v[28:29], v[28:29], v[30:31]
    s_not_b32 s48, s48
    v_add_f32 v28, v28, v29
    v_cvt_pk_bf16_f32 v28, v28, v28
    s_not_b32 s63, s48
    v_bfi_b32 v28, v19, s63, v28
    buffer_store_short v28, v3, s[16:19], 0 offen sc1
    s_waitcnt vmcnt(0)
    v_bfi_b32 v28, v19, s48, v28
    buffer_store_short v28, v3, s[16:19], 0 offen sc1
    v_mov_b64 v[40:41], v[32:33]
    v_mov_b64 v[42:43], v[34:35]
    v_mov_b64 v[44:45], v[36:37]
    v_mov_b64 v[46:47], v[38:39]
    s_branch ch_loop_1_3
ch_ent_1_3:
    ds_read_b128 v[112:115], v1 offset:12288
    ds_read_b128 v[116:119], v1 offset:13312
    ds_read_b128 v[120:123], v1 offset:14336
    ds_read_b128 v[124:127], v1 offset:15360
    ds_read_b128 v[128:131], v1 offset:28672
    ds_read_b128 v[132:135], v1 offset:29696
    ds_read_b128 v[136:139], v1 offset:30720
    ds_read_b128 v[140:143], v1 offset:31744
    s_branch ch_loop_1_3
ch13_KVW:
    s_cmp_ge_u32 s56, 64
    s_cbranch_scc1 ch13_KVOK
    s_mov_b32 s59, 0x40000
ch13_kp:
    v_lshrrev_b32 v20, 2, v1
    v_and_b32 v20, 63, v20
    buffer_load_dword v21, v20, s[96:99], s58 offen sc1
    s_waitcnt vmcnt(0)
    v_subrev_u32 v21, s101, v21
    v_cmp_lt_u32 vcc, 16, v21
    s_nop 1
    v_cndmask_b32 v21, v21, 0, vcc
    s_nop 1
    v_min_u32_dpp v21, v21, v21 quad_perm:[1,0,3,2] row_mask:0xf bank_mask:0xf
    s_nop 1
    v_min_u32_dpp v21, v21, v21 quad_perm:[2,3,0,1] row_mask:0xf bank_mask:0xf
    s_nop 1
    v_min_u32_dpp v21, v21, v21 row_half_mirror row_mask:0xf bank_mask:0xf
    s_nop 1
    v_min_u32_dpp v21, v21, v21 row_mirror row_mask:0xf bank_mask:0xf
    s_nop 0
    v_readfirstlane_b32 s57, v21
    s_lshl_b32 s57, s57, 2
    s_sub_u32 s59, s59, 1
    s_cbranch_scc1 ch13_kd
    s_cmp_ge_u32 s56, s57
    s_cbranch_scc1 ch13_kp
ch13_kd:
    s_branch ch13_KVOK
.section .rodata,"a"
.p2align 6
.amdhsa_kernel main_kernel
  .amdhsa_next_free_vgpr 512
  .amdhsa_next_free_sgpr 102
  .amdhsa_accum_offset 256
  .amdhsa_group_segment_fixed_size 0
  .amdhsa_kernarg_size 136
  .amdhsa_user_sgpr_count 2
  .amdhsa_user_sgpr_kernarg_segment_ptr 1
  .amdhsa_system_sgpr_workgroup_id_x 1
  .amdhsa_float_denorm_mode_32 3
.end_amdhsa_kernel
```
